```python
import torch

def _softmax(x, axis=-1):
    return torch.softmax(x, dim=axis)
def _gelu(x):
    return torch.nn.functional.gelu(x, approximate="tanh")
def _silu(x):
    return torch.nn.functional.silu(x)
def _sigmoid(x):
    return torch.sigmoid(x)
def _layernorm(x, axis=-1, eps=1e-5):
    m = x.mean(dim=axis, keepdim=True)
    v = x.var(dim=axis, keepdim=True, unbiased=False)
    return (x - m) / torch.sqrt(v + eps)
def _scatter_add(tgt, idx, src, axis=0):
    return tgt.clone().index_add_(axis, idx, src)
def _segment_sum(src, seg, n):
    out = torch.zeros((n,) + src.shape[1:], dtype=src.dtype)
    return out.index_add_(0, seg, src)
def _pad(x, pw):
    flat = tuple(v for pair in reversed(pw) for v in pair)
    return torch.nn.functional.pad(x, flat)

kernel_name = 'parallel_sum__compressed_kv_cla__glu_gated_geglu__prompt'

def setup_inputs():

    _w = (lambda a: (lambda t: t.to(torch.bfloat16) if t.is_floating_point() else t)(torch.as_tensor(a)))
    def _A_setup():
        B, H, Sq, Sk, D, M = 1, 32, 2048, 2048, 128, 512
        Dc = 4 * D
        return {
            "x": _w((lambda *s: torch.randn(*s, dtype=torch.bfloat16) * 0.05)(B, Sq, M)),
            "c_kv": _w((lambda *s: torch.randn(*s, dtype=torch.bfloat16) * 0.4)(B, Sk, Dc)),
            "w_q": _w((lambda *s: torch.randn(*s, dtype=torch.bfloat16) * 3.2)(M, H, D) * (M ** -0.5)),
            "w_uk": _w((lambda *s: torch.randn(*s, dtype=torch.bfloat16) * 3.2)(Dc, H, D) * (Dc ** -0.5)),
            "w_uv": _w((lambda *s: torch.randn(*s, dtype=torch.bfloat16) * 0.4)(Dc, H, D) * (Dc ** -0.5)),
            "w_o": _w((lambda *s: torch.randn(*s, dtype=torch.bfloat16) * 0.4)(H, D, M) * ((H * D) ** -0.5)),
        }
    _A_in = _A_setup()

    def _B_setup():
        B, S, Dm, Df = 1, 2048, 512, 1376
        return {
            "x": _w((lambda *s: torch.randn(*s, dtype=torch.bfloat16) * 0.05)(B, S, Dm)),
            "w_gate": _w((lambda *s: torch.randn(*s, dtype=torch.bfloat16) * 0.4)(Dm, Df) * (Dm ** -0.5)),
            "w_up": _w((lambda *s: torch.randn(*s, dtype=torch.bfloat16) * 0.4)(Dm, Df) * (Dm ** -0.5)),
            "w_down": _w((lambda *s: torch.randn(*s, dtype=torch.bfloat16) * 0.4)(Df, Dm) * (Df ** -0.5)),
        }
    _B_in = _B_setup()

    return {
        "A_x": _A_in["x"],
        "A_c_kv": _A_in["c_kv"],
        "A_w_q": _A_in["w_q"],
        "A_w_uk": _A_in["w_uk"],
        "A_w_uv": _A_in["w_uv"],
        "A_w_o": _A_in["w_o"],
        "B_x": _B_in["x"],
        "B_w_gate": _B_in["w_gate"],
        "B_w_up": _B_in["w_up"],
        "B_w_down": _B_in["w_down"],
    }

def reference(A_x, A_c_kv, A_w_q, A_w_uk, A_w_uv, A_w_o, B_x, B_w_gate, B_w_up, B_w_down):
    def _A_ref(x, c_kv, w_q, w_uk, w_uv, w_o):
        B, Sq, M = x.shape[0], x.shape[1], x.shape[2]
        Sk = c_kv.shape[1]
        H, D = w_q.shape[1], w_q.shape[2]
        q = torch.einsum("bqm,mhd->bhqd", x, w_q)
        k = torch.einsum("bkc,chd->bhkd", c_kv, w_uk)
        v = torch.einsum("bkc,chd->bhkd", c_kv, w_uv)
        scores = torch.einsum("bhqd,bhkd->bhqk", q, k) * (D ** -0.5)
        off = Sk - Sq
        qi = torch.arange(Sq)[:, None]
        kj = torch.arange(Sk)[None, :]
        cmask = kj <= (qi + off)
        scores = torch.where(cmask[None, None], scores, -1e9)
        p = _softmax(scores, axis=-1)
        ctx = torch.einsum("bhqk,bhkd->bhqd", p, v)
        return torch.einsum("bhqd,hdm->bqm", ctx, w_o)

    def _B_ref(x, w_gate, w_up, w_down):
        g = torch.einsum("bsd,df->bsf", x, w_gate)
        u = torch.einsum("bsd,df->bsf", x, w_up)
        h = _gelu(g) * u
        return torch.einsum("bsf,fd->bsd", h, w_down)

    x = A_x
    xn = _layernorm(x, axis=-1)
    return x + _A_ref(xn, A_c_kv, A_w_q, A_w_uk, A_w_uv, A_w_o) + _B_ref(xn, B_w_gate, B_w_up, B_w_down)
```

```asm
; @launch grid=(256,1,1) block=(512,1,1) lds=163840
.amdgcn_target "amdgcn-amd-amdhsa--gfx950"
.text
.globl parallel_sum__compressed_kv_cla__glu_gated_geglu__prompt_kernel
.p2align 8
.type parallel_sum__compressed_kv_cla__glu_gated_geglu__prompt_kernel,@function
parallel_sum__compressed_kv_cla__glu_gated_geglu__prompt_kernel:
  s_cmp_ge_u32 s2, 256
  s_cbranch_scc1 parallel_sum__compressed_kv_cla__glu_gated_geglu__prompt_kernel_end
  s_load_dwordx16 s[36:51], s[0:1], 0
  s_load_dwordx8 s[52:59], s[0:1], 64
  s_load_dwordx2 s[60:61], s[0:1], 96
  v_lshrrev_b32 v1, 6, v0
  v_and_b32 v240, 63, v0
  v_readfirstlane_b32 s26, v1
  s_and_b32 s33, s2, 7
  s_lshl_b32 s33, s33, 2
  s_lshr_b32 s34, s2, 3
  s_and_b32 s34, s34, 3
  s_add_u32 s24, s33, s34
  s_lshr_b32 s25, s2, 5
  s_sub_u32 s33, 15, s25
  s_cmp_ge_u32 s24, 16
  s_cselect_b32 s33, s33, s25
  s_lshl_b32 s33, s33, 4
  s_and_b32 s78, s24, 15
  s_add_u32 s78, s78, s33
  s_and_b32 s3, s24, 3
  s_mul_i32 s3, s3, 2
  s_mul_i32 s33, s25, 1
  s_add_u32 s3, s3, s33
  s_and_b32 s3, s3, 7
  s_waitcnt lgkmcnt(0)
  s_mov_b32 s20, s36
  s_mov_b32 s21, s37
  s_mov_b32 s22, 2097152
  s_mov_b32 s23, 0x20000
  s_lshl_b32 s33, s78, 3
  s_add_u32 s33, s33, s26
  s_lshl_b32 s33, s33, 10
  v_lshlrev_b32 v250, 4, v240
  buffer_load_dwordx4 v[64:67], v250, s[20:23], s33 offen
  s_mov_b32 s8, s38
  s_mov_b32 s9, s39
  s_mov_b32 s10, 2097152
  s_mov_b32 s11, 0x20000
  s_cmp_ge_u32 s26, 4
  s_cselect_b32 s12, s44, s42
  s_cselect_b32 s13, s45, s43
  s_cselect_b32 s35, 16384, 0
  s_mov_b32 s14, 4194304
  s_mov_b32 s15, 0x20000
  v_lshrrev_b32 v88, 5, v240
  v_bfe_u32 v89, v240, 2, 2
  v_lshl_add_u32 v88, v88, 2, v89
  v_lshlrev_b32 v88, 13, v88
  v_bfe_u32 v89, v240, 4, 1
  v_lshl_add_u32 v88, v89, 6, v88
  v_and_b32 v89, 3, v240
  v_lshl_add_u32 v88, v89, 4, v88
  s_and_b32 s33, s26, 3
  s_lshl_b32 s34, s33, 17
  s_lshl_b32 s29, s24, 8
  s_add_u32 s34, s34, s29
  v_add_u32 v245, s34, v88
  v_add_u32 v246, 128, v245
  v_add_u32 v247, 0x10000, v245
  v_add_u32 v248, 0x10080, v245
  s_lshl_b32 s29, s33, 12
  s_add_u32 s29, s29, s35
  s_add_u32 s30, s29, 1024
  s_add_u32 s31, s29, 2048
  s_add_u32 s32, s29, 3072
  s_mov_b32 s28, 524288
  s_mov_b32 s101, 4194304
  s_lshl_b32 s27, s3, 19
  s_lshl_b32 s74, s25, 3
  s_add_u32 s74, s74, s26
  s_lshl_b32 s48, s74, 15
  s_lshl_b32 s62, s3, 7
  s_or_b32 s62, s62, s48
  v_bfe_u32 v88, v240, 2, 3
  v_lshrrev_b32 v89, 5, v240
  v_lshlrev_b32 v88, 12, v88
  v_lshl_add_u32 v88, v89, 6, v88
  v_and_b32 v89, 3, v240
  v_lshl_add_u32 v249, v89, 4, v88
  s_add_u32 m0, s29, 0
  s_nop 0
  buffer_load_dwordx4 v245, s[12:15], s27 offen  lds
  s_add_u32 m0, s30, 0
  s_nop 0
  buffer_load_dwordx4 v246, s[12:15], s27 offen  lds
  s_add_u32 m0, s31, 0
  s_nop 0
  buffer_load_dwordx4 v247, s[12:15], s27 offen  lds
  s_add_u32 m0, s32, 0
  s_nop 0
  buffer_load_dwordx4 v248, s[12:15], s27 offen  lds
  s_add_u32 s27, s27, s28
  s_cmp_eq_u32 s27, s101
  s_cselect_b32 s27, 0, s27
  buffer_load_dwordx4 v[0:3], v249, s[8:11], s62 offen offset:0
  buffer_load_dwordx4 v[4:7], v249, s[8:11], s62 offen offset:1024
  buffer_load_dwordx4 v[8:11], v249, s[8:11], s62 offen offset:2048
  buffer_load_dwordx4 v[12:15], v249, s[8:11], s62 offen offset:3072
  s_add_u32 s62, s62, 128
  s_and_b32 s62, s62, 1023
  s_or_b32 s62, s62, s48
  s_barrier
  buffer_load_dwordx4 v[16:19], v249, s[8:11], s62 offen offset:0
  buffer_load_dwordx4 v[20:23], v249, s[8:11], s62 offen offset:1024
  buffer_load_dwordx4 v[24:27], v249, s[8:11], s62 offen offset:2048
  buffer_load_dwordx4 v[28:31], v249, s[8:11], s62 offen offset:3072
  s_add_u32 s62, s62, 128
  s_and_b32 s62, s62, 1023
  s_or_b32 s62, s62, s48
  v_lshrrev_b32 v96, 5, v240
  v_bfe_u32 v97, v240, 4, 1
  v_bfe_u32 v98, v240, 2, 2
  v_and_b32 v99, 3, v240
  v_lshlrev_b32 v100, 11, v96
  v_lshl_add_u32 v100, v98, 6, v100
  v_lshl_add_u32 v100, v97, 5, v100
  v_lshl_add_u32 v241, v99, 3, v100
  v_add_u32 v242, 0x10000, v241
  v_mul_u32_u24 v100, 6144, v96
  v_add_u32 v90, v241, v100
  v_add_u32 v91, 0x10000, v90
  v_mul_u32_u24 v100, 6272, v97
  v_mul_u32_u24 v101, 768, v96
  v_add_u32 v100, v100, v101
  v_lshl_add_u32 v100, v98, 5, v100
  v_lshl_add_u32 v243, v99, 3, v100
  v_add_u32 v244, 0x10000, v243
  s_add_u32 s16, s60, 2097152
  s_addc_u32 s17, s61, 0
  s_mov_b32 s18, 40370176
  s_mov_b32 s19, 0x20000
  s_mov_b32 s96, s58
  s_mov_b32 s97, s59
  s_mov_b32 s98, 256
  s_mov_b32 s99, 0x20000
  s_lshr_b32 s69, s24, 2
  s_lshl_b32 s69, s69, 3
  s_add_u32 s69, s69, s25
  s_lshl_b32 s69, s69, 7
  s_lshl_b32 s76, s25, 5
  s_add_u32 s76, s76, 4
  s_lshl_b32 s77, s24, 3
  s_mul_i32 s75, s24, 1261568
  s_lshl_b32 s33, s74, 14
  s_add_u32 s70, s75, s33
  s_add_u32 s71, s70, 4096
  s_add_u32 s72, s70, 40960
  s_add_u32 s73, s70, 45056
  s_lshl_b32 s33, s74, 12
  s_add_u32 s75, s75, s33
  s_add_u32 s75, s75, 1081344
  s_add_u32 s4, s60, 81657856
  s_addc_u32 s5, s61, 0
  s_mov_b32 s6, 40960
  s_mov_b32 s7, 0x20000
  s_and_b32 s33, s24, 3
  s_or_b32 s33, s33, s26
  s_cmp_lg_u32 s33, 0
  s_cbranch_scc1 ct_nozero
  v_mov_b32 v92, 0
  v_lshrrev_b32 v93, 2, v250
  s_mov_b64 exec, 15
  buffer_store_dword v92, v93, s[4:7], s69 offen sc1
  s_mov_b64 exec, -1
ct_nozero:
  s_cmp_ge_u32 s24, 4
  s_cbranch_scc1 rc_nozero
  s_lshl_b32 s33, s25, 2
  s_and_b32 s34, s24, 3
  s_add_u32 s33, s33, s34
  s_lshl_b32 s33, s33, 3
  s_add_u32 s33, s33, s26
  s_lshl_b32 s33, s33, 7
  s_add_u32 s33, s33, 8192
  v_mov_b32 v92, 0
  s_mov_b64 exec, 1
  buffer_store_dword v92, off, s[4:7], s33 sc1
  s_mov_b64 exec, -1
rc_nozero:
  s_waitcnt vmcnt(12)
  v_lshlrev_b32 v68, 16, v64
  v_and_b32 v69, 0xffff0000, v64
  v_lshlrev_b32 v70, 16, v65
  v_and_b32 v71, 0xffff0000, v65
  v_lshlrev_b32 v72, 16, v66
  v_and_b32 v73, 0xffff0000, v66
  v_lshlrev_b32 v74, 16, v67
  v_and_b32 v75, 0xffff0000, v67
  v_add_f32 v76, v68, v69
  v_add_f32 v76, v76, v70
  v_add_f32 v76, v76, v71
  v_add_f32 v76, v76, v72
  v_add_f32 v76, v76, v73
  v_add_f32 v76, v76, v74
  v_add_f32 v76, v76, v75
  s_nop 1
  v_add_f32_dpp v76, v76, v76 quad_perm:[1,0,3,2] row_mask:0xf bank_mask:0xf
  s_nop 1
  v_add_f32_dpp v76, v76, v76 quad_perm:[2,3,0,1] row_mask:0xf bank_mask:0xf
  s_nop 1
  v_add_f32_dpp v76, v76, v76 row_half_mirror row_mask:0xf bank_mask:0xf
  s_nop 1
  v_add_f32_dpp v76, v76, v76 row_mirror row_mask:0xf bank_mask:0xf
  v_mov_b32 v77, v76
  s_nop 1
  v_permlane16_swap_b32 v76, v77
  s_nop 1
  v_add_f32 v76, v76, v77
  v_mov_b32 v77, v76
  s_nop 1
  v_permlane32_swap_b32 v76, v77
  s_nop 1
  v_add_f32 v76, v76, v77
  v_mul_f32 v76, 0x3b000000, v76
  v_sub_f32 v78, v68, v76
  v_sub_f32 v79, v69, v76
  v_sub_f32 v80, v70, v76
  v_sub_f32 v81, v71, v76
  v_sub_f32 v82, v72, v76
  v_sub_f32 v83, v73, v76
  v_sub_f32 v84, v74, v76
  v_sub_f32 v85, v75, v76
  v_mul_f32 v86, v78, v78
  v_fmac_f32 v86, v79, v79
  v_fmac_f32 v86, v80, v80
  v_fmac_f32 v86, v81, v81
  v_fmac_f32 v86, v82, v82
  v_fmac_f32 v86, v83, v83
  v_fmac_f32 v86, v84, v84
  v_fmac_f32 v86, v85, v85
  s_nop 1
  v_add_f32_dpp v86, v86, v86 quad_perm:[1,0,3,2] row_mask:0xf bank_mask:0xf
  s_nop 1
  v_add_f32_dpp v86, v86, v86 quad_perm:[2,3,0,1] row_mask:0xf bank_mask:0xf
  s_nop 1
  v_add_f32_dpp v86, v86, v86 row_half_mirror row_mask:0xf bank_mask:0xf
  s_nop 1
  v_add_f32_dpp v86, v86, v86 row_mirror row_mask:0xf bank_mask:0xf
  v_mov_b32 v77, v86
  s_nop 1
  v_permlane16_swap_b32 v86, v77
  s_nop 1
  v_add_f32 v86, v86, v77
  v_mov_b32 v77, v86
  s_nop 1
  v_permlane32_swap_b32 v86, v77
  s_nop 1
  v_add_f32 v86, v86, v77
  v_mul_f32 v86, 0x3b000000, v86
  v_cvt_pk_bf16_f32 v86, v86, v86
  v_lshlrev_b32 v86, 16, v86
  v_add_f32 v86, 0x3727c5ac, v86
  v_cvt_pk_bf16_f32 v86, v86, v86
  v_lshlrev_b32 v86, 16, v86
  v_sqrt_f32 v86, v86
  s_nop 0
  v_cvt_pk_bf16_f32 v86, v86, v86
  v_lshlrev_b32 v86, 16, v86
  v_rcp_f32 v86, v86
  v_cvt_pk_bf16_f32 v76, v76, v76
  v_lshlrev_b32 v76, 16, v76
  v_sub_f32 v78, v68, v76
  v_cvt_pk_bf16_f32 v78, v78, v78
  v_lshlrev_b32 v78, 16, v78
  v_mul_f32 v78, v78, v86
  v_sub_f32 v79, v69, v76
  v_cvt_pk_bf16_f32 v79, v79, v79
  v_lshlrev_b32 v79, 16, v79
  v_mul_f32 v79, v79, v86
  v_sub_f32 v80, v70, v76
  v_cvt_pk_bf16_f32 v80, v80, v80
  v_lshlrev_b32 v80, 16, v80
  v_mul_f32 v80, v80, v86
  v_sub_f32 v81, v71, v76
  v_cvt_pk_bf16_f32 v81, v81, v81
  v_lshlrev_b32 v81, 16, v81
  v_mul_f32 v81, v81, v86
  v_sub_f32 v82, v72, v76
  v_cvt_pk_bf16_f32 v82, v82, v82
  v_lshlrev_b32 v82, 16, v82
  v_mul_f32 v82, v82, v86
  v_sub_f32 v83, v73, v76
  v_cvt_pk_bf16_f32 v83, v83, v83
  v_lshlrev_b32 v83, 16, v83
  v_mul_f32 v83, v83, v86
  v_sub_f32 v84, v74, v76
  v_cvt_pk_bf16_f32 v84, v84, v84
  v_lshlrev_b32 v84, 16, v84
  v_mul_f32 v84, v84, v86
  v_sub_f32 v85, v75, v76
  v_cvt_pk_bf16_f32 v85, v85, v85
  v_lshlrev_b32 v85, 16, v85
  v_mul_f32 v85, v85, v86
  v_cvt_pk_bf16_f32 v64, v78, v79
  v_cvt_pk_bf16_f32 v65, v80, v81
  v_cvt_pk_bf16_f32 v66, v82, v83
  v_cvt_pk_bf16_f32 v67, v84, v85
  s_lshl_b32 s33, s26, 10
  s_add_u32 s33, s33, 131072
  v_add_u32 v96, s33, v250
  ds_write_b128 v96, v[64:67]
  v_and_b32 v96, 7, v240
  v_lshrrev_b32 v97, 3, v240
  s_lshl_b32 s33, s26, 3
  v_add_u32 v97, s33, v97
  v_lshlrev_b32 v98, 10, v96
  v_lshl_add_u32 v98, v97, 4, v98
  v_add_u32 v68, 131072, v98
  v_lshrrev_b32 v98, 1, v97
  v_and_b32 v97, 1, v97
  v_lshlrev_b32 v98, 10, v98
  v_lshl_add_u32 v98, v97, 9, v98
  v_lshl_add_u32 v69, v96, 4, v98
  s_lshr_b32 s33, s78, 2
  s_lshl_b32 s33, s33, 15
  s_and_b32 s34, s78, 3
  s_lshl_b32 s34, s34, 7
  s_add_u32 s63, s33, s34
  s_mov_b32 s20, s60
  s_mov_b32 s21, s61
  s_mov_b32 s22, 2097152
  s_mov_b32 s23, 0x20000
  s_and_b32 s33, s26, 3
  s_sub_u32 s34, 15, s25
  s_cmp_ge_u32 s26, 4
  s_cselect_b32 s64, s34, s25
  s_add_u32 s65, s64, 1
  s_lshl_b32 s65, s65, 2
  s_lshl_b32 s64, s64, 2
  s_add_u32 s64, s64, s33
  s_lshl_b32 s49, s64, 15
  s_lshl_b32 s67, s25, 2
  s_sub_u32 s67, 64, s67
  s_mov_b32 s42, 4194304
  s_mov_b32 s79, 524288
  s_mov_b32 s38, 4194304
  s_lshl_b32 s39, s3, 19
  s_mov_b32 s43, s29
  v_mov_b32 v92, v245
  s_mov_b32 s44, s30
  v_mov_b32 v93, v246
  s_mov_b32 s45, s31
  v_mov_b32 v94, v247
  s_mov_b32 s78, s32
  v_mov_b32 v95, v248
  s_cmp_lt_u32 s26, 4
  s_cbranch_scc1 qf_pre_done
  s_cmp_ge_u32 s26, 6
  s_cselect_b32 s40, s52, s50
  s_cselect_b32 s41, s53, s51
  s_cselect_b32 s43, 6272, 0
  s_add_u32 s43, s43, 16384
  s_mov_b32 s42, 1409024
  s_and_b32 s33, s26, 1
  s_mul_i32 s33, s33, 3
  s_lshl_b32 s34, s33, 10
  s_add_u32 s43, s43, s34
  s_add_u32 s44, s43, 1024
  s_add_u32 s45, s43, 2048
  s_lshl_b32 s33, s33, 3
  s_mul_i32 s34, s24, 96
  s_mov_b32 s78, 28928
  s_mov_b32 s79, 176128
  s_mov_b32 s38, 1409024
  s_mul_i32 s39, s3, s79
  v_bfe_u32 v88, v240, 1, 2
  v_and_b32 v89, 1, v240
  v_lshlrev_b32 v89, 4, v89
  v_add_u32 v89, s34, v89
  v_lshrrev_b32 v101, 3, v240
  v_add_u32 v101, s33, v101
  v_add_u32 v101, 0, v101
  v_mul_u32_u24 v100, 43, v101
  v_lshrrev_b32 v100, 7, v100
  v_mul_u32_u24 v95, 3, v100
  v_sub_u32 v101, v101, v95
  v_lshl_add_u32 v100, v100, 2, v88
  v_mul_u32_u24 v100, 2752, v100
  v_lshl_add_u32 v100, v101, 5, v100
  v_add_u32 v92, v100, v89
  v_lshrrev_b32 v101, 3, v240
  v_add_u32 v101, s33, v101
  v_add_u32 v101, 8, v101
  v_mul_u32_u24 v100, 43, v101
  v_lshrrev_b32 v100, 7, v100
  v_mul_u32_u24 v95, 3, v100
  v_sub_u32 v101, v101, v95
  v_lshl_add_u32 v100, v100, 2, v88
  v_mul_u32_u24 v100, 2752, v100
  v_lshl_add_u32 v100, v101, 5, v100
  v_add_u32 v93, v100, v89
  v_lshrrev_b32 v101, 3, v240
  v_add_u32 v101, s33, v101
  v_add_u32 v101, 16, v101
  v_mul_u32_u24 v100, 43, v101
  v_lshrrev_b32 v100, 7, v100
  v_mul_u32_u24 v95, 3, v100
  v_sub_u32 v101, v101, v95
  v_lshl_add_u32 v100, v100, 2, v88
  v_mul_u32_u24 v100, 2752, v100
  v_lshl_add_u32 v100, v101, 5, v100
  v_add_u32 v94, v100, v89
  v_mov_b32 v95, 0x7f000000
qf_pre_done:
  s_sub_u32 s33, s74, 20
  s_lshr_b32 s34, s33, 3
  s_add_u32 s34, s34, s24
  s_add_u32 s34, s34, 1
  s_and_b32 s34, s34, 3
  s_and_b32 s35, s24, 28
  s_or_b32 s34, s34, s35
  s_lshl_b32 s34, s34, 3
  s_and_b32 s33, s33, 7
  s_add_u32 s34, s34, s33
  s_mul_i32 s35, s35, 3
  s_add_u32 s35, s35, s74
  s_sub_u32 s35, s35, 8
  s_lshl_b32 s33, s24, 3
  s_add_u32 s33, s33, s74
  s_cmp_lt_u32 s74, 8
  s_cselect_b32 s34, s33, s34
  s_sub_u32 s33, s74, 8
  s_cmp_lt_u32 s33, 12
  s_cselect_b32 s34, s35, s34
  s_cselect_b32 s4, s54, s46
  s_cselect_b32 s5, s55, s47
  s_cselect_b32 s6, 1409024, 0
  s_cmp_eq_u32 s6, 0
  s_cselect_b32 s6, 4194304, s6
  s_mov_b32 s7, 0x20000
  s_lshl_b32 s34, s34, 14
  s_and_b32 s33, s24, 3
  s_lshl_b32 s33, s33, 8
  s_add_u32 s33, s33, s34
  v_and_b32 v88, 31, v240
  v_lshrrev_b32 v89, 5, v240
  v_lshlrev_b32 v89, 12, v89
  v_lshl_add_u32 v88, v88, 2, v89
  v_add_u32 v254, s33, v88
  s_cmp_ge_u32 s74, 44
  s_cselect_b32 s33, 0x7f000000, 0
  v_add_u32 v255, s33, v250
  s_waitcnt lgkmcnt(0)
  s_waitcnt vmcnt(4)
  s_mov_b32 vcc_lo, 0x55555555
  s_mov_b32 vcc_hi, 0x55555555
  v_cndmask_b32_dpp v96, v4, v0, vcc quad_perm:[1,0,3,2] row_mask:0xf bank_mask:0xf
  v_cndmask_b32_dpp v97, v5, v1, vcc quad_perm:[1,0,3,2] row_mask:0xf bank_mask:0xf
  v_cndmask_b32_dpp v98, v6, v2, vcc quad_perm:[1,0,3,2] row_mask:0xf bank_mask:0xf
  v_cndmask_b32_dpp v99, v7, v3, vcc quad_perm:[1,0,3,2] row_mask:0xf bank_mask:0xf
  v_cndmask_b32_dpp v104, v12, v8, vcc quad_perm:[1,0,3,2] row_mask:0xf bank_mask:0xf
  v_cndmask_b32_dpp v105, v13, v9, vcc quad_perm:[1,0,3,2] row_mask:0xf bank_mask:0xf
  v_cndmask_b32_dpp v106, v14, v10, vcc quad_perm:[1,0,3,2] row_mask:0xf bank_mask:0xf
  v_cndmask_b32_dpp v107, v15, v11, vcc quad_perm:[1,0,3,2] row_mask:0xf bank_mask:0xf
  s_mov_b32 vcc_lo, 0xaaaaaaaa
  s_mov_b32 vcc_hi, 0xaaaaaaaa
  v_cndmask_b32_dpp v100, v0, v4, vcc quad_perm:[1,0,3,2] row_mask:0xf bank_mask:0xf
  v_cndmask_b32_dpp v101, v1, v5, vcc quad_perm:[1,0,3,2] row_mask:0xf bank_mask:0xf
  v_cndmask_b32_dpp v102, v2, v6, vcc quad_perm:[1,0,3,2] row_mask:0xf bank_mask:0xf
  v_cndmask_b32_dpp v103, v3, v7, vcc quad_perm:[1,0,3,2] row_mask:0xf bank_mask:0xf
  v_cndmask_b32_dpp v108, v8, v12, vcc quad_perm:[1,0,3,2] row_mask:0xf bank_mask:0xf
  v_cndmask_b32_dpp v109, v9, v13, vcc quad_perm:[1,0,3,2] row_mask:0xf bank_mask:0xf
  v_cndmask_b32_dpp v110, v10, v14, vcc quad_perm:[1,0,3,2] row_mask:0xf bank_mask:0xf
  v_cndmask_b32_dpp v111, v11, v15, vcc quad_perm:[1,0,3,2] row_mask:0xf bank_mask:0xf
  s_mov_b32 vcc_lo, 0x33333333
  s_mov_b32 vcc_hi, 0x33333333
  v_cndmask_b32_dpp v0, v104, v96, vcc quad_perm:[2,3,0,1] row_mask:0xf bank_mask:0xf
  v_cndmask_b32_dpp v1, v105, v97, vcc quad_perm:[2,3,0,1] row_mask:0xf bank_mask:0xf
  v_cndmask_b32_dpp v2, v106, v98, vcc quad_perm:[2,3,0,1] row_mask:0xf bank_mask:0xf
  v_cndmask_b32_dpp v3, v107, v99, vcc quad_perm:[2,3,0,1] row_mask:0xf bank_mask:0xf
  v_cndmask_b32_dpp v4, v108, v100, vcc quad_perm:[2,3,0,1] row_mask:0xf bank_mask:0xf
  v_cndmask_b32_dpp v5, v109, v101, vcc quad_perm:[2,3,0,1] row_mask:0xf bank_mask:0xf
  v_cndmask_b32_dpp v6, v110, v102, vcc quad_perm:[2,3,0,1] row_mask:0xf bank_mask:0xf
  v_cndmask_b32_dpp v7, v111, v103, vcc quad_perm:[2,3,0,1] row_mask:0xf bank_mask:0xf
  s_mov_b32 vcc_lo, 0xcccccccc
  s_mov_b32 vcc_hi, 0xcccccccc
  v_cndmask_b32_dpp v8, v96, v104, vcc quad_perm:[2,3,0,1] row_mask:0xf bank_mask:0xf
  v_cndmask_b32_dpp v9, v97, v105, vcc quad_perm:[2,3,0,1] row_mask:0xf bank_mask:0xf
  v_cndmask_b32_dpp v10, v98, v106, vcc quad_perm:[2,3,0,1] row_mask:0xf bank_mask:0xf
  v_cndmask_b32_dpp v11, v99, v107, vcc quad_perm:[2,3,0,1] row_mask:0xf bank_mask:0xf
  v_cndmask_b32_dpp v12, v100, v108, vcc quad_perm:[2,3,0,1] row_mask:0xf bank_mask:0xf
  v_cndmask_b32_dpp v13, v101, v109, vcc quad_perm:[2,3,0,1] row_mask:0xf bank_mask:0xf
  v_cndmask_b32_dpp v14, v102, v110, vcc quad_perm:[2,3,0,1] row_mask:0xf bank_mask:0xf
  v_cndmask_b32_dpp v15, v103, v111, vcc quad_perm:[2,3,0,1] row_mask:0xf bank_mask:0xf
  s_barrier
  ds_read_b128 v[64:67], v68
  s_waitcnt lgkmcnt(0)
  buffer_store_dwordx4 v[64:67], v69, s[20:23], s63 offen sc1
  ds_read_b64_tr_b16 v[224:225], v90 offset:0
  ds_read_b64_tr_b16 v[226:227], v90 offset:512
  ds_read_b64_tr_b16 v[228:229], v90 offset:256
  ds_read_b64_tr_b16 v[230:231], v90 offset:768
  ds_read_b64_tr_b16 v[232:233], v90 offset:1024
  ds_read_b64_tr_b16 v[234:235], v90 offset:1536
  s_waitcnt lgkmcnt(4)
  v_mfma_f32_32x32x16_bf16 v[96:111], v[224:227], v[0:3], 0
  ds_read_b64_tr_b16 v[236:237], v90 offset:1280
  ds_read_b64_tr_b16 v[238:239], v90 offset:1792
  s_add_u32 m0, s29, 32768
  s_nop 0
  buffer_load_dwordx4 v245, s[12:15], s27 offen  lds
  s_waitcnt lgkmcnt(4)
  v_mfma_f32_32x32x16_bf16 v[112:127], v[228:231], v[0:3], 0
  ds_read_b64_tr_b16 v[224:225], v90 offset:16384
  ds_read_b64_tr_b16 v[226:227], v90 offset:16896
  s_add_u32 m0, s30, 32768
  s_nop 0
  buffer_load_dwordx4 v246, s[12:15], s27 offen  lds
  s_waitcnt lgkmcnt(4)
  v_mfma_f32_32x32x16_bf16 v[128:143], v[232:235], v[0:3], 0
  ds_read_b64_tr_b16 v[228:229], v90 offset:16640
  ds_read_b64_tr_b16 v[230:231], v90 offset:17152
  s_add_u32 m0, s31, 32768
  s_nop 0
  buffer_load_dwordx4 v247, s[12:15], s27 offen  lds
  s_waitcnt lgkmcnt(4)
  v_mfma_f32_32x32x16_bf16 v[144:159], v[236:239], v[0:3], 0
  ds_read_b64_tr_b16 v[232:233], v90 offset:17408
  ds_read_b64_tr_b16 v[234:235], v90 offset:17920
  s_waitcnt lgkmcnt(4)
  v_mfma_f32_32x32x16_bf16 v[160:175], v[0:3], v[224:227], 0
  ds_read_b64_tr_b16 v[236:237], v90 offset:17664
  ds_read_b64_tr_b16 v[238:239], v90 offset:18176
  s_add_u32 m0, s32, 32768
  s_nop 0
  buffer_load_dwordx4 v248, s[12:15], s27 offen  lds
  s_add_u32 s27, s27, s28
  s_cmp_eq_u32 s27, s101
  s_cselect_b32 s27, 0, s27
  s_waitcnt lgkmcnt(4)
  v_mfma_f32_32x32x16_bf16 v[176:191], v[0:3], v[228:231], 0
  ds_read_b64_tr_b16 v[224:225], v90 offset:2048
  ds_read_b64_tr_b16 v[226:227], v90 offset:2560
  s_add_u32 m0, s29, 65536
  s_nop 0
  buffer_load_dwordx4 v245, s[12:15], s27 offen  lds
  s_waitcnt lgkmcnt(4)
  v_mfma_f32_32x32x16_bf16 v[192:207], v[0:3], v[232:235], 0
  ds_read_b64_tr_b16 v[228:229], v90 offset:2304
  ds_read_b64_tr_b16 v[230:231], v90 offset:2816
  s_waitcnt lgkmcnt(4)
  v_mfma_f32_32x32x16_bf16 v[208:223], v[0:3], v[236:239], 0
  ds_read_b64_tr_b16 v[232:233], v90 offset:3072
  ds_read_b64_tr_b16 v[234:235], v90 offset:3584
  s_add_u32 m0, s30, 65536
  s_nop 0
  buffer_load_dwordx4 v246, s[12:15], s27 offen  lds
  s_waitcnt lgkmcnt(4)
  v_mfma_f32_32x32x16_bf16 v[96:111], v[224:227], v[4:7], v[96:111]
  ds_read_b64_tr_b16 v[236:237], v90 offset:3328
  ds_read_b64_tr_b16 v[238:239], v90 offset:3840
  s_add_u32 m0, s31, 65536
  s_nop 0
  buffer_load_dwordx4 v247, s[12:15], s27 offen  lds
  s_waitcnt lgkmcnt(4)
  v_mfma_f32_32x32x16_bf16 v[112:127], v[228:231], v[4:7], v[112:127]
  ds_read_b64_tr_b16 v[224:225], v90 offset:18432
  ds_read_b64_tr_b16 v[226:227], v90 offset:18944
  s_waitcnt vmcnt(8)
  s_mov_b32 vcc_lo, 0x55555555
  s_mov_b32 vcc_hi, 0x55555555
  v_cndmask_b32_dpp v64, v20, v16, vcc quad_perm:[1,0,3,2] row_mask:0xf bank_mask:0xf
  s_waitcnt lgkmcnt(4)
  v_mfma_f32_32x32x16_bf16 v[128:143], v[232:235], v[4:7], v[128:143]
  ds_read_b64_tr_b16 v[228:229], v90 offset:18688
  ds_read_b64_tr_b16 v[230:231], v90 offset:19200
  v_cndmask_b32_dpp v65, v21, v17, vcc quad_perm:[1,0,3,2] row_mask:0xf bank_mask:0xf
  v_cndmask_b32_dpp v66, v22, v18, vcc quad_perm:[1,0,3,2] row_mask:0xf bank_mask:0xf
  s_add_u32 m0, s32, 65536
  s_nop 0
  buffer_load_dwordx4 v248, s[12:15], s27 offen  lds
  s_add_u32 s27, s27, s28
  s_cmp_eq_u32 s27, s101
  s_cselect_b32 s27, 0, s27
  s_waitcnt lgkmcnt(4)
  v_mfma_f32_32x32x16_bf16 v[144:159], v[236:239], v[4:7], v[144:159]
  ds_read_b64_tr_b16 v[232:233], v90 offset:19456
  ds_read_b64_tr_b16 v[234:235], v90 offset:19968
  v_cndmask_b32_dpp v67, v23, v19, vcc quad_perm:[1,0,3,2] row_mask:0xf bank_mask:0xf
  v_cndmask_b32_dpp v72, v28, v24, vcc quad_perm:[1,0,3,2] row_mask:0xf bank_mask:0xf
  buffer_load_dwordx4 v[32:35], v249, s[8:11], s62 offen offset:0
  s_waitcnt lgkmcnt(4)
  v_mfma_f32_32x32x16_bf16 v[160:175], v[4:7], v[224:227], v[160:175]
  ds_read_b64_tr_b16 v[236:237], v90 offset:19712
  ds_read_b64_tr_b16 v[238:239], v90 offset:20224
  v_cndmask_b32_dpp v73, v29, v25, vcc quad_perm:[1,0,3,2] row_mask:0xf bank_mask:0xf
  v_cndmask_b32_dpp v74, v30, v26, vcc quad_perm:[1,0,3,2] row_mask:0xf bank_mask:0xf
  s_waitcnt lgkmcnt(4)
  v_mfma_f32_32x32x16_bf16 v[176:191], v[4:7], v[228:231], v[176:191]
  ds_read_b64_tr_b16 v[224:225], v90 offset:4096
  ds_read_b64_tr_b16 v[226:227], v90 offset:4608
  v_cndmask_b32_dpp v75, v31, v27, vcc quad_perm:[1,0,3,2] row_mask:0xf bank_mask:0xf
  s_mov_b32 vcc_lo, 0xaaaaaaaa
  s_mov_b32 vcc_hi, 0xaaaaaaaa
  buffer_load_dwordx4 v[36:39], v249, s[8:11], s62 offen offset:1024
  s_waitcnt lgkmcnt(4)
  v_mfma_f32_32x32x16_bf16 v[192:207], v[4:7], v[232:235], v[192:207]
  ds_read_b64_tr_b16 v[228:229], v90 offset:4352
  ds_read_b64_tr_b16 v[230:231], v90 offset:4864
  v_cndmask_b32_dpp v68, v16, v20, vcc quad_perm:[1,0,3,2] row_mask:0xf bank_mask:0xf
  v_cndmask_b32_dpp v69, v17, v21, vcc quad_perm:[1,0,3,2] row_mask:0xf bank_mask:0xf
  buffer_load_dwordx4 v[40:43], v249, s[8:11], s62 offen offset:2048
  s_waitcnt lgkmcnt(4)
  v_mfma_f32_32x32x16_bf16 v[208:223], v[4:7], v[236:239], v[208:223]
  ds_read_b64_tr_b16 v[232:233], v90 offset:5120
  ds_read_b64_tr_b16 v[234:235], v90 offset:5632
  v_cndmask_b32_dpp v70, v18, v22, vcc quad_perm:[1,0,3,2] row_mask:0xf bank_mask:0xf
  v_cndmask_b32_dpp v71, v19, v23, vcc quad_perm:[1,0,3,2] row_mask:0xf bank_mask:0xf
  buffer_load_dwordx4 v[44:47], v249, s[8:11], s62 offen offset:3072
  s_add_u32 s62, s62, 128
  s_and_b32 s62, s62, 1023
  s_or_b32 s62, s62, s48
  s_waitcnt lgkmcnt(4)
  v_mfma_f32_32x32x16_bf16 v[96:111], v[224:227], v[8:11], v[96:111]
  ds_read_b64_tr_b16 v[236:237], v90 offset:5376
  ds_read_b64_tr_b16 v[238:239], v90 offset:5888
  v_cndmask_b32_dpp v76, v24, v28, vcc quad_perm:[1,0,3,2] row_mask:0xf bank_mask:0xf
  v_cndmask_b32_dpp v77, v25, v29, vcc quad_perm:[1,0,3,2] row_mask:0xf bank_mask:0xf
  s_waitcnt lgkmcnt(4)
  v_mfma_f32_32x32x16_bf16 v[112:127], v[228:231], v[8:11], v[112:127]
  ds_read_b64_tr_b16 v[224:225], v90 offset:20480
  ds_read_b64_tr_b16 v[226:227], v90 offset:20992
  v_cndmask_b32_dpp v78, v26, v30, vcc quad_perm:[1,0,3,2] row_mask:0xf bank_mask:0xf
  v_cndmask_b32_dpp v79, v27, v31, vcc quad_perm:[1,0,3,2] row_mask:0xf bank_mask:0xf
  s_add_u32 m0, s29, 98304
  s_nop 0
  buffer_load_dwordx4 v245, s[12:15], s27 offen  lds
  s_waitcnt lgkmcnt(4)
  v_mfma_f32_32x32x16_bf16 v[128:143], v[232:235], v[8:11], v[128:143]
  ds_read_b64_tr_b16 v[228:229], v90 offset:20736
  ds_read_b64_tr_b16 v[230:231], v90 offset:21248
  s_mov_b32 vcc_lo, 0x33333333
  s_mov_b32 vcc_hi, 0x33333333
  v_cndmask_b32_dpp v16, v72, v64, vcc quad_perm:[2,3,0,1] row_mask:0xf bank_mask:0xf
  s_add_u32 m0, s30, 98304
  s_nop 0
  buffer_load_dwordx4 v246, s[12:15], s27 offen  lds
  s_waitcnt lgkmcnt(4)
  v_mfma_f32_32x32x16_bf16 v[144:159], v[236:239], v[8:11], v[144:159]
  ds_read_b64_tr_b16 v[232:233], v90 offset:21504
  ds_read_b64_tr_b16 v[234:235], v90 offset:22016
  v_cndmask_b32_dpp v17, v73, v65, vcc quad_perm:[2,3,0,1] row_mask:0xf bank_mask:0xf
  v_cndmask_b32_dpp v18, v74, v66, vcc quad_perm:[2,3,0,1] row_mask:0xf bank_mask:0xf
  s_waitcnt lgkmcnt(4)
  v_mfma_f32_32x32x16_bf16 v[160:175], v[8:11], v[224:227], v[160:175]
  ds_read_b64_tr_b16 v[236:237], v90 offset:21760
  ds_read_b64_tr_b16 v[238:239], v90 offset:22272
  v_cndmask_b32_dpp v19, v75, v67, vcc quad_perm:[2,3,0,1] row_mask:0xf bank_mask:0xf
  v_cndmask_b32_dpp v20, v76, v68, vcc quad_perm:[2,3,0,1] row_mask:0xf bank_mask:0xf
  s_add_u32 m0, s31, 98304
  s_nop 0
  buffer_load_dwordx4 v247, s[12:15], s27 offen  lds
  s_waitcnt lgkmcnt(4)
  v_mfma_f32_32x32x16_bf16 v[176:191], v[8:11], v[228:231], v[176:191]
  ds_read_b64_tr_b16 v[224:225], v90 offset:6144
  ds_read_b64_tr_b16 v[226:227], v90 offset:6656
  v_cndmask_b32_dpp v21, v77, v69, vcc quad_perm:[2,3,0,1] row_mask:0xf bank_mask:0xf
  v_cndmask_b32_dpp v22, v78, v70, vcc quad_perm:[2,3,0,1] row_mask:0xf bank_mask:0xf
  s_add_u32 m0, s32, 98304
  s_nop 0
  buffer_load_dwordx4 v248, s[12:15], s27 offen  lds
  s_add_u32 s27, s27, s28
  s_cmp_eq_u32 s27, s101
  s_cselect_b32 s27, 0, s27
  s_waitcnt lgkmcnt(4)
  v_mfma_f32_32x32x16_bf16 v[192:207], v[8:11], v[232:235], v[192:207]
  ds_read_b64_tr_b16 v[228:229], v90 offset:6400
  ds_read_b64_tr_b16 v[230:231], v90 offset:6912
  v_cndmask_b32_dpp v23, v79, v71, vcc quad_perm:[2,3,0,1] row_mask:0xf bank_mask:0xf
  s_mov_b32 vcc_lo, 0xcccccccc
  s_mov_b32 vcc_hi, 0xcccccccc
  s_waitcnt lgkmcnt(4)
  v_mfma_f32_32x32x16_bf16 v[208:223], v[8:11], v[236:239], v[208:223]
  ds_read_b64_tr_b16 v[232:233], v90 offset:7168
  ds_read_b64_tr_b16 v[234:235], v90 offset:7680
  v_cndmask_b32_dpp v24, v64, v72, vcc quad_perm:[2,3,0,1] row_mask:0xf bank_mask:0xf
  v_cndmask_b32_dpp v25, v65, v73, vcc quad_perm:[2,3,0,1] row_mask:0xf bank_mask:0xf
  buffer_load_dwordx4 v[48:51], v249, s[8:11], s62 offen offset:0
  s_waitcnt lgkmcnt(4)
  v_mfma_f32_32x32x16_bf16 v[96:111], v[224:227], v[12:15], v[96:111]
  ds_read_b64_tr_b16 v[236:237], v90 offset:7424
  ds_read_b64_tr_b16 v[238:239], v90 offset:7936
  v_cndmask_b32_dpp v26, v66, v74, vcc quad_perm:[2,3,0,1] row_mask:0xf bank_mask:0xf
  v_cndmask_b32_dpp v27, v67, v75, vcc quad_perm:[2,3,0,1] row_mask:0xf bank_mask:0xf
  buffer_load_dwordx4 v[52:55], v249, s[8:11], s62 offen offset:1024
  s_waitcnt lgkmcnt(4)
  v_mfma_f32_32x32x16_bf16 v[112:127], v[228:231], v[12:15], v[112:127]
  ds_read_b64_tr_b16 v[224:225], v90 offset:22528
  ds_read_b64_tr_b16 v[226:227], v90 offset:23040
  v_cndmask_b32_dpp v28, v68, v76, vcc quad_perm:[2,3,0,1] row_mask:0xf bank_mask:0xf
  v_cndmask_b32_dpp v29, v69, v77, vcc quad_perm:[2,3,0,1] row_mask:0xf bank_mask:0xf
  s_waitcnt lgkmcnt(4)
  v_mfma_f32_32x32x16_bf16 v[128:143], v[232:235], v[12:15], v[128:143]
  ds_read_b64_tr_b16 v[228:229], v90 offset:22784
  ds_read_b64_tr_b16 v[230:231], v90 offset:23296
  v_cndmask_b32_dpp v30, v70, v78, vcc quad_perm:[2,3,0,1] row_mask:0xf bank_mask:0xf
  v_cndmask_b32_dpp v31, v71, v79, vcc quad_perm:[2,3,0,1] row_mask:0xf bank_mask:0xf
  buffer_load_dwordx4 v[56:59], v249, s[8:11], s62 offen offset:2048
  s_waitcnt lgkmcnt(4)
  v_mfma_f32_32x32x16_bf16 v[144:159], v[236:239], v[12:15], v[144:159]
  ds_read_b64_tr_b16 v[232:233], v90 offset:23552
  ds_read_b64_tr_b16 v[234:235], v90 offset:24064
  buffer_load_dwordx4 v[60:63], v249, s[8:11], s62 offen offset:3072
  s_add_u32 s62, s62, 128
  s_and_b32 s62, s62, 1023
  s_or_b32 s62, s62, s48
  s_waitcnt lgkmcnt(4)
  v_mfma_f32_32x32x16_bf16 v[160:175], v[12:15], v[224:227], v[160:175]
  ds_read_b64_tr_b16 v[236:237], v90 offset:23808
  ds_read_b64_tr_b16 v[238:239], v90 offset:24320
  s_waitcnt lgkmcnt(4)
  v_mfma_f32_32x32x16_bf16 v[176:191], v[12:15], v[228:231], v[176:191]
  s_waitcnt vmcnt(16)
  s_barrier
  ds_read_b64_tr_b16 v[224:225], v90 offset:32768
  ds_read_b64_tr_b16 v[226:227], v90 offset:33280
  s_waitcnt lgkmcnt(4)
  v_mfma_f32_32x32x16_bf16 v[192:207], v[12:15], v[232:235], v[192:207]
  ds_read_b64_tr_b16 v[228:229], v90 offset:33024
  ds_read_b64_tr_b16 v[230:231], v90 offset:33536
  s_waitcnt lgkmcnt(4)
  v_mfma_f32_32x32x16_bf16 v[208:223], v[12:15], v[236:239], v[208:223]
  ds_read_b64_tr_b16 v[232:233], v90 offset:33792
  ds_read_b64_tr_b16 v[234:235], v90 offset:34304
  s_waitcnt lgkmcnt(4)
  v_mfma_f32_32x32x16_bf16 v[96:111], v[224:227], v[16:19], v[96:111]
  ds_read_b64_tr_b16 v[236:237], v90 offset:34048
  ds_read_b64_tr_b16 v[238:239], v90 offset:34560
  s_add_u32 m0, s29, 0
  s_nop 0
  buffer_load_dwordx4 v245, s[12:15], s27 offen  lds
  s_waitcnt lgkmcnt(4)
  v_mfma_f32_32x32x16_bf16 v[112:127], v[228:231], v[16:19], v[112:127]
  ds_read_b64_tr_b16 v[224:225], v90 offset:49152
  ds_read_b64_tr_b16 v[226:227], v90 offset:49664
  s_waitcnt lgkmcnt(4)
  v_mfma_f32_32x32x16_bf16 v[128:143], v[232:235], v[16:19], v[128:143]
  ds_read_b64_tr_b16 v[228:229], v90 offset:49408
  ds_read_b64_tr_b16 v[230:231], v90 offset:49920
  s_waitcnt lgkmcnt(4)
  v_mfma_f32_32x32x16_bf16 v[144:159], v[236:239], v[16:19], v[144:159]
  ds_read_b64_tr_b16 v[232:233], v90 offset:50176
  ds_read_b64_tr_b16 v[234:235], v90 offset:50688
  s_waitcnt vmcnt(9)
  s_mov_b32 vcc_lo, 0x55555555
  s_mov_b32 vcc_hi, 0x55555555
  v_cndmask_b32_dpp v64, v36, v32, vcc quad_perm:[1,0,3,2] row_mask:0xf bank_mask:0xf
  s_add_u32 m0, s30, 0
  s_nop 0
  buffer_load_dwordx4 v246, s[12:15], s27 offen  lds
  s_waitcnt lgkmcnt(4)
  v_mfma_f32_32x32x16_bf16 v[160:175], v[16:19], v[224:227], v[160:175]
  ds_read_b64_tr_b16 v[236:237], v90 offset:50432
  ds_read_b64_tr_b16 v[238:239], v90 offset:50944
  v_cndmask_b32_dpp v65, v37, v33, vcc quad_perm:[1,0,3,2] row_mask:0xf bank_mask:0xf
  v_cndmask_b32_dpp v66, v38, v34, vcc quad_perm:[1,0,3,2] row_mask:0xf bank_mask:0xf
  s_waitcnt lgkmcnt(4)
  v_mfma_f32_32x32x16_bf16 v[176:191], v[16:19], v[228:231], v[176:191]
  ds_read_b64_tr_b16 v[224:225], v90 offset:34816
  ds_read_b64_tr_b16 v[226:227], v90 offset:35328
  v_cndmask_b32_dpp v67, v39, v35, vcc quad_perm:[1,0,3,2] row_mask:0xf bank_mask:0xf
  v_cndmask_b32_dpp v72, v44, v40, vcc quad_perm:[1,0,3,2] row_mask:0xf bank_mask:0xf
  s_waitcnt lgkmcnt(4)
  v_mfma_f32_32x32x16_bf16 v[192:207], v[16:19], v[232:235], v[192:207]
  ds_read_b64_tr_b16 v[228:229], v90 offset:35072
  ds_read_b64_tr_b16 v[230:231], v90 offset:35584
  v_cndmask_b32_dpp v73, v45, v41, vcc quad_perm:[1,0,3,2] row_mask:0xf bank_mask:0xf
  v_cndmask_b32_dpp v74, v46, v42, vcc quad_perm:[1,0,3,2] row_mask:0xf bank_mask:0xf
  s_waitcnt lgkmcnt(4)
  v_mfma_f32_32x32x16_bf16 v[208:223], v[16:19], v[236:239], v[208:223]
  ds_read_b64_tr_b16 v[232:233], v90 offset:35840
  ds_read_b64_tr_b16 v[234:235], v90 offset:36352
  v_cndmask_b32_dpp v75, v47, v43, vcc quad_perm:[1,0,3,2] row_mask:0xf bank_mask:0xf
  s_mov_b32 vcc_lo, 0xaaaaaaaa
  s_mov_b32 vcc_hi, 0xaaaaaaaa
  s_add_u32 m0, s31, 0
  s_nop 0
  buffer_load_dwordx4 v247, s[12:15], s27 offen  lds
  s_waitcnt lgkmcnt(4)
  v_mfma_f32_32x32x16_bf16 v[96:111], v[224:227], v[20:23], v[96:111]
  ds_read_b64_tr_b16 v[236:237], v90 offset:36096
  ds_read_b64_tr_b16 v[238:239], v90 offset:36608
  v_cndmask_b32_dpp v68, v32, v36, vcc quad_perm:[1,0,3,2] row_mask:0xf bank_mask:0xf
  v_cndmask_b32_dpp v69, v33, v37, vcc quad_perm:[1,0,3,2] row_mask:0xf bank_mask:0xf
  s_waitcnt lgkmcnt(4)
  v_mfma_f32_32x32x16_bf16 v[112:127], v[228:231], v[20:23], v[112:127]
  ds_read_b64_tr_b16 v[224:225], v90 offset:51200
  ds_read_b64_tr_b16 v[226:227], v90 offset:51712
  v_cndmask_b32_dpp v70, v34, v38, vcc quad_perm:[1,0,3,2] row_mask:0xf bank_mask:0xf
  v_cndmask_b32_dpp v71, v35, v39, vcc quad_perm:[1,0,3,2] row_mask:0xf bank_mask:0xf
  s_waitcnt lgkmcnt(4)
  v_mfma_f32_32x32x16_bf16 v[128:143], v[232:235], v[20:23], v[128:143]
  ds_read_b64_tr_b16 v[228:229], v90 offset:51456
  ds_read_b64_tr_b16 v[230:231], v90 offset:51968
  v_cndmask_b32_dpp v76, v40, v44, vcc quad_perm:[1,0,3,2] row_mask:0xf bank_mask:0xf
  v_cndmask_b32_dpp v77, v41, v45, vcc quad_perm:[1,0,3,2] row_mask:0xf bank_mask:0xf
  s_add_u32 m0, s32, 0
  s_nop 0
  buffer_load_dwordx4 v248, s[12:15], s27 offen  lds
  s_add_u32 s27, s27, s28
  s_cmp_eq_u32 s27, s101
  s_cselect_b32 s27, 0, s27
  s_waitcnt lgkmcnt(4)
  v_mfma_f32_32x32x16_bf16 v[144:159], v[236:239], v[20:23], v[144:159]
  ds_read_b64_tr_b16 v[232:233], v90 offset:52224
  ds_read_b64_tr_b16 v[234:235], v90 offset:52736
  v_cndmask_b32_dpp v78, v42, v46, vcc quad_perm:[1,0,3,2] row_mask:0xf bank_mask:0xf
  v_cndmask_b32_dpp v79, v43, v47, vcc quad_perm:[1,0,3,2] row_mask:0xf bank_mask:0xf
  s_waitcnt lgkmcnt(4)
  v_mfma_f32_32x32x16_bf16 v[160:175], v[20:23], v[224:227], v[160:175]
  ds_read_b64_tr_b16 v[236:237], v90 offset:52480
  ds_read_b64_tr_b16 v[238:239], v90 offset:52992
  s_mov_b32 vcc_lo, 0x33333333
  s_mov_b32 vcc_hi, 0x33333333
  v_cndmask_b32_dpp v32, v72, v64, vcc quad_perm:[2,3,0,1] row_mask:0xf bank_mask:0xf
  s_waitcnt lgkmcnt(4)
  v_mfma_f32_32x32x16_bf16 v[176:191], v[20:23], v[228:231], v[176:191]
  ds_read_b64_tr_b16 v[224:225], v90 offset:36864
  ds_read_b64_tr_b16 v[226:227], v90 offset:37376
  v_cndmask_b32_dpp v33, v73, v65, vcc quad_perm:[2,3,0,1] row_mask:0xf bank_mask:0xf
  v_cndmask_b32_dpp v34, v74, v66, vcc quad_perm:[2,3,0,1] row_mask:0xf bank_mask:0xf
  s_waitcnt lgkmcnt(4)
  v_mfma_f32_32x32x16_bf16 v[192:207], v[20:23], v[232:235], v[192:207]
  ds_read_b64_tr_b16 v[228:229], v90 offset:37120
  ds_read_b64_tr_b16 v[230:231], v90 offset:37632
  v_cndmask_b32_dpp v35, v75, v67, vcc quad_perm:[2,3,0,1] row_mask:0xf bank_mask:0xf
  v_cndmask_b32_dpp v36, v76, v68, vcc quad_perm:[2,3,0,1] row_mask:0xf bank_mask:0xf
  buffer_load_dwordx4 v[0:3], v249, s[8:11], s62 offen offset:0
  s_waitcnt lgkmcnt(4)
  v_mfma_f32_32x32x16_bf16 v[208:223], v[20:23], v[236:239], v[208:223]
  ds_read_b64_tr_b16 v[232:233], v90 offset:37888
  ds_read_b64_tr_b16 v[234:235], v90 offset:38400
  v_cndmask_b32_dpp v37, v77, v69, vcc quad_perm:[2,3,0,1] row_mask:0xf bank_mask:0xf
  v_cndmask_b32_dpp v38, v78, v70, vcc quad_perm:[2,3,0,1] row_mask:0xf bank_mask:0xf
  s_waitcnt lgkmcnt(4)
  v_mfma_f32_32x32x16_bf16 v[96:111], v[224:227], v[24:27], v[96:111]
  ds_read_b64_tr_b16 v[236:237], v90 offset:38144
  ds_read_b64_tr_b16 v[238:239], v90 offset:38656
  v_cndmask_b32_dpp v39, v79, v71, vcc quad_perm:[2,3,0,1] row_mask:0xf bank_mask:0xf
  s_mov_b32 vcc_lo, 0xcccccccc
  s_mov_b32 vcc_hi, 0xcccccccc
  s_waitcnt lgkmcnt(4)
  v_mfma_f32_32x32x16_bf16 v[112:127], v[228:231], v[24:27], v[112:127]
  ds_read_b64_tr_b16 v[224:225], v90 offset:53248
  ds_read_b64_tr_b16 v[226:227], v90 offset:53760
  v_cndmask_b32_dpp v40, v64, v72, vcc quad_perm:[2,3,0,1] row_mask:0xf bank_mask:0xf
  v_cndmask_b32_dpp v41, v65, v73, vcc quad_perm:[2,3,0,1] row_mask:0xf bank_mask:0xf
  s_waitcnt lgkmcnt(4)
  v_mfma_f32_32x32x16_bf16 v[128:143], v[232:235], v[24:27], v[128:143]
  ds_read_b64_tr_b16 v[228:229], v90 offset:53504
  ds_read_b64_tr_b16 v[230:231], v90 offset:54016
  v_cndmask_b32_dpp v42, v66, v74, vcc quad_perm:[2,3,0,1] row_mask:0xf bank_mask:0xf
  v_cndmask_b32_dpp v43, v67, v75, vcc quad_perm:[2,3,0,1] row_mask:0xf bank_mask:0xf
  buffer_load_dwordx4 v[4:7], v249, s[8:11], s62 offen offset:1024
  s_waitcnt lgkmcnt(4)
  v_mfma_f32_32x32x16_bf16 v[144:159], v[236:239], v[24:27], v[144:159]
  ds_read_b64_tr_b16 v[232:233], v90 offset:54272
  ds_read_b64_tr_b16 v[234:235], v90 offset:54784
  v_cndmask_b32_dpp v44, v68, v76, vcc quad_perm:[2,3,0,1] row_mask:0xf bank_mask:0xf
  v_cndmask_b32_dpp v45, v69, v77, vcc quad_perm:[2,3,0,1] row_mask:0xf bank_mask:0xf
  s_waitcnt lgkmcnt(4)
  v_mfma_f32_32x32x16_bf16 v[160:175], v[24:27], v[224:227], v[160:175]
  ds_read_b64_tr_b16 v[236:237], v90 offset:54528
  ds_read_b64_tr_b16 v[238:239], v90 offset:55040
  v_cndmask_b32_dpp v46, v70, v78, vcc quad_perm:[2,3,0,1] row_mask:0xf bank_mask:0xf
  v_cndmask_b32_dpp v47, v71, v79, vcc quad_perm:[2,3,0,1] row_mask:0xf bank_mask:0xf
  s_waitcnt lgkmcnt(4)
  v_mfma_f32_32x32x16_bf16 v[176:191], v[24:27], v[228:231], v[176:191]
  ds_read_b64_tr_b16 v[224:225], v90 offset:38912
  ds_read_b64_tr_b16 v[226:227], v90 offset:39424
  buffer_load_dwordx4 v[8:11], v249, s[8:11], s62 offen offset:2048
  s_waitcnt lgkmcnt(4)
  v_mfma_f32_32x32x16_bf16 v[192:207], v[24:27], v[232:235], v[192:207]
  ds_read_b64_tr_b16 v[228:229], v90 offset:39168
  ds_read_b64_tr_b16 v[230:231], v90 offset:39680
  s_waitcnt lgkmcnt(4)
  v_mfma_f32_32x32x16_bf16 v[208:223], v[24:27], v[236:239], v[208:223]
  ds_read_b64_tr_b16 v[232:233], v90 offset:39936
  ds_read_b64_tr_b16 v[234:235], v90 offset:40448
  s_waitcnt lgkmcnt(4)
  v_mfma_f32_32x32x16_bf16 v[96:111], v[224:227], v[28:31], v[96:111]
  ds_read_b64_tr_b16 v[236:237], v90 offset:40192
  ds_read_b64_tr_b16 v[238:239], v90 offset:40704
  s_waitcnt lgkmcnt(4)
  v_mfma_f32_32x32x16_bf16 v[112:127], v[228:231], v[28:31], v[112:127]
  ds_read_b64_tr_b16 v[224:225], v90 offset:55296
  ds_read_b64_tr_b16 v[226:227], v90 offset:55808
  buffer_load_dwordx4 v[12:15], v249, s[8:11], s62 offen offset:3072
  s_add_u32 s62, s62, 128
  s_and_b32 s62, s62, 1023
  s_or_b32 s62, s62, s48
  s_waitcnt lgkmcnt(4)
  v_mfma_f32_32x32x16_bf16 v[128:143], v[232:235], v[28:31], v[128:143]
  ds_read_b64_tr_b16 v[228:229], v90 offset:55552
  ds_read_b64_tr_b16 v[230:231], v90 offset:56064
  s_waitcnt lgkmcnt(4)
  v_mfma_f32_32x32x16_bf16 v[144:159], v[236:239], v[28:31], v[144:159]
  ds_read_b64_tr_b16 v[232:233], v90 offset:56320
  ds_read_b64_tr_b16 v[234:235], v90 offset:56832
  s_waitcnt lgkmcnt(4)
  v_mfma_f32_32x32x16_bf16 v[160:175], v[28:31], v[224:227], v[160:175]
  ds_read_b64_tr_b16 v[236:237], v90 offset:56576
  ds_read_b64_tr_b16 v[238:239], v90 offset:57088
  s_waitcnt lgkmcnt(4)
  v_mfma_f32_32x32x16_bf16 v[176:191], v[28:31], v[228:231], v[176:191]
  s_barrier
  s_cmp_eq_u32 s26, 0
  s_cbranch_scc1 sg_do1
sg_back1:
  ds_read_b64_tr_b16 v[224:225], v91 offset:0
  ds_read_b64_tr_b16 v[226:227], v91 offset:512
  s_waitcnt lgkmcnt(4)
  v_mfma_f32_32x32x16_bf16 v[192:207], v[28:31], v[232:235], v[192:207]
  ds_read_b64_tr_b16 v[228:229], v91 offset:256
  ds_read_b64_tr_b16 v[230:231], v91 offset:768
  s_waitcnt lgkmcnt(4)
  v_mfma_f32_32x32x16_bf16 v[208:223], v[28:31], v[236:239], v[208:223]
  ds_read_b64_tr_b16 v[232:233], v91 offset:1024
  ds_read_b64_tr_b16 v[234:235], v91 offset:1536
  s_waitcnt lgkmcnt(4)
  v_mfma_f32_32x32x16_bf16 v[96:111], v[224:227], v[32:35], v[96:111]
  ds_read_b64_tr_b16 v[236:237], v91 offset:1280
  ds_read_b64_tr_b16 v[238:239], v91 offset:1792
  s_add_u32 m0, s29, 32768
  s_nop 0
  buffer_load_dwordx4 v245, s[12:15], s27 offen  lds
  s_waitcnt lgkmcnt(4)
  v_mfma_f32_32x32x16_bf16 v[112:127], v[228:231], v[32:35], v[112:127]
  ds_read_b64_tr_b16 v[224:225], v91 offset:16384
  ds_read_b64_tr_b16 v[226:227], v91 offset:16896
  s_waitcnt lgkmcnt(4)
  v_mfma_f32_32x32x16_bf16 v[128:143], v[232:235], v[32:35], v[128:143]
  ds_read_b64_tr_b16 v[228:229], v91 offset:16640
  ds_read_b64_tr_b16 v[230:231], v91 offset:17152
  s_waitcnt lgkmcnt(4)
  v_mfma_f32_32x32x16_bf16 v[144:159], v[236:239], v[32:35], v[144:159]
  ds_read_b64_tr_b16 v[232:233], v91 offset:17408
  ds_read_b64_tr_b16 v[234:235], v91 offset:17920
  s_waitcnt vmcnt(9)
  s_mov_b32 vcc_lo, 0x55555555
  s_mov_b32 vcc_hi, 0x55555555
  v_cndmask_b32_dpp v64, v52, v48, vcc quad_perm:[1,0,3,2] row_mask:0xf bank_mask:0xf
  s_add_u32 m0, s30, 32768
  s_nop 0
  buffer_load_dwordx4 v246, s[12:15], s27 offen  lds
  s_waitcnt lgkmcnt(4)
  v_mfma_f32_32x32x16_bf16 v[160:175], v[32:35], v[224:227], v[160:175]
  ds_read_b64_tr_b16 v[236:237], v91 offset:17664
  ds_read_b64_tr_b16 v[238:239], v91 offset:18176
  v_cndmask_b32_dpp v65, v53, v49, vcc quad_perm:[1,0,3,2] row_mask:0xf bank_mask:0xf
  v_cndmask_b32_dpp v66, v54, v50, vcc quad_perm:[1,0,3,2] row_mask:0xf bank_mask:0xf
  s_waitcnt lgkmcnt(4)
  v_mfma_f32_32x32x16_bf16 v[176:191], v[32:35], v[228:231], v[176:191]
  ds_read_b64_tr_b16 v[224:225], v91 offset:2048
  ds_read_b64_tr_b16 v[226:227], v91 offset:2560
  v_cndmask_b32_dpp v67, v55, v51, vcc quad_perm:[1,0,3,2] row_mask:0xf bank_mask:0xf
  v_cndmask_b32_dpp v72, v60, v56, vcc quad_perm:[1,0,3,2] row_mask:0xf bank_mask:0xf
  s_waitcnt lgkmcnt(4)
  v_mfma_f32_32x32x16_bf16 v[192:207], v[32:35], v[232:235], v[192:207]
  ds_read_b64_tr_b16 v[228:229], v91 offset:2304
  ds_read_b64_tr_b16 v[230:231], v91 offset:2816
  v_cndmask_b32_dpp v73, v61, v57, vcc quad_perm:[1,0,3,2] row_mask:0xf bank_mask:0xf
  v_cndmask_b32_dpp v74, v62, v58, vcc quad_perm:[1,0,3,2] row_mask:0xf bank_mask:0xf
  s_waitcnt lgkmcnt(4)
  v_mfma_f32_32x32x16_bf16 v[208:223], v[32:35], v[236:239], v[208:223]
  ds_read_b64_tr_b16 v[232:233], v91 offset:3072
  ds_read_b64_tr_b16 v[234:235], v91 offset:3584
  v_cndmask_b32_dpp v75, v63, v59, vcc quad_perm:[1,0,3,2] row_mask:0xf bank_mask:0xf
  s_mov_b32 vcc_lo, 0xaaaaaaaa
  s_mov_b32 vcc_hi, 0xaaaaaaaa
  s_add_u32 m0, s31, 32768
  s_nop 0
  buffer_load_dwordx4 v247, s[12:15], s27 offen  lds
  s_waitcnt lgkmcnt(4)
  v_mfma_f32_32x32x16_bf16 v[96:111], v[224:227], v[36:39], v[96:111]
  ds_read_b64_tr_b16 v[236:237], v91 offset:3328
  ds_read_b64_tr_b16 v[238:239], v91 offset:3840
  v_cndmask_b32_dpp v68, v48, v52, vcc quad_perm:[1,0,3,2] row_mask:0xf bank_mask:0xf
  v_cndmask_b32_dpp v69, v49, v53, vcc quad_perm:[1,0,3,2] row_mask:0xf bank_mask:0xf
  s_waitcnt lgkmcnt(4)
  v_mfma_f32_32x32x16_bf16 v[112:127], v[228:231], v[36:39], v[112:127]
  ds_read_b64_tr_b16 v[224:225], v91 offset:18432
  ds_read_b64_tr_b16 v[226:227], v91 offset:18944
  v_cndmask_b32_dpp v70, v50, v54, vcc quad_perm:[1,0,3,2] row_mask:0xf bank_mask:0xf
  v_cndmask_b32_dpp v71, v51, v55, vcc quad_perm:[1,0,3,2] row_mask:0xf bank_mask:0xf
  s_waitcnt lgkmcnt(4)
  v_mfma_f32_32x32x16_bf16 v[128:143], v[232:235], v[36:39], v[128:143]
  ds_read_b64_tr_b16 v[228:229], v91 offset:18688
  ds_read_b64_tr_b16 v[230:231], v91 offset:19200
  v_cndmask_b32_dpp v76, v56, v60, vcc quad_perm:[1,0,3,2] row_mask:0xf bank_mask:0xf
  v_cndmask_b32_dpp v77, v57, v61, vcc quad_perm:[1,0,3,2] row_mask:0xf bank_mask:0xf
  s_add_u32 m0, s32, 32768
  s_nop 0
  buffer_load_dwordx4 v248, s[12:15], s27 offen  lds
  s_add_u32 s27, s27, s28
  s_cmp_eq_u32 s27, s101
  s_cselect_b32 s27, 0, s27
  s_waitcnt lgkmcnt(4)
  v_mfma_f32_32x32x16_bf16 v[144:159], v[236:239], v[36:39], v[144:159]
  ds_read_b64_tr_b16 v[232:233], v91 offset:19456
  ds_read_b64_tr_b16 v[234:235], v91 offset:19968
  v_cndmask_b32_dpp v78, v58, v62, vcc quad_perm:[1,0,3,2] row_mask:0xf bank_mask:0xf
  v_cndmask_b32_dpp v79, v59, v63, vcc quad_perm:[1,0,3,2] row_mask:0xf bank_mask:0xf
  s_waitcnt lgkmcnt(4)
  v_mfma_f32_32x32x16_bf16 v[160:175], v[36:39], v[224:227], v[160:175]
  ds_read_b64_tr_b16 v[236:237], v91 offset:19712
  ds_read_b64_tr_b16 v[238:239], v91 offset:20224
  s_mov_b32 vcc_lo, 0x33333333
  s_mov_b32 vcc_hi, 0x33333333
  v_cndmask_b32_dpp v48, v72, v64, vcc quad_perm:[2,3,0,1] row_mask:0xf bank_mask:0xf
  s_waitcnt lgkmcnt(4)
  v_mfma_f32_32x32x16_bf16 v[176:191], v[36:39], v[228:231], v[176:191]
  ds_read_b64_tr_b16 v[224:225], v91 offset:4096
  ds_read_b64_tr_b16 v[226:227], v91 offset:4608
  v_cndmask_b32_dpp v49, v73, v65, vcc quad_perm:[2,3,0,1] row_mask:0xf bank_mask:0xf
  v_cndmask_b32_dpp v50, v74, v66, vcc quad_perm:[2,3,0,1] row_mask:0xf bank_mask:0xf
  s_waitcnt lgkmcnt(4)
  v_mfma_f32_32x32x16_bf16 v[192:207], v[36:39], v[232:235], v[192:207]
  ds_read_b64_tr_b16 v[228:229], v91 offset:4352
  ds_read_b64_tr_b16 v[230:231], v91 offset:4864
  v_cndmask_b32_dpp v51, v75, v67, vcc quad_perm:[2,3,0,1] row_mask:0xf bank_mask:0xf
  v_cndmask_b32_dpp v52, v76, v68, vcc quad_perm:[2,3,0,1] row_mask:0xf bank_mask:0xf
  buffer_load_dwordx4 v[16:19], v249, s[8:11], s62 offen offset:0
  s_waitcnt lgkmcnt(4)
  v_mfma_f32_32x32x16_bf16 v[208:223], v[36:39], v[236:239], v[208:223]
  ds_read_b64_tr_b16 v[232:233], v91 offset:5120
  ds_read_b64_tr_b16 v[234:235], v91 offset:5632
  v_cndmask_b32_dpp v53, v77, v69, vcc quad_perm:[2,3,0,1] row_mask:0xf bank_mask:0xf
  v_cndmask_b32_dpp v54, v78, v70, vcc quad_perm:[2,3,0,1] row_mask:0xf bank_mask:0xf
  s_waitcnt lgkmcnt(4)
  v_mfma_f32_32x32x16_bf16 v[96:111], v[224:227], v[40:43], v[96:111]
  ds_read_b64_tr_b16 v[236:237], v91 offset:5376
  ds_read_b64_tr_b16 v[238:239], v91 offset:5888
  v_cndmask_b32_dpp v55, v79, v71, vcc quad_perm:[2,3,0,1] row_mask:0xf bank_mask:0xf
  s_mov_b32 vcc_lo, 0xcccccccc
  s_mov_b32 vcc_hi, 0xcccccccc
  s_waitcnt lgkmcnt(4)
  v_mfma_f32_32x32x16_bf16 v[112:127], v[228:231], v[40:43], v[112:127]
  ds_read_b64_tr_b16 v[224:225], v91 offset:20480
  ds_read_b64_tr_b16 v[226:227], v91 offset:20992
  v_cndmask_b32_dpp v56, v64, v72, vcc quad_perm:[2,3,0,1] row_mask:0xf bank_mask:0xf
  v_cndmask_b32_dpp v57, v65, v73, vcc quad_perm:[2,3,0,1] row_mask:0xf bank_mask:0xf
  s_waitcnt lgkmcnt(4)
  v_mfma_f32_32x32x16_bf16 v[128:143], v[232:235], v[40:43], v[128:143]
  ds_read_b64_tr_b16 v[228:229], v91 offset:20736
  ds_read_b64_tr_b16 v[230:231], v91 offset:21248
  v_cndmask_b32_dpp v58, v66, v74, vcc quad_perm:[2,3,0,1] row_mask:0xf bank_mask:0xf
  v_cndmask_b32_dpp v59, v67, v75, vcc quad_perm:[2,3,0,1] row_mask:0xf bank_mask:0xf
  buffer_load_dwordx4 v[20:23], v249, s[8:11], s62 offen offset:1024
  s_waitcnt lgkmcnt(4)
  v_mfma_f32_32x32x16_bf16 v[144:159], v[236:239], v[40:43], v[144:159]
  ds_read_b64_tr_b16 v[232:233], v91 offset:21504
  ds_read_b64_tr_b16 v[234:235], v91 offset:22016
  v_cndmask_b32_dpp v60, v68, v76, vcc quad_perm:[2,3,0,1] row_mask:0xf bank_mask:0xf
  v_cndmask_b32_dpp v61, v69, v77, vcc quad_perm:[2,3,0,1] row_mask:0xf bank_mask:0xf
  s_waitcnt lgkmcnt(4)
  v_mfma_f32_32x32x16_bf16 v[160:175], v[40:43], v[224:227], v[160:175]
  ds_read_b64_tr_b16 v[236:237], v91 offset:21760
  ds_read_b64_tr_b16 v[238:239], v91 offset:22272
  v_cndmask_b32_dpp v62, v70, v78, vcc quad_perm:[2,3,0,1] row_mask:0xf bank_mask:0xf
  v_cndmask_b32_dpp v63, v71, v79, vcc quad_perm:[2,3,0,1] row_mask:0xf bank_mask:0xf
  s_waitcnt lgkmcnt(4)
  v_mfma_f32_32x32x16_bf16 v[176:191], v[40:43], v[228:231], v[176:191]
  ds_read_b64_tr_b16 v[224:225], v91 offset:6144
  ds_read_b64_tr_b16 v[226:227], v91 offset:6656
  buffer_load_dwordx4 v[24:27], v249, s[8:11], s62 offen offset:2048
  s_waitcnt lgkmcnt(4)
  v_mfma_f32_32x32x16_bf16 v[192:207], v[40:43], v[232:235], v[192:207]
  ds_read_b64_tr_b16 v[228:229], v91 offset:6400
  ds_read_b64_tr_b16 v[230:231], v91 offset:6912
  s_waitcnt lgkmcnt(4)
  v_mfma_f32_32x32x16_bf16 v[208:223], v[40:43], v[236:239], v[208:223]
  ds_read_b64_tr_b16 v[232:233], v91 offset:7168
  ds_read_b64_tr_b16 v[234:235], v91 offset:7680
  s_waitcnt lgkmcnt(4)
  v_mfma_f32_32x32x16_bf16 v[96:111], v[224:227], v[44:47], v[96:111]
  ds_read_b64_tr_b16 v[236:237], v91 offset:7424
  ds_read_b64_tr_b16 v[238:239], v91 offset:7936
  s_waitcnt lgkmcnt(4)
  v_mfma_f32_32x32x16_bf16 v[112:127], v[228:231], v[44:47], v[112:127]
  ds_read_b64_tr_b16 v[224:225], v91 offset:22528
  ds_read_b64_tr_b16 v[226:227], v91 offset:23040
  buffer_load_dwordx4 v[28:31], v249, s[8:11], s62 offen offset:3072
  s_add_u32 s62, s62, 128
  s_and_b32 s62, s62, 1023
  s_or_b32 s62, s62, s48
  s_waitcnt lgkmcnt(4)
  v_mfma_f32_32x32x16_bf16 v[128:143], v[232:235], v[44:47], v[128:143]
  ds_read_b64_tr_b16 v[228:229], v91 offset:22784
  ds_read_b64_tr_b16 v[230:231], v91 offset:23296
  s_waitcnt lgkmcnt(4)
  v_mfma_f32_32x32x16_bf16 v[144:159], v[236:239], v[44:47], v[144:159]
  ds_read_b64_tr_b16 v[232:233], v91 offset:23552
  ds_read_b64_tr_b16 v[234:235], v91 offset:24064
  s_waitcnt lgkmcnt(4)
  v_mfma_f32_32x32x16_bf16 v[160:175], v[44:47], v[224:227], v[160:175]
  ds_read_b64_tr_b16 v[236:237], v91 offset:23808
  ds_read_b64_tr_b16 v[238:239], v91 offset:24320
  s_waitcnt lgkmcnt(4)
  v_mfma_f32_32x32x16_bf16 v[176:191], v[44:47], v[228:231], v[176:191]
  s_barrier
  ds_read_b64_tr_b16 v[224:225], v91 offset:32768
  ds_read_b64_tr_b16 v[226:227], v91 offset:33280
  s_waitcnt lgkmcnt(4)
  v_mfma_f32_32x32x16_bf16 v[192:207], v[44:47], v[232:235], v[192:207]
  ds_read_b64_tr_b16 v[228:229], v91 offset:33024
  ds_read_b64_tr_b16 v[230:231], v91 offset:33536
  s_waitcnt lgkmcnt(4)
  v_mfma_f32_32x32x16_bf16 v[208:223], v[44:47], v[236:239], v[208:223]
  ds_read_b64_tr_b16 v[232:233], v91 offset:33792
  ds_read_b64_tr_b16 v[234:235], v91 offset:34304
  s_waitcnt lgkmcnt(4)
  v_mfma_f32_32x32x16_bf16 v[96:111], v[224:227], v[48:51], v[96:111]
  ds_read_b64_tr_b16 v[236:237], v91 offset:34048
  ds_read_b64_tr_b16 v[238:239], v91 offset:34560
  s_add_u32 m0, s29, 65536
  s_nop 0
  buffer_load_dwordx4 v245, s[12:15], s27 offen  lds
  s_waitcnt lgkmcnt(4)
  v_mfma_f32_32x32x16_bf16 v[112:127], v[228:231], v[48:51], v[112:127]
  ds_read_b64_tr_b16 v[224:225], v91 offset:49152
  ds_read_b64_tr_b16 v[226:227], v91 offset:49664
  s_waitcnt lgkmcnt(4)
  v_mfma_f32_32x32x16_bf16 v[128:143], v[232:235], v[48:51], v[128:143]
  ds_read_b64_tr_b16 v[228:229], v91 offset:49408
  ds_read_b64_tr_b16 v[230:231], v91 offset:49920
  s_waitcnt lgkmcnt(4)
  v_mfma_f32_32x32x16_bf16 v[144:159], v[236:239], v[48:51], v[144:159]
  ds_read_b64_tr_b16 v[232:233], v91 offset:50176
  ds_read_b64_tr_b16 v[234:235], v91 offset:50688
  s_waitcnt vmcnt(9)
  s_mov_b32 vcc_lo, 0x55555555
  s_mov_b32 vcc_hi, 0x55555555
  v_cndmask_b32_dpp v64, v4, v0, vcc quad_perm:[1,0,3,2] row_mask:0xf bank_mask:0xf
  s_add_u32 m0, s30, 65536
  s_nop 0
  buffer_load_dwordx4 v246, s[12:15], s27 offen  lds
  s_waitcnt lgkmcnt(4)
  v_mfma_f32_32x32x16_bf16 v[160:175], v[48:51], v[224:227], v[160:175]
  ds_read_b64_tr_b16 v[236:237], v91 offset:50432
  ds_read_b64_tr_b16 v[238:239], v91 offset:50944
  v_cndmask_b32_dpp v65, v5, v1, vcc quad_perm:[1,0,3,2] row_mask:0xf bank_mask:0xf
  v_cndmask_b32_dpp v66, v6, v2, vcc quad_perm:[1,0,3,2] row_mask:0xf bank_mask:0xf
  s_waitcnt lgkmcnt(4)
  v_mfma_f32_32x32x16_bf16 v[176:191], v[48:51], v[228:231], v[176:191]
  ds_read_b64_tr_b16 v[224:225], v91 offset:34816
  ds_read_b64_tr_b16 v[226:227], v91 offset:35328
  v_cndmask_b32_dpp v67, v7, v3, vcc quad_perm:[1,0,3,2] row_mask:0xf bank_mask:0xf
  v_cndmask_b32_dpp v72, v12, v8, vcc quad_perm:[1,0,3,2] row_mask:0xf bank_mask:0xf
  s_waitcnt lgkmcnt(4)
  v_mfma_f32_32x32x16_bf16 v[192:207], v[48:51], v[232:235], v[192:207]
  ds_read_b64_tr_b16 v[228:229], v91 offset:35072
  ds_read_b64_tr_b16 v[230:231], v91 offset:35584
  v_cndmask_b32_dpp v73, v13, v9, vcc quad_perm:[1,0,3,2] row_mask:0xf bank_mask:0xf
  v_cndmask_b32_dpp v74, v14, v10, vcc quad_perm:[1,0,3,2] row_mask:0xf bank_mask:0xf
  s_waitcnt lgkmcnt(4)
  v_mfma_f32_32x32x16_bf16 v[208:223], v[48:51], v[236:239], v[208:223]
  ds_read_b64_tr_b16 v[232:233], v91 offset:35840
  ds_read_b64_tr_b16 v[234:235], v91 offset:36352
  v_cndmask_b32_dpp v75, v15, v11, vcc quad_perm:[1,0,3,2] row_mask:0xf bank_mask:0xf
  s_mov_b32 vcc_lo, 0xaaaaaaaa
  s_mov_b32 vcc_hi, 0xaaaaaaaa
  s_add_u32 m0, s31, 65536
  s_nop 0
  buffer_load_dwordx4 v247, s[12:15], s27 offen  lds
  s_waitcnt lgkmcnt(4)
  v_mfma_f32_32x32x16_bf16 v[96:111], v[224:227], v[52:55], v[96:111]
  ds_read_b64_tr_b16 v[236:237], v91 offset:36096
  ds_read_b64_tr_b16 v[238:239], v91 offset:36608
  v_cndmask_b32_dpp v68, v0, v4, vcc quad_perm:[1,0,3,2] row_mask:0xf bank_mask:0xf
  v_cndmask_b32_dpp v69, v1, v5, vcc quad_perm:[1,0,3,2] row_mask:0xf bank_mask:0xf
  s_waitcnt lgkmcnt(4)
  v_mfma_f32_32x32x16_bf16 v[112:127], v[228:231], v[52:55], v[112:127]
  ds_read_b64_tr_b16 v[224:225], v91 offset:51200
  ds_read_b64_tr_b16 v[226:227], v91 offset:51712
  v_cndmask_b32_dpp v70, v2, v6, vcc quad_perm:[1,0,3,2] row_mask:0xf bank_mask:0xf
  v_cndmask_b32_dpp v71, v3, v7, vcc quad_perm:[1,0,3,2] row_mask:0xf bank_mask:0xf
  s_waitcnt lgkmcnt(4)
  v_mfma_f32_32x32x16_bf16 v[128:143], v[232:235], v[52:55], v[128:143]
  ds_read_b64_tr_b16 v[228:229], v91 offset:51456
  ds_read_b64_tr_b16 v[230:231], v91 offset:51968
  v_cndmask_b32_dpp v76, v8, v12, vcc quad_perm:[1,0,3,2] row_mask:0xf bank_mask:0xf
  v_cndmask_b32_dpp v77, v9, v13, vcc quad_perm:[1,0,3,2] row_mask:0xf bank_mask:0xf
  s_add_u32 m0, s32, 65536
  s_nop 0
  buffer_load_dwordx4 v248, s[12:15], s27 offen  lds
  s_add_u32 s27, s27, s28
  s_cmp_eq_u32 s27, s101
  s_cselect_b32 s27, 0, s27
  s_waitcnt lgkmcnt(4)
  v_mfma_f32_32x32x16_bf16 v[144:159], v[236:239], v[52:55], v[144:159]
  ds_read_b64_tr_b16 v[232:233], v91 offset:52224
  ds_read_b64_tr_b16 v[234:235], v91 offset:52736
  v_cndmask_b32_dpp v78, v10, v14, vcc quad_perm:[1,0,3,2] row_mask:0xf bank_mask:0xf
  v_cndmask_b32_dpp v79, v11, v15, vcc quad_perm:[1,0,3,2] row_mask:0xf bank_mask:0xf
  s_waitcnt lgkmcnt(4)
  v_mfma_f32_32x32x16_bf16 v[160:175], v[52:55], v[224:227], v[160:175]
  ds_read_b64_tr_b16 v[236:237], v91 offset:52480
  ds_read_b64_tr_b16 v[238:239], v91 offset:52992
  s_mov_b32 vcc_lo, 0x33333333
  s_mov_b32 vcc_hi, 0x33333333
  v_cndmask_b32_dpp v0, v72, v64, vcc quad_perm:[2,3,0,1] row_mask:0xf bank_mask:0xf
  s_waitcnt lgkmcnt(4)
  v_mfma_f32_32x32x16_bf16 v[176:191], v[52:55], v[228:231], v[176:191]
  ds_read_b64_tr_b16 v[224:225], v91 offset:36864
  ds_read_b64_tr_b16 v[226:227], v91 offset:37376
  v_cndmask_b32_dpp v1, v73, v65, vcc quad_perm:[2,3,0,1] row_mask:0xf bank_mask:0xf
  v_cndmask_b32_dpp v2, v74, v66, vcc quad_perm:[2,3,0,1] row_mask:0xf bank_mask:0xf
  s_waitcnt lgkmcnt(4)
  v_mfma_f32_32x32x16_bf16 v[192:207], v[52:55], v[232:235], v[192:207]
  ds_read_b64_tr_b16 v[228:229], v91 offset:37120
  ds_read_b64_tr_b16 v[230:231], v91 offset:37632
  v_cndmask_b32_dpp v3, v75, v67, vcc quad_perm:[2,3,0,1] row_mask:0xf bank_mask:0xf
  v_cndmask_b32_dpp v4, v76, v68, vcc quad_perm:[2,3,0,1] row_mask:0xf bank_mask:0xf
  buffer_load_dwordx4 v[32:35], v249, s[8:11], s62 offen offset:0
  s_waitcnt lgkmcnt(4)
  v_mfma_f32_32x32x16_bf16 v[208:223], v[52:55], v[236:239], v[208:223]
  ds_read_b64_tr_b16 v[232:233], v91 offset:37888
  ds_read_b64_tr_b16 v[234:235], v91 offset:38400
  v_cndmask_b32_dpp v5, v77, v69, vcc quad_perm:[2,3,0,1] row_mask:0xf bank_mask:0xf
  v_cndmask_b32_dpp v6, v78, v70, vcc quad_perm:[2,3,0,1] row_mask:0xf bank_mask:0xf
  s_waitcnt lgkmcnt(4)
  v_mfma_f32_32x32x16_bf16 v[96:111], v[224:227], v[56:59], v[96:111]
  ds_read_b64_tr_b16 v[236:237], v91 offset:38144
  ds_read_b64_tr_b16 v[238:239], v91 offset:38656
  v_cndmask_b32_dpp v7, v79, v71, vcc quad_perm:[2,3,0,1] row_mask:0xf bank_mask:0xf
  s_mov_b32 vcc_lo, 0xcccccccc
  s_mov_b32 vcc_hi, 0xcccccccc
  s_waitcnt lgkmcnt(4)
  v_mfma_f32_32x32x16_bf16 v[112:127], v[228:231], v[56:59], v[112:127]
  ds_read_b64_tr_b16 v[224:225], v91 offset:53248
  ds_read_b64_tr_b16 v[226:227], v91 offset:53760
  v_cndmask_b32_dpp v8, v64, v72, vcc quad_perm:[2,3,0,1] row_mask:0xf bank_mask:0xf
  v_cndmask_b32_dpp v9, v65, v73, vcc quad_perm:[2,3,0,1] row_mask:0xf bank_mask:0xf
  s_waitcnt lgkmcnt(4)
  v_mfma_f32_32x32x16_bf16 v[128:143], v[232:235], v[56:59], v[128:143]
  ds_read_b64_tr_b16 v[228:229], v91 offset:53504
  ds_read_b64_tr_b16 v[230:231], v91 offset:54016
  v_cndmask_b32_dpp v10, v66, v74, vcc quad_perm:[2,3,0,1] row_mask:0xf bank_mask:0xf
  v_cndmask_b32_dpp v11, v67, v75, vcc quad_perm:[2,3,0,1] row_mask:0xf bank_mask:0xf
  buffer_load_dwordx4 v[36:39], v249, s[8:11], s62 offen offset:1024
  s_waitcnt lgkmcnt(4)
  v_mfma_f32_32x32x16_bf16 v[144:159], v[236:239], v[56:59], v[144:159]
  ds_read_b64_tr_b16 v[232:233], v91 offset:54272
  ds_read_b64_tr_b16 v[234:235], v91 offset:54784
  v_cndmask_b32_dpp v12, v68, v76, vcc quad_perm:[2,3,0,1] row_mask:0xf bank_mask:0xf
  v_cndmask_b32_dpp v13, v69, v77, vcc quad_perm:[2,3,0,1] row_mask:0xf bank_mask:0xf
  s_waitcnt lgkmcnt(4)
  v_mfma_f32_32x32x16_bf16 v[160:175], v[56:59], v[224:227], v[160:175]
  ds_read_b64_tr_b16 v[236:237], v91 offset:54528
  ds_read_b64_tr_b16 v[238:239], v91 offset:55040
  v_cndmask_b32_dpp v14, v70, v78, vcc quad_perm:[2,3,0,1] row_mask:0xf bank_mask:0xf
  v_cndmask_b32_dpp v15, v71, v79, vcc quad_perm:[2,3,0,1] row_mask:0xf bank_mask:0xf
  s_waitcnt lgkmcnt(4)
  v_mfma_f32_32x32x16_bf16 v[176:191], v[56:59], v[228:231], v[176:191]
  ds_read_b64_tr_b16 v[224:225], v91 offset:38912
  ds_read_b64_tr_b16 v[226:227], v91 offset:39424
  buffer_load_dwordx4 v[40:43], v249, s[8:11], s62 offen offset:2048
  s_waitcnt lgkmcnt(4)
  v_mfma_f32_32x32x16_bf16 v[192:207], v[56:59], v[232:235], v[192:207]
  ds_read_b64_tr_b16 v[228:229], v91 offset:39168
  ds_read_b64_tr_b16 v[230:231], v91 offset:39680
  s_waitcnt lgkmcnt(4)
  v_mfma_f32_32x32x16_bf16 v[208:223], v[56:59], v[236:239], v[208:223]
  ds_read_b64_tr_b16 v[232:233], v91 offset:39936
  ds_read_b64_tr_b16 v[234:235], v91 offset:40448
  s_waitcnt lgkmcnt(4)
  v_mfma_f32_32x32x16_bf16 v[96:111], v[224:227], v[60:63], v[96:111]
  ds_read_b64_tr_b16 v[236:237], v91 offset:40192
  ds_read_b64_tr_b16 v[238:239], v91 offset:40704
  s_waitcnt lgkmcnt(4)
  v_mfma_f32_32x32x16_bf16 v[112:127], v[228:231], v[60:63], v[112:127]
  ds_read_b64_tr_b16 v[224:225], v91 offset:55296
  ds_read_b64_tr_b16 v[226:227], v91 offset:55808
  buffer_load_dwordx4 v[44:47], v249, s[8:11], s62 offen offset:3072
  s_add_u32 s62, s62, 128
  s_and_b32 s62, s62, 1023
  s_or_b32 s62, s62, s48
  s_waitcnt lgkmcnt(4)
  v_mfma_f32_32x32x16_bf16 v[128:143], v[232:235], v[60:63], v[128:143]
  ds_read_b64_tr_b16 v[228:229], v91 offset:55552
  ds_read_b64_tr_b16 v[230:231], v91 offset:56064
  s_waitcnt lgkmcnt(4)
  v_mfma_f32_32x32x16_bf16 v[144:159], v[236:239], v[60:63], v[144:159]
  ds_read_b64_tr_b16 v[232:233], v91 offset:56320
  ds_read_b64_tr_b16 v[234:235], v91 offset:56832
  s_waitcnt lgkmcnt(4)
  v_mfma_f32_32x32x16_bf16 v[160:175], v[60:63], v[224:227], v[160:175]
  ds_read_b64_tr_b16 v[236:237], v91 offset:56576
  ds_read_b64_tr_b16 v[238:239], v91 offset:57088
  s_waitcnt lgkmcnt(4)
  v_mfma_f32_32x32x16_bf16 v[176:191], v[60:63], v[228:231], v[176:191]
  s_barrier
  ds_read_b64_tr_b16 v[224:225], v90 offset:0
  ds_read_b64_tr_b16 v[226:227], v90 offset:512
  s_waitcnt lgkmcnt(4)
  v_mfma_f32_32x32x16_bf16 v[192:207], v[60:63], v[232:235], v[192:207]
  ds_read_b64_tr_b16 v[228:229], v90 offset:256
  ds_read_b64_tr_b16 v[230:231], v90 offset:768
  s_waitcnt lgkmcnt(4)
  v_mfma_f32_32x32x16_bf16 v[208:223], v[60:63], v[236:239], v[208:223]
  ds_read_b64_tr_b16 v[232:233], v90 offset:1024
  ds_read_b64_tr_b16 v[234:235], v90 offset:1536
  s_waitcnt lgkmcnt(4)
  v_mfma_f32_32x32x16_bf16 v[96:111], v[224:227], v[0:3], v[96:111]
  ds_read_b64_tr_b16 v[236:237], v90 offset:1280
  ds_read_b64_tr_b16 v[238:239], v90 offset:1792
  s_add_u32 m0, s29, 98304
  s_nop 0
  buffer_load_dwordx4 v245, s[12:15], s27 offen  lds
  s_waitcnt lgkmcnt(4)
  v_mfma_f32_32x32x16_bf16 v[112:127], v[228:231], v[0:3], v[112:127]
  ds_read_b64_tr_b16 v[224:225], v90 offset:16384
  ds_read_b64_tr_b16 v[226:227], v90 offset:16896
  s_waitcnt lgkmcnt(4)
  v_mfma_f32_32x32x16_bf16 v[128:143], v[232:235], v[0:3], v[128:143]
  ds_read_b64_tr_b16 v[228:229], v90 offset:16640
  ds_read_b64_tr_b16 v[230:231], v90 offset:17152
  s_waitcnt lgkmcnt(4)
  v_mfma_f32_32x32x16_bf16 v[144:159], v[236:239], v[0:3], v[144:159]
  ds_read_b64_tr_b16 v[232:233], v90 offset:17408
  ds_read_b64_tr_b16 v[234:235], v90 offset:17920
  s_waitcnt vmcnt(9)
  s_mov_b32 vcc_lo, 0x55555555
  s_mov_b32 vcc_hi, 0x55555555
  v_cndmask_b32_dpp v64, v20, v16, vcc quad_perm:[1,0,3,2] row_mask:0xf bank_mask:0xf
  s_add_u32 m0, s30, 98304
  s_nop 0
  buffer_load_dwordx4 v246, s[12:15], s27 offen  lds
  s_waitcnt lgkmcnt(4)
  v_mfma_f32_32x32x16_bf16 v[160:175], v[0:3], v[224:227], v[160:175]
  ds_read_b64_tr_b16 v[236:237], v90 offset:17664
  ds_read_b64_tr_b16 v[238:239], v90 offset:18176
  v_cndmask_b32_dpp v65, v21, v17, vcc quad_perm:[1,0,3,2] row_mask:0xf bank_mask:0xf
  v_cndmask_b32_dpp v66, v22, v18, vcc quad_perm:[1,0,3,2] row_mask:0xf bank_mask:0xf
  s_waitcnt lgkmcnt(4)
  v_mfma_f32_32x32x16_bf16 v[176:191], v[0:3], v[228:231], v[176:191]
  ds_read_b64_tr_b16 v[224:225], v90 offset:2048
  ds_read_b64_tr_b16 v[226:227], v90 offset:2560
  v_cndmask_b32_dpp v67, v23, v19, vcc quad_perm:[1,0,3,2] row_mask:0xf bank_mask:0xf
  v_cndmask_b32_dpp v72, v28, v24, vcc quad_perm:[1,0,3,2] row_mask:0xf bank_mask:0xf
  s_waitcnt lgkmcnt(4)
  v_mfma_f32_32x32x16_bf16 v[192:207], v[0:3], v[232:235], v[192:207]
  ds_read_b64_tr_b16 v[228:229], v90 offset:2304
  ds_read_b64_tr_b16 v[230:231], v90 offset:2816
  v_cndmask_b32_dpp v73, v29, v25, vcc quad_perm:[1,0,3,2] row_mask:0xf bank_mask:0xf
  v_cndmask_b32_dpp v74, v30, v26, vcc quad_perm:[1,0,3,2] row_mask:0xf bank_mask:0xf
  s_waitcnt lgkmcnt(4)
  v_mfma_f32_32x32x16_bf16 v[208:223], v[0:3], v[236:239], v[208:223]
  ds_read_b64_tr_b16 v[232:233], v90 offset:3072
  ds_read_b64_tr_b16 v[234:235], v90 offset:3584
  v_cndmask_b32_dpp v75, v31, v27, vcc quad_perm:[1,0,3,2] row_mask:0xf bank_mask:0xf
  s_mov_b32 vcc_lo, 0xaaaaaaaa
  s_mov_b32 vcc_hi, 0xaaaaaaaa
  s_add_u32 m0, s31, 98304
  s_nop 0
  buffer_load_dwordx4 v247, s[12:15], s27 offen  lds
  s_waitcnt lgkmcnt(4)
  v_mfma_f32_32x32x16_bf16 v[96:111], v[224:227], v[4:7], v[96:111]
  ds_read_b64_tr_b16 v[236:237], v90 offset:3328
  ds_read_b64_tr_b16 v[238:239], v90 offset:3840
  v_cndmask_b32_dpp v68, v16, v20, vcc quad_perm:[1,0,3,2] row_mask:0xf bank_mask:0xf
  v_cndmask_b32_dpp v69, v17, v21, vcc quad_perm:[1,0,3,2] row_mask:0xf bank_mask:0xf
  s_waitcnt lgkmcnt(4)
  v_mfma_f32_32x32x16_bf16 v[112:127], v[228:231], v[4:7], v[112:127]
  ds_read_b64_tr_b16 v[224:225], v90 offset:18432
  ds_read_b64_tr_b16 v[226:227], v90 offset:18944
  v_cndmask_b32_dpp v70, v18, v22, vcc quad_perm:[1,0,3,2] row_mask:0xf bank_mask:0xf
  v_cndmask_b32_dpp v71, v19, v23, vcc quad_perm:[1,0,3,2] row_mask:0xf bank_mask:0xf
  s_waitcnt lgkmcnt(4)
  v_mfma_f32_32x32x16_bf16 v[128:143], v[232:235], v[4:7], v[128:143]
  ds_read_b64_tr_b16 v[228:229], v90 offset:18688
  ds_read_b64_tr_b16 v[230:231], v90 offset:19200
  v_cndmask_b32_dpp v76, v24, v28, vcc quad_perm:[1,0,3,2] row_mask:0xf bank_mask:0xf
  v_cndmask_b32_dpp v77, v25, v29, vcc quad_perm:[1,0,3,2] row_mask:0xf bank_mask:0xf
  s_add_u32 m0, s32, 98304
  s_nop 0
  buffer_load_dwordx4 v248, s[12:15], s27 offen  lds
  s_add_u32 s27, s27, s28
  s_cmp_eq_u32 s27, s101
  s_cselect_b32 s27, 0, s27
  s_waitcnt lgkmcnt(4)
  v_mfma_f32_32x32x16_bf16 v[144:159], v[236:239], v[4:7], v[144:159]
  ds_read_b64_tr_b16 v[232:233], v90 offset:19456
  ds_read_b64_tr_b16 v[234:235], v90 offset:19968
  s_mov_b32 s12, s40
  s_mov_b32 s13, s41
  s_waitcnt lgkmcnt(4)
  v_mfma_f32_32x32x16_bf16 v[160:175], v[4:7], v[224:227], v[160:175]
  ds_read_b64_tr_b16 v[236:237], v90 offset:19712
  ds_read_b64_tr_b16 v[238:239], v90 offset:20224
  s_mov_b32 s14, s42
  s_mov_b32 s28, s79
  s_waitcnt lgkmcnt(4)
  v_mfma_f32_32x32x16_bf16 v[176:191], v[4:7], v[228:231], v[176:191]
  ds_read_b64_tr_b16 v[224:225], v90 offset:4096
  ds_read_b64_tr_b16 v[226:227], v90 offset:4608
  s_mov_b32 s101, s38
  s_mov_b32 s27, s39
  s_waitcnt lgkmcnt(4)
  v_mfma_f32_32x32x16_bf16 v[192:207], v[4:7], v[232:235], v[192:207]
  ds_read_b64_tr_b16 v[228:229], v90 offset:4352
  ds_read_b64_tr_b16 v[230:231], v90 offset:4864
  s_mov_b32 s29, s43
  v_mov_b32 v245, v92
  buffer_load_dword v251, off, s[96:99], s76 offset:0 sc1
  buffer_load_dwordx4 v[48:51], v249, s[8:11], s62 offen offset:0
  s_waitcnt lgkmcnt(4)
  v_mfma_f32_32x32x16_bf16 v[208:223], v[4:7], v[236:239], v[208:223]
  ds_read_b64_tr_b16 v[232:233], v90 offset:5120
  ds_read_b64_tr_b16 v[234:235], v90 offset:5632
  s_mov_b32 s30, s44
  v_mov_b32 v246, v93
  s_waitcnt lgkmcnt(4)
  v_mfma_f32_32x32x16_bf16 v[96:111], v[224:227], v[8:11], v[96:111]
  ds_read_b64_tr_b16 v[236:237], v90 offset:5376
  ds_read_b64_tr_b16 v[238:239], v90 offset:5888
  s_mov_b32 s31, s45
  v_mov_b32 v247, v94
  s_waitcnt lgkmcnt(4)
  v_mfma_f32_32x32x16_bf16 v[112:127], v[228:231], v[8:11], v[112:127]
  ds_read_b64_tr_b16 v[224:225], v90 offset:20480
  ds_read_b64_tr_b16 v[226:227], v90 offset:20992
  s_mov_b32 s32, s78
  v_mov_b32 v248, v95
  s_waitcnt lgkmcnt(4)
  v_mfma_f32_32x32x16_bf16 v[128:143], v[232:235], v[8:11], v[128:143]
  ds_read_b64_tr_b16 v[228:229], v90 offset:20736
  ds_read_b64_tr_b16 v[230:231], v90 offset:21248
  v_cndmask_b32_dpp v78, v26, v30, vcc quad_perm:[1,0,3,2] row_mask:0xf bank_mask:0xf
  v_cndmask_b32_dpp v79, v27, v31, vcc quad_perm:[1,0,3,2] row_mask:0xf bank_mask:0xf
  buffer_load_dwordx4 v[52:55], v249, s[8:11], s62 offen offset:1024
  s_waitcnt lgkmcnt(4)
  v_mfma_f32_32x32x16_bf16 v[144:159], v[236:239], v[8:11], v[144:159]
  ds_read_b64_tr_b16 v[232:233], v90 offset:21504
  ds_read_b64_tr_b16 v[234:235], v90 offset:22016
  s_mov_b32 vcc_lo, 0x33333333
  s_mov_b32 vcc_hi, 0x33333333
  v_cndmask_b32_dpp v16, v72, v64, vcc quad_perm:[2,3,0,1] row_mask:0xf bank_mask:0xf
  s_waitcnt lgkmcnt(4)
  v_mfma_f32_32x32x16_bf16 v[160:175], v[8:11], v[224:227], v[160:175]
  ds_read_b64_tr_b16 v[236:237], v90 offset:21760
  ds_read_b64_tr_b16 v[238:239], v90 offset:22272
  v_cndmask_b32_dpp v17, v73, v65, vcc quad_perm:[2,3,0,1] row_mask:0xf bank_mask:0xf
  v_cndmask_b32_dpp v18, v74, v66, vcc quad_perm:[2,3,0,1] row_mask:0xf bank_mask:0xf
  s_waitcnt lgkmcnt(4)
  v_mfma_f32_32x32x16_bf16 v[176:191], v[8:11], v[228:231], v[176:191]
  ds_read_b64_tr_b16 v[224:225], v90 offset:6144
  ds_read_b64_tr_b16 v[226:227], v90 offset:6656
  v_cndmask_b32_dpp v19, v75, v67, vcc quad_perm:[2,3,0,1] row_mask:0xf bank_mask:0xf
  v_cndmask_b32_dpp v20, v76, v68, vcc quad_perm:[2,3,0,1] row_mask:0xf bank_mask:0xf
  buffer_load_dwordx4 v[56:59], v249, s[8:11], s62 offen offset:2048
  s_waitcnt lgkmcnt(4)
  v_mfma_f32_32x32x16_bf16 v[192:207], v[8:11], v[232:235], v[192:207]
  ds_read_b64_tr_b16 v[228:229], v90 offset:6400
  ds_read_b64_tr_b16 v[230:231], v90 offset:6912
  v_cndmask_b32_dpp v21, v77, v69, vcc quad_perm:[2,3,0,1] row_mask:0xf bank_mask:0xf
  v_cndmask_b32_dpp v22, v78, v70, vcc quad_perm:[2,3,0,1] row_mask:0xf bank_mask:0xf
  s_waitcnt lgkmcnt(4)
  v_mfma_f32_32x32x16_bf16 v[208:223], v[8:11], v[236:239], v[208:223]
  ds_read_b64_tr_b16 v[232:233], v90 offset:7168
  ds_read_b64_tr_b16 v[234:235], v90 offset:7680
  v_cndmask_b32_dpp v23, v79, v71, vcc quad_perm:[2,3,0,1] row_mask:0xf bank_mask:0xf
  s_mov_b32 vcc_lo, 0xcccccccc
  s_mov_b32 vcc_hi, 0xcccccccc
  s_waitcnt lgkmcnt(4)
  v_mfma_f32_32x32x16_bf16 v[96:111], v[224:227], v[12:15], v[96:111]
  ds_read_b64_tr_b16 v[236:237], v90 offset:7424
  ds_read_b64_tr_b16 v[238:239], v90 offset:7936
  v_cndmask_b32_dpp v24, v64, v72, vcc quad_perm:[2,3,0,1] row_mask:0xf bank_mask:0xf
  v_cndmask_b32_dpp v25, v65, v73, vcc quad_perm:[2,3,0,1] row_mask:0xf bank_mask:0xf
  s_waitcnt lgkmcnt(4)
  v_mfma_f32_32x32x16_bf16 v[112:127], v[228:231], v[12:15], v[112:127]
  ds_read_b64_tr_b16 v[224:225], v90 offset:22528
  ds_read_b64_tr_b16 v[226:227], v90 offset:23040
  v_cndmask_b32_dpp v26, v66, v74, vcc quad_perm:[2,3,0,1] row_mask:0xf bank_mask:0xf
  v_cndmask_b32_dpp v27, v67, v75, vcc quad_perm:[2,3,0,1] row_mask:0xf bank_mask:0xf
  buffer_load_dwordx4 v[60:63], v249, s[8:11], s62 offen offset:3072
  s_add_u32 s62, s62, 128
  s_and_b32 s62, s62, 1023
  s_or_b32 s62, s62, s48
  s_waitcnt lgkmcnt(4)
  v_mfma_f32_32x32x16_bf16 v[128:143], v[232:235], v[12:15], v[128:143]
  ds_read_b64_tr_b16 v[228:229], v90 offset:22784
  ds_read_b64_tr_b16 v[230:231], v90 offset:23296
  v_cndmask_b32_dpp v28, v68, v76, vcc quad_perm:[2,3,0,1] row_mask:0xf bank_mask:0xf
  v_cndmask_b32_dpp v29, v69, v77, vcc quad_perm:[2,3,0,1] row_mask:0xf bank_mask:0xf
  s_waitcnt lgkmcnt(4)
  v_mfma_f32_32x32x16_bf16 v[144:159], v[236:239], v[12:15], v[144:159]
  ds_read_b64_tr_b16 v[232:233], v90 offset:23552
  ds_read_b64_tr_b16 v[234:235], v90 offset:24064
  v_cndmask_b32_dpp v30, v70, v78, vcc quad_perm:[2,3,0,1] row_mask:0xf bank_mask:0xf
  v_cndmask_b32_dpp v31, v71, v79, vcc quad_perm:[2,3,0,1] row_mask:0xf bank_mask:0xf
  s_waitcnt lgkmcnt(4)
  v_mfma_f32_32x32x16_bf16 v[160:175], v[12:15], v[224:227], v[160:175]
  ds_read_b64_tr_b16 v[236:237], v90 offset:23808
  ds_read_b64_tr_b16 v[238:239], v90 offset:24320
  s_mov_b32 s8, s60
  s_mov_b32 s9, s61
  s_waitcnt lgkmcnt(4)
  v_mfma_f32_32x32x16_bf16 v[176:191], v[12:15], v[228:231], v[176:191]
  s_barrier
  ds_read_b64_tr_b16 v[224:225], v90 offset:32768
  ds_read_b64_tr_b16 v[226:227], v90 offset:33280
  s_mov_b32 s48, s49
  s_lshl_b32 s62, s3, 12
  s_waitcnt lgkmcnt(4)
  v_mfma_f32_32x32x16_bf16 v[192:207], v[12:15], v[232:235], v[192:207]
  ds_read_b64_tr_b16 v[228:229], v90 offset:33024
  ds_read_b64_tr_b16 v[230:231], v90 offset:33536
  s_or_b32 s62, s62, s48
  s_waitcnt lgkmcnt(4)
  v_mfma_f32_32x32x16_bf16 v[208:223], v[12:15], v[236:239], v[208:223]
  ds_read_b64_tr_b16 v[232:233], v90 offset:33792
  ds_read_b64_tr_b16 v[234:235], v90 offset:34304
  s_waitcnt lgkmcnt(4)
  v_mfma_f32_32x32x16_bf16 v[96:111], v[224:227], v[16:19], v[96:111]
  ds_read_b64_tr_b16 v[236:237], v90 offset:34048
  ds_read_b64_tr_b16 v[238:239], v90 offset:34560
  s_add_u32 m0, s29, 0
  s_nop 0
  buffer_load_dwordx4 v245, s[12:15], s27 offen  lds
  s_waitcnt lgkmcnt(4)
  v_mfma_f32_32x32x16_bf16 v[112:127], v[228:231], v[16:19], v[112:127]
  ds_read_b64_tr_b16 v[224:225], v90 offset:49152
  ds_read_b64_tr_b16 v[226:227], v90 offset:49664
  s_waitcnt lgkmcnt(4)
  v_mfma_f32_32x32x16_bf16 v[128:143], v[232:235], v[16:19], v[128:143]
  ds_read_b64_tr_b16 v[228:229], v90 offset:49408
  ds_read_b64_tr_b16 v[230:231], v90 offset:49920
  s_waitcnt lgkmcnt(4)
  v_mfma_f32_32x32x16_bf16 v[144:159], v[236:239], v[16:19], v[144:159]
  ds_read_b64_tr_b16 v[232:233], v90 offset:50176
  ds_read_b64_tr_b16 v[234:235], v90 offset:50688
  s_waitcnt vmcnt(10)
  s_mov_b32 vcc_lo, 0x55555555
  s_mov_b32 vcc_hi, 0x55555555
  v_cndmask_b32_dpp v64, v36, v32, vcc quad_perm:[1,0,3,2] row_mask:0xf bank_mask:0xf
  s_add_u32 m0, s30, 0
  s_nop 0
  buffer_load_dwordx4 v246, s[12:15], s27 offen  lds
  s_waitcnt lgkmcnt(4)
  v_mfma_f32_32x32x16_bf16 v[160:175], v[16:19], v[224:227], v[160:175]
  ds_read_b64_tr_b16 v[236:237], v90 offset:50432
  ds_read_b64_tr_b16 v[238:239], v90 offset:50944
  v_cndmask_b32_dpp v65, v37, v33, vcc quad_perm:[1,0,3,2] row_mask:0xf bank_mask:0xf
  v_cndmask_b32_dpp v66, v38, v34, vcc quad_perm:[1,0,3,2] row_mask:0xf bank_mask:0xf
  s_waitcnt lgkmcnt(4)
  v_mfma_f32_32x32x16_bf16 v[176:191], v[16:19], v[228:231], v[176:191]
  ds_read_b64_tr_b16 v[224:225], v90 offset:34816
  ds_read_b64_tr_b16 v[226:227], v90 offset:35328
  v_cndmask_b32_dpp v67, v39, v35, vcc quad_perm:[1,0,3,2] row_mask:0xf bank_mask:0xf
  v_cndmask_b32_dpp v72, v44, v40, vcc quad_perm:[1,0,3,2] row_mask:0xf bank_mask:0xf
  s_waitcnt lgkmcnt(4)
  v_mfma_f32_32x32x16_bf16 v[192:207], v[16:19], v[232:235], v[192:207]
  ds_read_b64_tr_b16 v[228:229], v90 offset:35072
  ds_read_b64_tr_b16 v[230:231], v90 offset:35584
  v_cndmask_b32_dpp v73, v45, v41, vcc quad_perm:[1,0,3,2] row_mask:0xf bank_mask:0xf
  v_cndmask_b32_dpp v74, v46, v42, vcc quad_perm:[1,0,3,2] row_mask:0xf bank_mask:0xf
  s_waitcnt lgkmcnt(4)
  v_mfma_f32_32x32x16_bf16 v[208:223], v[16:19], v[236:239], v[208:223]
  ds_read_b64_tr_b16 v[232:233], v90 offset:35840
  ds_read_b64_tr_b16 v[234:235], v90 offset:36352
  v_cndmask_b32_dpp v75, v47, v43, vcc quad_perm:[1,0,3,2] row_mask:0xf bank_mask:0xf
  s_mov_b32 vcc_lo, 0xaaaaaaaa
  s_mov_b32 vcc_hi, 0xaaaaaaaa
  s_add_u32 m0, s31, 0
  s_nop 0
  buffer_load_dwordx4 v247, s[12:15], s27 offen  lds
  s_waitcnt lgkmcnt(4)
  v_mfma_f32_32x32x16_bf16 v[96:111], v[224:227], v[20:23], v[96:111]
  ds_read_b64_tr_b16 v[236:237], v90 offset:36096
  ds_read_b64_tr_b16 v[238:239], v90 offset:36608
  v_cndmask_b32_dpp v68, v32, v36, vcc quad_perm:[1,0,3,2] row_mask:0xf bank_mask:0xf
  v_cndmask_b32_dpp v69, v33, v37, vcc quad_perm:[1,0,3,2] row_mask:0xf bank_mask:0xf
  s_waitcnt lgkmcnt(4)
  v_mfma_f32_32x32x16_bf16 v[112:127], v[228:231], v[20:23], v[112:127]
  ds_read_b64_tr_b16 v[224:225], v90 offset:51200
  ds_read_b64_tr_b16 v[226:227], v90 offset:51712
  v_cndmask_b32_dpp v70, v34, v38, vcc quad_perm:[1,0,3,2] row_mask:0xf bank_mask:0xf
  v_cndmask_b32_dpp v71, v35, v39, vcc quad_perm:[1,0,3,2] row_mask:0xf bank_mask:0xf
  s_waitcnt lgkmcnt(4)
  v_mfma_f32_32x32x16_bf16 v[128:143], v[232:235], v[20:23], v[128:143]
  ds_read_b64_tr_b16 v[228:229], v90 offset:51456
  ds_read_b64_tr_b16 v[230:231], v90 offset:51968
  v_cndmask_b32_dpp v76, v40, v44, vcc quad_perm:[1,0,3,2] row_mask:0xf bank_mask:0xf
  v_cndmask_b32_dpp v77, v41, v45, vcc quad_perm:[1,0,3,2] row_mask:0xf bank_mask:0xf
  s_add_u32 m0, s32, 0
  s_nop 0
  buffer_load_dwordx4 v248, s[12:15], s27 offen  lds
  s_add_u32 s27, s27, s28
  s_cmp_eq_u32 s27, s101
  s_cselect_b32 s27, 0, s27
  s_waitcnt lgkmcnt(4)
  v_mfma_f32_32x32x16_bf16 v[144:159], v[236:239], v[20:23], v[144:159]
  ds_read_b64_tr_b16 v[232:233], v90 offset:52224
  ds_read_b64_tr_b16 v[234:235], v90 offset:52736
  v_cndmask_b32_dpp v78, v42, v46, vcc quad_perm:[1,0,3,2] row_mask:0xf bank_mask:0xf
  v_cndmask_b32_dpp v79, v43, v47, vcc quad_perm:[1,0,3,2] row_mask:0xf bank_mask:0xf
  s_waitcnt lgkmcnt(4)
  v_mfma_f32_32x32x16_bf16 v[160:175], v[20:23], v[224:227], v[160:175]
  ds_read_b64_tr_b16 v[236:237], v90 offset:52480
  ds_read_b64_tr_b16 v[238:239], v90 offset:52992
  s_mov_b32 vcc_lo, 0x33333333
  s_mov_b32 vcc_hi, 0x33333333
  v_cndmask_b32_dpp v32, v72, v64, vcc quad_perm:[2,3,0,1] row_mask:0xf bank_mask:0xf
  s_waitcnt lgkmcnt(4)
  v_mfma_f32_32x32x16_bf16 v[176:191], v[20:23], v[228:231], v[176:191]
  ds_read_b64_tr_b16 v[224:225], v90 offset:36864
  ds_read_b64_tr_b16 v[226:227], v90 offset:37376
  v_cndmask_b32_dpp v33, v73, v65, vcc quad_perm:[2,3,0,1] row_mask:0xf bank_mask:0xf
  v_cndmask_b32_dpp v34, v74, v66, vcc quad_perm:[2,3,0,1] row_mask:0xf bank_mask:0xf
  s_waitcnt lgkmcnt(4)
  v_mfma_f32_32x32x16_bf16 v[192:207], v[20:23], v[232:235], v[192:207]
  ds_read_b64_tr_b16 v[228:229], v90 offset:37120
  ds_read_b64_tr_b16 v[230:231], v90 offset:37632
  v_cndmask_b32_dpp v35, v75, v67, vcc quad_perm:[2,3,0,1] row_mask:0xf bank_mask:0xf
  v_cndmask_b32_dpp v36, v76, v68, vcc quad_perm:[2,3,0,1] row_mask:0xf bank_mask:0xf
  s_waitcnt vmcnt(8)
  v_readfirstlane_b32 s100, v251
  s_bfe_u32 s100, s100, 524304
  s_cmp_lt_u32 s100, 32
  s_cbranch_scc1 pc_spin2
pc_back2:
  buffer_load_dwordx4 v[0:3], v250, s[8:11], s62 offen offset:0 sc1
  s_waitcnt lgkmcnt(4)
  v_mfma_f32_32x32x16_bf16 v[208:223], v[20:23], v[236:239], v[208:223]
  ds_read_b64_tr_b16 v[232:233], v90 offset:37888
  ds_read_b64_tr_b16 v[234:235], v90 offset:38400
  v_cndmask_b32_dpp v37, v77, v69, vcc quad_perm:[2,3,0,1] row_mask:0xf bank_mask:0xf
  v_cndmask_b32_dpp v38, v78, v70, vcc quad_perm:[2,3,0,1] row_mask:0xf bank_mask:0xf
  s_waitcnt lgkmcnt(4)
  v_mfma_f32_32x32x16_bf16 v[96:111], v[224:227], v[24:27], v[96:111]
  ds_read_b64_tr_b16 v[236:237], v90 offset:38144
  ds_read_b64_tr_b16 v[238:239], v90 offset:38656
  v_cndmask_b32_dpp v39, v79, v71, vcc quad_perm:[2,3,0,1] row_mask:0xf bank_mask:0xf
  s_mov_b32 vcc_lo, 0xcccccccc
  s_mov_b32 vcc_hi, 0xcccccccc
  s_waitcnt lgkmcnt(4)
  v_mfma_f32_32x32x16_bf16 v[112:127], v[228:231], v[24:27], v[112:127]
  ds_read_b64_tr_b16 v[224:225], v90 offset:53248
  ds_read_b64_tr_b16 v[226:227], v90 offset:53760
  v_cndmask_b32_dpp v40, v64, v72, vcc quad_perm:[2,3,0,1] row_mask:0xf bank_mask:0xf
  v_cndmask_b32_dpp v41, v65, v73, vcc quad_perm:[2,3,0,1] row_mask:0xf bank_mask:0xf
  s_waitcnt lgkmcnt(4)
  v_mfma_f32_32x32x16_bf16 v[128:143], v[232:235], v[24:27], v[128:143]
  ds_read_b64_tr_b16 v[228:229], v90 offset:53504
  ds_read_b64_tr_b16 v[230:231], v90 offset:54016
  v_cndmask_b32_dpp v42, v66, v74, vcc quad_perm:[2,3,0,1] row_mask:0xf bank_mask:0xf
  v_cndmask_b32_dpp v43, v67, v75, vcc quad_perm:[2,3,0,1] row_mask:0xf bank_mask:0xf
  buffer_load_dwordx4 v[4:7], v250, s[8:11], s62 offen offset:1024 sc1
  s_waitcnt lgkmcnt(4)
  v_mfma_f32_32x32x16_bf16 v[144:159], v[236:239], v[24:27], v[144:159]
  ds_read_b64_tr_b16 v[232:233], v90 offset:54272
  ds_read_b64_tr_b16 v[234:235], v90 offset:54784
  v_cndmask_b32_dpp v44, v68, v76, vcc quad_perm:[2,3,0,1] row_mask:0xf bank_mask:0xf
  v_cndmask_b32_dpp v45, v69, v77, vcc quad_perm:[2,3,0,1] row_mask:0xf bank_mask:0xf
  s_waitcnt lgkmcnt(4)
  v_mfma_f32_32x32x16_bf16 v[160:175], v[24:27], v[224:227], v[160:175]
  ds_read_b64_tr_b16 v[236:237], v90 offset:54528
  ds_read_b64_tr_b16 v[238:239], v90 offset:55040
  v_cndmask_b32_dpp v46, v70, v78, vcc quad_perm:[2,3,0,1] row_mask:0xf bank_mask:0xf
  v_cndmask_b32_dpp v47, v71, v79, vcc quad_perm:[2,3,0,1] row_mask:0xf bank_mask:0xf
  s_waitcnt lgkmcnt(4)
  v_mfma_f32_32x32x16_bf16 v[176:191], v[24:27], v[228:231], v[176:191]
  ds_read_b64_tr_b16 v[224:225], v90 offset:38912
  ds_read_b64_tr_b16 v[226:227], v90 offset:39424
  buffer_load_dwordx4 v[8:11], v250, s[8:11], s62 offen offset:2048 sc1
  s_waitcnt lgkmcnt(4)
  v_mfma_f32_32x32x16_bf16 v[192:207], v[24:27], v[232:235], v[192:207]
  ds_read_b64_tr_b16 v[228:229], v90 offset:39168
  ds_read_b64_tr_b16 v[230:231], v90 offset:39680
  s_waitcnt lgkmcnt(4)
  v_mfma_f32_32x32x16_bf16 v[208:223], v[24:27], v[236:239], v[208:223]
  ds_read_b64_tr_b16 v[232:233], v90 offset:39936
  ds_read_b64_tr_b16 v[234:235], v90 offset:40448
  s_waitcnt lgkmcnt(4)
  v_mfma_f32_32x32x16_bf16 v[96:111], v[224:227], v[28:31], v[96:111]
  ds_read_b64_tr_b16 v[236:237], v90 offset:40192
  ds_read_b64_tr_b16 v[238:239], v90 offset:40704
  s_waitcnt lgkmcnt(4)
  v_mfma_f32_32x32x16_bf16 v[112:127], v[228:231], v[28:31], v[112:127]
  ds_read_b64_tr_b16 v[224:225], v90 offset:55296
  ds_read_b64_tr_b16 v[226:227], v90 offset:55808
  buffer_load_dwordx4 v[12:15], v250, s[8:11], s62 offen offset:3072 sc1
  s_add_u32 s62, s62, 4096
  s_and_b32 s62, s62, 32767
  s_or_b32 s62, s62, s48
  s_waitcnt lgkmcnt(4)
  v_mfma_f32_32x32x16_bf16 v[128:143], v[232:235], v[28:31], v[128:143]
  ds_read_b64_tr_b16 v[228:229], v90 offset:55552
  ds_read_b64_tr_b16 v[230:231], v90 offset:56064
  s_waitcnt lgkmcnt(4)
  v_mfma_f32_32x32x16_bf16 v[144:159], v[236:239], v[28:31], v[144:159]
  ds_read_b64_tr_b16 v[232:233], v90 offset:56320
  ds_read_b64_tr_b16 v[234:235], v90 offset:56832
  s_waitcnt lgkmcnt(4)
  v_mfma_f32_32x32x16_bf16 v[160:175], v[28:31], v[224:227], v[160:175]
  ds_read_b64_tr_b16 v[236:237], v90 offset:56576
  ds_read_b64_tr_b16 v[238:239], v90 offset:57088
  s_waitcnt lgkmcnt(4)
  v_mfma_f32_32x32x16_bf16 v[176:191], v[28:31], v[228:231], v[176:191]
  s_barrier
  ds_read_b64_tr_b16 v[224:225], v91 offset:0
  ds_read_b64_tr_b16 v[226:227], v91 offset:512
  s_waitcnt lgkmcnt(4)
  v_mfma_f32_32x32x16_bf16 v[192:207], v[28:31], v[232:235], v[192:207]
  ds_read_b64_tr_b16 v[228:229], v91 offset:256
  ds_read_b64_tr_b16 v[230:231], v91 offset:768
  s_waitcnt lgkmcnt(4)
  v_mfma_f32_32x32x16_bf16 v[208:223], v[28:31], v[236:239], v[208:223]
  ds_read_b64_tr_b16 v[232:233], v91 offset:1024
  ds_read_b64_tr_b16 v[234:235], v91 offset:1536
  s_waitcnt lgkmcnt(4)
  v_mfma_f32_32x32x16_bf16 v[96:111], v[224:227], v[32:35], v[96:111]
  ds_read_b64_tr_b16 v[236:237], v91 offset:1280
  ds_read_b64_tr_b16 v[238:239], v91 offset:1792
  s_add_u32 m0, s29, 32768
  s_nop 0
  buffer_load_dwordx4 v245, s[12:15], s27 offen  lds
  s_waitcnt lgkmcnt(4)
  v_mfma_f32_32x32x16_bf16 v[112:127], v[228:231], v[32:35], v[112:127]
  ds_read_b64_tr_b16 v[224:225], v91 offset:16384
  ds_read_b64_tr_b16 v[226:227], v91 offset:16896
  s_waitcnt lgkmcnt(4)
  v_mfma_f32_32x32x16_bf16 v[128:143], v[232:235], v[32:35], v[128:143]
  ds_read_b64_tr_b16 v[228:229], v91 offset:16640
  ds_read_b64_tr_b16 v[230:231], v91 offset:17152
  s_waitcnt lgkmcnt(4)
  v_mfma_f32_32x32x16_bf16 v[144:159], v[236:239], v[32:35], v[144:159]
  ds_read_b64_tr_b16 v[232:233], v91 offset:17408
  ds_read_b64_tr_b16 v[234:235], v91 offset:17920
  s_waitcnt vmcnt(9)
  s_mov_b32 vcc_lo, 0x55555555
  s_mov_b32 vcc_hi, 0x55555555
  v_cndmask_b32_dpp v64, v52, v48, vcc quad_perm:[1,0,3,2] row_mask:0xf bank_mask:0xf
  s_add_u32 m0, s30, 32768
  s_nop 0
  buffer_load_dwordx4 v246, s[12:15], s27 offen  lds
  s_waitcnt lgkmcnt(4)
  v_mfma_f32_32x32x16_bf16 v[160:175], v[32:35], v[224:227], v[160:175]
  ds_read_b64_tr_b16 v[236:237], v91 offset:17664
  ds_read_b64_tr_b16 v[238:239], v91 offset:18176
  v_cndmask_b32_dpp v65, v53, v49, vcc quad_perm:[1,0,3,2] row_mask:0xf bank_mask:0xf
  v_cndmask_b32_dpp v66, v54, v50, vcc quad_perm:[1,0,3,2] row_mask:0xf bank_mask:0xf
  s_waitcnt lgkmcnt(4)
  v_mfma_f32_32x32x16_bf16 v[176:191], v[32:35], v[228:231], v[176:191]
  ds_read_b64_tr_b16 v[224:225], v91 offset:2048
  ds_read_b64_tr_b16 v[226:227], v91 offset:2560
  v_cndmask_b32_dpp v67, v55, v51, vcc quad_perm:[1,0,3,2] row_mask:0xf bank_mask:0xf
  v_cndmask_b32_dpp v72, v60, v56, vcc quad_perm:[1,0,3,2] row_mask:0xf bank_mask:0xf
  s_waitcnt lgkmcnt(4)
  v_mfma_f32_32x32x16_bf16 v[192:207], v[32:35], v[232:235], v[192:207]
  ds_read_b64_tr_b16 v[228:229], v91 offset:2304
  ds_read_b64_tr_b16 v[230:231], v91 offset:2816
  v_cndmask_b32_dpp v73, v61, v57, vcc quad_perm:[1,0,3,2] row_mask:0xf bank_mask:0xf
  v_cndmask_b32_dpp v74, v62, v58, vcc quad_perm:[1,0,3,2] row_mask:0xf bank_mask:0xf
  s_waitcnt lgkmcnt(4)
  v_mfma_f32_32x32x16_bf16 v[208:223], v[32:35], v[236:239], v[208:223]
  ds_read_b64_tr_b16 v[232:233], v91 offset:3072
  ds_read_b64_tr_b16 v[234:235], v91 offset:3584
  v_cndmask_b32_dpp v75, v63, v59, vcc quad_perm:[1,0,3,2] row_mask:0xf bank_mask:0xf
  s_mov_b32 vcc_lo, 0xaaaaaaaa
  s_mov_b32 vcc_hi, 0xaaaaaaaa
  s_add_u32 m0, s31, 32768
  s_nop 0
  buffer_load_dwordx4 v247, s[12:15], s27 offen  lds
  s_waitcnt lgkmcnt(4)
  v_mfma_f32_32x32x16_bf16 v[96:111], v[224:227], v[36:39], v[96:111]
  ds_read_b64_tr_b16 v[236:237], v91 offset:3328
  ds_read_b64_tr_b16 v[238:239], v91 offset:3840
  v_cndmask_b32_dpp v68, v48, v52, vcc quad_perm:[1,0,3,2] row_mask:0xf bank_mask:0xf
  v_cndmask_b32_dpp v69, v49, v53, vcc quad_perm:[1,0,3,2] row_mask:0xf bank_mask:0xf
  s_waitcnt lgkmcnt(4)
  v_mfma_f32_32x32x16_bf16 v[112:127], v[228:231], v[36:39], v[112:127]
  ds_read_b64_tr_b16 v[224:225], v91 offset:18432
  ds_read_b64_tr_b16 v[226:227], v91 offset:18944
  v_cndmask_b32_dpp v70, v50, v54, vcc quad_perm:[1,0,3,2] row_mask:0xf bank_mask:0xf
  v_cndmask_b32_dpp v71, v51, v55, vcc quad_perm:[1,0,3,2] row_mask:0xf bank_mask:0xf
  s_waitcnt lgkmcnt(4)
  v_mfma_f32_32x32x16_bf16 v[128:143], v[232:235], v[36:39], v[128:143]
  ds_read_b64_tr_b16 v[228:229], v91 offset:18688
  ds_read_b64_tr_b16 v[230:231], v91 offset:19200
  v_cndmask_b32_dpp v76, v56, v60, vcc quad_perm:[1,0,3,2] row_mask:0xf bank_mask:0xf
  v_cndmask_b32_dpp v77, v57, v61, vcc quad_perm:[1,0,3,2] row_mask:0xf bank_mask:0xf
  s_add_u32 m0, s32, 32768
  s_nop 0
  buffer_load_dwordx4 v248, s[12:15], s27 offen  lds
  s_add_u32 s27, s27, s28
  s_cmp_eq_u32 s27, s101
  s_cselect_b32 s27, 0, s27
  s_waitcnt lgkmcnt(4)
  v_mfma_f32_32x32x16_bf16 v[144:159], v[236:239], v[36:39], v[144:159]
  ds_read_b64_tr_b16 v[232:233], v91 offset:19456
  ds_read_b64_tr_b16 v[234:235], v91 offset:19968
  v_cndmask_b32_dpp v78, v58, v62, vcc quad_perm:[1,0,3,2] row_mask:0xf bank_mask:0xf
  v_cndmask_b32_dpp v79, v59, v63, vcc quad_perm:[1,0,3,2] row_mask:0xf bank_mask:0xf
  s_waitcnt lgkmcnt(4)
  v_mfma_f32_32x32x16_bf16 v[160:175], v[36:39], v[224:227], v[160:175]
  ds_read_b64_tr_b16 v[236:237], v91 offset:19712
  ds_read_b64_tr_b16 v[238:239], v91 offset:20224
  s_mov_b32 vcc_lo, 0x33333333
  s_mov_b32 vcc_hi, 0x33333333
  v_cndmask_b32_dpp v48, v72, v64, vcc quad_perm:[2,3,0,1] row_mask:0xf bank_mask:0xf
  s_waitcnt lgkmcnt(4)
  v_mfma_f32_32x32x16_bf16 v[176:191], v[36:39], v[228:231], v[176:191]
  ds_read_b64_tr_b16 v[224:225], v91 offset:4096
  ds_read_b64_tr_b16 v[226:227], v91 offset:4608
  v_cndmask_b32_dpp v49, v73, v65, vcc quad_perm:[2,3,0,1] row_mask:0xf bank_mask:0xf
  v_cndmask_b32_dpp v50, v74, v66, vcc quad_perm:[2,3,0,1] row_mask:0xf bank_mask:0xf
  s_waitcnt lgkmcnt(4)
  v_mfma_f32_32x32x16_bf16 v[192:207], v[36:39], v[232:235], v[192:207]
  ds_read_b64_tr_b16 v[228:229], v91 offset:4352
  ds_read_b64_tr_b16 v[230:231], v91 offset:4864
  v_cndmask_b32_dpp v51, v75, v67, vcc quad_perm:[2,3,0,1] row_mask:0xf bank_mask:0xf
  v_cndmask_b32_dpp v52, v76, v68, vcc quad_perm:[2,3,0,1] row_mask:0xf bank_mask:0xf
  buffer_load_dwordx4 v[16:19], v250, s[8:11], s62 offen offset:0 sc1
  s_waitcnt lgkmcnt(4)
  v_mfma_f32_32x32x16_bf16 v[208:223], v[36:39], v[236:239], v[208:223]
  ds_read_b64_tr_b16 v[232:233], v91 offset:5120
  ds_read_b64_tr_b16 v[234:235], v91 offset:5632
  v_cndmask_b32_dpp v53, v77, v69, vcc quad_perm:[2,3,0,1] row_mask:0xf bank_mask:0xf
  v_cndmask_b32_dpp v54, v78, v70, vcc quad_perm:[2,3,0,1] row_mask:0xf bank_mask:0xf
  s_waitcnt lgkmcnt(4)
  v_mfma_f32_32x32x16_bf16 v[96:111], v[224:227], v[40:43], v[96:111]
  ds_read_b64_tr_b16 v[236:237], v91 offset:5376
  ds_read_b64_tr_b16 v[238:239], v91 offset:5888
  v_cndmask_b32_dpp v55, v79, v71, vcc quad_perm:[2,3,0,1] row_mask:0xf bank_mask:0xf
  s_mov_b32 vcc_lo, 0xcccccccc
  s_mov_b32 vcc_hi, 0xcccccccc
  s_waitcnt lgkmcnt(4)
  v_mfma_f32_32x32x16_bf16 v[112:127], v[228:231], v[40:43], v[112:127]
  ds_read_b64_tr_b16 v[224:225], v91 offset:20480
  ds_read_b64_tr_b16 v[226:227], v91 offset:20992
  v_cndmask_b32_dpp v56, v64, v72, vcc quad_perm:[2,3,0,1] row_mask:0xf bank_mask:0xf
  v_cndmask_b32_dpp v57, v65, v73, vcc quad_perm:[2,3,0,1] row_mask:0xf bank_mask:0xf
  s_waitcnt lgkmcnt(4)
  v_mfma_f32_32x32x16_bf16 v[128:143], v[232:235], v[40:43], v[128:143]
  ds_read_b64_tr_b16 v[228:229], v91 offset:20736
  ds_read_b64_tr_b16 v[230:231], v91 offset:21248
  v_cndmask_b32_dpp v58, v66, v74, vcc quad_perm:[2,3,0,1] row_mask:0xf bank_mask:0xf
  v_cndmask_b32_dpp v59, v67, v75, vcc quad_perm:[2,3,0,1] row_mask:0xf bank_mask:0xf
  buffer_load_dwordx4 v[20:23], v250, s[8:11], s62 offen offset:1024 sc1
  s_waitcnt lgkmcnt(4)
  v_mfma_f32_32x32x16_bf16 v[144:159], v[236:239], v[40:43], v[144:159]
  ds_read_b64_tr_b16 v[232:233], v91 offset:21504
  ds_read_b64_tr_b16 v[234:235], v91 offset:22016
  v_cndmask_b32_dpp v60, v68, v76, vcc quad_perm:[2,3,0,1] row_mask:0xf bank_mask:0xf
  v_cndmask_b32_dpp v61, v69, v77, vcc quad_perm:[2,3,0,1] row_mask:0xf bank_mask:0xf
  s_waitcnt lgkmcnt(4)
  v_mfma_f32_32x32x16_bf16 v[160:175], v[40:43], v[224:227], v[160:175]
  ds_read_b64_tr_b16 v[236:237], v91 offset:21760
  ds_read_b64_tr_b16 v[238:239], v91 offset:22272
  v_cndmask_b32_dpp v62, v70, v78, vcc quad_perm:[2,3,0,1] row_mask:0xf bank_mask:0xf
  v_cndmask_b32_dpp v63, v71, v79, vcc quad_perm:[2,3,0,1] row_mask:0xf bank_mask:0xf
  s_waitcnt lgkmcnt(4)
  v_mfma_f32_32x32x16_bf16 v[176:191], v[40:43], v[228:231], v[176:191]
  ds_read_b64_tr_b16 v[224:225], v91 offset:6144
  ds_read_b64_tr_b16 v[226:227], v91 offset:6656
  buffer_load_dwordx4 v[24:27], v250, s[8:11], s62 offen offset:2048 sc1
  s_waitcnt lgkmcnt(4)
  v_mfma_f32_32x32x16_bf16 v[192:207], v[40:43], v[232:235], v[192:207]
  ds_read_b64_tr_b16 v[228:229], v91 offset:6400
  ds_read_b64_tr_b16 v[230:231], v91 offset:6912
  s_waitcnt lgkmcnt(4)
  v_mfma_f32_32x32x16_bf16 v[208:223], v[40:43], v[236:239], v[208:223]
  ds_read_b64_tr_b16 v[232:233], v91 offset:7168
  ds_read_b64_tr_b16 v[234:235], v91 offset:7680
  s_waitcnt lgkmcnt(4)
  v_mfma_f32_32x32x16_bf16 v[96:111], v[224:227], v[44:47], v[96:111]
  ds_read_b64_tr_b16 v[236:237], v91 offset:7424
  ds_read_b64_tr_b16 v[238:239], v91 offset:7936
  s_waitcnt lgkmcnt(4)
  v_mfma_f32_32x32x16_bf16 v[112:127], v[228:231], v[44:47], v[112:127]
  ds_read_b64_tr_b16 v[224:225], v91 offset:22528
  ds_read_b64_tr_b16 v[226:227], v91 offset:23040
  buffer_load_dwordx4 v[28:31], v250, s[8:11], s62 offen offset:3072 sc1
  s_add_u32 s62, s62, 4096
  s_and_b32 s62, s62, 32767
  s_or_b32 s62, s62, s48
  s_waitcnt lgkmcnt(4)
  v_mfma_f32_32x32x16_bf16 v[128:143], v[232:235], v[44:47], v[128:143]
  ds_read_b64_tr_b16 v[228:229], v91 offset:22784
  ds_read_b64_tr_b16 v[230:231], v91 offset:23296
  s_waitcnt lgkmcnt(4)
  v_mfma_f32_32x32x16_bf16 v[144:159], v[236:239], v[44:47], v[144:159]
  ds_read_b64_tr_b16 v[232:233], v91 offset:23552
  ds_read_b64_tr_b16 v[234:235], v91 offset:24064
  s_waitcnt lgkmcnt(4)
  v_mfma_f32_32x32x16_bf16 v[160:175], v[44:47], v[224:227], v[160:175]
  ds_read_b64_tr_b16 v[236:237], v91 offset:23808
  ds_read_b64_tr_b16 v[238:239], v91 offset:24320
  s_waitcnt lgkmcnt(4)
  v_mfma_f32_32x32x16_bf16 v[176:191], v[44:47], v[228:231], v[176:191]
  s_barrier
  ds_read_b64_tr_b16 v[224:225], v91 offset:32768
  ds_read_b64_tr_b16 v[226:227], v91 offset:33280
  s_waitcnt lgkmcnt(4)
  v_mfma_f32_32x32x16_bf16 v[192:207], v[44:47], v[232:235], v[192:207]
  ds_read_b64_tr_b16 v[228:229], v91 offset:33024
  ds_read_b64_tr_b16 v[230:231], v91 offset:33536
  s_waitcnt lgkmcnt(4)
  v_mfma_f32_32x32x16_bf16 v[208:223], v[44:47], v[236:239], v[208:223]
  ds_read_b64_tr_b16 v[232:233], v91 offset:33792
  ds_read_b64_tr_b16 v[234:235], v91 offset:34304
  s_waitcnt lgkmcnt(4)
  v_mfma_f32_32x32x16_bf16 v[96:111], v[224:227], v[48:51], v[96:111]
  ds_read_b64_tr_b16 v[236:237], v91 offset:34048
  ds_read_b64_tr_b16 v[238:239], v91 offset:34560
  s_add_u32 m0, s29, 65536
  s_nop 0
  buffer_load_dwordx4 v245, s[12:15], s27 offen  lds
  s_waitcnt lgkmcnt(4)
  v_mfma_f32_32x32x16_bf16 v[112:127], v[228:231], v[48:51], v[112:127]
  ds_read_b64_tr_b16 v[224:225], v91 offset:49152
  ds_read_b64_tr_b16 v[226:227], v91 offset:49664
  s_waitcnt lgkmcnt(4)
  v_mfma_f32_32x32x16_bf16 v[128:143], v[232:235], v[48:51], v[128:143]
  ds_read_b64_tr_b16 v[228:229], v91 offset:49408
  ds_read_b64_tr_b16 v[230:231], v91 offset:49920
  s_waitcnt lgkmcnt(4)
  v_mfma_f32_32x32x16_bf16 v[144:159], v[236:239], v[48:51], v[144:159]
  ds_read_b64_tr_b16 v[232:233], v91 offset:50176
  ds_read_b64_tr_b16 v[234:235], v91 offset:50688
  s_add_u32 m0, s30, 65536
  s_nop 0
  buffer_load_dwordx4 v246, s[12:15], s27 offen  lds
  s_waitcnt lgkmcnt(4)
  v_mfma_f32_32x32x16_bf16 v[160:175], v[48:51], v[224:227], v[160:175]
  ds_read_b64_tr_b16 v[236:237], v91 offset:50432
  ds_read_b64_tr_b16 v[238:239], v91 offset:50944
  s_waitcnt lgkmcnt(4)
  v_mfma_f32_32x32x16_bf16 v[176:191], v[48:51], v[228:231], v[176:191]
  ds_read_b64_tr_b16 v[224:225], v91 offset:34816
  ds_read_b64_tr_b16 v[226:227], v91 offset:35328
  s_waitcnt lgkmcnt(4)
  v_mfma_f32_32x32x16_bf16 v[192:207], v[48:51], v[232:235], v[192:207]
  ds_read_b64_tr_b16 v[228:229], v91 offset:35072
  ds_read_b64_tr_b16 v[230:231], v91 offset:35584
  s_waitcnt lgkmcnt(4)
  v_mfma_f32_32x32x16_bf16 v[208:223], v[48:51], v[236:239], v[208:223]
  ds_read_b64_tr_b16 v[232:233], v91 offset:35840
  ds_read_b64_tr_b16 v[234:235], v91 offset:36352
  s_add_u32 m0, s31, 65536
  s_nop 0
  buffer_load_dwordx4 v247, s[12:15], s27 offen  lds
  s_waitcnt lgkmcnt(4)
  v_mfma_f32_32x32x16_bf16 v[96:111], v[224:227], v[52:55], v[96:111]
  ds_read_b64_tr_b16 v[236:237], v91 offset:36096
  ds_read_b64_tr_b16 v[238:239], v91 offset:36608
  s_waitcnt lgkmcnt(4)
  v_mfma_f32_32x32x16_bf16 v[112:127], v[228:231], v[52:55], v[112:127]
  ds_read_b64_tr_b16 v[224:225], v91 offset:51200
  ds_read_b64_tr_b16 v[226:227], v91 offset:51712
  s_waitcnt lgkmcnt(4)
  v_mfma_f32_32x32x16_bf16 v[128:143], v[232:235], v[52:55], v[128:143]
  ds_read_b64_tr_b16 v[228:229], v91 offset:51456
  ds_read_b64_tr_b16 v[230:231], v91 offset:51968
  s_add_u32 m0, s32, 65536
  s_nop 0
  buffer_load_dwordx4 v248, s[12:15], s27 offen  lds
  s_add_u32 s27, s27, s28
  s_cmp_eq_u32 s27, s101
  s_cselect_b32 s27, 0, s27
  s_waitcnt lgkmcnt(4)
  v_mfma_f32_32x32x16_bf16 v[144:159], v[236:239], v[52:55], v[144:159]
  ds_read_b64_tr_b16 v[232:233], v91 offset:52224
  ds_read_b64_tr_b16 v[234:235], v91 offset:52736
  s_waitcnt lgkmcnt(4)
  v_mfma_f32_32x32x16_bf16 v[160:175], v[52:55], v[224:227], v[160:175]
  ds_read_b64_tr_b16 v[236:237], v91 offset:52480
  ds_read_b64_tr_b16 v[238:239], v91 offset:52992
  s_waitcnt lgkmcnt(4)
  v_mfma_f32_32x32x16_bf16 v[176:191], v[52:55], v[228:231], v[176:191]
  ds_read_b64_tr_b16 v[224:225], v91 offset:36864
  ds_read_b64_tr_b16 v[226:227], v91 offset:37376
  s_waitcnt lgkmcnt(4)
  v_mfma_f32_32x32x16_bf16 v[192:207], v[52:55], v[232:235], v[192:207]
  ds_read_b64_tr_b16 v[228:229], v91 offset:37120
  ds_read_b64_tr_b16 v[230:231], v91 offset:37632
  buffer_load_dwordx4 v[32:35], v250, s[8:11], s62 offen offset:0 sc1
  s_waitcnt lgkmcnt(4)
  v_mfma_f32_32x32x16_bf16 v[208:223], v[52:55], v[236:239], v[208:223]
  ds_read_b64_tr_b16 v[232:233], v91 offset:37888
  ds_read_b64_tr_b16 v[234:235], v91 offset:38400
  s_waitcnt lgkmcnt(4)
  v_mfma_f32_32x32x16_bf16 v[96:111], v[224:227], v[56:59], v[96:111]
  ds_read_b64_tr_b16 v[236:237], v91 offset:38144
  ds_read_b64_tr_b16 v[238:239], v91 offset:38656
  s_waitcnt lgkmcnt(4)
  v_mfma_f32_32x32x16_bf16 v[112:127], v[228:231], v[56:59], v[112:127]
  ds_read_b64_tr_b16 v[224:225], v91 offset:53248
  ds_read_b64_tr_b16 v[226:227], v91 offset:53760
  s_waitcnt lgkmcnt(4)
  v_mfma_f32_32x32x16_bf16 v[128:143], v[232:235], v[56:59], v[128:143]
  ds_read_b64_tr_b16 v[228:229], v91 offset:53504
  ds_read_b64_tr_b16 v[230:231], v91 offset:54016
  buffer_load_dwordx4 v[36:39], v250, s[8:11], s62 offen offset:1024 sc1
  s_waitcnt lgkmcnt(4)
  v_mfma_f32_32x32x16_bf16 v[144:159], v[236:239], v[56:59], v[144:159]
  ds_read_b64_tr_b16 v[232:233], v91 offset:54272
  ds_read_b64_tr_b16 v[234:235], v91 offset:54784
  s_waitcnt lgkmcnt(4)
  v_mfma_f32_32x32x16_bf16 v[160:175], v[56:59], v[224:227], v[160:175]
  ds_read_b64_tr_b16 v[236:237], v91 offset:54528
  ds_read_b64_tr_b16 v[238:239], v91 offset:55040
  s_waitcnt lgkmcnt(4)
  v_mfma_f32_32x32x16_bf16 v[176:191], v[56:59], v[228:231], v[176:191]
  ds_read_b64_tr_b16 v[224:225], v91 offset:38912
  ds_read_b64_tr_b16 v[226:227], v91 offset:39424
  buffer_load_dwordx4 v[40:43], v250, s[8:11], s62 offen offset:2048 sc1
  s_waitcnt lgkmcnt(4)
  v_mfma_f32_32x32x16_bf16 v[192:207], v[56:59], v[232:235], v[192:207]
  ds_read_b64_tr_b16 v[228:229], v91 offset:39168
  ds_read_b64_tr_b16 v[230:231], v91 offset:39680
  s_waitcnt lgkmcnt(4)
  v_mfma_f32_32x32x16_bf16 v[208:223], v[56:59], v[236:239], v[208:223]
  ds_read_b64_tr_b16 v[232:233], v91 offset:39936
  ds_read_b64_tr_b16 v[234:235], v91 offset:40448
  s_waitcnt lgkmcnt(4)
  v_mfma_f32_32x32x16_bf16 v[96:111], v[224:227], v[60:63], v[96:111]
  ds_read_b64_tr_b16 v[236:237], v91 offset:40192
  ds_read_b64_tr_b16 v[238:239], v91 offset:40704
  s_waitcnt lgkmcnt(4)
  v_mfma_f32_32x32x16_bf16 v[112:127], v[228:231], v[60:63], v[112:127]
  ds_read_b64_tr_b16 v[224:225], v91 offset:55296
  ds_read_b64_tr_b16 v[226:227], v91 offset:55808
  buffer_load_dwordx4 v[44:47], v250, s[8:11], s62 offen offset:3072 sc1
  s_add_u32 s62, s62, 4096
  s_and_b32 s62, s62, 32767
  s_or_b32 s62, s62, s48
  s_waitcnt lgkmcnt(4)
  v_mfma_f32_32x32x16_bf16 v[128:143], v[232:235], v[60:63], v[128:143]
  ds_read_b64_tr_b16 v[228:229], v91 offset:55552
  ds_read_b64_tr_b16 v[230:231], v91 offset:56064
  s_nop 1
  v_cvt_pk_bf16_f32 v96, v96, v97
  v_cvt_pk_bf16_f32 v97, v98, v99
  v_cvt_pk_bf16_f32 v98, v100, v101
  v_cvt_pk_bf16_f32 v99, v102, v103
  v_cvt_pk_bf16_f32 v100, v104, v105
  v_cvt_pk_bf16_f32 v101, v106, v107
  v_cvt_pk_bf16_f32 v102, v108, v109
  v_cvt_pk_bf16_f32 v103, v110, v111
  buffer_store_dwordx4 v[96:99], v250, s[16:19], s70 offen offset:0 sc1
  buffer_store_dwordx4 v[100:103], v250, s[16:19], s70 offen offset:1024 sc1
  s_waitcnt lgkmcnt(4)
  v_mfma_f32_32x32x16_bf16 v[144:159], v[236:239], v[60:63], v[144:159]
  ds_read_b64_tr_b16 v[232:233], v91 offset:56320
  ds_read_b64_tr_b16 v[234:235], v91 offset:56832
  v_cvt_pk_bf16_f32 v112, v112, v113
  v_cvt_pk_bf16_f32 v113, v114, v115
  v_cvt_pk_bf16_f32 v114, v116, v117
  v_cvt_pk_bf16_f32 v115, v118, v119
  v_cvt_pk_bf16_f32 v116, v120, v121
  v_cvt_pk_bf16_f32 v117, v122, v123
  v_cvt_pk_bf16_f32 v118, v124, v125
  v_cvt_pk_bf16_f32 v119, v126, v127
  buffer_store_dwordx4 v[112:115], v250, s[16:19], s70 offen offset:2048 sc1
  buffer_store_dwordx4 v[116:119], v250, s[16:19], s70 offen offset:3072 sc1
  s_waitcnt lgkmcnt(4)
  v_mfma_f32_32x32x16_bf16 v[160:175], v[60:63], v[224:227], v[160:175]
  ds_read_b64_tr_b16 v[236:237], v91 offset:56576
  ds_read_b64_tr_b16 v[238:239], v91 offset:57088
  v_cvt_pk_bf16_f32 v64, v128, v129
  v_cvt_pk_bf16_f32 v65, v130, v131
  v_cvt_pk_bf16_f32 v66, v132, v133
  v_cvt_pk_bf16_f32 v67, v134, v135
  v_cvt_pk_bf16_f32 v68, v136, v137
  v_cvt_pk_bf16_f32 v69, v138, v139
  v_cvt_pk_bf16_f32 v70, v140, v141
  v_cvt_pk_bf16_f32 v71, v142, v143
  s_waitcnt lgkmcnt(4)
  v_mfma_f32_32x32x16_bf16 v[176:191], v[60:63], v[228:231], v[176:191]
  s_waitcnt vmcnt(20)
  s_barrier
  ds_read_b64_tr_b16 v[224:225], v241 offset:0
  ds_read_b64_tr_b16 v[226:227], v241 offset:512
  v_cvt_pk_bf16_f32 v72, v144, v145
  v_cvt_pk_bf16_f32 v73, v146, v147
  v_cvt_pk_bf16_f32 v74, v148, v149
  v_cvt_pk_bf16_f32 v75, v150, v151
  v_cvt_pk_bf16_f32 v76, v152, v153
  v_cvt_pk_bf16_f32 v77, v154, v155
  v_cvt_pk_bf16_f32 v78, v156, v157
  v_cvt_pk_bf16_f32 v79, v158, v159
  s_waitcnt lgkmcnt(4)
  v_mfma_f32_32x32x16_bf16 v[192:207], v[60:63], v[232:235], v[192:207]
  ds_read_b64_tr_b16 v[228:229], v241 offset:256
  ds_read_b64_tr_b16 v[230:231], v241 offset:768
  v_cvt_pk_bf16_f32 v80, v160, v161
  v_cvt_pk_bf16_f32 v81, v162, v163
  v_cvt_pk_bf16_f32 v82, v164, v165
  v_cvt_pk_bf16_f32 v83, v166, v167
  v_cvt_pk_bf16_f32 v84, v168, v169
  v_cvt_pk_bf16_f32 v85, v170, v171
  v_cvt_pk_bf16_f32 v86, v172, v173
  v_cvt_pk_bf16_f32 v87, v174, v175
  s_waitcnt lgkmcnt(4)
  v_mfma_f32_32x32x16_bf16 v[208:223], v[60:63], v[236:239], v[208:223]
  ds_read_b64_tr_b16 v[232:233], v241 offset:1024
  ds_read_b64_tr_b16 v[234:235], v241 offset:1536
  v_cvt_pk_bf16_f32 v88, v176, v177
  v_cvt_pk_bf16_f32 v89, v178, v179
  v_cvt_pk_bf16_f32 v90, v180, v181
  v_cvt_pk_bf16_f32 v91, v182, v183
  v_cvt_pk_bf16_f32 v92, v184, v185
  v_cvt_pk_bf16_f32 v93, v186, v187
  v_cvt_pk_bf16_f32 v94, v188, v189
  v_cvt_pk_bf16_f32 v95, v190, v191
  s_waitcnt lgkmcnt(4)
  v_mfma_f32_32x32x16_bf16 v[96:111], v[224:227], v[0:3], 0
  ds_read_b64_tr_b16 v[236:237], v241 offset:1280
  ds_read_b64_tr_b16 v[238:239], v241 offset:1792
  s_nop 1
  v_cvt_pk_bf16_f32 v208, v208, v209
  v_cvt_pk_bf16_f32 v209, v210, v211
  v_cvt_pk_bf16_f32 v210, v212, v213
  v_cvt_pk_bf16_f32 v211, v214, v215
  v_cvt_pk_bf16_f32 v212, v216, v217
  v_cvt_pk_bf16_f32 v213, v218, v219
  v_cvt_pk_bf16_f32 v214, v220, v221
  v_cvt_pk_bf16_f32 v215, v222, v223
  s_add_u32 m0, s29, 98304
  s_nop 0
  buffer_load_dwordx4 v245, s[12:15], s27 offen  lds
  s_waitcnt lgkmcnt(4)
  v_mfma_f32_32x32x16_bf16 v[112:127], v[228:231], v[0:3], 0
  ds_read_b64_tr_b16 v[224:225], v243 offset:16384
  ds_read_b64_tr_b16 v[226:227], v243 offset:16768
  v_cvt_pk_bf16_f32 v216, v192, v193
  v_cvt_pk_bf16_f32 v217, v194, v195
  v_cvt_pk_bf16_f32 v218, v196, v197
  v_cvt_pk_bf16_f32 v219, v198, v199
  v_cvt_pk_bf16_f32 v220, v200, v201
  v_cvt_pk_bf16_f32 v221, v202, v203
  v_cvt_pk_bf16_f32 v222, v204, v205
  v_cvt_pk_bf16_f32 v223, v206, v207
  s_waitcnt lgkmcnt(4)
  v_mfma_f32_32x32x16_bf16 v[128:143], v[232:235], v[0:3], 0
  ds_read_b64_tr_b16 v[228:229], v243 offset:16512
  ds_read_b64_tr_b16 v[230:231], v243 offset:16896
  s_waitcnt lgkmcnt(4)
  v_mfma_f32_32x32x16_bf16 v[144:159], v[236:239], v[0:3], 0
  ds_read_b64_tr_b16 v[232:233], v243 offset:16640
  ds_read_b64_tr_b16 v[234:235], v243 offset:17024
  s_add_u32 m0, s30, 98304
  s_nop 0
  buffer_load_dwordx4 v246, s[12:15], s27 offen  lds
  s_waitcnt lgkmcnt(4)
  v_mfma_f32_32x32x16_bf16 v[160:175], v[224:227], v[0:3], 0
  ds_read_b64_tr_b16 v[236:237], v241 offset:4096
  ds_read_b64_tr_b16 v[238:239], v241 offset:4608
  buffer_store_dwordx4 v[64:67], v250, s[16:19], s71 offen offset:0 sc1
  s_waitcnt lgkmcnt(4)
  v_mfma_f32_32x32x16_bf16 v[176:191], v[228:231], v[0:3], 0
  ds_read_b64_tr_b16 v[224:225], v241 offset:4352
  ds_read_b64_tr_b16 v[226:227], v241 offset:4864
  s_waitcnt lgkmcnt(4)
  v_mfma_f32_32x32x16_bf16 v[192:207], v[232:235], v[0:3], 0
  ds_read_b64_tr_b16 v[228:229], v241 offset:5120
  ds_read_b64_tr_b16 v[230:231], v241 offset:5632
  s_add_u32 m0, s31, 98304
  s_nop 0
  buffer_load_dwordx4 v247, s[12:15], s27 offen  lds
  s_waitcnt lgkmcnt(4)
  v_mfma_f32_32x32x16_bf16 v[96:111], v[236:239], v[4:7], v[96:111]
  ds_read_b64_tr_b16 v[232:233], v241 offset:5376
  ds_read_b64_tr_b16 v[234:235], v241 offset:5888
  s_waitcnt lgkmcnt(4)
  v_mfma_f32_32x32x16_bf16 v[112:127], v[224:227], v[4:7], v[112:127]
  ds_read_b64_tr_b16 v[236:237], v243 offset:17920
  ds_read_b64_tr_b16 v[238:239], v243 offset:18304
  s_waitcnt lgkmcnt(4)
  v_mfma_f32_32x32x16_bf16 v[128:143], v[228:231], v[4:7], v[128:143]
  ds_read_b64_tr_b16 v[224:225], v243 offset:18048
  ds_read_b64_tr_b16 v[226:227], v243 offset:18432
  s_add_u32 m0, s32, 98304
  s_nop 0
  buffer_load_dwordx4 v248, s[12:15], s27 offen  lds
  s_add_u32 s27, s27, s28
  s_cmp_eq_u32 s27, s101
  s_cselect_b32 s27, 0, s27
  s_waitcnt lgkmcnt(4)
  v_mfma_f32_32x32x16_bf16 v[144:159], v[232:235], v[4:7], v[144:159]
  ds_read_b64_tr_b16 v[228:229], v243 offset:18176
  ds_read_b64_tr_b16 v[230:231], v243 offset:18560
  s_cmp_eq_u32 s74, 0
  s_cbranch_scc1 kv_dup
kv_dup_back:
  s_waitcnt lgkmcnt(4)
  v_mfma_f32_32x32x16_bf16 v[160:175], v[236:239], v[4:7], v[160:175]
  ds_read_b64_tr_b16 v[232:233], v241 offset:8192
  ds_read_b64_tr_b16 v[234:235], v241 offset:8704
  buffer_store_dwordx4 v[68:71], v250, s[16:19], s71 offen offset:1024 sc1
  s_waitcnt lgkmcnt(4)
  v_mfma_f32_32x32x16_bf16 v[176:191], v[224:227], v[4:7], v[176:191]
  ds_read_b64_tr_b16 v[236:237], v241 offset:8448
  ds_read_b64_tr_b16 v[238:239], v241 offset:8960
  buffer_load_dwordx4 v[48:51], v250, s[8:11], s62 offen offset:0 sc1
  s_waitcnt lgkmcnt(4)
  v_mfma_f32_32x32x16_bf16 v[192:207], v[228:231], v[4:7], v[192:207]
  ds_read_b64_tr_b16 v[224:225], v241 offset:9216
  ds_read_b64_tr_b16 v[226:227], v241 offset:9728
  s_waitcnt lgkmcnt(4)
  v_mfma_f32_32x32x16_bf16 v[96:111], v[232:235], v[8:11], v[96:111]
  ds_read_b64_tr_b16 v[228:229], v241 offset:9472
  ds_read_b64_tr_b16 v[230:231], v241 offset:9984
  s_waitcnt lgkmcnt(4)
  v_mfma_f32_32x32x16_bf16 v[112:127], v[236:239], v[8:11], v[112:127]
  ds_read_b64_tr_b16 v[232:233], v243 offset:19456
  ds_read_b64_tr_b16 v[234:235], v243 offset:19840
  buffer_load_dwordx4 v[52:55], v250, s[8:11], s62 offen offset:1024 sc1
  s_waitcnt lgkmcnt(4)
  v_mfma_f32_32x32x16_bf16 v[128:143], v[224:227], v[8:11], v[128:143]
  ds_read_b64_tr_b16 v[236:237], v243 offset:19584
  ds_read_b64_tr_b16 v[238:239], v243 offset:19968
  s_waitcnt lgkmcnt(4)
  v_mfma_f32_32x32x16_bf16 v[144:159], v[228:231], v[8:11], v[144:159]
  ds_read_b64_tr_b16 v[224:225], v243 offset:19712
  ds_read_b64_tr_b16 v[226:227], v243 offset:20096
  s_waitcnt lgkmcnt(4)
  v_mfma_f32_32x32x16_bf16 v[160:175], v[232:235], v[8:11], v[160:175]
  ds_read_b64_tr_b16 v[228:229], v241 offset:12288
  ds_read_b64_tr_b16 v[230:231], v241 offset:12800
  buffer_store_dwordx4 v[72:75], v250, s[16:19], s71 offen offset:2048 sc1
  buffer_load_dwordx4 v[56:59], v250, s[8:11], s62 offen offset:2048 sc1
  s_waitcnt lgkmcnt(4)
  v_mfma_f32_32x32x16_bf16 v[176:191], v[236:239], v[8:11], v[176:191]
  ds_read_b64_tr_b16 v[232:233], v241 offset:12544
  ds_read_b64_tr_b16 v[234:235], v241 offset:13056
  s_waitcnt lgkmcnt(4)
  v_mfma_f32_32x32x16_bf16 v[192:207], v[224:227], v[8:11], v[192:207]
  ds_read_b64_tr_b16 v[236:237], v241 offset:13312
  ds_read_b64_tr_b16 v[238:239], v241 offset:13824
  s_waitcnt lgkmcnt(4)
  v_mfma_f32_32x32x16_bf16 v[96:111], v[228:231], v[12:15], v[96:111]
  ds_read_b64_tr_b16 v[224:225], v241 offset:13568
  ds_read_b64_tr_b16 v[226:227], v241 offset:14080
  buffer_load_dwordx4 v[60:63], v250, s[8:11], s62 offen offset:3072 sc1
  s_add_u32 s62, s62, 4096
  s_and_b32 s62, s62, 32767
  s_or_b32 s62, s62, s48
  s_waitcnt lgkmcnt(4)
  v_mfma_f32_32x32x16_bf16 v[112:127], v[232:235], v[12:15], v[112:127]
  ds_read_b64_tr_b16 v[228:229], v243 offset:20992
  ds_read_b64_tr_b16 v[230:231], v243 offset:21376
  s_waitcnt lgkmcnt(4)
  v_mfma_f32_32x32x16_bf16 v[128:143], v[236:239], v[12:15], v[128:143]
  ds_read_b64_tr_b16 v[232:233], v243 offset:21120
  ds_read_b64_tr_b16 v[234:235], v243 offset:21504
  s_waitcnt lgkmcnt(4)
  v_mfma_f32_32x32x16_bf16 v[144:159], v[224:227], v[12:15], v[144:159]
  ds_read_b64_tr_b16 v[236:237], v243 offset:21248
  ds_read_b64_tr_b16 v[238:239], v243 offset:21632
  s_waitcnt lgkmcnt(4)
  v_mfma_f32_32x32x16_bf16 v[160:175], v[228:231], v[12:15], v[160:175]
  s_waitcnt vmcnt(23)
  s_barrier
  ds_read_b64_tr_b16 v[224:225], v241 offset:32768
  ds_read_b64_tr_b16 v[226:227], v241 offset:33280
  s_waitcnt lgkmcnt(4)
  v_mfma_f32_32x32x16_bf16 v[176:191], v[232:235], v[12:15], v[176:191]
  ds_read_b64_tr_b16 v[228:229], v241 offset:33024
  ds_read_b64_tr_b16 v[230:231], v241 offset:33536
  s_waitcnt lgkmcnt(4)
  v_mfma_f32_32x32x16_bf16 v[192:207], v[236:239], v[12:15], v[192:207]
  ds_read_b64_tr_b16 v[232:233], v241 offset:33792
  ds_read_b64_tr_b16 v[234:235], v241 offset:34304
  s_waitcnt lgkmcnt(4)
  v_mfma_f32_32x32x16_bf16 v[96:111], v[224:227], v[16:19], v[96:111]
  ds_read_b64_tr_b16 v[236:237], v241 offset:34048
  ds_read_b64_tr_b16 v[238:239], v241 offset:34560
  s_add_u32 m0, s29, 0
  s_nop 0
  buffer_load_dwordx4 v245, s[12:15], s27 offen  lds
  s_waitcnt lgkmcnt(4)
  v_mfma_f32_32x32x16_bf16 v[112:127], v[228:231], v[16:19], v[112:127]
  ds_read_b64_tr_b16 v[224:225], v243 offset:49152
  ds_read_b64_tr_b16 v[226:227], v243 offset:49536
  s_waitcnt lgkmcnt(4)
  v_mfma_f32_32x32x16_bf16 v[128:143], v[232:235], v[16:19], v[128:143]
  ds_read_b64_tr_b16 v[228:229], v243 offset:49280
  ds_read_b64_tr_b16 v[230:231], v243 offset:49664
  s_waitcnt lgkmcnt(4)
  v_mfma_f32_32x32x16_bf16 v[144:159], v[236:239], v[16:19], v[144:159]
  ds_read_b64_tr_b16 v[232:233], v243 offset:49408
  ds_read_b64_tr_b16 v[234:235], v243 offset:49792
  s_add_u32 m0, s30, 0
  s_nop 0
  buffer_load_dwordx4 v246, s[12:15], s27 offen  lds
  s_waitcnt lgkmcnt(4)
  v_mfma_f32_32x32x16_bf16 v[160:175], v[224:227], v[16:19], v[160:175]
  ds_read_b64_tr_b16 v[236:237], v241 offset:36864
  ds_read_b64_tr_b16 v[238:239], v241 offset:37376
  buffer_store_dwordx4 v[76:79], v250, s[16:19], s71 offen offset:3072 sc1
  s_waitcnt lgkmcnt(4)
  v_mfma_f32_32x32x16_bf16 v[176:191], v[228:231], v[16:19], v[176:191]
  ds_read_b64_tr_b16 v[224:225], v241 offset:37120
  ds_read_b64_tr_b16 v[226:227], v241 offset:37632
  s_waitcnt lgkmcnt(4)
  v_mfma_f32_32x32x16_bf16 v[192:207], v[232:235], v[16:19], v[192:207]
  ds_read_b64_tr_b16 v[228:229], v241 offset:37888
  ds_read_b64_tr_b16 v[230:231], v241 offset:38400
  s_add_u32 m0, s31, 0
  s_nop 0
  buffer_load_dwordx4 v247, s[12:15], s27 offen  lds
  s_waitcnt lgkmcnt(4)
  v_mfma_f32_32x32x16_bf16 v[96:111], v[236:239], v[20:23], v[96:111]
  ds_read_b64_tr_b16 v[232:233], v241 offset:38144
  ds_read_b64_tr_b16 v[234:235], v241 offset:38656
  s_waitcnt lgkmcnt(4)
  v_mfma_f32_32x32x16_bf16 v[112:127], v[224:227], v[20:23], v[112:127]
  ds_read_b64_tr_b16 v[236:237], v243 offset:50688
  ds_read_b64_tr_b16 v[238:239], v243 offset:51072
  s_waitcnt lgkmcnt(4)
  v_mfma_f32_32x32x16_bf16 v[128:143], v[228:231], v[20:23], v[128:143]
  ds_read_b64_tr_b16 v[224:225], v243 offset:50816
  ds_read_b64_tr_b16 v[226:227], v243 offset:51200
  s_add_u32 m0, s32, 0
  s_nop 0
  buffer_load_dwordx4 v248, s[12:15], s27 offen  lds
  s_add_u32 s27, s27, s28
  s_cmp_eq_u32 s27, s101
  s_cselect_b32 s27, 0, s27
  s_waitcnt lgkmcnt(4)
  v_mfma_f32_32x32x16_bf16 v[144:159], v[232:235], v[20:23], v[144:159]
  ds_read_b64_tr_b16 v[228:229], v243 offset:50944
  ds_read_b64_tr_b16 v[230:231], v243 offset:51328
  s_waitcnt lgkmcnt(4)
  v_mfma_f32_32x32x16_bf16 v[160:175], v[236:239], v[20:23], v[160:175]
  ds_read_b64_tr_b16 v[232:233], v241 offset:40960
  ds_read_b64_tr_b16 v[234:235], v241 offset:41472
  buffer_store_dwordx4 v[80:83], v250, s[16:19], s72 offen offset:0 sc1
  s_waitcnt lgkmcnt(4)
  v_mfma_f32_32x32x16_bf16 v[176:191], v[224:227], v[20:23], v[176:191]
  ds_read_b64_tr_b16 v[236:237], v241 offset:41216
  ds_read_b64_tr_b16 v[238:239], v241 offset:41728
  buffer_load_dwordx4 v[0:3], v250, s[8:11], s62 offen offset:0 sc1
  s_waitcnt lgkmcnt(4)
  v_mfma_f32_32x32x16_bf16 v[192:207], v[228:231], v[20:23], v[192:207]
  ds_read_b64_tr_b16 v[224:225], v241 offset:41984
  ds_read_b64_tr_b16 v[226:227], v241 offset:42496
  s_waitcnt lgkmcnt(4)
  v_mfma_f32_32x32x16_bf16 v[96:111], v[232:235], v[24:27], v[96:111]
  ds_read_b64_tr_b16 v[228:229], v241 offset:42240
  ds_read_b64_tr_b16 v[230:231], v241 offset:42752
  s_waitcnt lgkmcnt(4)
  v_mfma_f32_32x32x16_bf16 v[112:127], v[236:239], v[24:27], v[112:127]
  ds_read_b64_tr_b16 v[232:233], v243 offset:52224
  ds_read_b64_tr_b16 v[234:235], v243 offset:52608
  buffer_load_dwordx4 v[4:7], v250, s[8:11], s62 offen offset:1024 sc1
  s_waitcnt lgkmcnt(4)
  v_mfma_f32_32x32x16_bf16 v[128:143], v[224:227], v[24:27], v[128:143]
  ds_read_b64_tr_b16 v[236:237], v243 offset:52352
  ds_read_b64_tr_b16 v[238:239], v243 offset:52736
  s_waitcnt lgkmcnt(4)
  v_mfma_f32_32x32x16_bf16 v[144:159], v[228:231], v[24:27], v[144:159]
  ds_read_b64_tr_b16 v[224:225], v243 offset:52480
  ds_read_b64_tr_b16 v[226:227], v243 offset:52864
  s_waitcnt lgkmcnt(4)
  v_mfma_f32_32x32x16_bf16 v[160:175], v[232:235], v[24:27], v[160:175]
  ds_read_b64_tr_b16 v[228:229], v241 offset:45056
  ds_read_b64_tr_b16 v[230:231], v241 offset:45568
  buffer_store_dwordx4 v[84:87], v250, s[16:19], s73 offen offset:0 sc1
  buffer_load_dwordx4 v[8:11], v250, s[8:11], s62 offen offset:2048 sc1
  s_waitcnt lgkmcnt(4)
  v_mfma_f32_32x32x16_bf16 v[176:191], v[236:239], v[24:27], v[176:191]
  ds_read_b64_tr_b16 v[232:233], v241 offset:45312
  ds_read_b64_tr_b16 v[234:235], v241 offset:45824
  s_waitcnt lgkmcnt(4)
  v_mfma_f32_32x32x16_bf16 v[192:207], v[224:227], v[24:27], v[192:207]
  ds_read_b64_tr_b16 v[236:237], v241 offset:46080
  ds_read_b64_tr_b16 v[238:239], v241 offset:46592
  s_waitcnt lgkmcnt(4)
  v_mfma_f32_32x32x16_bf16 v[96:111], v[228:231], v[28:31], v[96:111]
  ds_read_b64_tr_b16 v[224:225], v241 offset:46336
  ds_read_b64_tr_b16 v[226:227], v241 offset:46848
  buffer_load_dwordx4 v[12:15], v250, s[8:11], s62 offen offset:3072 sc1
  s_add_u32 s62, s62, 4096
  s_and_b32 s62, s62, 32767
  s_or_b32 s62, s62, s48
  s_waitcnt lgkmcnt(4)
  v_mfma_f32_32x32x16_bf16 v[112:127], v[232:235], v[28:31], v[112:127]
  ds_read_b64_tr_b16 v[228:229], v243 offset:53760
  ds_read_b64_tr_b16 v[230:231], v243 offset:54144
  s_waitcnt lgkmcnt(4)
  v_mfma_f32_32x32x16_bf16 v[128:143], v[236:239], v[28:31], v[128:143]
  ds_read_b64_tr_b16 v[232:233], v243 offset:53888
  ds_read_b64_tr_b16 v[234:235], v243 offset:54272
  s_waitcnt lgkmcnt(4)
  v_mfma_f32_32x32x16_bf16 v[144:159], v[224:227], v[28:31], v[144:159]
  ds_read_b64_tr_b16 v[236:237], v243 offset:54016
  ds_read_b64_tr_b16 v[238:239], v243 offset:54400
  s_waitcnt lgkmcnt(4)
  v_mfma_f32_32x32x16_bf16 v[160:175], v[228:231], v[28:31], v[160:175]
  s_waitcnt vmcnt(26)
  s_barrier
  ds_read_b64_tr_b16 v[224:225], v242 offset:0
  ds_read_b64_tr_b16 v[226:227], v242 offset:512
  s_waitcnt lgkmcnt(4)
  v_mfma_f32_32x32x16_bf16 v[176:191], v[232:235], v[28:31], v[176:191]
  ds_read_b64_tr_b16 v[228:229], v242 offset:256
  ds_read_b64_tr_b16 v[230:231], v242 offset:768
  s_waitcnt lgkmcnt(4)
  v_mfma_f32_32x32x16_bf16 v[192:207], v[236:239], v[28:31], v[192:207]
  ds_read_b64_tr_b16 v[232:233], v242 offset:1024
  ds_read_b64_tr_b16 v[234:235], v242 offset:1536
  s_waitcnt lgkmcnt(4)
  v_mfma_f32_32x32x16_bf16 v[96:111], v[224:227], v[32:35], v[96:111]
  ds_read_b64_tr_b16 v[236:237], v242 offset:1280
  ds_read_b64_tr_b16 v[238:239], v242 offset:1792
  s_add_u32 m0, s29, 32768
  s_nop 0
  buffer_load_dwordx4 v245, s[12:15], s27 offen  lds
  s_waitcnt lgkmcnt(4)
  v_mfma_f32_32x32x16_bf16 v[112:127], v[228:231], v[32:35], v[112:127]
  ds_read_b64_tr_b16 v[224:225], v244 offset:16384
  ds_read_b64_tr_b16 v[226:227], v244 offset:16768
  s_waitcnt lgkmcnt(4)
  v_mfma_f32_32x32x16_bf16 v[128:143], v[232:235], v[32:35], v[128:143]
  ds_read_b64_tr_b16 v[228:229], v244 offset:16512
  ds_read_b64_tr_b16 v[230:231], v244 offset:16896
  s_waitcnt lgkmcnt(4)
  v_mfma_f32_32x32x16_bf16 v[144:159], v[236:239], v[32:35], v[144:159]
  ds_read_b64_tr_b16 v[232:233], v244 offset:16640
  ds_read_b64_tr_b16 v[234:235], v244 offset:17024
  s_add_u32 m0, s30, 32768
  s_nop 0
  buffer_load_dwordx4 v246, s[12:15], s27 offen  lds
  s_waitcnt lgkmcnt(4)
  v_mfma_f32_32x32x16_bf16 v[160:175], v[224:227], v[32:35], v[160:175]
  ds_read_b64_tr_b16 v[236:237], v242 offset:4096
  ds_read_b64_tr_b16 v[238:239], v242 offset:4608
  buffer_store_dwordx4 v[88:91], v250, s[16:19], s72 offen offset:1024 sc1
  s_waitcnt lgkmcnt(4)
  v_mfma_f32_32x32x16_bf16 v[176:191], v[228:231], v[32:35], v[176:191]
  ds_read_b64_tr_b16 v[224:225], v242 offset:4352
  ds_read_b64_tr_b16 v[226:227], v242 offset:4864
  s_waitcnt lgkmcnt(4)
  v_mfma_f32_32x32x16_bf16 v[192:207], v[232:235], v[32:35], v[192:207]
  ds_read_b64_tr_b16 v[228:229], v242 offset:5120
  ds_read_b64_tr_b16 v[230:231], v242 offset:5632
  s_add_u32 m0, s31, 32768
  s_nop 0
  buffer_load_dwordx4 v247, s[12:15], s27 offen  lds
  s_waitcnt lgkmcnt(4)
  v_mfma_f32_32x32x16_bf16 v[96:111], v[236:239], v[36:39], v[96:111]
  ds_read_b64_tr_b16 v[232:233], v242 offset:5376
  ds_read_b64_tr_b16 v[234:235], v242 offset:5888
  s_waitcnt lgkmcnt(4)
  v_mfma_f32_32x32x16_bf16 v[112:127], v[224:227], v[36:39], v[112:127]
  ds_read_b64_tr_b16 v[236:237], v244 offset:17920
  ds_read_b64_tr_b16 v[238:239], v244 offset:18304
  s_waitcnt lgkmcnt(4)
  v_mfma_f32_32x32x16_bf16 v[128:143], v[228:231], v[36:39], v[128:143]
  ds_read_b64_tr_b16 v[224:225], v244 offset:18048
  ds_read_b64_tr_b16 v[226:227], v244 offset:18432
  s_add_u32 m0, s32, 32768
  s_nop 0
  buffer_load_dwordx4 v248, s[12:15], s27 offen  lds
  s_add_u32 s27, s27, s28
  s_cmp_eq_u32 s27, s101
  s_cselect_b32 s27, 0, s27
  s_waitcnt lgkmcnt(4)
  v_mfma_f32_32x32x16_bf16 v[144:159], v[232:235], v[36:39], v[144:159]
  ds_read_b64_tr_b16 v[228:229], v244 offset:18176
  ds_read_b64_tr_b16 v[230:231], v244 offset:18560
  s_waitcnt lgkmcnt(4)
  v_mfma_f32_32x32x16_bf16 v[160:175], v[236:239], v[36:39], v[160:175]
  ds_read_b64_tr_b16 v[232:233], v242 offset:8192
  ds_read_b64_tr_b16 v[234:235], v242 offset:8704
  buffer_store_dwordx4 v[92:95], v250, s[16:19], s73 offen offset:1024 sc1
  s_waitcnt lgkmcnt(4)
  v_mfma_f32_32x32x16_bf16 v[176:191], v[224:227], v[36:39], v[176:191]
  ds_read_b64_tr_b16 v[236:237], v242 offset:8448
  ds_read_b64_tr_b16 v[238:239], v242 offset:8960
  buffer_load_dwordx4 v[16:19], v250, s[8:11], s62 offen offset:0 sc1
  s_waitcnt lgkmcnt(4)
  v_mfma_f32_32x32x16_bf16 v[192:207], v[228:231], v[36:39], v[192:207]
  ds_read_b64_tr_b16 v[224:225], v242 offset:9216
  ds_read_b64_tr_b16 v[226:227], v242 offset:9728
  s_waitcnt lgkmcnt(4)
  v_mfma_f32_32x32x16_bf16 v[96:111], v[232:235], v[40:43], v[96:111]
  ds_read_b64_tr_b16 v[228:229], v242 offset:9472
  ds_read_b64_tr_b16 v[230:231], v242 offset:9984
  s_waitcnt lgkmcnt(4)
  v_mfma_f32_32x32x16_bf16 v[112:127], v[236:239], v[40:43], v[112:127]
  ds_read_b64_tr_b16 v[232:233], v244 offset:19456
  ds_read_b64_tr_b16 v[234:235], v244 offset:19840
  buffer_load_dwordx4 v[20:23], v250, s[8:11], s62 offen offset:1024 sc1
  s_waitcnt lgkmcnt(4)
  v_mfma_f32_32x32x16_bf16 v[128:143], v[224:227], v[40:43], v[128:143]
  ds_read_b64_tr_b16 v[236:237], v244 offset:19584
  ds_read_b64_tr_b16 v[238:239], v244 offset:19968
  s_waitcnt lgkmcnt(4)
  v_mfma_f32_32x32x16_bf16 v[144:159], v[228:231], v[40:43], v[144:159]
  ds_read_b64_tr_b16 v[224:225], v244 offset:19712
  ds_read_b64_tr_b16 v[226:227], v244 offset:20096
  s_waitcnt lgkmcnt(4)
  v_mfma_f32_32x32x16_bf16 v[160:175], v[232:235], v[40:43], v[160:175]
  ds_read_b64_tr_b16 v[228:229], v242 offset:12288
  ds_read_b64_tr_b16 v[230:231], v242 offset:12800
  buffer_store_dwordx4 v[216:219], v250, s[16:19], s72 offen offset:2048 sc1
  buffer_load_dwordx4 v[24:27], v250, s[8:11], s62 offen offset:2048 sc1
  s_waitcnt lgkmcnt(4)
  v_mfma_f32_32x32x16_bf16 v[176:191], v[236:239], v[40:43], v[176:191]
  ds_read_b64_tr_b16 v[232:233], v242 offset:12544
  ds_read_b64_tr_b16 v[234:235], v242 offset:13056
  s_waitcnt lgkmcnt(4)
  v_mfma_f32_32x32x16_bf16 v[192:207], v[224:227], v[40:43], v[192:207]
  ds_read_b64_tr_b16 v[236:237], v242 offset:13312
  ds_read_b64_tr_b16 v[238:239], v242 offset:13824
  s_waitcnt lgkmcnt(4)
  v_mfma_f32_32x32x16_bf16 v[96:111], v[228:231], v[44:47], v[96:111]
  ds_read_b64_tr_b16 v[224:225], v242 offset:13568
  ds_read_b64_tr_b16 v[226:227], v242 offset:14080
  buffer_load_dwordx4 v[28:31], v250, s[8:11], s62 offen offset:3072 sc1
  s_add_u32 s62, s62, 4096
  s_and_b32 s62, s62, 32767
  s_or_b32 s62, s62, s48
  s_waitcnt lgkmcnt(4)
  v_mfma_f32_32x32x16_bf16 v[112:127], v[232:235], v[44:47], v[112:127]
  ds_read_b64_tr_b16 v[228:229], v244 offset:20992
  ds_read_b64_tr_b16 v[230:231], v244 offset:21376
  s_waitcnt lgkmcnt(4)
  v_mfma_f32_32x32x16_bf16 v[128:143], v[236:239], v[44:47], v[128:143]
  ds_read_b64_tr_b16 v[232:233], v244 offset:21120
  ds_read_b64_tr_b16 v[234:235], v244 offset:21504
  s_waitcnt lgkmcnt(4)
  v_mfma_f32_32x32x16_bf16 v[144:159], v[224:227], v[44:47], v[144:159]
  ds_read_b64_tr_b16 v[236:237], v244 offset:21248
  ds_read_b64_tr_b16 v[238:239], v244 offset:21632
  s_waitcnt lgkmcnt(4)
  v_mfma_f32_32x32x16_bf16 v[160:175], v[228:231], v[44:47], v[160:175]
  s_waitcnt vmcnt(22)
  s_barrier
  ds_read_b64_tr_b16 v[224:225], v242 offset:32768
  ds_read_b64_tr_b16 v[226:227], v242 offset:33280
  s_waitcnt lgkmcnt(4)
  v_mfma_f32_32x32x16_bf16 v[176:191], v[232:235], v[44:47], v[176:191]
  ds_read_b64_tr_b16 v[228:229], v242 offset:33024
  ds_read_b64_tr_b16 v[230:231], v242 offset:33536
  s_waitcnt lgkmcnt(4)
  v_mfma_f32_32x32x16_bf16 v[192:207], v[236:239], v[44:47], v[192:207]
  ds_read_b64_tr_b16 v[232:233], v242 offset:33792
  ds_read_b64_tr_b16 v[234:235], v242 offset:34304
  s_waitcnt lgkmcnt(4)
  v_mfma_f32_32x32x16_bf16 v[96:111], v[224:227], v[48:51], v[96:111]
  ds_read_b64_tr_b16 v[236:237], v242 offset:34048
  ds_read_b64_tr_b16 v[238:239], v242 offset:34560
  s_add_u32 m0, s29, 65536
  s_nop 0
  buffer_load_dwordx4 v245, s[12:15], s27 offen  lds
  s_waitcnt lgkmcnt(4)
  v_mfma_f32_32x32x16_bf16 v[112:127], v[228:231], v[48:51], v[112:127]
  ds_read_b64_tr_b16 v[224:225], v244 offset:49152
  ds_read_b64_tr_b16 v[226:227], v244 offset:49536
  s_waitcnt lgkmcnt(4)
  v_mfma_f32_32x32x16_bf16 v[128:143], v[232:235], v[48:51], v[128:143]
  ds_read_b64_tr_b16 v[228:229], v244 offset:49280
  ds_read_b64_tr_b16 v[230:231], v244 offset:49664
  s_waitcnt lgkmcnt(4)
  v_mfma_f32_32x32x16_bf16 v[144:159], v[236:239], v[48:51], v[144:159]
  ds_read_b64_tr_b16 v[232:233], v244 offset:49408
  ds_read_b64_tr_b16 v[234:235], v244 offset:49792
  s_add_u32 m0, s30, 65536
  s_nop 0
  buffer_load_dwordx4 v246, s[12:15], s27 offen  lds
  s_waitcnt lgkmcnt(4)
  v_mfma_f32_32x32x16_bf16 v[160:175], v[224:227], v[48:51], v[160:175]
  ds_read_b64_tr_b16 v[236:237], v242 offset:36864
  ds_read_b64_tr_b16 v[238:239], v242 offset:37376
  buffer_store_dwordx4 v[220:223], v250, s[16:19], s73 offen offset:2048 sc1
  s_waitcnt lgkmcnt(4)
  v_mfma_f32_32x32x16_bf16 v[176:191], v[228:231], v[48:51], v[176:191]
  ds_read_b64_tr_b16 v[224:225], v242 offset:37120
  ds_read_b64_tr_b16 v[226:227], v242 offset:37632
  s_waitcnt lgkmcnt(4)
  v_mfma_f32_32x32x16_bf16 v[192:207], v[232:235], v[48:51], v[192:207]
  ds_read_b64_tr_b16 v[228:229], v242 offset:37888
  ds_read_b64_tr_b16 v[230:231], v242 offset:38400
  s_add_u32 m0, s31, 65536
  s_nop 0
  buffer_load_dwordx4 v247, s[12:15], s27 offen  lds
  s_waitcnt lgkmcnt(4)
  v_mfma_f32_32x32x16_bf16 v[96:111], v[236:239], v[52:55], v[96:111]
  ds_read_b64_tr_b16 v[232:233], v242 offset:38144
  ds_read_b64_tr_b16 v[234:235], v242 offset:38656
  s_waitcnt lgkmcnt(4)
  v_mfma_f32_32x32x16_bf16 v[112:127], v[224:227], v[52:55], v[112:127]
  ds_read_b64_tr_b16 v[236:237], v244 offset:50688
  ds_read_b64_tr_b16 v[238:239], v244 offset:51072
  s_waitcnt lgkmcnt(4)
  v_mfma_f32_32x32x16_bf16 v[128:143], v[228:231], v[52:55], v[128:143]
  ds_read_b64_tr_b16 v[224:225], v244 offset:50816
  ds_read_b64_tr_b16 v[226:227], v244 offset:51200
  s_add_u32 m0, s32, 65536
  s_nop 0
  buffer_load_dwordx4 v248, s[12:15], s27 offen  lds
  s_add_u32 s27, s27, s28
  s_cmp_eq_u32 s27, s101
  s_cselect_b32 s27, 0, s27
  s_waitcnt lgkmcnt(4)
  v_mfma_f32_32x32x16_bf16 v[144:159], v[232:235], v[52:55], v[144:159]
  ds_read_b64_tr_b16 v[228:229], v244 offset:50944
  ds_read_b64_tr_b16 v[230:231], v244 offset:51328
  s_waitcnt lgkmcnt(4)
  v_mfma_f32_32x32x16_bf16 v[160:175], v[236:239], v[52:55], v[160:175]
  ds_read_b64_tr_b16 v[232:233], v242 offset:40960
  ds_read_b64_tr_b16 v[234:235], v242 offset:41472
  buffer_store_dwordx4 v[208:211], v250, s[16:19], s72 offen offset:3072 sc1
  s_waitcnt lgkmcnt(4)
  v_mfma_f32_32x32x16_bf16 v[176:191], v[224:227], v[52:55], v[176:191]
  ds_read_b64_tr_b16 v[236:237], v242 offset:41216
  ds_read_b64_tr_b16 v[238:239], v242 offset:41728
  buffer_load_dwordx4 v[32:35], v250, s[8:11], s62 offen offset:0 sc1
  s_waitcnt lgkmcnt(4)
  v_mfma_f32_32x32x16_bf16 v[192:207], v[228:231], v[52:55], v[192:207]
  ds_read_b64_tr_b16 v[224:225], v242 offset:41984
  ds_read_b64_tr_b16 v[226:227], v242 offset:42496
  s_waitcnt lgkmcnt(4)
  v_mfma_f32_32x32x16_bf16 v[96:111], v[232:235], v[56:59], v[96:111]
  ds_read_b64_tr_b16 v[228:229], v242 offset:42240
  ds_read_b64_tr_b16 v[230:231], v242 offset:42752
  s_waitcnt lgkmcnt(4)
  v_mfma_f32_32x32x16_bf16 v[112:127], v[236:239], v[56:59], v[112:127]
  ds_read_b64_tr_b16 v[232:233], v244 offset:52224
  ds_read_b64_tr_b16 v[234:235], v244 offset:52608
  buffer_load_dwordx4 v[36:39], v250, s[8:11], s62 offen offset:1024 sc1
  s_waitcnt lgkmcnt(4)
  v_mfma_f32_32x32x16_bf16 v[128:143], v[224:227], v[56:59], v[128:143]
  ds_read_b64_tr_b16 v[236:237], v244 offset:52352
  ds_read_b64_tr_b16 v[238:239], v244 offset:52736
  s_waitcnt lgkmcnt(4)
  v_mfma_f32_32x32x16_bf16 v[144:159], v[228:231], v[56:59], v[144:159]
  ds_read_b64_tr_b16 v[224:225], v244 offset:52480
  ds_read_b64_tr_b16 v[226:227], v244 offset:52864
  s_waitcnt lgkmcnt(4)
  v_mfma_f32_32x32x16_bf16 v[160:175], v[232:235], v[56:59], v[160:175]
  ds_read_b64_tr_b16 v[228:229], v242 offset:45056
  ds_read_b64_tr_b16 v[230:231], v242 offset:45568
  buffer_store_dwordx4 v[212:215], v250, s[16:19], s73 offen offset:3072 sc1
  buffer_load_dwordx4 v[40:43], v250, s[8:11], s62 offen offset:2048 sc1
  s_waitcnt lgkmcnt(4)
  v_mfma_f32_32x32x16_bf16 v[176:191], v[236:239], v[56:59], v[176:191]
  ds_read_b64_tr_b16 v[232:233], v242 offset:45312
  ds_read_b64_tr_b16 v[234:235], v242 offset:45824
  s_waitcnt lgkmcnt(4)
  v_mfma_f32_32x32x16_bf16 v[192:207], v[224:227], v[56:59], v[192:207]
  ds_read_b64_tr_b16 v[236:237], v242 offset:46080
  ds_read_b64_tr_b16 v[238:239], v242 offset:46592
  s_waitcnt lgkmcnt(4)
  v_mfma_f32_32x32x16_bf16 v[96:111], v[228:231], v[60:63], v[96:111]
  ds_read_b64_tr_b16 v[224:225], v242 offset:46336
  ds_read_b64_tr_b16 v[226:227], v242 offset:46848
  buffer_load_dwordx4 v[44:47], v250, s[8:11], s62 offen offset:3072 sc1
  s_add_u32 s62, s62, 4096
  s_and_b32 s62, s62, 32767
  s_or_b32 s62, s62, s48
  s_waitcnt lgkmcnt(4)
  v_mfma_f32_32x32x16_bf16 v[112:127], v[232:235], v[60:63], v[112:127]
  ds_read_b64_tr_b16 v[228:229], v244 offset:53760
  ds_read_b64_tr_b16 v[230:231], v244 offset:54144
  s_waitcnt lgkmcnt(4)
  v_mfma_f32_32x32x16_bf16 v[128:143], v[236:239], v[60:63], v[128:143]
  ds_read_b64_tr_b16 v[232:233], v244 offset:53888
  ds_read_b64_tr_b16 v[234:235], v244 offset:54272
  s_waitcnt lgkmcnt(4)
  v_mfma_f32_32x32x16_bf16 v[144:159], v[224:227], v[60:63], v[144:159]
  ds_read_b64_tr_b16 v[236:237], v244 offset:54016
  ds_read_b64_tr_b16 v[238:239], v244 offset:54400
  s_waitcnt lgkmcnt(4)
  v_mfma_f32_32x32x16_bf16 v[160:175], v[228:231], v[60:63], v[160:175]
  s_waitcnt vmcnt(22)
  s_barrier
  ds_read_b64_tr_b16 v[224:225], v241 offset:0
  ds_read_b64_tr_b16 v[226:227], v241 offset:512
  s_waitcnt lgkmcnt(4)
  v_mfma_f32_32x32x16_bf16 v[176:191], v[232:235], v[60:63], v[176:191]
  ds_read_b64_tr_b16 v[228:229], v241 offset:256
  ds_read_b64_tr_b16 v[230:231], v241 offset:768
  s_waitcnt lgkmcnt(4)
  v_mfma_f32_32x32x16_bf16 v[192:207], v[236:239], v[60:63], v[192:207]
  ds_read_b64_tr_b16 v[232:233], v241 offset:1024
  ds_read_b64_tr_b16 v[234:235], v241 offset:1536
  s_waitcnt lgkmcnt(4)
  v_mfma_f32_32x32x16_bf16 v[96:111], v[224:227], v[0:3], v[96:111]
  ds_read_b64_tr_b16 v[236:237], v241 offset:1280
  ds_read_b64_tr_b16 v[238:239], v241 offset:1792
  s_add_u32 m0, s29, 98304
  s_nop 0
  buffer_load_dwordx4 v245, s[12:15], s27 offen  lds
  s_waitcnt lgkmcnt(4)
  v_mfma_f32_32x32x16_bf16 v[112:127], v[228:231], v[0:3], v[112:127]
  ds_read_b64_tr_b16 v[224:225], v243 offset:16384
  ds_read_b64_tr_b16 v[226:227], v243 offset:16768
  s_waitcnt lgkmcnt(4)
  v_mfma_f32_32x32x16_bf16 v[128:143], v[232:235], v[0:3], v[128:143]
  ds_read_b64_tr_b16 v[228:229], v243 offset:16512
  ds_read_b64_tr_b16 v[230:231], v243 offset:16896
  s_waitcnt lgkmcnt(4)
  v_mfma_f32_32x32x16_bf16 v[144:159], v[236:239], v[0:3], v[144:159]
  ds_read_b64_tr_b16 v[232:233], v243 offset:16640
  ds_read_b64_tr_b16 v[234:235], v243 offset:17024
  s_add_u32 m0, s30, 98304
  s_nop 0
  buffer_load_dwordx4 v246, s[12:15], s27 offen  lds
  s_waitcnt lgkmcnt(4)
  v_mfma_f32_32x32x16_bf16 v[160:175], v[224:227], v[0:3], v[160:175]
  ds_read_b64_tr_b16 v[236:237], v241 offset:4096
  ds_read_b64_tr_b16 v[238:239], v241 offset:4608
  s_waitcnt lgkmcnt(4)
  v_mfma_f32_32x32x16_bf16 v[176:191], v[228:231], v[0:3], v[176:191]
  ds_read_b64_tr_b16 v[224:225], v241 offset:4352
  ds_read_b64_tr_b16 v[226:227], v241 offset:4864
  s_waitcnt lgkmcnt(4)
  v_mfma_f32_32x32x16_bf16 v[192:207], v[232:235], v[0:3], v[192:207]
  ds_read_b64_tr_b16 v[228:229], v241 offset:5120
  ds_read_b64_tr_b16 v[230:231], v241 offset:5632
  s_add_u32 m0, s31, 98304
  s_nop 0
  buffer_load_dwordx4 v247, s[12:15], s27 offen  lds
  s_waitcnt lgkmcnt(4)
  v_mfma_f32_32x32x16_bf16 v[96:111], v[236:239], v[4:7], v[96:111]
  ds_read_b64_tr_b16 v[232:233], v241 offset:5376
  ds_read_b64_tr_b16 v[234:235], v241 offset:5888
  s_waitcnt lgkmcnt(4)
  v_mfma_f32_32x32x16_bf16 v[112:127], v[224:227], v[4:7], v[112:127]
  ds_read_b64_tr_b16 v[236:237], v243 offset:17920
  ds_read_b64_tr_b16 v[238:239], v243 offset:18304
  s_waitcnt lgkmcnt(4)
  v_mfma_f32_32x32x16_bf16 v[128:143], v[228:231], v[4:7], v[128:143]
  ds_read_b64_tr_b16 v[224:225], v243 offset:18048
  ds_read_b64_tr_b16 v[226:227], v243 offset:18432
  s_add_u32 m0, s32, 98304
  s_nop 0
  buffer_load_dwordx4 v248, s[12:15], s27 offen  lds
  s_add_u32 s27, s27, s28
  s_cmp_eq_u32 s27, s101
  s_cselect_b32 s27, 0, s27
  s_waitcnt lgkmcnt(4)
  v_mfma_f32_32x32x16_bf16 v[144:159], v[232:235], v[4:7], v[144:159]
  ds_read_b64_tr_b16 v[228:229], v243 offset:18176
  ds_read_b64_tr_b16 v[230:231], v243 offset:18560
  s_waitcnt lgkmcnt(4)
  v_mfma_f32_32x32x16_bf16 v[160:175], v[236:239], v[4:7], v[160:175]
  ds_read_b64_tr_b16 v[232:233], v241 offset:8192
  ds_read_b64_tr_b16 v[234:235], v241 offset:8704
  s_waitcnt lgkmcnt(4)
  v_mfma_f32_32x32x16_bf16 v[176:191], v[224:227], v[4:7], v[176:191]
  ds_read_b64_tr_b16 v[236:237], v241 offset:8448
  ds_read_b64_tr_b16 v[238:239], v241 offset:8960
  buffer_load_dwordx4 v[48:51], v250, s[8:11], s62 offen offset:0 sc1
  s_waitcnt lgkmcnt(4)
  v_mfma_f32_32x32x16_bf16 v[192:207], v[228:231], v[4:7], v[192:207]
  ds_read_b64_tr_b16 v[224:225], v241 offset:9216
  ds_read_b64_tr_b16 v[226:227], v241 offset:9728
  s_waitcnt lgkmcnt(4)
  v_mfma_f32_32x32x16_bf16 v[96:111], v[232:235], v[8:11], v[96:111]
  ds_read_b64_tr_b16 v[228:229], v241 offset:9472
  ds_read_b64_tr_b16 v[230:231], v241 offset:9984
  s_waitcnt lgkmcnt(4)
  v_mfma_f32_32x32x16_bf16 v[112:127], v[236:239], v[8:11], v[112:127]
  ds_read_b64_tr_b16 v[232:233], v243 offset:19456
  ds_read_b64_tr_b16 v[234:235], v243 offset:19840
  buffer_load_dwordx4 v[52:55], v250, s[8:11], s62 offen offset:1024 sc1
  s_waitcnt lgkmcnt(4)
  v_mfma_f32_32x32x16_bf16 v[128:143], v[224:227], v[8:11], v[128:143]
  ds_read_b64_tr_b16 v[236:237], v243 offset:19584
  ds_read_b64_tr_b16 v[238:239], v243 offset:19968
  s_waitcnt lgkmcnt(4)
  v_mfma_f32_32x32x16_bf16 v[144:159], v[228:231], v[8:11], v[144:159]
  ds_read_b64_tr_b16 v[224:225], v243 offset:19712
  ds_read_b64_tr_b16 v[226:227], v243 offset:20096
  s_waitcnt lgkmcnt(4)
  v_mfma_f32_32x32x16_bf16 v[160:175], v[232:235], v[8:11], v[160:175]
  ds_read_b64_tr_b16 v[228:229], v241 offset:12288
  ds_read_b64_tr_b16 v[230:231], v241 offset:12800
  buffer_load_dwordx4 v[56:59], v250, s[8:11], s62 offen offset:2048 sc1
  s_waitcnt lgkmcnt(4)
  v_mfma_f32_32x32x16_bf16 v[176:191], v[236:239], v[8:11], v[176:191]
  ds_read_b64_tr_b16 v[232:233], v241 offset:12544
  ds_read_b64_tr_b16 v[234:235], v241 offset:13056
  s_waitcnt lgkmcnt(4)
  v_mfma_f32_32x32x16_bf16 v[192:207], v[224:227], v[8:11], v[192:207]
  ds_read_b64_tr_b16 v[236:237], v241 offset:13312
  ds_read_b64_tr_b16 v[238:239], v241 offset:13824
  s_waitcnt lgkmcnt(4)
  v_mfma_f32_32x32x16_bf16 v[96:111], v[228:231], v[12:15], v[96:111]
  ds_read_b64_tr_b16 v[224:225], v241 offset:13568
  ds_read_b64_tr_b16 v[226:227], v241 offset:14080
  buffer_load_dwordx4 v[60:63], v250, s[8:11], s62 offen offset:3072 sc1
  s_add_u32 s62, s62, 4096
  s_and_b32 s62, s62, 32767
  s_or_b32 s62, s62, s48
  s_waitcnt lgkmcnt(4)
  v_mfma_f32_32x32x16_bf16 v[112:127], v[232:235], v[12:15], v[112:127]
  ds_read_b64_tr_b16 v[228:229], v243 offset:20992
  ds_read_b64_tr_b16 v[230:231], v243 offset:21376
  s_waitcnt lgkmcnt(4)
  v_mfma_f32_32x32x16_bf16 v[128:143], v[236:239], v[12:15], v[128:143]
  ds_read_b64_tr_b16 v[232:233], v243 offset:21120
  ds_read_b64_tr_b16 v[234:235], v243 offset:21504
  s_waitcnt lgkmcnt(4)
  v_mfma_f32_32x32x16_bf16 v[144:159], v[224:227], v[12:15], v[144:159]
  ds_read_b64_tr_b16 v[236:237], v243 offset:21248
  ds_read_b64_tr_b16 v[238:239], v243 offset:21632
  s_waitcnt lgkmcnt(4)
  v_mfma_f32_32x32x16_bf16 v[160:175], v[228:231], v[12:15], v[160:175]
  s_waitcnt vmcnt(10)
  s_barrier
  s_cmp_eq_u32 s26, 0
  s_cbranch_scc1 sg_do3
sg_back3:
  ds_read_b64_tr_b16 v[224:225], v241 offset:32768
  ds_read_b64_tr_b16 v[226:227], v241 offset:33280
  s_waitcnt lgkmcnt(4)
  v_mfma_f32_32x32x16_bf16 v[176:191], v[232:235], v[12:15], v[176:191]
  ds_read_b64_tr_b16 v[228:229], v241 offset:33024
  ds_read_b64_tr_b16 v[230:231], v241 offset:33536
  s_waitcnt lgkmcnt(4)
  v_mfma_f32_32x32x16_bf16 v[192:207], v[236:239], v[12:15], v[192:207]
  ds_read_b64_tr_b16 v[232:233], v241 offset:33792
  ds_read_b64_tr_b16 v[234:235], v241 offset:34304
  s_waitcnt lgkmcnt(4)
  v_mfma_f32_32x32x16_bf16 v[96:111], v[224:227], v[16:19], v[96:111]
  ds_read_b64_tr_b16 v[236:237], v241 offset:34048
  ds_read_b64_tr_b16 v[238:239], v241 offset:34560
  s_mov_b32 s35, 0x2000
  buffer_load_dword v72, v254, s[4:7], 0 offen offset:0
  s_waitcnt lgkmcnt(4)
  v_mfma_f32_32x32x16_bf16 v[112:127], v[228:231], v[16:19], v[112:127]
  ds_read_b64_tr_b16 v[224:225], v243 offset:49152
  ds_read_b64_tr_b16 v[226:227], v243 offset:49536
  buffer_load_dword v76, v254, s[4:7], 0 offen offset:1024
  s_waitcnt lgkmcnt(4)
  v_mfma_f32_32x32x16_bf16 v[128:143], v[232:235], v[16:19], v[128:143]
  ds_read_b64_tr_b16 v[228:229], v243 offset:49280
  ds_read_b64_tr_b16 v[230:231], v243 offset:49664
  buffer_load_dword v73, v254, s[4:7], 0 offen offset:2048
  s_waitcnt lgkmcnt(4)
  v_mfma_f32_32x32x16_bf16 v[144:159], v[236:239], v[16:19], v[144:159]
  ds_read_b64_tr_b16 v[232:233], v243 offset:49408
  ds_read_b64_tr_b16 v[234:235], v243 offset:49792
  buffer_load_dword v77, v254, s[4:7], 0 offen offset:3072
  s_waitcnt lgkmcnt(4)
  v_mfma_f32_32x32x16_bf16 v[160:175], v[224:227], v[16:19], v[160:175]
  ds_read_b64_tr_b16 v[236:237], v241 offset:36864
  ds_read_b64_tr_b16 v[238:239], v241 offset:37376
  buffer_load_dword v74, v254, s[4:7], s35 offen offset:0
  s_waitcnt lgkmcnt(4)
  v_mfma_f32_32x32x16_bf16 v[176:191], v[228:231], v[16:19], v[176:191]
  ds_read_b64_tr_b16 v[224:225], v241 offset:37120
  ds_read_b64_tr_b16 v[226:227], v241 offset:37632
  buffer_load_dword v78, v254, s[4:7], s35 offen offset:1024
  s_waitcnt lgkmcnt(4)
  v_mfma_f32_32x32x16_bf16 v[192:207], v[232:235], v[16:19], v[192:207]
  ds_read_b64_tr_b16 v[228:229], v241 offset:37888
  ds_read_b64_tr_b16 v[230:231], v241 offset:38400
  buffer_load_dword v75, v254, s[4:7], s35 offen offset:2048
  s_waitcnt lgkmcnt(4)
  v_mfma_f32_32x32x16_bf16 v[96:111], v[236:239], v[20:23], v[96:111]
  ds_read_b64_tr_b16 v[232:233], v241 offset:38144
  ds_read_b64_tr_b16 v[234:235], v241 offset:38656
  buffer_load_dword v79, v254, s[4:7], s35 offen offset:3072
  s_waitcnt lgkmcnt(4)
  v_mfma_f32_32x32x16_bf16 v[112:127], v[224:227], v[20:23], v[112:127]
  ds_read_b64_tr_b16 v[236:237], v243 offset:50688
  ds_read_b64_tr_b16 v[238:239], v243 offset:51072
  buffer_load_dword v80, v254, s[4:7], 0 offen offset:128
  s_waitcnt lgkmcnt(4)
  v_mfma_f32_32x32x16_bf16 v[128:143], v[228:231], v[20:23], v[128:143]
  ds_read_b64_tr_b16 v[224:225], v243 offset:50816
  ds_read_b64_tr_b16 v[226:227], v243 offset:51200
  buffer_load_dword v84, v254, s[4:7], 0 offen offset:1152
  s_waitcnt lgkmcnt(4)
  v_mfma_f32_32x32x16_bf16 v[144:159], v[232:235], v[20:23], v[144:159]
  ds_read_b64_tr_b16 v[228:229], v243 offset:50944
  ds_read_b64_tr_b16 v[230:231], v243 offset:51328
  buffer_load_dword v81, v254, s[4:7], 0 offen offset:2176
  s_waitcnt lgkmcnt(4)
  v_mfma_f32_32x32x16_bf16 v[160:175], v[236:239], v[20:23], v[160:175]
  ds_read_b64_tr_b16 v[232:233], v241 offset:40960
  ds_read_b64_tr_b16 v[234:235], v241 offset:41472
  buffer_load_dword v85, v254, s[4:7], 0 offen offset:3200
  s_waitcnt lgkmcnt(4)
  v_mfma_f32_32x32x16_bf16 v[176:191], v[224:227], v[20:23], v[176:191]
  ds_read_b64_tr_b16 v[236:237], v241 offset:41216
  ds_read_b64_tr_b16 v[238:239], v241 offset:41728
  buffer_load_dword v82, v254, s[4:7], s35 offen offset:128
  s_waitcnt lgkmcnt(4)
  v_mfma_f32_32x32x16_bf16 v[192:207], v[228:231], v[20:23], v[192:207]
  ds_read_b64_tr_b16 v[224:225], v241 offset:41984
  ds_read_b64_tr_b16 v[226:227], v241 offset:42496
  buffer_load_dword v86, v254, s[4:7], s35 offen offset:1152
  s_waitcnt lgkmcnt(4)
  v_mfma_f32_32x32x16_bf16 v[96:111], v[232:235], v[24:27], v[96:111]
  ds_read_b64_tr_b16 v[228:229], v241 offset:42240
  ds_read_b64_tr_b16 v[230:231], v241 offset:42752
  buffer_load_dword v83, v254, s[4:7], s35 offen offset:2176
  s_waitcnt lgkmcnt(4)
  v_mfma_f32_32x32x16_bf16 v[112:127], v[236:239], v[24:27], v[112:127]
  ds_read_b64_tr_b16 v[232:233], v243 offset:52224
  ds_read_b64_tr_b16 v[234:235], v243 offset:52608
  buffer_load_dword v87, v254, s[4:7], s35 offen offset:3200
  s_waitcnt lgkmcnt(4)
  v_mfma_f32_32x32x16_bf16 v[128:143], v[224:227], v[24:27], v[128:143]
  ds_read_b64_tr_b16 v[236:237], v243 offset:52352
  ds_read_b64_tr_b16 v[238:239], v243 offset:52736
  s_waitcnt lgkmcnt(4)
  v_mfma_f32_32x32x16_bf16 v[144:159], v[228:231], v[24:27], v[144:159]
  ds_read_b64_tr_b16 v[224:225], v243 offset:52480
  ds_read_b64_tr_b16 v[226:227], v243 offset:52864
  s_waitcnt lgkmcnt(4)
  v_mfma_f32_32x32x16_bf16 v[160:175], v[232:235], v[24:27], v[160:175]
  ds_read_b64_tr_b16 v[228:229], v241 offset:45056
  ds_read_b64_tr_b16 v[230:231], v241 offset:45568
  s_waitcnt lgkmcnt(4)
  v_mfma_f32_32x32x16_bf16 v[176:191], v[236:239], v[24:27], v[176:191]
  ds_read_b64_tr_b16 v[232:233], v241 offset:45312
  ds_read_b64_tr_b16 v[234:235], v241 offset:45824
  s_waitcnt lgkmcnt(4)
  v_mfma_f32_32x32x16_bf16 v[192:207], v[224:227], v[24:27], v[192:207]
  ds_read_b64_tr_b16 v[236:237], v241 offset:46080
  ds_read_b64_tr_b16 v[238:239], v241 offset:46592
  s_waitcnt lgkmcnt(4)
  v_mfma_f32_32x32x16_bf16 v[96:111], v[228:231], v[28:31], v[96:111]
  ds_read_b64_tr_b16 v[224:225], v241 offset:46336
  ds_read_b64_tr_b16 v[226:227], v241 offset:46848
  s_waitcnt lgkmcnt(4)
  v_mfma_f32_32x32x16_bf16 v[112:127], v[232:235], v[28:31], v[112:127]
  ds_read_b64_tr_b16 v[228:229], v243 offset:53760
  ds_read_b64_tr_b16 v[230:231], v243 offset:54144
  s_waitcnt lgkmcnt(4)
  v_mfma_f32_32x32x16_bf16 v[128:143], v[236:239], v[28:31], v[128:143]
  ds_read_b64_tr_b16 v[232:233], v243 offset:53888
  ds_read_b64_tr_b16 v[234:235], v243 offset:54272
  s_waitcnt lgkmcnt(4)
  v_mfma_f32_32x32x16_bf16 v[144:159], v[224:227], v[28:31], v[144:159]
  ds_read_b64_tr_b16 v[236:237], v243 offset:54016
  ds_read_b64_tr_b16 v[238:239], v243 offset:54400
  s_waitcnt lgkmcnt(4)
  v_mfma_f32_32x32x16_bf16 v[160:175], v[228:231], v[28:31], v[160:175]
  s_waitcnt vmcnt(24)
  s_barrier
  ds_read_b64_tr_b16 v[224:225], v242 offset:0
  ds_read_b64_tr_b16 v[226:227], v242 offset:512
  s_waitcnt lgkmcnt(4)
  v_mfma_f32_32x32x16_bf16 v[176:191], v[232:235], v[28:31], v[176:191]
  ds_read_b64_tr_b16 v[228:229], v242 offset:256
  ds_read_b64_tr_b16 v[230:231], v242 offset:768
  s_waitcnt lgkmcnt(4)
  v_mfma_f32_32x32x16_bf16 v[192:207], v[236:239], v[28:31], v[192:207]
  ds_read_b64_tr_b16 v[232:233], v242 offset:1024
  ds_read_b64_tr_b16 v[234:235], v242 offset:1536
  s_waitcnt lgkmcnt(4)
  v_mfma_f32_32x32x16_bf16 v[96:111], v[224:227], v[32:35], v[96:111]
  ds_read_b64_tr_b16 v[236:237], v242 offset:1280
  ds_read_b64_tr_b16 v[238:239], v242 offset:1792
  s_waitcnt lgkmcnt(4)
  v_mfma_f32_32x32x16_bf16 v[112:127], v[228:231], v[32:35], v[112:127]
  ds_read_b64_tr_b16 v[224:225], v244 offset:16384
  ds_read_b64_tr_b16 v[226:227], v244 offset:16768
  s_waitcnt lgkmcnt(4)
  v_mfma_f32_32x32x16_bf16 v[128:143], v[232:235], v[32:35], v[128:143]
  ds_read_b64_tr_b16 v[228:229], v244 offset:16512
  ds_read_b64_tr_b16 v[230:231], v244 offset:16896
  s_waitcnt lgkmcnt(4)
  v_mfma_f32_32x32x16_bf16 v[144:159], v[236:239], v[32:35], v[144:159]
  ds_read_b64_tr_b16 v[232:233], v244 offset:16640
  ds_read_b64_tr_b16 v[234:235], v244 offset:17024
  s_waitcnt lgkmcnt(4)
  v_mfma_f32_32x32x16_bf16 v[160:175], v[224:227], v[32:35], v[160:175]
  ds_read_b64_tr_b16 v[236:237], v242 offset:4096
  ds_read_b64_tr_b16 v[238:239], v242 offset:4608
  s_waitcnt lgkmcnt(4)
  v_mfma_f32_32x32x16_bf16 v[176:191], v[228:231], v[32:35], v[176:191]
  ds_read_b64_tr_b16 v[224:225], v242 offset:4352
  ds_read_b64_tr_b16 v[226:227], v242 offset:4864
  s_waitcnt lgkmcnt(4)
  v_mfma_f32_32x32x16_bf16 v[192:207], v[232:235], v[32:35], v[192:207]
  ds_read_b64_tr_b16 v[228:229], v242 offset:5120
  ds_read_b64_tr_b16 v[230:231], v242 offset:5632
  s_waitcnt lgkmcnt(4)
  v_mfma_f32_32x32x16_bf16 v[96:111], v[236:239], v[36:39], v[96:111]
  ds_read_b64_tr_b16 v[232:233], v242 offset:5376
  ds_read_b64_tr_b16 v[234:235], v242 offset:5888
  s_waitcnt lgkmcnt(4)
  v_mfma_f32_32x32x16_bf16 v[112:127], v[224:227], v[36:39], v[112:127]
  ds_read_b64_tr_b16 v[236:237], v244 offset:17920
  ds_read_b64_tr_b16 v[238:239], v244 offset:18304
  s_waitcnt lgkmcnt(4)
  v_mfma_f32_32x32x16_bf16 v[128:143], v[228:231], v[36:39], v[128:143]
  ds_read_b64_tr_b16 v[224:225], v244 offset:18048
  ds_read_b64_tr_b16 v[226:227], v244 offset:18432
  s_waitcnt lgkmcnt(4)
  v_mfma_f32_32x32x16_bf16 v[144:159], v[232:235], v[36:39], v[144:159]
  ds_read_b64_tr_b16 v[228:229], v244 offset:18176
  ds_read_b64_tr_b16 v[230:231], v244 offset:18560
  s_waitcnt lgkmcnt(4)
  v_mfma_f32_32x32x16_bf16 v[160:175], v[236:239], v[36:39], v[160:175]
  ds_read_b64_tr_b16 v[232:233], v242 offset:8192
  ds_read_b64_tr_b16 v[234:235], v242 offset:8704
  s_waitcnt lgkmcnt(4)
  v_mfma_f32_32x32x16_bf16 v[176:191], v[224:227], v[36:39], v[176:191]
  ds_read_b64_tr_b16 v[236:237], v242 offset:8448
  ds_read_b64_tr_b16 v[238:239], v242 offset:8960
  s_waitcnt lgkmcnt(4)
  v_mfma_f32_32x32x16_bf16 v[192:207], v[228:231], v[36:39], v[192:207]
  ds_read_b64_tr_b16 v[224:225], v242 offset:9216
  ds_read_b64_tr_b16 v[226:227], v242 offset:9728
  s_waitcnt lgkmcnt(4)
  v_mfma_f32_32x32x16_bf16 v[96:111], v[232:235], v[40:43], v[96:111]
  ds_read_b64_tr_b16 v[228:229], v242 offset:9472
  ds_read_b64_tr_b16 v[230:231], v242 offset:9984
  s_mul_i32 s33, s24, 1261568
  s_add_u32 s33, s33, 2097152
  s_waitcnt lgkmcnt(4)
  v_mfma_f32_32x32x16_bf16 v[112:127], v[236:239], v[40:43], v[112:127]
  ds_read_b64_tr_b16 v[232:233], v244 offset:19456
  ds_read_b64_tr_b16 v[234:235], v244 offset:19840
  s_add_u32 s12, s60, s33
  s_addc_u32 s13, s61, 0
  s_waitcnt lgkmcnt(4)
  v_mfma_f32_32x32x16_bf16 v[128:143], v[224:227], v[40:43], v[128:143]
  ds_read_b64_tr_b16 v[236:237], v244 offset:19584
  ds_read_b64_tr_b16 v[238:239], v244 offset:19968
  s_mov_b32 s14, 1261568
  s_lshl_b32 s30, s26, 12
  s_waitcnt lgkmcnt(4)
  v_mfma_f32_32x32x16_bf16 v[144:159], v[228:231], v[40:43], v[144:159]
  ds_read_b64_tr_b16 v[224:225], v244 offset:19712
  ds_read_b64_tr_b16 v[226:227], v244 offset:20096
  v_add_u32 v253, s30, v250
  s_mov_b32 s27, 0
  s_waitcnt lgkmcnt(4)
  v_mfma_f32_32x32x16_bf16 v[160:175], v[232:235], v[40:43], v[160:175]
  ds_read_b64_tr_b16 v[228:229], v242 offset:12288
  ds_read_b64_tr_b16 v[230:231], v242 offset:12800
  s_add_u32 s79, s67, 2
  s_lshl_b32 s79, s79, 14
  s_waitcnt lgkmcnt(4)
  v_mfma_f32_32x32x16_bf16 v[176:191], v[236:239], v[40:43], v[176:191]
  ds_read_b64_tr_b16 v[232:233], v242 offset:12544
  ds_read_b64_tr_b16 v[234:235], v242 offset:13056
  s_mov_b32 s29, 131072
  s_waitcnt lgkmcnt(4)
  v_mfma_f32_32x32x16_bf16 v[192:207], v[224:227], v[40:43], v[192:207]
  ds_read_b64_tr_b16 v[236:237], v242 offset:13312
  ds_read_b64_tr_b16 v[238:239], v242 offset:13824
  s_waitcnt lgkmcnt(4)
  v_mfma_f32_32x32x16_bf16 v[96:111], v[228:231], v[44:47], v[96:111]
  ds_read_b64_tr_b16 v[224:225], v242 offset:13568
  ds_read_b64_tr_b16 v[226:227], v242 offset:14080
  s_waitcnt lgkmcnt(4)
  v_mfma_f32_32x32x16_bf16 v[112:127], v[232:235], v[44:47], v[112:127]
  ds_read_b64_tr_b16 v[228:229], v244 offset:20992
  ds_read_b64_tr_b16 v[230:231], v244 offset:21376
  s_waitcnt lgkmcnt(4)
  v_mfma_f32_32x32x16_bf16 v[128:143], v[236:239], v[44:47], v[128:143]
  ds_read_b64_tr_b16 v[232:233], v244 offset:21120
  ds_read_b64_tr_b16 v[234:235], v244 offset:21504
  s_waitcnt lgkmcnt(4)
  v_mfma_f32_32x32x16_bf16 v[144:159], v[224:227], v[44:47], v[144:159]
  ds_read_b64_tr_b16 v[236:237], v244 offset:21248
  ds_read_b64_tr_b16 v[238:239], v244 offset:21632
  s_waitcnt lgkmcnt(4)
  v_mfma_f32_32x32x16_bf16 v[160:175], v[228:231], v[44:47], v[160:175]
  s_waitcnt vmcnt(16)
  s_barrier
  ds_read_b64_tr_b16 v[224:225], v242 offset:32768
  ds_read_b64_tr_b16 v[226:227], v242 offset:33280
  s_waitcnt lgkmcnt(4)
  v_mfma_f32_32x32x16_bf16 v[176:191], v[232:235], v[44:47], v[176:191]
  ds_read_b64_tr_b16 v[228:229], v242 offset:33024
  ds_read_b64_tr_b16 v[230:231], v242 offset:33536
  s_waitcnt lgkmcnt(4)
  v_mfma_f32_32x32x16_bf16 v[192:207], v[236:239], v[44:47], v[192:207]
  ds_read_b64_tr_b16 v[232:233], v242 offset:33792
  ds_read_b64_tr_b16 v[234:235], v242 offset:34304
  s_waitcnt lgkmcnt(4)
  v_mfma_f32_32x32x16_bf16 v[96:111], v[224:227], v[48:51], v[96:111]
  ds_read_b64_tr_b16 v[236:237], v242 offset:34048
  ds_read_b64_tr_b16 v[238:239], v242 offset:34560
  s_waitcnt lgkmcnt(4)
  v_mfma_f32_32x32x16_bf16 v[112:127], v[228:231], v[48:51], v[112:127]
  ds_read_b64_tr_b16 v[224:225], v244 offset:49152
  ds_read_b64_tr_b16 v[226:227], v244 offset:49536
  s_waitcnt lgkmcnt(4)
  v_mfma_f32_32x32x16_bf16 v[128:143], v[232:235], v[48:51], v[128:143]
  ds_read_b64_tr_b16 v[228:229], v244 offset:49280
  ds_read_b64_tr_b16 v[230:231], v244 offset:49664
  s_waitcnt lgkmcnt(4)
  v_mfma_f32_32x32x16_bf16 v[144:159], v[236:239], v[48:51], v[144:159]
  ds_read_b64_tr_b16 v[232:233], v244 offset:49408
  ds_read_b64_tr_b16 v[234:235], v244 offset:49792
  s_waitcnt lgkmcnt(4)
  v_mfma_f32_32x32x16_bf16 v[160:175], v[224:227], v[48:51], v[160:175]
  ds_read_b64_tr_b16 v[236:237], v242 offset:36864
  ds_read_b64_tr_b16 v[238:239], v242 offset:37376
  s_waitcnt lgkmcnt(4)
  v_mfma_f32_32x32x16_bf16 v[176:191], v[228:231], v[48:51], v[176:191]
  ds_read_b64_tr_b16 v[224:225], v242 offset:37120
  ds_read_b64_tr_b16 v[226:227], v242 offset:37632
  s_waitcnt lgkmcnt(4)
  v_mfma_f32_32x32x16_bf16 v[192:207], v[232:235], v[48:51], v[192:207]
  ds_read_b64_tr_b16 v[228:229], v242 offset:37888
  ds_read_b64_tr_b16 v[230:231], v242 offset:38400
  s_waitcnt lgkmcnt(4)
  v_mfma_f32_32x32x16_bf16 v[96:111], v[236:239], v[52:55], v[96:111]
  ds_read_b64_tr_b16 v[232:233], v242 offset:38144
  ds_read_b64_tr_b16 v[234:235], v242 offset:38656
  buffer_load_dword v251, off, s[96:99], s77 offset:0 sc1
  s_waitcnt vmcnt(1)
  s_mov_b32 s33, 0x05040100
  s_mov_b32 s34, 0x07060302
  s_waitcnt lgkmcnt(4)
  v_mfma_f32_32x32x16_bf16 v[112:127], v[224:227], v[52:55], v[112:127]
  ds_read_b64_tr_b16 v[236:237], v244 offset:50688
  ds_read_b64_tr_b16 v[238:239], v244 offset:51072
  v_perm_b32 v64, v76, v72, s33
  v_perm_b32 v76, v76, v72, s34
  s_waitcnt lgkmcnt(4)
  v_mfma_f32_32x32x16_bf16 v[128:143], v[228:231], v[52:55], v[128:143]
  ds_read_b64_tr_b16 v[224:225], v244 offset:50816
  ds_read_b64_tr_b16 v[226:227], v244 offset:51200
  v_perm_b32 v65, v77, v73, s33
  v_perm_b32 v77, v77, v73, s34
  s_waitcnt lgkmcnt(4)
  v_mfma_f32_32x32x16_bf16 v[144:159], v[232:235], v[52:55], v[144:159]
  ds_read_b64_tr_b16 v[228:229], v244 offset:50944
  ds_read_b64_tr_b16 v[230:231], v244 offset:51328
  v_perm_b32 v66, v78, v74, s33
  v_perm_b32 v78, v78, v74, s34
  s_waitcnt lgkmcnt(4)
  v_mfma_f32_32x32x16_bf16 v[160:175], v[236:239], v[52:55], v[160:175]
  ds_read_b64_tr_b16 v[232:233], v242 offset:40960
  ds_read_b64_tr_b16 v[234:235], v242 offset:41472
  v_perm_b32 v67, v79, v75, s33
  v_perm_b32 v79, v79, v75, s34
  s_waitcnt lgkmcnt(4)
  v_mfma_f32_32x32x16_bf16 v[176:191], v[224:227], v[52:55], v[176:191]
  ds_read_b64_tr_b16 v[236:237], v242 offset:41216
  ds_read_b64_tr_b16 v[238:239], v242 offset:41728
  v_perm_b32 v68, v84, v80, s33
  v_perm_b32 v84, v84, v80, s34
  s_waitcnt lgkmcnt(4)
  v_mfma_f32_32x32x16_bf16 v[192:207], v[228:231], v[52:55], v[192:207]
  ds_read_b64_tr_b16 v[224:225], v242 offset:41984
  ds_read_b64_tr_b16 v[226:227], v242 offset:42496
  v_perm_b32 v69, v85, v81, s33
  v_perm_b32 v85, v85, v81, s34
  s_waitcnt lgkmcnt(4)
  v_mfma_f32_32x32x16_bf16 v[96:111], v[232:235], v[56:59], v[96:111]
  ds_read_b64_tr_b16 v[228:229], v242 offset:42240
  ds_read_b64_tr_b16 v[230:231], v242 offset:42752
  v_perm_b32 v70, v86, v82, s33
  v_perm_b32 v86, v86, v82, s34
  s_waitcnt lgkmcnt(4)
  v_mfma_f32_32x32x16_bf16 v[112:127], v[236:239], v[56:59], v[112:127]
  ds_read_b64_tr_b16 v[232:233], v244 offset:52224
  ds_read_b64_tr_b16 v[234:235], v244 offset:52608
  v_perm_b32 v71, v87, v83, s33
  v_perm_b32 v87, v87, v83, s34
  s_waitcnt lgkmcnt(4)
  v_mfma_f32_32x32x16_bf16 v[128:143], v[224:227], v[56:59], v[128:143]
  ds_read_b64_tr_b16 v[236:237], v244 offset:52352
  ds_read_b64_tr_b16 v[238:239], v244 offset:52736
  buffer_store_dwordx4 v[64:67], v255, s[16:19], s75 offen offset:0 sc1
  s_waitcnt lgkmcnt(4)
  v_mfma_f32_32x32x16_bf16 v[144:159], v[228:231], v[56:59], v[144:159]
  ds_read_b64_tr_b16 v[224:225], v244 offset:52480
  ds_read_b64_tr_b16 v[226:227], v244 offset:52864
  s_waitcnt lgkmcnt(4)
  v_mfma_f32_32x32x16_bf16 v[160:175], v[232:235], v[56:59], v[160:175]
  ds_read_b64_tr_b16 v[228:229], v242 offset:45056
  ds_read_b64_tr_b16 v[230:231], v242 offset:45568
  buffer_store_dwordx4 v[76:79], v255, s[16:19], s75 offen offset:1024 sc1
  s_waitcnt lgkmcnt(4)
  v_mfma_f32_32x32x16_bf16 v[176:191], v[236:239], v[56:59], v[176:191]
  ds_read_b64_tr_b16 v[232:233], v242 offset:45312
  ds_read_b64_tr_b16 v[234:235], v242 offset:45824
  s_waitcnt lgkmcnt(4)
  v_mfma_f32_32x32x16_bf16 v[192:207], v[224:227], v[56:59], v[192:207]
  ds_read_b64_tr_b16 v[236:237], v242 offset:46080
  ds_read_b64_tr_b16 v[238:239], v242 offset:46592
  buffer_store_dwordx4 v[68:71], v255, s[16:19], s75 offen offset:2048 sc1
  s_waitcnt lgkmcnt(4)
  v_mfma_f32_32x32x16_bf16 v[96:111], v[228:231], v[60:63], v[96:111]
  ds_read_b64_tr_b16 v[224:225], v242 offset:46336
  ds_read_b64_tr_b16 v[226:227], v242 offset:46848
  s_waitcnt lgkmcnt(4)
  v_mfma_f32_32x32x16_bf16 v[112:127], v[232:235], v[60:63], v[112:127]
  ds_read_b64_tr_b16 v[228:229], v244 offset:53760
  ds_read_b64_tr_b16 v[230:231], v244 offset:54144
  buffer_store_dwordx4 v[84:87], v255, s[16:19], s75 offen offset:3072 sc1
  s_waitcnt lgkmcnt(4)
  v_mfma_f32_32x32x16_bf16 v[128:143], v[236:239], v[60:63], v[128:143]
  ds_read_b64_tr_b16 v[232:233], v244 offset:53888
  ds_read_b64_tr_b16 v[234:235], v244 offset:54272
  s_waitcnt lgkmcnt(4)
  v_mfma_f32_32x32x16_bf16 v[144:159], v[224:227], v[60:63], v[144:159]
  ds_read_b64_tr_b16 v[236:237], v244 offset:54016
  ds_read_b64_tr_b16 v[238:239], v244 offset:54400
  s_waitcnt lgkmcnt(4)
  v_mfma_f32_32x32x16_bf16 v[160:175], v[228:231], v[60:63], v[160:175]
  s_waitcnt lgkmcnt(2)
  v_mfma_f32_32x32x16_bf16 v[176:191], v[232:235], v[60:63], v[176:191]
  s_waitcnt lgkmcnt(0)
  v_mfma_f32_32x32x16_bf16 v[192:207], v[236:239], v[60:63], v[192:207]
  s_add_u32 s16, s60, 42467328
  s_addc_u32 s17, s61, 0
  s_mov_b32 s18, 22413312
  s_mov_b32 s19, 0x20000
  s_cmp_ge_u32 s26, 4
  s_cbranch_scc1 qe_B
  s_waitcnt vmcnt(4)
  v_readfirstlane_b32 s100, v251
  s_bfe_u32 s100, s100, 524296
  s_cmp_lt_u32 s100, 8
  s_cbranch_scc1 pc_spin4
pc_back4:
  s_mul_i32 s63, s64, 350208
  s_mul_i32 s34, s24, 3
  s_lshl_b32 s35, s34, 10
  s_add_u32 s35, s35, s63
  s_add_u32 s35, s35, 262144
  s_mov_b32 s4, 0x3e0293ee
  s_mov_b32 s5, s4
  s_mov_b32 s33, 0xbdd2d3e8
  v_mov_b32 v63, 0xc0135761
  s_add_u32 m0, s29, s30
  s_add_u32 s29, s29, 0x4000
  buffer_load_dwordx4 v253, s[12:15], s27 offen offset:0 sc1 lds
  v_pk_mul_f32 v[96:97], v[96:97], s[4:5]
  v_pk_mul_f32 v[98:99], v[98:99], s[4:5]
  v_pk_mul_f32 v[100:101], v[100:101], s[4:5]
  v_cvt_pk_bf16_f32 v64, v96, v97
  v_pk_mul_f32 v[102:103], v[102:103], s[4:5]
  v_cvt_pk_bf16_f32 v65, v98, v99
  v_pk_mul_f32 v[104:105], v[104:105], s[4:5]
  v_cvt_pk_bf16_f32 v66, v100, v101
  buffer_load_dwordx4 v253, s[12:15], s27 offen offset:1024 sc1 lds
  v_pk_mul_f32 v[106:107], v[106:107], s[4:5]
  v_cvt_pk_bf16_f32 v67, v102, v103
  v_pk_mul_f32 v[108:109], v[108:109], s[4:5]
  v_cvt_pk_bf16_f32 v68, v104, v105
  v_pk_mul_f32 v[110:111], v[110:111], s[4:5]
  v_cvt_pk_bf16_f32 v69, v106, v107
  v_pk_mul_f32 v[112:113], v[112:113], s[4:5]
  v_cvt_pk_bf16_f32 v70, v108, v109
  buffer_load_dwordx4 v253, s[12:15], s27 offen offset:2048 sc1 lds
  s_and_b32 s29, s29, 0x1ffff
  v_pk_mul_f32 v[114:115], v[114:115], s[4:5]
  v_cvt_pk_bf16_f32 v71, v110, v111
  v_pk_mul_f32 v[116:117], v[116:117], s[4:5]
  v_cvt_pk_bf16_f32 v72, v112, v113
  v_pk_mul_f32 v[118:119], v[118:119], s[4:5]
  v_cvt_pk_bf16_f32 v73, v114, v115
  v_pk_mul_f32 v[120:121], v[120:121], s[4:5]
  v_cvt_pk_bf16_f32 v74, v116, v117
  buffer_load_dwordx4 v253, s[12:15], s27 offen offset:3072 sc1 lds
  s_add_u32 s27, s27, 0x4000
  s_cmp_eq_u32 s27, s79
  s_cselect_b32 s27, 1081344, s27
  s_mov_b32 s29, 0
  v_pk_mul_f32 v[122:123], v[122:123], s[4:5]
  v_cvt_pk_bf16_f32 v75, v118, v119
  v_pk_mul_f32 v[124:125], v[124:125], s[4:5]
  v_cvt_pk_bf16_f32 v76, v120, v121
  v_pk_mul_f32 v[126:127], v[126:127], s[4:5]
  v_cvt_pk_bf16_f32 v77, v122, v123
  v_pk_mul_f32 v[128:129], v[128:129], s[4:5]
  v_cvt_pk_bf16_f32 v78, v124, v125
  s_add_u32 m0, s29, s30
  s_add_u32 s29, s29, 0x4000
  buffer_load_dwordx4 v253, s[12:15], s27 offen offset:0 sc1 lds
  v_pk_mul_f32 v[130:131], v[130:131], s[4:5]
  v_cvt_pk_bf16_f32 v79, v126, v127
  v_pk_mul_f32 v[132:133], v[132:133], s[4:5]
  v_cvt_pk_bf16_f32 v80, v128, v129
  v_pk_mul_f32 v[134:135], v[134:135], s[4:5]
  v_cvt_pk_bf16_f32 v81, v130, v131
  v_pk_mul_f32 v[136:137], v[136:137], s[4:5]
  v_cvt_pk_bf16_f32 v82, v132, v133
  buffer_load_dwordx4 v253, s[12:15], s27 offen offset:1024 sc1 lds
  v_pk_mul_f32 v[138:139], v[138:139], s[4:5]
  v_cvt_pk_bf16_f32 v83, v134, v135
  v_pk_mul_f32 v[140:141], v[140:141], s[4:5]
  v_cvt_pk_bf16_f32 v84, v136, v137
  v_pk_mul_f32 v[142:143], v[142:143], s[4:5]
  v_cvt_pk_bf16_f32 v85, v138, v139
  v_pk_mul_f32 v[144:145], v[144:145], s[4:5]
  v_cvt_pk_bf16_f32 v86, v140, v141
  buffer_load_dwordx4 v253, s[12:15], s27 offen offset:2048 sc1 lds
  s_and_b32 s29, s29, 0x1ffff
  v_pk_mul_f32 v[146:147], v[146:147], s[4:5]
  v_cvt_pk_bf16_f32 v87, v142, v143
  v_pk_mul_f32 v[148:149], v[148:149], s[4:5]
  v_cvt_pk_bf16_f32 v88, v144, v145
  v_pk_mul_f32 v[150:151], v[150:151], s[4:5]
  v_cvt_pk_bf16_f32 v89, v146, v147
  v_pk_mul_f32 v[152:153], v[152:153], s[4:5]
  v_cvt_pk_bf16_f32 v90, v148, v149
  buffer_load_dwordx4 v253, s[12:15], s27 offen offset:3072 sc1 lds
  s_add_u32 s27, s27, 0x4000
  s_cmp_eq_u32 s27, s79
  s_cselect_b32 s27, 1081344, s27
  v_pk_mul_f32 v[154:155], v[154:155], s[4:5]
  v_cvt_pk_bf16_f32 v91, v150, v151
  v_pk_mul_f32 v[156:157], v[156:157], s[4:5]
  v_cvt_pk_bf16_f32 v92, v152, v153
  v_pk_mul_f32 v[158:159], v[158:159], s[4:5]
  v_cvt_pk_bf16_f32 v93, v154, v155
  v_cvt_pk_bf16_f32 v94, v156, v157
  v_cvt_pk_bf16_f32 v95, v158, v159
  s_add_u32 m0, s29, s30
  s_add_u32 s29, s29, 0x4000
  buffer_load_dwordx4 v253, s[12:15], s27 offen offset:0 sc1 lds
  v_mul_f32 v0, v160, v160
  v_mul_f32 v1, v161, v161
  v_mul_f32 v2, v162, v162
  v_mul_f32 v3, v163, v163
  v_mul_f32 v4, v164, v164
  v_mul_f32 v5, v165, v165
  v_mul_f32 v6, v166, v166
  v_mul_f32 v7, v167, v167
  buffer_load_dwordx4 v253, s[12:15], s27 offen offset:1024 sc1 lds
  v_fma_f32 v0, v0, s33, v63
  v_fma_f32 v1, v1, s33, v63
  v_fma_f32 v2, v2, s33, v63
  v_fma_f32 v3, v3, s33, v63
  v_fma_f32 v4, v4, s33, v63
  v_fma_f32 v5, v5, s33, v63
  v_fma_f32 v6, v6, s33, v63
  v_fma_f32 v7, v7, s33, v63
  buffer_load_dwordx4 v253, s[12:15], s27 offen offset:2048 sc1 lds
  s_and_b32 s29, s29, 0x1ffff
  v_mul_f32 v0, v0, v160
  v_mul_f32 v1, v1, v161
  v_mul_f32 v2, v2, v162
  v_mul_f32 v3, v3, v163
  v_mul_f32 v4, v4, v164
  v_mul_f32 v5, v5, v165
  v_mul_f32 v6, v6, v166
  v_mul_f32 v7, v7, v167
  buffer_load_dwordx4 v253, s[12:15], s27 offen offset:3072 sc1 lds
  s_add_u32 s27, s27, 0x4000
  s_cmp_eq_u32 s27, s79
  s_cselect_b32 s27, 1081344, s27
  v_exp_f32 v0, v0
  v_exp_f32 v1, v1
  v_exp_f32 v2, v2
  v_exp_f32 v3, v3
  v_exp_f32 v4, v4
  v_exp_f32 v5, v5
  v_exp_f32 v6, v6
  v_exp_f32 v7, v7
  s_add_u32 m0, s29, s30
  s_add_u32 s29, s29, 0x4000
  buffer_load_dwordx4 v253, s[12:15], s27 offen offset:0 sc1 lds
  v_add_f32 v0, 1.0, v0
  v_add_f32 v1, 1.0, v1
  v_add_f32 v2, 1.0, v2
  v_add_f32 v3, 1.0, v3
  v_add_f32 v4, 1.0, v4
  v_add_f32 v5, 1.0, v5
  v_add_f32 v6, 1.0, v6
  v_add_f32 v7, 1.0, v7
  buffer_load_dwordx4 v253, s[12:15], s27 offen offset:1024 sc1 lds
  v_rcp_f32 v0, v0
  v_rcp_f32 v1, v1
  v_rcp_f32 v2, v2
  v_rcp_f32 v3, v3
  v_rcp_f32 v4, v4
  v_rcp_f32 v5, v5
  v_rcp_f32 v6, v6
  v_rcp_f32 v7, v7
  buffer_load_dwordx4 v253, s[12:15], s27 offen offset:2048 sc1 lds
  s_and_b32 s29, s29, 0x1ffff
  v_mul_f32 v0, v0, v160
  v_mul_f32 v1, v1, v161
  v_mul_f32 v2, v2, v162
  v_mul_f32 v3, v3, v163
  v_mul_f32 v4, v4, v164
  v_mul_f32 v5, v5, v165
  v_mul_f32 v6, v6, v166
  v_mul_f32 v7, v7, v167
  buffer_load_dwordx4 v253, s[12:15], s27 offen offset:3072 sc1 lds
  s_add_u32 s27, s27, 0x4000
  s_cmp_eq_u32 s27, s79
  s_cselect_b32 s27, 1081344, s27
  v_mul_f32 v0, v0, v168
  v_mul_f32 v1, v1, v169
  v_mul_f32 v2, v2, v170
  v_mul_f32 v3, v3, v171
  v_mul_f32 v4, v4, v172
  v_mul_f32 v5, v5, v173
  v_mul_f32 v6, v6, v174
  v_mul_f32 v7, v7, v175
  s_add_u32 m0, s29, s30
  s_add_u32 s29, s29, 0x4000
  buffer_load_dwordx4 v253, s[12:15], s27 offen offset:0 sc1 lds
  v_cvt_pk_bf16_f32 v16, v0, v1
  v_cvt_pk_bf16_f32 v17, v2, v3
  v_cvt_pk_bf16_f32 v18, v4, v5
  v_cvt_pk_bf16_f32 v19, v6, v7
  v_mul_f32 v0, v176, v176
  v_mul_f32 v1, v177, v177
  v_mul_f32 v2, v178, v178
  v_mul_f32 v3, v179, v179
  buffer_load_dwordx4 v253, s[12:15], s27 offen offset:1024 sc1 lds
  v_mul_f32 v4, v180, v180
  v_mul_f32 v5, v181, v181
  v_mul_f32 v6, v182, v182
  v_mul_f32 v7, v183, v183
  v_fma_f32 v0, v0, s33, v63
  v_fma_f32 v1, v1, s33, v63
  v_fma_f32 v2, v2, s33, v63
  v_fma_f32 v3, v3, s33, v63
  buffer_load_dwordx4 v253, s[12:15], s27 offen offset:2048 sc1 lds
  s_and_b32 s29, s29, 0x1ffff
  v_fma_f32 v4, v4, s33, v63
  v_fma_f32 v5, v5, s33, v63
  v_fma_f32 v6, v6, s33, v63
  v_fma_f32 v7, v7, s33, v63
  v_mul_f32 v0, v0, v176
  v_mul_f32 v1, v1, v177
  v_mul_f32 v2, v2, v178
  v_mul_f32 v3, v3, v179
  buffer_load_dwordx4 v253, s[12:15], s27 offen offset:3072 sc1 lds
  s_add_u32 s27, s27, 0x4000
  s_cmp_eq_u32 s27, s79
  s_cselect_b32 s27, 1081344, s27
  v_mul_f32 v4, v4, v180
  v_mul_f32 v5, v5, v181
  v_mul_f32 v6, v6, v182
  v_mul_f32 v7, v7, v183
  v_exp_f32 v0, v0
  v_exp_f32 v1, v1
  v_exp_f32 v2, v2
  v_exp_f32 v3, v3
  s_add_u32 m0, s29, s30
  s_add_u32 s29, s29, 0x4000
  buffer_load_dwordx4 v253, s[12:15], s27 offen offset:0 sc1 lds
  v_exp_f32 v4, v4
  v_exp_f32 v5, v5
  v_exp_f32 v6, v6
  v_exp_f32 v7, v7
  v_add_f32 v0, 1.0, v0
  v_add_f32 v1, 1.0, v1
  v_add_f32 v2, 1.0, v2
  v_add_f32 v3, 1.0, v3
  buffer_load_dwordx4 v253, s[12:15], s27 offen offset:1024 sc1 lds
  v_add_f32 v4, 1.0, v4
  v_add_f32 v5, 1.0, v5
  v_add_f32 v6, 1.0, v6
  v_add_f32 v7, 1.0, v7
  v_rcp_f32 v0, v0
  v_rcp_f32 v1, v1
  v_rcp_f32 v2, v2
  v_rcp_f32 v3, v3
  buffer_load_dwordx4 v253, s[12:15], s27 offen offset:2048 sc1 lds
  s_and_b32 s29, s29, 0x1ffff
  v_rcp_f32 v4, v4
  v_rcp_f32 v5, v5
  v_rcp_f32 v6, v6
  v_rcp_f32 v7, v7
  v_mul_f32 v0, v0, v176
  v_mul_f32 v1, v1, v177
  v_mul_f32 v2, v2, v178
  v_mul_f32 v3, v3, v179
  buffer_load_dwordx4 v253, s[12:15], s27 offen offset:3072 sc1 lds
  s_add_u32 s27, s27, 0x4000
  s_cmp_eq_u32 s27, s79
  s_cselect_b32 s27, 1081344, s27
  v_mul_f32 v4, v4, v180
  v_mul_f32 v5, v5, v181
  v_mul_f32 v6, v6, v182
  v_mul_f32 v7, v7, v183
  v_mul_f32 v0, v0, v184
  v_mul_f32 v1, v1, v185
  v_mul_f32 v2, v2, v186
  v_mul_f32 v3, v3, v187
  s_add_u32 m0, s29, s30
  s_add_u32 s29, s29, 0x4000
  buffer_load_dwordx4 v253, s[12:15], s27 offen offset:0 sc1 lds
  v_mul_f32 v4, v4, v188
  v_mul_f32 v5, v5, v189
  v_mul_f32 v6, v6, v190
  v_mul_f32 v7, v7, v191
  v_cvt_pk_bf16_f32 v20, v0, v1
  v_cvt_pk_bf16_f32 v21, v2, v3
  v_cvt_pk_bf16_f32 v22, v4, v5
  v_cvt_pk_bf16_f32 v23, v6, v7
  buffer_load_dwordx4 v253, s[12:15], s27 offen offset:1024 sc1 lds
  v_mul_f32 v0, v192, v192
  v_mul_f32 v1, v193, v193
  v_mul_f32 v2, v194, v194
  v_mul_f32 v3, v195, v195
  v_mul_f32 v4, v196, v196
  v_mul_f32 v5, v197, v197
  v_mul_f32 v6, v198, v198
  v_mul_f32 v7, v199, v199
  buffer_load_dwordx4 v253, s[12:15], s27 offen offset:2048 sc1 lds
  s_and_b32 s29, s29, 0x1ffff
  v_fma_f32 v0, v0, s33, v63
  v_fma_f32 v1, v1, s33, v63
  v_fma_f32 v2, v2, s33, v63
  v_fma_f32 v3, v3, s33, v63
  v_fma_f32 v4, v4, s33, v63
  v_fma_f32 v5, v5, s33, v63
  v_fma_f32 v6, v6, s33, v63
  v_fma_f32 v7, v7, s33, v63
  buffer_load_dwordx4 v253, s[12:15], s27 offen offset:3072 sc1 lds
  s_add_u32 s27, s27, 0x4000
  s_cmp_eq_u32 s27, s79
  s_cselect_b32 s27, 1081344, s27
  v_mul_f32 v0, v0, v192
  v_mul_f32 v1, v1, v193
  v_mul_f32 v2, v2, v194
  v_mul_f32 v3, v3, v195
  v_mul_f32 v4, v4, v196
  v_mul_f32 v5, v5, v197
  v_mul_f32 v6, v6, v198
  v_mul_f32 v7, v7, v199
  v_exp_f32 v0, v0
  v_exp_f32 v1, v1
  v_exp_f32 v2, v2
  v_exp_f32 v3, v3
  v_exp_f32 v4, v4
  v_exp_f32 v5, v5
  v_exp_f32 v6, v6
  v_exp_f32 v7, v7
  v_add_f32 v0, 1.0, v0
  v_add_f32 v1, 1.0, v1
  v_add_f32 v2, 1.0, v2
  v_add_f32 v3, 1.0, v3
  v_add_f32 v4, 1.0, v4
  v_add_f32 v5, 1.0, v5
  v_add_f32 v6, 1.0, v6
  v_add_f32 v7, 1.0, v7
  v_rcp_f32 v0, v0
  v_rcp_f32 v1, v1
  v_rcp_f32 v2, v2
  v_rcp_f32 v3, v3
  v_rcp_f32 v4, v4
  v_rcp_f32 v5, v5
  v_rcp_f32 v6, v6
  v_rcp_f32 v7, v7
  v_mul_f32 v0, v0, v192
  v_mul_f32 v1, v1, v193
  v_mul_f32 v2, v2, v194
  v_mul_f32 v3, v3, v195
  v_mul_f32 v4, v4, v196
  v_mul_f32 v5, v5, v197
  v_mul_f32 v6, v6, v198
  v_mul_f32 v7, v7, v199
  v_mul_f32 v0, v0, v200
  v_mul_f32 v1, v1, v201
  v_mul_f32 v2, v2, v202
  v_mul_f32 v3, v3, v203
  v_mul_f32 v4, v4, v204
  v_mul_f32 v5, v5, v205
  v_mul_f32 v6, v6, v206
  v_mul_f32 v7, v7, v207
  v_cvt_pk_bf16_f32 v24, v0, v1
  v_cvt_pk_bf16_f32 v25, v2, v3
  v_cvt_pk_bf16_f32 v26, v4, v5
  v_cvt_pk_bf16_f32 v27, v6, v7
  s_cmp_ge_u32 s34, 86
  s_cbranch_scc1 qf_h_doneA
  buffer_store_dwordx4 v[16:19], v250, s[16:19], s35 offen offset:0 sc1
  s_cmp_ge_u32 s34, 85
  s_cbranch_scc1 qf_h_doneA
  buffer_store_dwordx4 v[20:23], v250, s[16:19], s35 offen offset:1024 sc1
  s_cmp_ge_u32 s34, 84
  s_cbranch_scc1 qf_h_doneA
  buffer_store_dwordx4 v[24:27], v250, s[16:19], s35 offen offset:2048 sc1
qf_h_doneA:
  s_branch qe_done
qe_B:
  s_mul_i32 s63, s64, 350208
  s_mul_i32 s34, s24, 3
  s_lshl_b32 s35, s34, 10
  s_add_u32 s35, s35, s63
  s_add_u32 s35, s35, 262144
  s_mov_b32 s4, 0x3e0293ee
  s_mov_b32 s5, s4
  s_mov_b32 s33, 0xbdd2d3e8
  v_mov_b32 v63, 0xc0135761
  v_pk_mul_f32 v[96:97], v[96:97], s[4:5]
  v_pk_mul_f32 v[98:99], v[98:99], s[4:5]
  v_pk_mul_f32 v[100:101], v[100:101], s[4:5]
  v_cvt_pk_bf16_f32 v64, v96, v97
  v_pk_mul_f32 v[102:103], v[102:103], s[4:5]
  v_cvt_pk_bf16_f32 v65, v98, v99
  v_pk_mul_f32 v[104:105], v[104:105], s[4:5]
  v_cvt_pk_bf16_f32 v66, v100, v101
  v_pk_mul_f32 v[106:107], v[106:107], s[4:5]
  v_cvt_pk_bf16_f32 v67, v102, v103
  v_pk_mul_f32 v[108:109], v[108:109], s[4:5]
  v_cvt_pk_bf16_f32 v68, v104, v105
  v_pk_mul_f32 v[110:111], v[110:111], s[4:5]
  v_cvt_pk_bf16_f32 v69, v106, v107
  v_pk_mul_f32 v[112:113], v[112:113], s[4:5]
  v_cvt_pk_bf16_f32 v70, v108, v109
  v_pk_mul_f32 v[114:115], v[114:115], s[4:5]
  v_cvt_pk_bf16_f32 v71, v110, v111
  v_pk_mul_f32 v[116:117], v[116:117], s[4:5]
  v_cvt_pk_bf16_f32 v72, v112, v113
  v_pk_mul_f32 v[118:119], v[118:119], s[4:5]
  v_cvt_pk_bf16_f32 v73, v114, v115
  v_pk_mul_f32 v[120:121], v[120:121], s[4:5]
  v_cvt_pk_bf16_f32 v74, v116, v117
  v_pk_mul_f32 v[122:123], v[122:123], s[4:5]
  v_cvt_pk_bf16_f32 v75, v118, v119
  v_pk_mul_f32 v[124:125], v[124:125], s[4:5]
  v_cvt_pk_bf16_f32 v76, v120, v121
  v_pk_mul_f32 v[126:127], v[126:127], s[4:5]
  v_cvt_pk_bf16_f32 v77, v122, v123
  v_pk_mul_f32 v[128:129], v[128:129], s[4:5]
  v_cvt_pk_bf16_f32 v78, v124, v125
  v_pk_mul_f32 v[130:131], v[130:131], s[4:5]
  v_cvt_pk_bf16_f32 v79, v126, v127
  v_pk_mul_f32 v[132:133], v[132:133], s[4:5]
  v_cvt_pk_bf16_f32 v80, v128, v129
  v_pk_mul_f32 v[134:135], v[134:135], s[4:5]
  v_cvt_pk_bf16_f32 v81, v130, v131
  v_pk_mul_f32 v[136:137], v[136:137], s[4:5]
  v_cvt_pk_bf16_f32 v82, v132, v133
  v_pk_mul_f32 v[138:139], v[138:139], s[4:5]
  v_cvt_pk_bf16_f32 v83, v134, v135
  v_pk_mul_f32 v[140:141], v[140:141], s[4:5]
  v_cvt_pk_bf16_f32 v84, v136, v137
  v_pk_mul_f32 v[142:143], v[142:143], s[4:5]
  v_cvt_pk_bf16_f32 v85, v138, v139
  v_pk_mul_f32 v[144:145], v[144:145], s[4:5]
  v_cvt_pk_bf16_f32 v86, v140, v141
  v_pk_mul_f32 v[146:147], v[146:147], s[4:5]
  v_cvt_pk_bf16_f32 v87, v142, v143
  v_pk_mul_f32 v[148:149], v[148:149], s[4:5]
  v_cvt_pk_bf16_f32 v88, v144, v145
  v_pk_mul_f32 v[150:151], v[150:151], s[4:5]
  v_cvt_pk_bf16_f32 v89, v146, v147
  v_pk_mul_f32 v[152:153], v[152:153], s[4:5]
  v_cvt_pk_bf16_f32 v90, v148, v149
  v_pk_mul_f32 v[154:155], v[154:155], s[4:5]
  v_cvt_pk_bf16_f32 v91, v150, v151
  v_pk_mul_f32 v[156:157], v[156:157], s[4:5]
  v_cvt_pk_bf16_f32 v92, v152, v153
  v_pk_mul_f32 v[158:159], v[158:159], s[4:5]
  v_cvt_pk_bf16_f32 v93, v154, v155
  v_cvt_pk_bf16_f32 v94, v156, v157
  v_cvt_pk_bf16_f32 v95, v158, v159
  v_mul_f32 v0, v160, v160
  v_mul_f32 v1, v161, v161
  v_mul_f32 v2, v162, v162
  v_mul_f32 v3, v163, v163
  v_mul_f32 v4, v164, v164
  v_mul_f32 v5, v165, v165
  v_mul_f32 v6, v166, v166
  v_mul_f32 v7, v167, v167
  v_fma_f32 v0, v0, s33, v63
  v_fma_f32 v1, v1, s33, v63
  v_fma_f32 v2, v2, s33, v63
  v_fma_f32 v3, v3, s33, v63
  v_fma_f32 v4, v4, s33, v63
  v_fma_f32 v5, v5, s33, v63
  v_fma_f32 v6, v6, s33, v63
  v_fma_f32 v7, v7, s33, v63
  v_mul_f32 v0, v0, v160
  v_mul_f32 v1, v1, v161
  v_mul_f32 v2, v2, v162
  v_mul_f32 v3, v3, v163
  v_mul_f32 v4, v4, v164
  v_mul_f32 v5, v5, v165
  v_mul_f32 v6, v6, v166
  v_mul_f32 v7, v7, v167
  v_exp_f32 v0, v0
  v_exp_f32 v1, v1
  v_exp_f32 v2, v2
  v_exp_f32 v3, v3
  v_exp_f32 v4, v4
  v_exp_f32 v5, v5
  v_exp_f32 v6, v6
  v_exp_f32 v7, v7
  v_add_f32 v0, 1.0, v0
  v_add_f32 v1, 1.0, v1
  v_add_f32 v2, 1.0, v2
  v_add_f32 v3, 1.0, v3
  v_add_f32 v4, 1.0, v4
  v_add_f32 v5, 1.0, v5
  v_add_f32 v6, 1.0, v6
  v_add_f32 v7, 1.0, v7
  v_rcp_f32 v0, v0
  v_rcp_f32 v1, v1
  v_rcp_f32 v2, v2
  v_rcp_f32 v3, v3
  v_rcp_f32 v4, v4
  v_rcp_f32 v5, v5
  v_rcp_f32 v6, v6
  v_rcp_f32 v7, v7
  v_mul_f32 v0, v0, v160
  v_mul_f32 v1, v1, v161
  v_mul_f32 v2, v2, v162
  v_mul_f32 v3, v3, v163
  v_mul_f32 v4, v4, v164
  v_mul_f32 v5, v5, v165
  v_mul_f32 v6, v6, v166
  v_mul_f32 v7, v7, v167
  v_mul_f32 v0, v0, v168
  v_mul_f32 v1, v1, v169
  v_mul_f32 v2, v2, v170
  v_mul_f32 v3, v3, v171
  v_mul_f32 v4, v4, v172
  v_mul_f32 v5, v5, v173
  v_mul_f32 v6, v6, v174
  v_mul_f32 v7, v7, v175
  v_cvt_pk_bf16_f32 v16, v0, v1
  v_cvt_pk_bf16_f32 v17, v2, v3
  v_cvt_pk_bf16_f32 v18, v4, v5
  v_cvt_pk_bf16_f32 v19, v6, v7
  v_mul_f32 v0, v176, v176
  v_mul_f32 v1, v177, v177
  v_mul_f32 v2, v178, v178
  v_mul_f32 v3, v179, v179
  v_mul_f32 v4, v180, v180
  v_mul_f32 v5, v181, v181
  v_mul_f32 v6, v182, v182
  v_mul_f32 v7, v183, v183
  v_fma_f32 v0, v0, s33, v63
  v_fma_f32 v1, v1, s33, v63
  v_fma_f32 v2, v2, s33, v63
  v_fma_f32 v3, v3, s33, v63
  v_fma_f32 v4, v4, s33, v63
  v_fma_f32 v5, v5, s33, v63
  v_fma_f32 v6, v6, s33, v63
  v_fma_f32 v7, v7, s33, v63
  v_mul_f32 v0, v0, v176
  v_mul_f32 v1, v1, v177
  v_mul_f32 v2, v2, v178
  v_mul_f32 v3, v3, v179
  v_mul_f32 v4, v4, v180
  v_mul_f32 v5, v5, v181
  v_mul_f32 v6, v6, v182
  v_mul_f32 v7, v7, v183
  v_exp_f32 v0, v0
  v_exp_f32 v1, v1
  v_exp_f32 v2, v2
  v_exp_f32 v3, v3
  v_exp_f32 v4, v4
  v_exp_f32 v5, v5
  v_exp_f32 v6, v6
  v_exp_f32 v7, v7
  v_add_f32 v0, 1.0, v0
  v_add_f32 v1, 1.0, v1
  v_add_f32 v2, 1.0, v2
  v_add_f32 v3, 1.0, v3
  v_add_f32 v4, 1.0, v4
  v_add_f32 v5, 1.0, v5
  v_add_f32 v6, 1.0, v6
  v_add_f32 v7, 1.0, v7
  v_rcp_f32 v0, v0
  v_rcp_f32 v1, v1
  v_rcp_f32 v2, v2
  v_rcp_f32 v3, v3
  v_rcp_f32 v4, v4
  v_rcp_f32 v5, v5
  v_rcp_f32 v6, v6
  v_rcp_f32 v7, v7
  v_mul_f32 v0, v0, v176
  v_mul_f32 v1, v1, v177
  v_mul_f32 v2, v2, v178
  v_mul_f32 v3, v3, v179
  v_mul_f32 v4, v4, v180
  v_mul_f32 v5, v5, v181
  v_mul_f32 v6, v6, v182
  v_mul_f32 v7, v7, v183
  v_mul_f32 v0, v0, v184
  v_mul_f32 v1, v1, v185
  v_mul_f32 v2, v2, v186
  v_mul_f32 v3, v3, v187
  v_mul_f32 v4, v4, v188
  v_mul_f32 v5, v5, v189
  v_mul_f32 v6, v6, v190
  v_mul_f32 v7, v7, v191
  v_cvt_pk_bf16_f32 v20, v0, v1
  v_cvt_pk_bf16_f32 v21, v2, v3
  v_cvt_pk_bf16_f32 v22, v4, v5
  v_cvt_pk_bf16_f32 v23, v6, v7
  v_mul_f32 v0, v192, v192
  v_mul_f32 v1, v193, v193
  v_mul_f32 v2, v194, v194
  v_mul_f32 v3, v195, v195
  v_mul_f32 v4, v196, v196
  v_mul_f32 v5, v197, v197
  v_mul_f32 v6, v198, v198
  v_mul_f32 v7, v199, v199
  v_fma_f32 v0, v0, s33, v63
  v_fma_f32 v1, v1, s33, v63
  v_fma_f32 v2, v2, s33, v63
  v_fma_f32 v3, v3, s33, v63
  v_fma_f32 v4, v4, s33, v63
  v_fma_f32 v5, v5, s33, v63
  v_fma_f32 v6, v6, s33, v63
  v_fma_f32 v7, v7, s33, v63
  v_mul_f32 v0, v0, v192
  v_mul_f32 v1, v1, v193
  v_mul_f32 v2, v2, v194
  v_mul_f32 v3, v3, v195
  v_mul_f32 v4, v4, v196
  v_mul_f32 v5, v5, v197
  v_mul_f32 v6, v6, v198
  v_mul_f32 v7, v7, v199
  v_exp_f32 v0, v0
  v_exp_f32 v1, v1
  v_exp_f32 v2, v2
  v_exp_f32 v3, v3
  v_exp_f32 v4, v4
  v_exp_f32 v5, v5
  v_exp_f32 v6, v6
  v_exp_f32 v7, v7
  v_add_f32 v0, 1.0, v0
  v_add_f32 v1, 1.0, v1
  v_add_f32 v2, 1.0, v2
  v_add_f32 v3, 1.0, v3
  v_add_f32 v4, 1.0, v4
  v_add_f32 v5, 1.0, v5
  v_add_f32 v6, 1.0, v6
  v_add_f32 v7, 1.0, v7
  v_rcp_f32 v0, v0
  v_rcp_f32 v1, v1
  v_rcp_f32 v2, v2
  v_rcp_f32 v3, v3
  v_rcp_f32 v4, v4
  v_rcp_f32 v5, v5
  v_rcp_f32 v6, v6
  v_rcp_f32 v7, v7
  v_mul_f32 v0, v0, v192
  v_mul_f32 v1, v1, v193
  v_mul_f32 v2, v2, v194
  v_mul_f32 v3, v3, v195
  v_mul_f32 v4, v4, v196
  v_mul_f32 v5, v5, v197
  v_mul_f32 v6, v6, v198
  v_mul_f32 v7, v7, v199
  v_mul_f32 v0, v0, v200
  v_mul_f32 v1, v1, v201
  v_mul_f32 v2, v2, v202
  v_mul_f32 v3, v3, v203
  v_mul_f32 v4, v4, v204
  v_mul_f32 v5, v5, v205
  v_mul_f32 v6, v6, v206
  v_mul_f32 v7, v7, v207
  v_cvt_pk_bf16_f32 v24, v0, v1
  v_cvt_pk_bf16_f32 v25, v2, v3
  v_cvt_pk_bf16_f32 v26, v4, v5
  v_cvt_pk_bf16_f32 v27, v6, v7
  s_cmp_ge_u32 s34, 86
  s_cbranch_scc1 qf_h_doneB
  buffer_store_dwordx4 v[16:19], v250, s[16:19], s35 offen offset:0 sc1
  s_cmp_ge_u32 s34, 85
  s_cbranch_scc1 qf_h_doneB
  buffer_store_dwordx4 v[20:23], v250, s[16:19], s35 offen offset:1024 sc1
  s_cmp_ge_u32 s34, 84
  s_cbranch_scc1 qf_h_doneB
  buffer_store_dwordx4 v[24:27], v250, s[16:19], s35 offen offset:2048 sc1
qf_h_doneB:
qe_done:
  s_mov_b32 s38, s77
  v_mov_b32 v204, v250
  v_add_u32 v205, 0x10000, v250
  v_add_u32 v1, 131072, v250
  v_mov_b32 v208, 0xff800000
  s_mov_b32 s68, 0x53800000
  v_and_b32 v2, 31, v240
  v_lshrrev_b32 v3, 5, v240
  v_lshlrev_b32 v3, 2, v3
  v_sub_u32 v2, v2, v3
  s_and_b32 s33, s26, 3
  s_add_u32 s33, s33, s65
  s_sub_u32 s33, s33, 4
  s_lshl_b32 s33, s33, 5
  v_add_u32 v206, s33, v2
  s_waitcnt vmcnt(24)
  s_barrier
  ds_read_b128 v[160:163], v1 offset:0
  ds_read_b128 v[164:167], v1 offset:1024
  ds_read_b128 v[168:171], v1 offset:2048
  ds_read_b128 v[172:175], v1 offset:3072
  ds_read_b128 v[176:179], v1 offset:4096
  ds_read_b128 v[180:183], v1 offset:5120
  ds_read_b128 v[184:187], v1 offset:6144
  ds_read_b128 v[188:191], v1 offset:7168
  v_mov_b32 v2, 0
  v_mov_b32 v3, 0
  v_mov_b32 v4, 0
  v_mov_b32 v5, 0
  v_mov_b32 v6, 0
  v_mov_b32 v7, 0
  v_mov_b32 v8, 0
  v_mov_b32 v9, 0
  v_mov_b32 v10, 0
  v_mov_b32 v11, 0
  v_mov_b32 v12, 0
  v_mov_b32 v13, 0
  v_mov_b32 v14, 0
  v_mov_b32 v15, 0
  v_mov_b32 v16, 0
  v_mov_b32 v17, 0
  v_mov_b32 v18, 0
  v_mov_b32 v19, 0
  v_mov_b32 v20, 0
  v_mov_b32 v21, 0
  v_mov_b32 v22, 0
  v_mov_b32 v23, 0
  v_mov_b32 v24, 0
  v_mov_b32 v25, 0
  v_mov_b32 v26, 0
  v_mov_b32 v27, 0
  v_mov_b32 v28, 0
  v_mov_b32 v29, 0
  v_mov_b32 v30, 0
  v_mov_b32 v31, 0
  v_mov_b32 v32, 0
  v_mov_b32 v33, 0
  v_mov_b32 v34, 0
  v_mov_b32 v35, 0
  v_mov_b32 v36, 0
  v_mov_b32 v37, 0
  v_mov_b32 v38, 0
  v_mov_b32 v39, 0
  v_mov_b32 v40, 0
  v_mov_b32 v41, 0
  v_mov_b32 v42, 0
  v_mov_b32 v43, 0
  v_mov_b32 v44, 0
  v_mov_b32 v45, 0
  v_mov_b32 v46, 0
  v_mov_b32 v47, 0
  v_mov_b32 v48, 0
  v_mov_b32 v49, 0
  v_mov_b32 v50, 0
  v_mov_b32 v51, 0
  v_mov_b32 v52, 0
  v_mov_b32 v53, 0
  v_mov_b32 v54, 0
  v_mov_b32 v55, 0
  v_mov_b32 v56, 0
  v_mov_b32 v57, 0
  v_mov_b32 v58, 0
  v_mov_b32 v59, 0
  v_mov_b32 v60, 0
  v_mov_b32 v61, 0
  v_mov_b32 v62, 0
  v_mov_b32 v63, 0
  v_mov_b32 v136, 0
  v_mov_b32 v137, 0
  v_mov_b32 v138, 0
  v_mov_b32 v139, 0
  v_mov_b32 v140, 0
  v_mov_b32 v141, 0
  v_mov_b32 v142, 0
  v_mov_b32 v143, 0
  v_mov_b32 v200, 0
  v_mov_b32 v201, 0
  s_waitcnt lgkmcnt(7)
  v_mfma_f32_32x32x16_bf16 v[96:111], v[160:163], v[64:67], 0
  s_waitcnt lgkmcnt(6)
  v_mfma_f32_32x32x16_bf16 v[96:111], v[164:167], v[68:71], v[96:111]
  s_waitcnt lgkmcnt(5)
  v_mfma_f32_32x32x16_bf16 v[96:111], v[168:171], v[72:75], v[96:111]
  s_waitcnt lgkmcnt(4)
  v_mfma_f32_32x32x16_bf16 v[96:111], v[172:175], v[76:79], v[96:111]
  s_waitcnt lgkmcnt(3)
  v_mfma_f32_32x32x16_bf16 v[96:111], v[176:179], v[80:83], v[96:111]
  s_waitcnt lgkmcnt(2)
  v_mfma_f32_32x32x16_bf16 v[96:111], v[180:183], v[84:87], v[96:111]
  s_waitcnt lgkmcnt(1)
  v_mfma_f32_32x32x16_bf16 v[96:111], v[184:187], v[88:91], v[96:111]
  s_waitcnt lgkmcnt(0)
  v_mfma_f32_32x32x16_bf16 v[96:111], v[188:191], v[92:95], v[96:111]
  v_mov_b32 v0, 0
  v_mov_b32 v1, 0
  s_waitcnt vmcnt(16)
  s_cmp_lt_u32 s26, 4
  s_cbranch_scc1 at_p2
  s_waitcnt vmcnt(0)
at_p2:
  s_barrier
  s_cmp_eq_u32 s26, 0
  s_cbranch_scc1 sg_do5
sg_back5:
  ds_read_b128 v[160:163], v204 offset:0
  ds_read_b128 v[164:167], v204 offset:1024
  ds_read_b128 v[168:171], v204 offset:2048
  ds_read_b128 v[172:175], v204 offset:3072
  ds_read_b128 v[176:179], v204 offset:4096
  ds_read_b128 v[180:183], v204 offset:5120
  s_nop 3
  v_cmp_gt_i32 s[70:71], 0, v206
  v_cmp_gt_i32 s[72:73], 1, v206
  v_cmp_gt_i32 s[74:75], 2, v206
  v_cmp_gt_i32 s[76:77], 3, v206
  v_cndmask_b32 v96, v96, v208, s[70:71]
  v_cndmask_b32 v97, v97, v208, s[72:73]
  v_cndmask_b32 v98, v98, v208, s[74:75]
  v_cndmask_b32 v99, v99, v208, s[76:77]
  v_cmp_gt_i32 s[70:71], 8, v206
  v_cmp_gt_i32 s[72:73], 9, v206
  v_cmp_gt_i32 s[74:75], 10, v206
  v_cmp_gt_i32 s[76:77], 11, v206
  v_cndmask_b32 v100, v100, v208, s[70:71]
  v_cndmask_b32 v101, v101, v208, s[72:73]
  v_cndmask_b32 v102, v102, v208, s[74:75]
  v_cndmask_b32 v103, v103, v208, s[76:77]
  v_cmp_gt_i32 s[70:71], 16, v206
  v_cmp_gt_i32 s[72:73], 17, v206
  v_cmp_gt_i32 s[74:75], 18, v206
  v_cmp_gt_i32 s[76:77], 19, v206
  v_cndmask_b32 v104, v104, v208, s[70:71]
  v_cndmask_b32 v105, v105, v208, s[72:73]
  v_cndmask_b32 v106, v106, v208, s[74:75]
  v_cndmask_b32 v107, v107, v208, s[76:77]
  v_cmp_gt_i32 s[70:71], 24, v206
  v_cmp_gt_i32 s[72:73], 25, v206
  v_cmp_gt_i32 s[74:75], 26, v206
  v_cmp_gt_i32 s[76:77], 27, v206
  v_cndmask_b32 v108, v108, v208, s[70:71]
  v_cndmask_b32 v109, v109, v208, s[72:73]
  v_cndmask_b32 v110, v110, v208, s[74:75]
  v_cndmask_b32 v111, v111, v208, s[76:77]
  v_max3_f32 v210, v96, v97, v98
  v_max3_f32 v210, v210, v99, v100
  v_max3_f32 v210, v210, v101, v102
  v_max3_f32 v210, v210, v103, v104
  v_max3_f32 v210, v210, v105, v106
  v_max3_f32 v210, v210, v107, v108
  v_max3_f32 v210, v210, v109, v110
  v_max_f32 v210, v210, v111
  v_mov_b32 v211, v210
  s_nop 1
  v_permlane32_swap_b32 v210, v211
  s_nop 1
  v_max_f32 v210, v210, v211
  v_sub_f32 v96, v96, v210
  v_sub_f32 v144, 0, v210
  v_sub_f32 v97, v97, v210
  v_sub_f32 v145, 0, v210
  v_sub_f32 v98, v98, v210
  v_sub_f32 v146, 0, v210
  v_sub_f32 v99, v99, v210
  v_sub_f32 v147, 0, v210
  v_sub_f32 v100, v100, v210
  v_sub_f32 v148, 0, v210
  v_sub_f32 v101, v101, v210
  v_sub_f32 v149, 0, v210
  v_sub_f32 v102, v102, v210
  v_sub_f32 v150, 0, v210
  v_sub_f32 v103, v103, v210
  v_sub_f32 v151, 0, v210
  v_sub_f32 v104, v104, v210
  v_sub_f32 v152, 0, v210
  v_sub_f32 v105, v105, v210
  v_sub_f32 v153, 0, v210
  v_sub_f32 v106, v106, v210
  v_sub_f32 v154, 0, v210
  v_sub_f32 v107, v107, v210
  v_sub_f32 v155, 0, v210
  v_sub_f32 v108, v108, v210
  v_sub_f32 v156, 0, v210
  v_sub_f32 v109, v109, v210
  v_sub_f32 v157, 0, v210
  v_sub_f32 v110, v110, v210
  v_sub_f32 v158, 0, v210
  v_sub_f32 v111, v111, v210
  v_sub_f32 v159, 0, v210
  s_sub_u32 s33, s65, 4
  s_lshl_b32 s33, s33, 5
  v_subrev_u32 v206, s33, v206
  s_lshr_b32 s66, s65, 2
  s_cmp_ge_u32 s26, 4
  s_cbranch_scc1 at_B
at_A:
  s_cmp_eq_u32 s66, 1
  s_cbranch_scc1 at_A_last
.p2align 3
at_A_loop:
  v_add_f32 v200, v200, v201
  v_exp_f32 v192, v96
  s_waitcnt lgkmcnt(4)
  v_mfma_f32_32x32x16_bf16 v[112:127], v[160:163], v[64:67], v[144:159]
  ds_read_b128 v[184:187], v204 offset:6144
  v_exp_f32 v193, v97
  v_mfma_f32_32x32x16_bf16 v[112:127], v[164:167], v[68:71], v[112:127]
  ds_read_b128 v[188:191], v204 offset:7168
  v_exp_f32 v194, v98
  v_add_f32 v201, v192, v193
  v_cvt_pk_bf16_f32 v128, v192, v193
  s_waitcnt lgkmcnt(4)
  v_mfma_f32_32x32x16_bf16 v[112:127], v[168:171], v[72:75], v[112:127]
  ds_read_b128 v[160:163], v204 offset:8192
  v_exp_f32 v195, v99
  v_add_f32 v201, v201, v194
  s_add_u32 m0, s29, s30
  s_add_u32 s29, s29, 0x4000
  buffer_load_dwordx4 v253, s[12:15], s27 offen offset:0 sc1 lds
  v_mfma_f32_32x32x16_bf16 v[112:127], v[172:175], v[76:79], v[112:127]
  ds_read_b128 v[164:167], v204 offset:9216
  v_exp_f32 v196, v100
  v_add_f32 v201, v201, v195
  v_cvt_pk_bf16_f32 v129, v194, v195
  s_waitcnt lgkmcnt(4)
  v_mfma_f32_32x32x16_bf16 v[112:127], v[176:179], v[80:83], v[112:127]
  ds_read_b128 v[168:171], v204 offset:10240
  v_exp_f32 v197, v101
  v_add_f32 v201, v201, v196
  buffer_load_dwordx4 v253, s[12:15], s27 offen offset:1024 sc1 lds
  v_mfma_f32_32x32x16_bf16 v[112:127], v[180:183], v[84:87], v[112:127]
  ds_read_b128 v[172:175], v204 offset:11264
  v_exp_f32 v198, v102
  v_add_f32 v201, v201, v197
  v_cvt_pk_bf16_f32 v130, v196, v197
  s_waitcnt lgkmcnt(4)
  v_mfma_f32_32x32x16_bf16 v[112:127], v[184:187], v[88:91], v[112:127]
  ds_read_b128 v[176:179], v204 offset:12288
  v_exp_f32 v199, v103
  v_add_f32 v201, v201, v198
  buffer_load_dwordx4 v253, s[12:15], s27 offen offset:2048 sc1 lds
  s_and_b32 s29, s29, 0x1ffff
  v_mfma_f32_32x32x16_bf16 v[112:127], v[188:191], v[92:95], v[112:127]
  ds_read_b128 v[180:183], v204 offset:13312
  v_exp_f32 v192, v104
  v_add_f32 v201, v201, v199
  v_cvt_pk_bf16_f32 v131, v198, v199
  s_waitcnt lgkmcnt(4)
  v_mfma_f32_32x32x16_bf16 v[0:15], v[160:163], v[136:139], v[0:15]
  ds_read_b128 v[184:187], v204 offset:14336
  v_exp_f32 v193, v105
  v_add_f32 v201, v201, v192
  buffer_load_dwordx4 v253, s[12:15], s27 offen offset:3072 sc1 lds
  s_add_u32 s27, s27, 0x4000
  s_cmp_eq_u32 s27, s79
  s_cselect_b32 s27, 1081344, s27
  v_mfma_f32_32x32x16_bf16 v[16:31], v[164:167], v[136:139], v[16:31]
  ds_read_b128 v[188:191], v204 offset:15360
  v_exp_f32 v194, v106
  v_add_f32 v201, v201, v193
  v_cvt_pk_bf16_f32 v132, v192, v193
  s_waitcnt lgkmcnt(4)
  v_mfma_f32_32x32x16_bf16 v[32:47], v[168:171], v[136:139], v[32:47]
  ds_read_b128 v[160:163], v204 offset:16384
  v_exp_f32 v195, v107
  v_add_f32 v201, v201, v194
  v_mfma_f32_32x32x16_bf16 v[48:63], v[172:175], v[136:139], v[48:63]
  ds_read_b128 v[164:167], v204 offset:17408
  v_exp_f32 v196, v108
  v_add_f32 v201, v201, v195
  v_cvt_pk_bf16_f32 v133, v194, v195
  s_waitcnt lgkmcnt(4)
  v_mfma_f32_32x32x16_bf16 v[0:15], v[176:179], v[140:143], v[0:15]
  ds_read_b128 v[168:171], v204 offset:18432
  v_exp_f32 v197, v109
  v_add_f32 v201, v201, v196
  v_mfma_f32_32x32x16_bf16 v[16:31], v[180:183], v[140:143], v[16:31]
  ds_read_b128 v[172:175], v204 offset:19456
  v_exp_f32 v198, v110
  v_add_f32 v201, v201, v197
  v_cvt_pk_bf16_f32 v134, v196, v197
  s_waitcnt lgkmcnt(4)
  v_mfma_f32_32x32x16_bf16 v[32:47], v[184:187], v[140:143], v[32:47]
  ds_read_b128 v[176:179], v204 offset:20480
  v_exp_f32 v199, v111
  v_add_f32 v201, v201, v198
  v_mfma_f32_32x32x16_bf16 v[48:63], v[188:191], v[140:143], v[48:63]
  ds_read_b128 v[180:183], v204 offset:21504
  v_add_f32 v201, v201, v199
  v_cvt_pk_bf16_f32 v135, v198, v199
  v_cmp_lt_f32 vcc, s68, v201
  s_cbranch_vccnz slow_An0
back_An0:
  v_add_f32 v200, v200, v201
  v_exp_f32 v192, v112
  s_waitcnt lgkmcnt(4)
  v_mfma_f32_32x32x16_bf16 v[96:111], v[160:163], v[64:67], v[144:159]
  ds_read_b128 v[184:187], v204 offset:22528
  v_exp_f32 v193, v113
  v_mfma_f32_32x32x16_bf16 v[96:111], v[164:167], v[68:71], v[96:111]
  ds_read_b128 v[188:191], v204 offset:23552
  v_exp_f32 v194, v114
  v_add_f32 v201, v192, v193
  v_cvt_pk_bf16_f32 v136, v192, v193
  s_waitcnt lgkmcnt(4)
  v_mfma_f32_32x32x16_bf16 v[96:111], v[168:171], v[72:75], v[96:111]
  ds_read_b128 v[160:163], v204 offset:24576
  v_exp_f32 v195, v115
  v_add_f32 v201, v201, v194
  v_mfma_f32_32x32x16_bf16 v[96:111], v[172:175], v[76:79], v[96:111]
  ds_read_b128 v[164:167], v204 offset:25600
  v_exp_f32 v196, v116
  v_add_f32 v201, v201, v195
  v_cvt_pk_bf16_f32 v137, v194, v195
  s_waitcnt lgkmcnt(4)
  v_mfma_f32_32x32x16_bf16 v[96:111], v[176:179], v[80:83], v[96:111]
  ds_read_b128 v[168:171], v204 offset:26624
  v_exp_f32 v197, v117
  v_add_f32 v201, v201, v196
  v_mfma_f32_32x32x16_bf16 v[96:111], v[180:183], v[84:87], v[96:111]
  ds_read_b128 v[172:175], v204 offset:27648
  v_exp_f32 v198, v118
  v_add_f32 v201, v201, v197
  v_cvt_pk_bf16_f32 v138, v196, v197
  s_waitcnt lgkmcnt(4)
  v_mfma_f32_32x32x16_bf16 v[96:111], v[184:187], v[88:91], v[96:111]
  ds_read_b128 v[176:179], v204 offset:28672
  v_exp_f32 v199, v119
  v_add_f32 v201, v201, v198
  v_mfma_f32_32x32x16_bf16 v[96:111], v[188:191], v[92:95], v[96:111]
  ds_read_b128 v[180:183], v204 offset:29696
  v_exp_f32 v192, v120
  v_add_f32 v201, v201, v199
  v_cvt_pk_bf16_f32 v139, v198, v199
  s_waitcnt lgkmcnt(4)
  v_mfma_f32_32x32x16_bf16 v[0:15], v[160:163], v[128:131], v[0:15]
  ds_read_b128 v[184:187], v204 offset:30720
  v_exp_f32 v193, v121
  v_add_f32 v201, v201, v192
  v_mfma_f32_32x32x16_bf16 v[16:31], v[164:167], v[128:131], v[16:31]
  ds_read_b128 v[188:191], v204 offset:31744
  v_exp_f32 v194, v122
  v_add_f32 v201, v201, v193
  v_cvt_pk_bf16_f32 v140, v192, v193
  s_waitcnt lgkmcnt(4)
  v_mfma_f32_32x32x16_bf16 v[32:47], v[168:171], v[128:131], v[32:47]
  s_waitcnt vmcnt(12)
  s_barrier
  ds_read_b128 v[160:163], v204 offset:32768
  v_exp_f32 v195, v123
  v_add_f32 v201, v201, v194
  s_add_u32 m0, s29, s30
  s_add_u32 s29, s29, 0x4000
  buffer_load_dwordx4 v253, s[12:15], s27 offen offset:0 sc1 lds
  v_mfma_f32_32x32x16_bf16 v[48:63], v[172:175], v[128:131], v[48:63]
  ds_read_b128 v[164:167], v204 offset:33792
  v_exp_f32 v196, v124
  v_add_f32 v201, v201, v195
  v_cvt_pk_bf16_f32 v141, v194, v195
  s_waitcnt lgkmcnt(4)
  v_mfma_f32_32x32x16_bf16 v[0:15], v[176:179], v[132:135], v[0:15]
  ds_read_b128 v[168:171], v204 offset:34816
  v_exp_f32 v197, v125
  v_add_f32 v201, v201, v196
  buffer_load_dwordx4 v253, s[12:15], s27 offen offset:1024 sc1 lds
  v_mfma_f32_32x32x16_bf16 v[16:31], v[180:183], v[132:135], v[16:31]
  ds_read_b128 v[172:175], v204 offset:35840
  v_exp_f32 v198, v126
  v_add_f32 v201, v201, v197
  v_cvt_pk_bf16_f32 v142, v196, v197
  buffer_load_dwordx4 v253, s[12:15], s27 offen offset:2048 sc1 lds
  s_and_b32 s29, s29, 0x1ffff
  s_waitcnt lgkmcnt(4)
  v_mfma_f32_32x32x16_bf16 v[32:47], v[184:187], v[132:135], v[32:47]
  ds_read_b128 v[176:179], v204 offset:36864
  v_exp_f32 v199, v127
  v_add_f32 v201, v201, v198
  buffer_load_dwordx4 v253, s[12:15], s27 offen offset:3072 sc1 lds
  s_add_u32 s27, s27, 0x4000
  s_cmp_eq_u32 s27, s79
  s_cselect_b32 s27, 1081344, s27
  v_mfma_f32_32x32x16_bf16 v[48:63], v[188:191], v[132:135], v[48:63]
  ds_read_b128 v[180:183], v204 offset:37888
  v_add_f32 v201, v201, v199
  v_cvt_pk_bf16_f32 v143, v198, v199
  v_cmp_lt_f32 vcc, s68, v201
  s_cbranch_vccnz slow_An1
back_An1:
  v_add_f32 v200, v200, v201
  v_exp_f32 v192, v96
  s_waitcnt lgkmcnt(4)
  v_mfma_f32_32x32x16_bf16 v[112:127], v[160:163], v[64:67], v[144:159]
  ds_read_b128 v[184:187], v204 offset:38912
  v_exp_f32 v193, v97
  v_mfma_f32_32x32x16_bf16 v[112:127], v[164:167], v[68:71], v[112:127]
  ds_read_b128 v[188:191], v204 offset:39936
  v_exp_f32 v194, v98
  v_add_f32 v201, v192, v193
  v_cvt_pk_bf16_f32 v128, v192, v193
  s_waitcnt lgkmcnt(4)
  v_mfma_f32_32x32x16_bf16 v[112:127], v[168:171], v[72:75], v[112:127]
  ds_read_b128 v[160:163], v204 offset:40960
  v_exp_f32 v195, v99
  v_add_f32 v201, v201, v194
  s_add_u32 m0, s29, s30
  s_add_u32 s29, s29, 0x4000
  buffer_load_dwordx4 v253, s[12:15], s27 offen offset:0 sc1 lds
  v_mfma_f32_32x32x16_bf16 v[112:127], v[172:175], v[76:79], v[112:127]
  ds_read_b128 v[164:167], v204 offset:41984
  v_exp_f32 v196, v100
  v_add_f32 v201, v201, v195
  v_cvt_pk_bf16_f32 v129, v194, v195
  s_waitcnt lgkmcnt(4)
  v_mfma_f32_32x32x16_bf16 v[112:127], v[176:179], v[80:83], v[112:127]
  ds_read_b128 v[168:171], v204 offset:43008
  v_exp_f32 v197, v101
  v_add_f32 v201, v201, v196
  buffer_load_dwordx4 v253, s[12:15], s27 offen offset:1024 sc1 lds
  v_mfma_f32_32x32x16_bf16 v[112:127], v[180:183], v[84:87], v[112:127]
  ds_read_b128 v[172:175], v204 offset:44032
  v_exp_f32 v198, v102
  v_add_f32 v201, v201, v197
  v_cvt_pk_bf16_f32 v130, v196, v197
  s_waitcnt lgkmcnt(4)
  v_mfma_f32_32x32x16_bf16 v[112:127], v[184:187], v[88:91], v[112:127]
  ds_read_b128 v[176:179], v204 offset:45056
  v_exp_f32 v199, v103
  v_add_f32 v201, v201, v198
  buffer_load_dwordx4 v253, s[12:15], s27 offen offset:2048 sc1 lds
  s_and_b32 s29, s29, 0x1ffff
  v_mfma_f32_32x32x16_bf16 v[112:127], v[188:191], v[92:95], v[112:127]
  ds_read_b128 v[180:183], v204 offset:46080
  v_exp_f32 v192, v104
  v_add_f32 v201, v201, v199
  v_cvt_pk_bf16_f32 v131, v198, v199
  s_waitcnt lgkmcnt(4)
  v_mfma_f32_32x32x16_bf16 v[0:15], v[160:163], v[136:139], v[0:15]
  ds_read_b128 v[184:187], v204 offset:47104
  v_exp_f32 v193, v105
  v_add_f32 v201, v201, v192
  buffer_load_dwordx4 v253, s[12:15], s27 offen offset:3072 sc1 lds
  s_add_u32 s27, s27, 0x4000
  s_cmp_eq_u32 s27, s79
  s_cselect_b32 s27, 1081344, s27
  v_mfma_f32_32x32x16_bf16 v[16:31], v[164:167], v[136:139], v[16:31]
  ds_read_b128 v[188:191], v204 offset:48128
  v_exp_f32 v194, v106
  v_add_f32 v201, v201, v193
  v_cvt_pk_bf16_f32 v132, v192, v193
  s_waitcnt lgkmcnt(4)
  v_mfma_f32_32x32x16_bf16 v[32:47], v[168:171], v[136:139], v[32:47]
  ds_read_b128 v[160:163], v204 offset:49152
  v_exp_f32 v195, v107
  v_add_f32 v201, v201, v194
  v_mfma_f32_32x32x16_bf16 v[48:63], v[172:175], v[136:139], v[48:63]
  ds_read_b128 v[164:167], v204 offset:50176
  v_exp_f32 v196, v108
  v_add_f32 v201, v201, v195
  v_cvt_pk_bf16_f32 v133, v194, v195
  s_waitcnt lgkmcnt(4)
  v_mfma_f32_32x32x16_bf16 v[0:15], v[176:179], v[140:143], v[0:15]
  ds_read_b128 v[168:171], v204 offset:51200
  v_exp_f32 v197, v109
  v_add_f32 v201, v201, v196
  v_mfma_f32_32x32x16_bf16 v[16:31], v[180:183], v[140:143], v[16:31]
  ds_read_b128 v[172:175], v204 offset:52224
  v_exp_f32 v198, v110
  v_add_f32 v201, v201, v197
  v_cvt_pk_bf16_f32 v134, v196, v197
  s_waitcnt lgkmcnt(4)
  v_mfma_f32_32x32x16_bf16 v[32:47], v[184:187], v[140:143], v[32:47]
  ds_read_b128 v[176:179], v204 offset:53248
  v_exp_f32 v199, v111
  v_add_f32 v201, v201, v198
  v_mfma_f32_32x32x16_bf16 v[48:63], v[188:191], v[140:143], v[48:63]
  ds_read_b128 v[180:183], v204 offset:54272
  v_add_f32 v201, v201, v199
  v_cvt_pk_bf16_f32 v135, v198, v199
  v_cmp_lt_f32 vcc, s68, v201
  s_cbranch_vccnz slow_An2
back_An2:
  v_add_f32 v200, v200, v201
  v_exp_f32 v192, v112
  s_waitcnt lgkmcnt(4)
  v_mfma_f32_32x32x16_bf16 v[96:111], v[160:163], v[64:67], v[144:159]
  ds_read_b128 v[184:187], v204 offset:55296
  v_exp_f32 v193, v113
  v_mfma_f32_32x32x16_bf16 v[96:111], v[164:167], v[68:71], v[96:111]
  ds_read_b128 v[188:191], v204 offset:56320
  v_exp_f32 v194, v114
  v_add_f32 v201, v192, v193
  v_cvt_pk_bf16_f32 v136, v192, v193
  s_waitcnt lgkmcnt(4)
  v_mfma_f32_32x32x16_bf16 v[96:111], v[168:171], v[72:75], v[96:111]
  ds_read_b128 v[160:163], v204 offset:57344
  v_exp_f32 v195, v115
  v_add_f32 v201, v201, v194
  v_mfma_f32_32x32x16_bf16 v[96:111], v[172:175], v[76:79], v[96:111]
  ds_read_b128 v[164:167], v204 offset:58368
  v_exp_f32 v196, v116
  v_add_f32 v201, v201, v195
  v_cvt_pk_bf16_f32 v137, v194, v195
  s_waitcnt lgkmcnt(4)
  v_mfma_f32_32x32x16_bf16 v[96:111], v[176:179], v[80:83], v[96:111]
  ds_read_b128 v[168:171], v204 offset:59392
  v_exp_f32 v197, v117
  v_add_f32 v201, v201, v196
  v_mfma_f32_32x32x16_bf16 v[96:111], v[180:183], v[84:87], v[96:111]
  ds_read_b128 v[172:175], v204 offset:60416
  v_exp_f32 v198, v118
  v_add_f32 v201, v201, v197
  v_cvt_pk_bf16_f32 v138, v196, v197
  s_waitcnt lgkmcnt(4)
  v_mfma_f32_32x32x16_bf16 v[96:111], v[184:187], v[88:91], v[96:111]
  ds_read_b128 v[176:179], v204 offset:61440
  v_exp_f32 v199, v119
  v_add_f32 v201, v201, v198
  v_mfma_f32_32x32x16_bf16 v[96:111], v[188:191], v[92:95], v[96:111]
  ds_read_b128 v[180:183], v204 offset:62464
  v_exp_f32 v192, v120
  v_add_f32 v201, v201, v199
  v_cvt_pk_bf16_f32 v139, v198, v199
  s_waitcnt lgkmcnt(4)
  v_mfma_f32_32x32x16_bf16 v[0:15], v[160:163], v[128:131], v[0:15]
  ds_read_b128 v[184:187], v204 offset:63488
  v_exp_f32 v193, v121
  v_add_f32 v201, v201, v192
  v_mfma_f32_32x32x16_bf16 v[16:31], v[164:167], v[128:131], v[16:31]
  ds_read_b128 v[188:191], v204 offset:64512
  v_exp_f32 v194, v122
  v_add_f32 v201, v201, v193
  v_cvt_pk_bf16_f32 v140, v192, v193
  s_waitcnt lgkmcnt(4)
  v_mfma_f32_32x32x16_bf16 v[32:47], v[168:171], v[128:131], v[32:47]
  s_waitcnt vmcnt(12)
  s_barrier
  ds_read_b128 v[160:163], v205 offset:0
  v_exp_f32 v195, v123
  v_add_f32 v201, v201, v194
  s_add_u32 m0, s29, s30
  s_add_u32 s29, s29, 0x4000
  buffer_load_dwordx4 v253, s[12:15], s27 offen offset:0 sc1 lds
  v_mfma_f32_32x32x16_bf16 v[48:63], v[172:175], v[128:131], v[48:63]
  ds_read_b128 v[164:167], v205 offset:1024
  v_exp_f32 v196, v124
  v_add_f32 v201, v201, v195
  v_cvt_pk_bf16_f32 v141, v194, v195
  s_waitcnt lgkmcnt(4)
  v_mfma_f32_32x32x16_bf16 v[0:15], v[176:179], v[132:135], v[0:15]
  ds_read_b128 v[168:171], v205 offset:2048
  v_exp_f32 v197, v125
  v_add_f32 v201, v201, v196
  buffer_load_dwordx4 v253, s[12:15], s27 offen offset:1024 sc1 lds
  v_mfma_f32_32x32x16_bf16 v[16:31], v[180:183], v[132:135], v[16:31]
  ds_read_b128 v[172:175], v205 offset:3072
  v_exp_f32 v198, v126
  v_add_f32 v201, v201, v197
  v_cvt_pk_bf16_f32 v142, v196, v197
  buffer_load_dwordx4 v253, s[12:15], s27 offen offset:2048 sc1 lds
  s_and_b32 s29, s29, 0x1ffff
  s_waitcnt lgkmcnt(4)
  v_mfma_f32_32x32x16_bf16 v[32:47], v[184:187], v[132:135], v[32:47]
  ds_read_b128 v[176:179], v205 offset:4096
  v_exp_f32 v199, v127
  v_add_f32 v201, v201, v198
  buffer_load_dwordx4 v253, s[12:15], s27 offen offset:3072 sc1 lds
  s_add_u32 s27, s27, 0x4000
  s_cmp_eq_u32 s27, s79
  s_cselect_b32 s27, 1081344, s27
  v_mfma_f32_32x32x16_bf16 v[48:63], v[188:191], v[132:135], v[48:63]
  ds_read_b128 v[180:183], v205 offset:5120
  v_add_f32 v201, v201, v199
  v_cvt_pk_bf16_f32 v143, v198, v199
  v_cmp_lt_f32 vcc, s68, v201
  v_xor_b32 v204, 0x10000, v204
  v_xor_b32 v205, 0x10000, v205
  s_cbranch_vccnz slow_An3
back_An3:
  s_sub_u32 s66, s66, 1
  s_cmp_gt_u32 s66, 1
  s_cbranch_scc1 at_A_loop
at_A_last:
  buffer_load_dword v251, off, s[96:99], s38 offset:0 sc1
  s_and_b32 s33, s26, 3
  s_cmp_eq_u32 s33, 0
  s_cbranch_scc1 at_A_d0
  s_cmp_eq_u32 s33, 1
  s_cbranch_scc1 at_A_d1
  s_cmp_eq_u32 s33, 2
  s_cbranch_scc1 at_A_d2
at_A_d3:
  v_subrev_u32 v206, 96, v206
  v_add_f32 v200, v200, v201
  v_exp_f32 v192, v96
  s_waitcnt lgkmcnt(4)
  v_mfma_f32_32x32x16_bf16 v[112:127], v[160:163], v[64:67], v[144:159]
  ds_read_b128 v[184:187], v204 offset:6144
  v_exp_f32 v193, v97
  v_mfma_f32_32x32x16_bf16 v[112:127], v[164:167], v[68:71], v[112:127]
  ds_read_b128 v[188:191], v204 offset:7168
  v_exp_f32 v194, v98
  v_add_f32 v201, v192, v193
  v_cvt_pk_bf16_f32 v128, v192, v193
  s_waitcnt lgkmcnt(4)
  v_mfma_f32_32x32x16_bf16 v[112:127], v[168:171], v[72:75], v[112:127]
  ds_read_b128 v[160:163], v204 offset:8192
  v_exp_f32 v195, v99
  v_add_f32 v201, v201, v194
  s_add_u32 m0, s29, s30
  s_add_u32 s29, s29, 0x4000
  buffer_load_dwordx4 v253, s[12:15], s27 offen offset:0 sc1 lds
  v_mfma_f32_32x32x16_bf16 v[112:127], v[172:175], v[76:79], v[112:127]
  ds_read_b128 v[164:167], v204 offset:9216
  v_exp_f32 v196, v100
  v_add_f32 v201, v201, v195
  v_cvt_pk_bf16_f32 v129, v194, v195
  s_waitcnt lgkmcnt(4)
  v_mfma_f32_32x32x16_bf16 v[112:127], v[176:179], v[80:83], v[112:127]
  ds_read_b128 v[168:171], v204 offset:10240
  v_exp_f32 v197, v101
  v_add_f32 v201, v201, v196
  buffer_load_dwordx4 v253, s[12:15], s27 offen offset:1024 sc1 lds
  v_mfma_f32_32x32x16_bf16 v[112:127], v[180:183], v[84:87], v[112:127]
  ds_read_b128 v[172:175], v204 offset:11264
  v_exp_f32 v198, v102
  v_add_f32 v201, v201, v197
  v_cvt_pk_bf16_f32 v130, v196, v197
  s_waitcnt lgkmcnt(4)
  v_mfma_f32_32x32x16_bf16 v[112:127], v[184:187], v[88:91], v[112:127]
  ds_read_b128 v[176:179], v204 offset:12288
  v_exp_f32 v199, v103
  v_add_f32 v201, v201, v198
  buffer_load_dwordx4 v253, s[12:15], s27 offen offset:2048 sc1 lds
  s_and_b32 s29, s29, 0x1ffff
  v_mfma_f32_32x32x16_bf16 v[112:127], v[188:191], v[92:95], v[112:127]
  ds_read_b128 v[180:183], v204 offset:13312
  v_exp_f32 v192, v104
  v_add_f32 v201, v201, v199
  v_cvt_pk_bf16_f32 v131, v198, v199
  s_waitcnt lgkmcnt(4)
  v_mfma_f32_32x32x16_bf16 v[0:15], v[160:163], v[136:139], v[0:15]
  ds_read_b128 v[184:187], v204 offset:14336
  v_exp_f32 v193, v105
  v_add_f32 v201, v201, v192
  buffer_load_dwordx4 v253, s[12:15], s27 offen offset:3072 sc1 lds
  s_add_u32 s27, s27, 0x4000
  s_cmp_eq_u32 s27, s79
  s_cselect_b32 s27, 1081344, s27
  v_mfma_f32_32x32x16_bf16 v[16:31], v[164:167], v[136:139], v[16:31]
  ds_read_b128 v[188:191], v204 offset:15360
  v_exp_f32 v194, v106
  v_add_f32 v201, v201, v193
  v_cvt_pk_bf16_f32 v132, v192, v193
  s_waitcnt lgkmcnt(4)
  v_mfma_f32_32x32x16_bf16 v[32:47], v[168:171], v[136:139], v[32:47]
  ds_read_b128 v[160:163], v204 offset:16384
  v_exp_f32 v195, v107
  v_add_f32 v201, v201, v194
  v_mfma_f32_32x32x16_bf16 v[48:63], v[172:175], v[136:139], v[48:63]
  ds_read_b128 v[164:167], v204 offset:17408
  v_exp_f32 v196, v108
  v_add_f32 v201, v201, v195
  v_cvt_pk_bf16_f32 v133, v194, v195
  s_waitcnt lgkmcnt(4)
  v_mfma_f32_32x32x16_bf16 v[0:15], v[176:179], v[140:143], v[0:15]
  ds_read_b128 v[168:171], v204 offset:18432
  v_exp_f32 v197, v109
  v_add_f32 v201, v201, v196
  v_mfma_f32_32x32x16_bf16 v[16:31], v[180:183], v[140:143], v[16:31]
  ds_read_b128 v[172:175], v204 offset:19456
  v_exp_f32 v198, v110
  v_add_f32 v201, v201, v197
  v_cvt_pk_bf16_f32 v134, v196, v197
  s_waitcnt lgkmcnt(4)
  v_mfma_f32_32x32x16_bf16 v[32:47], v[184:187], v[140:143], v[32:47]
  ds_read_b128 v[176:179], v204 offset:20480
  v_exp_f32 v199, v111
  v_add_f32 v201, v201, v198
  v_mfma_f32_32x32x16_bf16 v[48:63], v[188:191], v[140:143], v[48:63]
  ds_read_b128 v[180:183], v204 offset:21504
  v_add_f32 v201, v201, v199
  v_cvt_pk_bf16_f32 v135, v198, v199
  v_cmp_lt_f32 vcc, s68, v201
  s_cbranch_vccnz slow_A3m0
back_A3m0:
  v_add_f32 v200, v200, v201
  v_exp_f32 v192, v112
  s_waitcnt lgkmcnt(4)
  v_mfma_f32_32x32x16_bf16 v[96:111], v[160:163], v[64:67], v[144:159]
  ds_read_b128 v[184:187], v204 offset:22528
  v_exp_f32 v193, v113
  v_mfma_f32_32x32x16_bf16 v[96:111], v[164:167], v[68:71], v[96:111]
  ds_read_b128 v[188:191], v204 offset:23552
  v_exp_f32 v194, v114
  v_add_f32 v201, v192, v193
  v_cvt_pk_bf16_f32 v136, v192, v193
  s_waitcnt lgkmcnt(4)
  v_mfma_f32_32x32x16_bf16 v[96:111], v[168:171], v[72:75], v[96:111]
  ds_read_b128 v[160:163], v204 offset:24576
  v_exp_f32 v195, v115
  v_add_f32 v201, v201, v194
  v_mfma_f32_32x32x16_bf16 v[96:111], v[172:175], v[76:79], v[96:111]
  ds_read_b128 v[164:167], v204 offset:25600
  v_exp_f32 v196, v116
  v_add_f32 v201, v201, v195
  v_cvt_pk_bf16_f32 v137, v194, v195
  s_waitcnt lgkmcnt(4)
  v_mfma_f32_32x32x16_bf16 v[96:111], v[176:179], v[80:83], v[96:111]
  ds_read_b128 v[168:171], v204 offset:26624
  v_exp_f32 v197, v117
  v_add_f32 v201, v201, v196
  v_mfma_f32_32x32x16_bf16 v[96:111], v[180:183], v[84:87], v[96:111]
  ds_read_b128 v[172:175], v204 offset:27648
  v_exp_f32 v198, v118
  v_add_f32 v201, v201, v197
  v_cvt_pk_bf16_f32 v138, v196, v197
  s_waitcnt lgkmcnt(4)
  v_mfma_f32_32x32x16_bf16 v[96:111], v[184:187], v[88:91], v[96:111]
  ds_read_b128 v[176:179], v204 offset:28672
  v_exp_f32 v199, v119
  v_add_f32 v201, v201, v198
  v_mfma_f32_32x32x16_bf16 v[96:111], v[188:191], v[92:95], v[96:111]
  ds_read_b128 v[180:183], v204 offset:29696
  v_exp_f32 v192, v120
  v_add_f32 v201, v201, v199
  v_cvt_pk_bf16_f32 v139, v198, v199
  s_waitcnt lgkmcnt(4)
  v_mfma_f32_32x32x16_bf16 v[0:15], v[160:163], v[128:131], v[0:15]
  ds_read_b128 v[184:187], v204 offset:30720
  v_exp_f32 v193, v121
  v_add_f32 v201, v201, v192
  v_mfma_f32_32x32x16_bf16 v[16:31], v[164:167], v[128:131], v[16:31]
  ds_read_b128 v[188:191], v204 offset:31744
  v_exp_f32 v194, v122
  v_add_f32 v201, v201, v193
  v_cvt_pk_bf16_f32 v140, v192, v193
  s_waitcnt lgkmcnt(4)
  v_mfma_f32_32x32x16_bf16 v[32:47], v[168:171], v[128:131], v[32:47]
  s_waitcnt vmcnt(12)
  s_barrier
  ds_read_b128 v[160:163], v204 offset:32768
  v_exp_f32 v195, v123
  v_add_f32 v201, v201, v194
  s_add_u32 m0, s29, s30
  s_add_u32 s29, s29, 0x4000
  buffer_load_dwordx4 v253, s[12:15], s27 offen offset:0 sc1 lds
  v_mfma_f32_32x32x16_bf16 v[48:63], v[172:175], v[128:131], v[48:63]
  ds_read_b128 v[164:167], v204 offset:33792
  v_exp_f32 v196, v124
  v_add_f32 v201, v201, v195
  v_cvt_pk_bf16_f32 v141, v194, v195
  s_waitcnt lgkmcnt(4)
  v_mfma_f32_32x32x16_bf16 v[0:15], v[176:179], v[132:135], v[0:15]
  ds_read_b128 v[168:171], v204 offset:34816
  v_exp_f32 v197, v125
  v_add_f32 v201, v201, v196
  buffer_load_dwordx4 v253, s[12:15], s27 offen offset:1024 sc1 lds
  v_mfma_f32_32x32x16_bf16 v[16:31], v[180:183], v[132:135], v[16:31]
  ds_read_b128 v[172:175], v204 offset:35840
  v_exp_f32 v198, v126
  v_add_f32 v201, v201, v197
  v_cvt_pk_bf16_f32 v142, v196, v197
  buffer_load_dwordx4 v253, s[12:15], s27 offen offset:2048 sc1 lds
  s_and_b32 s29, s29, 0x1ffff
  s_waitcnt lgkmcnt(4)
  v_mfma_f32_32x32x16_bf16 v[32:47], v[184:187], v[132:135], v[32:47]
  ds_read_b128 v[176:179], v204 offset:36864
  v_exp_f32 v199, v127
  v_add_f32 v201, v201, v198
  buffer_load_dwordx4 v253, s[12:15], s27 offen offset:3072 sc1 lds
  s_add_u32 s27, s27, 0x4000
  s_cmp_eq_u32 s27, s79
  s_cselect_b32 s27, 1081344, s27
  v_mfma_f32_32x32x16_bf16 v[48:63], v[188:191], v[132:135], v[48:63]
  ds_read_b128 v[180:183], v204 offset:37888
  v_add_f32 v201, v201, v199
  v_cvt_pk_bf16_f32 v143, v198, v199
  v_cmp_lt_f32 vcc, s68, v201
  s_cbranch_vccnz slow_A3m1
back_A3m1:
  v_add_f32 v200, v200, v201
  v_exp_f32 v192, v96
  s_waitcnt lgkmcnt(4)
  v_mfma_f32_32x32x16_bf16 v[112:127], v[160:163], v[64:67], v[144:159]
  ds_read_b128 v[184:187], v204 offset:38912
  v_exp_f32 v193, v97
  v_mfma_f32_32x32x16_bf16 v[112:127], v[164:167], v[68:71], v[112:127]
  ds_read_b128 v[188:191], v204 offset:39936
  v_exp_f32 v194, v98
  v_add_f32 v201, v192, v193
  v_cvt_pk_bf16_f32 v128, v192, v193
  s_waitcnt lgkmcnt(4)
  v_mfma_f32_32x32x16_bf16 v[112:127], v[168:171], v[72:75], v[112:127]
  ds_read_b128 v[160:163], v204 offset:40960
  v_exp_f32 v195, v99
  v_add_f32 v201, v201, v194
  s_add_u32 m0, s29, s30
  s_add_u32 s29, s29, 0x4000
  buffer_load_dwordx4 v253, s[12:15], s27 offen offset:0 sc1 lds
  v_mfma_f32_32x32x16_bf16 v[112:127], v[172:175], v[76:79], v[112:127]
  ds_read_b128 v[164:167], v204 offset:41984
  v_exp_f32 v196, v100
  v_add_f32 v201, v201, v195
  v_cvt_pk_bf16_f32 v129, v194, v195
  s_waitcnt lgkmcnt(4)
  v_mfma_f32_32x32x16_bf16 v[112:127], v[176:179], v[80:83], v[112:127]
  ds_read_b128 v[168:171], v204 offset:43008
  v_exp_f32 v197, v101
  v_add_f32 v201, v201, v196
  buffer_load_dwordx4 v253, s[12:15], s27 offen offset:1024 sc1 lds
  v_mfma_f32_32x32x16_bf16 v[112:127], v[180:183], v[84:87], v[112:127]
  ds_read_b128 v[172:175], v204 offset:44032
  v_exp_f32 v198, v102
  v_add_f32 v201, v201, v197
  v_cvt_pk_bf16_f32 v130, v196, v197
  s_waitcnt lgkmcnt(4)
  v_mfma_f32_32x32x16_bf16 v[112:127], v[184:187], v[88:91], v[112:127]
  ds_read_b128 v[176:179], v204 offset:45056
  v_exp_f32 v199, v103
  v_add_f32 v201, v201, v198
  buffer_load_dwordx4 v253, s[12:15], s27 offen offset:2048 sc1 lds
  s_and_b32 s29, s29, 0x1ffff
  v_mfma_f32_32x32x16_bf16 v[112:127], v[188:191], v[92:95], v[112:127]
  ds_read_b128 v[180:183], v204 offset:46080
  v_exp_f32 v192, v104
  v_add_f32 v201, v201, v199
  v_cvt_pk_bf16_f32 v131, v198, v199
  s_waitcnt lgkmcnt(4)
  v_mfma_f32_32x32x16_bf16 v[0:15], v[160:163], v[136:139], v[0:15]
  ds_read_b128 v[184:187], v204 offset:47104
  v_exp_f32 v193, v105
  v_add_f32 v201, v201, v192
  buffer_load_dwordx4 v253, s[12:15], s27 offen offset:3072 sc1 lds
  s_add_u32 s27, s27, 0x4000
  s_cmp_eq_u32 s27, s79
  s_cselect_b32 s27, 1081344, s27
  v_mfma_f32_32x32x16_bf16 v[16:31], v[164:167], v[136:139], v[16:31]
  ds_read_b128 v[188:191], v204 offset:48128
  v_exp_f32 v194, v106
  v_add_f32 v201, v201, v193
  v_cvt_pk_bf16_f32 v132, v192, v193
  s_waitcnt lgkmcnt(4)
  v_mfma_f32_32x32x16_bf16 v[32:47], v[168:171], v[136:139], v[32:47]
  v_exp_f32 v195, v107
  v_add_f32 v201, v201, v194
  v_mfma_f32_32x32x16_bf16 v[48:63], v[172:175], v[136:139], v[48:63]
  v_exp_f32 v196, v108
  v_add_f32 v201, v201, v195
  v_cvt_pk_bf16_f32 v133, v194, v195
  s_waitcnt lgkmcnt(2)
  v_mfma_f32_32x32x16_bf16 v[0:15], v[176:179], v[140:143], v[0:15]
  v_exp_f32 v197, v109
  v_add_f32 v201, v201, v196
  v_mfma_f32_32x32x16_bf16 v[16:31], v[180:183], v[140:143], v[16:31]
  v_exp_f32 v198, v110
  v_add_f32 v201, v201, v197
  v_cvt_pk_bf16_f32 v134, v196, v197
  s_waitcnt lgkmcnt(0)
  v_mfma_f32_32x32x16_bf16 v[32:47], v[184:187], v[140:143], v[32:47]
  v_exp_f32 v199, v111
  v_add_f32 v201, v201, v198
  v_mfma_f32_32x32x16_bf16 v[48:63], v[188:191], v[140:143], v[48:63]
  v_add_f32 v201, v201, v199
  v_cvt_pk_bf16_f32 v135, v198, v199
  v_cmp_lt_f32 vcc, s68, v201
  s_cbranch_vccnz slow_A3m2
back_A3m2:
  v_add_f32 v200, v200, v201
  ds_read_b128 v[160:163], v204 offset:57344
  v_cmp_gt_i32 s[70:71], 0, v206
  v_cmp_gt_i32 s[72:73], 1, v206
  v_cmp_gt_i32 s[74:75], 2, v206
  v_cndmask_b32 v112, v112, v208, s[70:71]
  v_cndmask_b32 v113, v113, v208, s[72:73]
  v_exp_f32 v192, v112
  ds_read_b128 v[164:167], v204 offset:58368
  v_cmp_gt_i32 s[76:77], 3, v206
  v_exp_f32 v193, v113
  v_cndmask_b32 v114, v114, v208, s[74:75]
  s_waitcnt lgkmcnt(1)
  v_mfma_f32_32x32x16_bf16 v[0:15], v[160:163], v[128:131], v[0:15]
  ds_read_b128 v[168:171], v204 offset:59392
  v_cmp_gt_i32 s[70:71], 8, v206
  v_exp_f32 v194, v114
  v_cndmask_b32 v115, v115, v208, s[76:77]
  v_add_f32 v201, v192, v193
  v_cvt_pk_bf16_f32 v136, v192, v193
  ds_read_b128 v[172:175], v204 offset:60416
  v_cmp_gt_i32 s[72:73], 9, v206
  v_exp_f32 v195, v115
  v_cndmask_b32 v116, v116, v208, s[70:71]
  v_add_f32 v201, v201, v194
  s_waitcnt lgkmcnt(2)
  v_mfma_f32_32x32x16_bf16 v[16:31], v[164:167], v[128:131], v[16:31]
  ds_read_b128 v[176:179], v204 offset:61440
  v_cmp_gt_i32 s[74:75], 10, v206
  v_exp_f32 v196, v116
  v_cndmask_b32 v117, v117, v208, s[72:73]
  v_add_f32 v201, v201, v195
  v_cvt_pk_bf16_f32 v137, v194, v195
  ds_read_b128 v[180:183], v204 offset:62464
  v_cmp_gt_i32 s[76:77], 11, v206
  v_exp_f32 v197, v117
  v_cndmask_b32 v118, v118, v208, s[74:75]
  v_add_f32 v201, v201, v196
  s_waitcnt lgkmcnt(3)
  v_mfma_f32_32x32x16_bf16 v[32:47], v[168:171], v[128:131], v[32:47]
  ds_read_b128 v[184:187], v204 offset:63488
  v_cmp_gt_i32 s[70:71], 16, v206
  v_exp_f32 v198, v118
  v_cndmask_b32 v119, v119, v208, s[76:77]
  v_add_f32 v201, v201, v197
  v_cvt_pk_bf16_f32 v138, v196, v197
  ds_read_b128 v[188:191], v204 offset:64512
  v_cmp_gt_i32 s[72:73], 17, v206
  v_exp_f32 v199, v119
  v_cndmask_b32 v120, v120, v208, s[70:71]
  v_add_f32 v201, v201, v198
  s_waitcnt lgkmcnt(4)
  v_mfma_f32_32x32x16_bf16 v[48:63], v[172:175], v[128:131], v[48:63]
  v_cmp_gt_i32 s[74:75], 18, v206
  v_exp_f32 v192, v120
  v_cndmask_b32 v121, v121, v208, s[72:73]
  v_add_f32 v201, v201, v199
  v_cvt_pk_bf16_f32 v139, v198, v199
  v_cmp_gt_i32 s[76:77], 19, v206
  v_exp_f32 v193, v121
  v_cndmask_b32 v122, v122, v208, s[74:75]
  v_add_f32 v201, v201, v192
  s_waitcnt lgkmcnt(3)
  v_mfma_f32_32x32x16_bf16 v[0:15], v[176:179], v[132:135], v[0:15]
  v_cmp_gt_i32 s[70:71], 24, v206
  v_exp_f32 v194, v122
  v_cndmask_b32 v123, v123, v208, s[76:77]
  v_add_f32 v201, v201, v193
  v_cvt_pk_bf16_f32 v140, v192, v193
  v_cmp_gt_i32 s[72:73], 25, v206
  s_waitcnt vmcnt(12)
  s_barrier
  v_exp_f32 v195, v123
  v_cndmask_b32 v124, v124, v208, s[70:71]
  v_add_f32 v201, v201, v194
  s_add_u32 m0, s29, s30
  s_add_u32 s29, s29, 0x4000
  buffer_load_dwordx4 v253, s[12:15], s27 offen offset:0 sc1 lds
  s_waitcnt lgkmcnt(2)
  v_mfma_f32_32x32x16_bf16 v[16:31], v[180:183], v[132:135], v[16:31]
  v_cmp_gt_i32 s[74:75], 26, v206
  v_exp_f32 v196, v124
  v_cndmask_b32 v125, v125, v208, s[72:73]
  v_add_f32 v201, v201, v195
  v_cvt_pk_bf16_f32 v141, v194, v195
  v_cmp_gt_i32 s[76:77], 27, v206
  v_exp_f32 v197, v125
  v_cndmask_b32 v126, v126, v208, s[74:75]
  v_add_f32 v201, v201, v196
  buffer_load_dwordx4 v253, s[12:15], s27 offen offset:1024 sc1 lds
  s_waitcnt lgkmcnt(1)
  v_mfma_f32_32x32x16_bf16 v[32:47], v[184:187], v[132:135], v[32:47]
  v_exp_f32 v198, v126
  v_cndmask_b32 v127, v127, v208, s[76:77]
  v_add_f32 v201, v201, v197
  v_cvt_pk_bf16_f32 v142, v196, v197
  buffer_load_dwordx4 v253, s[12:15], s27 offen offset:2048 sc1 lds
  s_and_b32 s29, s29, 0x1ffff
  v_exp_f32 v199, v127
  v_add_f32 v201, v201, v198
  buffer_load_dwordx4 v253, s[12:15], s27 offen offset:3072 sc1 lds
  s_add_u32 s27, s27, 0x4000
  s_cmp_eq_u32 s27, s79
  s_cselect_b32 s27, 1081344, s27
  s_waitcnt lgkmcnt(0)
  v_mfma_f32_32x32x16_bf16 v[48:63], v[188:191], v[132:135], v[48:63]
  v_add_f32 v201, v201, v199
  v_cvt_pk_bf16_f32 v143, v198, v199
  v_cmp_lt_f32 vcc, s68, v201
  v_xor_b32 v204, 0x10000, v204
  v_xor_b32 v205, 0x10000, v205
  s_cbranch_vccnz slow_A3m3
back_A3m3:
  s_branch at_A_dend
at_A_d2:
  v_subrev_u32 v206, 64, v206
  v_add_f32 v200, v200, v201
  v_exp_f32 v192, v96
  s_waitcnt lgkmcnt(4)
  v_mfma_f32_32x32x16_bf16 v[112:127], v[160:163], v[64:67], v[144:159]
  ds_read_b128 v[184:187], v204 offset:6144
  v_exp_f32 v193, v97
  v_mfma_f32_32x32x16_bf16 v[112:127], v[164:167], v[68:71], v[112:127]
  ds_read_b128 v[188:191], v204 offset:7168
  v_exp_f32 v194, v98
  v_add_f32 v201, v192, v193
  v_cvt_pk_bf16_f32 v128, v192, v193
  s_waitcnt lgkmcnt(4)
  v_mfma_f32_32x32x16_bf16 v[112:127], v[168:171], v[72:75], v[112:127]
  ds_read_b128 v[160:163], v204 offset:8192
  v_exp_f32 v195, v99
  v_add_f32 v201, v201, v194
  s_add_u32 m0, s29, s30
  s_add_u32 s29, s29, 0x4000
  buffer_load_dwordx4 v253, s[12:15], s27 offen offset:0 sc1 lds
  v_mfma_f32_32x32x16_bf16 v[112:127], v[172:175], v[76:79], v[112:127]
  ds_read_b128 v[164:167], v204 offset:9216
  v_exp_f32 v196, v100
  v_add_f32 v201, v201, v195
  v_cvt_pk_bf16_f32 v129, v194, v195
  s_waitcnt lgkmcnt(4)
  v_mfma_f32_32x32x16_bf16 v[112:127], v[176:179], v[80:83], v[112:127]
  ds_read_b128 v[168:171], v204 offset:10240
  v_exp_f32 v197, v101
  v_add_f32 v201, v201, v196
  buffer_load_dwordx4 v253, s[12:15], s27 offen offset:1024 sc1 lds
  v_mfma_f32_32x32x16_bf16 v[112:127], v[180:183], v[84:87], v[112:127]
  ds_read_b128 v[172:175], v204 offset:11264
  v_exp_f32 v198, v102
  v_add_f32 v201, v201, v197
  v_cvt_pk_bf16_f32 v130, v196, v197
  s_waitcnt lgkmcnt(4)
  v_mfma_f32_32x32x16_bf16 v[112:127], v[184:187], v[88:91], v[112:127]
  ds_read_b128 v[176:179], v204 offset:12288
  v_exp_f32 v199, v103
  v_add_f32 v201, v201, v198
  buffer_load_dwordx4 v253, s[12:15], s27 offen offset:2048 sc1 lds
  s_and_b32 s29, s29, 0x1ffff
  v_mfma_f32_32x32x16_bf16 v[112:127], v[188:191], v[92:95], v[112:127]
  ds_read_b128 v[180:183], v204 offset:13312
  v_exp_f32 v192, v104
  v_add_f32 v201, v201, v199
  v_cvt_pk_bf16_f32 v131, v198, v199
  s_waitcnt lgkmcnt(4)
  v_mfma_f32_32x32x16_bf16 v[0:15], v[160:163], v[136:139], v[0:15]
  ds_read_b128 v[184:187], v204 offset:14336
  v_exp_f32 v193, v105
  v_add_f32 v201, v201, v192
  buffer_load_dwordx4 v253, s[12:15], s27 offen offset:3072 sc1 lds
  s_add_u32 s27, s27, 0x4000
  s_cmp_eq_u32 s27, s79
  s_cselect_b32 s27, 1081344, s27
  v_mfma_f32_32x32x16_bf16 v[16:31], v[164:167], v[136:139], v[16:31]
  ds_read_b128 v[188:191], v204 offset:15360
  v_exp_f32 v194, v106
  v_add_f32 v201, v201, v193
  v_cvt_pk_bf16_f32 v132, v192, v193
  s_waitcnt lgkmcnt(4)
  v_mfma_f32_32x32x16_bf16 v[32:47], v[168:171], v[136:139], v[32:47]
  ds_read_b128 v[160:163], v204 offset:16384
  v_exp_f32 v195, v107
  v_add_f32 v201, v201, v194
  v_mfma_f32_32x32x16_bf16 v[48:63], v[172:175], v[136:139], v[48:63]
  ds_read_b128 v[164:167], v204 offset:17408
  v_exp_f32 v196, v108
  v_add_f32 v201, v201, v195
  v_cvt_pk_bf16_f32 v133, v194, v195
  s_waitcnt lgkmcnt(4)
  v_mfma_f32_32x32x16_bf16 v[0:15], v[176:179], v[140:143], v[0:15]
  ds_read_b128 v[168:171], v204 offset:18432
  v_exp_f32 v197, v109
  v_add_f32 v201, v201, v196
  v_mfma_f32_32x32x16_bf16 v[16:31], v[180:183], v[140:143], v[16:31]
  ds_read_b128 v[172:175], v204 offset:19456
  v_exp_f32 v198, v110
  v_add_f32 v201, v201, v197
  v_cvt_pk_bf16_f32 v134, v196, v197
  s_waitcnt lgkmcnt(4)
  v_mfma_f32_32x32x16_bf16 v[32:47], v[184:187], v[140:143], v[32:47]
  ds_read_b128 v[176:179], v204 offset:20480
  v_exp_f32 v199, v111
  v_add_f32 v201, v201, v198
  v_mfma_f32_32x32x16_bf16 v[48:63], v[188:191], v[140:143], v[48:63]
  ds_read_b128 v[180:183], v204 offset:21504
  v_add_f32 v201, v201, v199
  v_cvt_pk_bf16_f32 v135, v198, v199
  v_cmp_lt_f32 vcc, s68, v201
  s_cbranch_vccnz slow_A2m0
back_A2m0:
  v_add_f32 v200, v200, v201
  v_exp_f32 v192, v112
  s_waitcnt lgkmcnt(4)
  v_mfma_f32_32x32x16_bf16 v[96:111], v[160:163], v[64:67], v[144:159]
  ds_read_b128 v[184:187], v204 offset:22528
  v_exp_f32 v193, v113
  v_mfma_f32_32x32x16_bf16 v[96:111], v[164:167], v[68:71], v[96:111]
  ds_read_b128 v[188:191], v204 offset:23552
  v_exp_f32 v194, v114
  v_add_f32 v201, v192, v193
  v_cvt_pk_bf16_f32 v136, v192, v193
  s_waitcnt lgkmcnt(4)
  v_mfma_f32_32x32x16_bf16 v[96:111], v[168:171], v[72:75], v[96:111]
  ds_read_b128 v[160:163], v204 offset:24576
  v_exp_f32 v195, v115
  v_add_f32 v201, v201, v194
  v_mfma_f32_32x32x16_bf16 v[96:111], v[172:175], v[76:79], v[96:111]
  ds_read_b128 v[164:167], v204 offset:25600
  v_exp_f32 v196, v116
  v_add_f32 v201, v201, v195
  v_cvt_pk_bf16_f32 v137, v194, v195
  s_waitcnt lgkmcnt(4)
  v_mfma_f32_32x32x16_bf16 v[96:111], v[176:179], v[80:83], v[96:111]
  ds_read_b128 v[168:171], v204 offset:26624
  v_exp_f32 v197, v117
  v_add_f32 v201, v201, v196
  v_mfma_f32_32x32x16_bf16 v[96:111], v[180:183], v[84:87], v[96:111]
  ds_read_b128 v[172:175], v204 offset:27648
  v_exp_f32 v198, v118
  v_add_f32 v201, v201, v197
  v_cvt_pk_bf16_f32 v138, v196, v197
  s_waitcnt lgkmcnt(4)
  v_mfma_f32_32x32x16_bf16 v[96:111], v[184:187], v[88:91], v[96:111]
  ds_read_b128 v[176:179], v204 offset:28672
  v_exp_f32 v199, v119
  v_add_f32 v201, v201, v198
  v_mfma_f32_32x32x16_bf16 v[96:111], v[188:191], v[92:95], v[96:111]
  ds_read_b128 v[180:183], v204 offset:29696
  v_exp_f32 v192, v120
  v_add_f32 v201, v201, v199
  v_cvt_pk_bf16_f32 v139, v198, v199
  s_waitcnt lgkmcnt(4)
  v_mfma_f32_32x32x16_bf16 v[0:15], v[160:163], v[128:131], v[0:15]
  ds_read_b128 v[184:187], v204 offset:30720
  v_exp_f32 v193, v121
  v_add_f32 v201, v201, v192
  v_mfma_f32_32x32x16_bf16 v[16:31], v[164:167], v[128:131], v[16:31]
  ds_read_b128 v[188:191], v204 offset:31744
  v_exp_f32 v194, v122
  v_add_f32 v201, v201, v193
  v_cvt_pk_bf16_f32 v140, v192, v193
  s_waitcnt lgkmcnt(4)
  v_mfma_f32_32x32x16_bf16 v[32:47], v[168:171], v[128:131], v[32:47]
  s_waitcnt vmcnt(12)
  s_barrier
  v_exp_f32 v195, v123
  v_add_f32 v201, v201, v194
  s_add_u32 m0, s29, s30
  s_add_u32 s29, s29, 0x4000
  buffer_load_dwordx4 v253, s[12:15], s27 offen offset:0 sc1 lds
  v_mfma_f32_32x32x16_bf16 v[48:63], v[172:175], v[128:131], v[48:63]
  v_exp_f32 v196, v124
  v_add_f32 v201, v201, v195
  v_cvt_pk_bf16_f32 v141, v194, v195
  s_waitcnt lgkmcnt(2)
  v_mfma_f32_32x32x16_bf16 v[0:15], v[176:179], v[132:135], v[0:15]
  v_exp_f32 v197, v125
  v_add_f32 v201, v201, v196
  buffer_load_dwordx4 v253, s[12:15], s27 offen offset:1024 sc1 lds
  v_mfma_f32_32x32x16_bf16 v[16:31], v[180:183], v[132:135], v[16:31]
  v_exp_f32 v198, v126
  v_add_f32 v201, v201, v197
  v_cvt_pk_bf16_f32 v142, v196, v197
  buffer_load_dwordx4 v253, s[12:15], s27 offen offset:2048 sc1 lds
  s_and_b32 s29, s29, 0x1ffff
  s_waitcnt lgkmcnt(0)
  v_mfma_f32_32x32x16_bf16 v[32:47], v[184:187], v[132:135], v[32:47]
  v_exp_f32 v199, v127
  v_add_f32 v201, v201, v198
  buffer_load_dwordx4 v253, s[12:15], s27 offen offset:3072 sc1 lds
  s_add_u32 s27, s27, 0x4000
  s_cmp_eq_u32 s27, s79
  s_cselect_b32 s27, 1081344, s27
  v_mfma_f32_32x32x16_bf16 v[48:63], v[188:191], v[132:135], v[48:63]
  v_add_f32 v201, v201, v199
  v_cvt_pk_bf16_f32 v143, v198, v199
  v_cmp_lt_f32 vcc, s68, v201
  s_cbranch_vccnz slow_A2m1
back_A2m1:
  v_add_f32 v200, v200, v201
  ds_read_b128 v[160:163], v204 offset:40960
  v_cmp_gt_i32 s[70:71], 0, v206
  v_cmp_gt_i32 s[72:73], 1, v206
  v_cmp_gt_i32 s[74:75], 2, v206
  v_cndmask_b32 v96, v96, v208, s[70:71]
  v_cndmask_b32 v97, v97, v208, s[72:73]
  v_exp_f32 v192, v96
  ds_read_b128 v[164:167], v204 offset:41984
  v_cmp_gt_i32 s[76:77], 3, v206
  v_exp_f32 v193, v97
  v_cndmask_b32 v98, v98, v208, s[74:75]
  s_waitcnt lgkmcnt(1)
  v_mfma_f32_32x32x16_bf16 v[0:15], v[160:163], v[136:139], v[0:15]
  ds_read_b128 v[168:171], v204 offset:43008
  v_cmp_gt_i32 s[70:71], 8, v206
  v_exp_f32 v194, v98
  v_cndmask_b32 v99, v99, v208, s[76:77]
  v_add_f32 v201, v192, v193
  v_cvt_pk_bf16_f32 v128, v192, v193
  ds_read_b128 v[172:175], v204 offset:44032
  v_cmp_gt_i32 s[72:73], 9, v206
  v_exp_f32 v195, v99
  v_cndmask_b32 v100, v100, v208, s[70:71]
  v_add_f32 v201, v201, v194
  s_add_u32 m0, s29, s30
  s_add_u32 s29, s29, 0x4000
  buffer_load_dwordx4 v253, s[12:15], s27 offen offset:0 sc1 lds
  s_waitcnt lgkmcnt(2)
  v_mfma_f32_32x32x16_bf16 v[16:31], v[164:167], v[136:139], v[16:31]
  ds_read_b128 v[176:179], v204 offset:45056
  v_cmp_gt_i32 s[74:75], 10, v206
  v_exp_f32 v196, v100
  v_cndmask_b32 v101, v101, v208, s[72:73]
  v_add_f32 v201, v201, v195
  v_cvt_pk_bf16_f32 v129, v194, v195
  ds_read_b128 v[180:183], v204 offset:46080
  v_cmp_gt_i32 s[76:77], 11, v206
  v_exp_f32 v197, v101
  v_cndmask_b32 v102, v102, v208, s[74:75]
  v_add_f32 v201, v201, v196
  buffer_load_dwordx4 v253, s[12:15], s27 offen offset:1024 sc1 lds
  s_waitcnt lgkmcnt(3)
  v_mfma_f32_32x32x16_bf16 v[32:47], v[168:171], v[136:139], v[32:47]
  ds_read_b128 v[184:187], v204 offset:47104
  v_cmp_gt_i32 s[70:71], 16, v206
  v_exp_f32 v198, v102
  v_cndmask_b32 v103, v103, v208, s[76:77]
  v_add_f32 v201, v201, v197
  v_cvt_pk_bf16_f32 v130, v196, v197
  ds_read_b128 v[188:191], v204 offset:48128
  v_cmp_gt_i32 s[72:73], 17, v206
  v_exp_f32 v199, v103
  v_cndmask_b32 v104, v104, v208, s[70:71]
  v_add_f32 v201, v201, v198
  buffer_load_dwordx4 v253, s[12:15], s27 offen offset:2048 sc1 lds
  s_and_b32 s29, s29, 0x1ffff
  s_waitcnt lgkmcnt(4)
  v_mfma_f32_32x32x16_bf16 v[48:63], v[172:175], v[136:139], v[48:63]
  v_cmp_gt_i32 s[74:75], 18, v206
  v_exp_f32 v192, v104
  v_cndmask_b32 v105, v105, v208, s[72:73]
  v_add_f32 v201, v201, v199
  v_cvt_pk_bf16_f32 v131, v198, v199
  v_cmp_gt_i32 s[76:77], 19, v206
  v_exp_f32 v193, v105
  v_cndmask_b32 v106, v106, v208, s[74:75]
  v_add_f32 v201, v201, v192
  buffer_load_dwordx4 v253, s[12:15], s27 offen offset:3072 sc1 lds
  s_add_u32 s27, s27, 0x4000
  s_cmp_eq_u32 s27, s79
  s_cselect_b32 s27, 1081344, s27
  s_waitcnt lgkmcnt(3)
  v_mfma_f32_32x32x16_bf16 v[0:15], v[176:179], v[140:143], v[0:15]
  v_cmp_gt_i32 s[70:71], 24, v206
  v_exp_f32 v194, v106
  v_cndmask_b32 v107, v107, v208, s[76:77]
  v_add_f32 v201, v201, v193
  v_cvt_pk_bf16_f32 v132, v192, v193
  v_cmp_gt_i32 s[72:73], 25, v206
  v_exp_f32 v195, v107
  v_cndmask_b32 v108, v108, v208, s[70:71]
  v_add_f32 v201, v201, v194
  s_waitcnt lgkmcnt(2)
  v_mfma_f32_32x32x16_bf16 v[16:31], v[180:183], v[140:143], v[16:31]
  v_cmp_gt_i32 s[74:75], 26, v206
  v_exp_f32 v196, v108
  v_cndmask_b32 v109, v109, v208, s[72:73]
  v_add_f32 v201, v201, v195
  v_cvt_pk_bf16_f32 v133, v194, v195
  v_cmp_gt_i32 s[76:77], 27, v206
  v_exp_f32 v197, v109
  v_cndmask_b32 v110, v110, v208, s[74:75]
  v_add_f32 v201, v201, v196
  s_waitcnt lgkmcnt(1)
  v_mfma_f32_32x32x16_bf16 v[32:47], v[184:187], v[140:143], v[32:47]
  v_exp_f32 v198, v110
  v_cndmask_b32 v111, v111, v208, s[76:77]
  v_add_f32 v201, v201, v197
  v_cvt_pk_bf16_f32 v134, v196, v197
  v_exp_f32 v199, v111
  v_add_f32 v201, v201, v198
  s_waitcnt lgkmcnt(0)
  v_mfma_f32_32x32x16_bf16 v[48:63], v[188:191], v[140:143], v[48:63]
  v_add_f32 v201, v201, v199
  v_cvt_pk_bf16_f32 v135, v198, v199
  v_cmp_lt_f32 vcc, s68, v201
  s_nop 1
  s_cbranch_vccnz slow_A2m2
back_A2m2:
  v_add_f32 v200, v200, v201
  v_mov_b32 v201, 0
  ds_read_b128 v[160:163], v204 offset:57344
  ds_read_b128 v[164:167], v204 offset:58368
  s_waitcnt lgkmcnt(1)
  v_mfma_f32_32x32x16_bf16 v[0:15], v[160:163], v[128:131], v[0:15]
  ds_read_b128 v[168:171], v204 offset:59392
  ds_read_b128 v[172:175], v204 offset:60416
  s_waitcnt lgkmcnt(2)
  v_mfma_f32_32x32x16_bf16 v[16:31], v[164:167], v[128:131], v[16:31]
  ds_read_b128 v[176:179], v204 offset:61440
  ds_read_b128 v[180:183], v204 offset:62464
  s_waitcnt lgkmcnt(3)
  v_mfma_f32_32x32x16_bf16 v[32:47], v[168:171], v[128:131], v[32:47]
  ds_read_b128 v[184:187], v204 offset:63488
  ds_read_b128 v[188:191], v204 offset:64512
  s_waitcnt lgkmcnt(4)
  v_mfma_f32_32x32x16_bf16 v[48:63], v[172:175], v[128:131], v[48:63]
  s_waitcnt lgkmcnt(3)
  v_mfma_f32_32x32x16_bf16 v[0:15], v[176:179], v[132:135], v[0:15]
  s_waitcnt vmcnt(12)
  s_barrier
  s_add_u32 m0, s29, s30
  s_add_u32 s29, s29, 0x4000
  buffer_load_dwordx4 v253, s[12:15], s27 offen offset:0 sc1 lds
  s_waitcnt lgkmcnt(2)
  v_mfma_f32_32x32x16_bf16 v[16:31], v[180:183], v[132:135], v[16:31]
  buffer_load_dwordx4 v253, s[12:15], s27 offen offset:1024 sc1 lds
  s_waitcnt lgkmcnt(1)
  v_mfma_f32_32x32x16_bf16 v[32:47], v[184:187], v[132:135], v[32:47]
  buffer_load_dwordx4 v253, s[12:15], s27 offen offset:2048 sc1 lds
  s_and_b32 s29, s29, 0x1ffff
  buffer_load_dwordx4 v253, s[12:15], s27 offen offset:3072 sc1 lds
  s_add_u32 s27, s27, 0x4000
  s_cmp_eq_u32 s27, s79
  s_cselect_b32 s27, 1081344, s27
  s_waitcnt lgkmcnt(0)
  v_mfma_f32_32x32x16_bf16 v[48:63], v[188:191], v[132:135], v[48:63]
  v_xor_b32 v204, 0x10000, v204
  v_xor_b32 v205, 0x10000, v205
  s_branch at_A_dend
at_A_d1:
  v_subrev_u32 v206, 32, v206
  v_add_f32 v200, v200, v201
  v_exp_f32 v192, v96
  s_waitcnt lgkmcnt(4)
  v_mfma_f32_32x32x16_bf16 v[112:127], v[160:163], v[64:67], v[144:159]
  ds_read_b128 v[184:187], v204 offset:6144
  v_exp_f32 v193, v97
  v_mfma_f32_32x32x16_bf16 v[112:127], v[164:167], v[68:71], v[112:127]
  ds_read_b128 v[188:191], v204 offset:7168
  v_exp_f32 v194, v98
  v_add_f32 v201, v192, v193
  v_cvt_pk_bf16_f32 v128, v192, v193
  s_waitcnt lgkmcnt(4)
  v_mfma_f32_32x32x16_bf16 v[112:127], v[168:171], v[72:75], v[112:127]
  ds_read_b128 v[160:163], v204 offset:8192
  v_exp_f32 v195, v99
  v_add_f32 v201, v201, v194
  s_add_u32 m0, s29, s30
  s_add_u32 s29, s29, 0x4000
  buffer_load_dwordx4 v253, s[12:15], s27 offen offset:0 sc1 lds
  v_mfma_f32_32x32x16_bf16 v[112:127], v[172:175], v[76:79], v[112:127]
  ds_read_b128 v[164:167], v204 offset:9216
  v_exp_f32 v196, v100
  v_add_f32 v201, v201, v195
  v_cvt_pk_bf16_f32 v129, v194, v195
  s_waitcnt lgkmcnt(4)
  v_mfma_f32_32x32x16_bf16 v[112:127], v[176:179], v[80:83], v[112:127]
  ds_read_b128 v[168:171], v204 offset:10240
  v_exp_f32 v197, v101
  v_add_f32 v201, v201, v196
  buffer_load_dwordx4 v253, s[12:15], s27 offen offset:1024 sc1 lds
  v_mfma_f32_32x32x16_bf16 v[112:127], v[180:183], v[84:87], v[112:127]
  ds_read_b128 v[172:175], v204 offset:11264
  v_exp_f32 v198, v102
  v_add_f32 v201, v201, v197
  v_cvt_pk_bf16_f32 v130, v196, v197
  s_waitcnt lgkmcnt(4)
  v_mfma_f32_32x32x16_bf16 v[112:127], v[184:187], v[88:91], v[112:127]
  ds_read_b128 v[176:179], v204 offset:12288
  v_exp_f32 v199, v103
  v_add_f32 v201, v201, v198
  buffer_load_dwordx4 v253, s[12:15], s27 offen offset:2048 sc1 lds
  s_and_b32 s29, s29, 0x1ffff
  v_mfma_f32_32x32x16_bf16 v[112:127], v[188:191], v[92:95], v[112:127]
  ds_read_b128 v[180:183], v204 offset:13312
  v_exp_f32 v192, v104
  v_add_f32 v201, v201, v199
  v_cvt_pk_bf16_f32 v131, v198, v199
  s_waitcnt lgkmcnt(4)
  v_mfma_f32_32x32x16_bf16 v[0:15], v[160:163], v[136:139], v[0:15]
  ds_read_b128 v[184:187], v204 offset:14336
  v_exp_f32 v193, v105
  v_add_f32 v201, v201, v192
  buffer_load_dwordx4 v253, s[12:15], s27 offen offset:3072 sc1 lds
  s_add_u32 s27, s27, 0x4000
  s_cmp_eq_u32 s27, s79
  s_cselect_b32 s27, 1081344, s27
  v_mfma_f32_32x32x16_bf16 v[16:31], v[164:167], v[136:139], v[16:31]
  ds_read_b128 v[188:191], v204 offset:15360
  v_exp_f32 v194, v106
  v_add_f32 v201, v201, v193
  v_cvt_pk_bf16_f32 v132, v192, v193
  s_waitcnt lgkmcnt(4)
  v_mfma_f32_32x32x16_bf16 v[32:47], v[168:171], v[136:139], v[32:47]
  v_exp_f32 v195, v107
  v_add_f32 v201, v201, v194
  v_mfma_f32_32x32x16_bf16 v[48:63], v[172:175], v[136:139], v[48:63]
  v_exp_f32 v196, v108
  v_add_f32 v201, v201, v195
  v_cvt_pk_bf16_f32 v133, v194, v195
  s_waitcnt lgkmcnt(2)
  v_mfma_f32_32x32x16_bf16 v[0:15], v[176:179], v[140:143], v[0:15]
  v_exp_f32 v197, v109
  v_add_f32 v201, v201, v196
  v_mfma_f32_32x32x16_bf16 v[16:31], v[180:183], v[140:143], v[16:31]
  v_exp_f32 v198, v110
  v_add_f32 v201, v201, v197
  v_cvt_pk_bf16_f32 v134, v196, v197
  s_waitcnt lgkmcnt(0)
  v_mfma_f32_32x32x16_bf16 v[32:47], v[184:187], v[140:143], v[32:47]
  v_exp_f32 v199, v111
  v_add_f32 v201, v201, v198
  v_mfma_f32_32x32x16_bf16 v[48:63], v[188:191], v[140:143], v[48:63]
  v_add_f32 v201, v201, v199
  v_cvt_pk_bf16_f32 v135, v198, v199
  v_cmp_lt_f32 vcc, s68, v201
  s_cbranch_vccnz slow_A1m0
back_A1m0:
  v_add_f32 v200, v200, v201
  ds_read_b128 v[160:163], v204 offset:24576
  v_cmp_gt_i32 s[70:71], 0, v206
  v_cmp_gt_i32 s[72:73], 1, v206
  v_cmp_gt_i32 s[74:75], 2, v206
  v_cndmask_b32 v112, v112, v208, s[70:71]
  v_cndmask_b32 v113, v113, v208, s[72:73]
  v_exp_f32 v192, v112
  ds_read_b128 v[164:167], v204 offset:25600
  v_cmp_gt_i32 s[76:77], 3, v206
  v_exp_f32 v193, v113
  v_cndmask_b32 v114, v114, v208, s[74:75]
  s_waitcnt lgkmcnt(1)
  v_mfma_f32_32x32x16_bf16 v[0:15], v[160:163], v[128:131], v[0:15]
  ds_read_b128 v[168:171], v204 offset:26624
  v_cmp_gt_i32 s[70:71], 8, v206
  v_exp_f32 v194, v114
  v_cndmask_b32 v115, v115, v208, s[76:77]
  v_add_f32 v201, v192, v193
  v_cvt_pk_bf16_f32 v136, v192, v193
  ds_read_b128 v[172:175], v204 offset:27648
  v_cmp_gt_i32 s[72:73], 9, v206
  v_exp_f32 v195, v115
  v_cndmask_b32 v116, v116, v208, s[70:71]
  v_add_f32 v201, v201, v194
  s_waitcnt lgkmcnt(2)
  v_mfma_f32_32x32x16_bf16 v[16:31], v[164:167], v[128:131], v[16:31]
  ds_read_b128 v[176:179], v204 offset:28672
  v_cmp_gt_i32 s[74:75], 10, v206
  v_exp_f32 v196, v116
  v_cndmask_b32 v117, v117, v208, s[72:73]
  v_add_f32 v201, v201, v195
  v_cvt_pk_bf16_f32 v137, v194, v195
  ds_read_b128 v[180:183], v204 offset:29696
  v_cmp_gt_i32 s[76:77], 11, v206
  v_exp_f32 v197, v117
  v_cndmask_b32 v118, v118, v208, s[74:75]
  v_add_f32 v201, v201, v196
  s_waitcnt lgkmcnt(3)
  v_mfma_f32_32x32x16_bf16 v[32:47], v[168:171], v[128:131], v[32:47]
  ds_read_b128 v[184:187], v204 offset:30720
  v_cmp_gt_i32 s[70:71], 16, v206
  v_exp_f32 v198, v118
  v_cndmask_b32 v119, v119, v208, s[76:77]
  v_add_f32 v201, v201, v197
  v_cvt_pk_bf16_f32 v138, v196, v197
  ds_read_b128 v[188:191], v204 offset:31744
  v_cmp_gt_i32 s[72:73], 17, v206
  v_exp_f32 v199, v119
  v_cndmask_b32 v120, v120, v208, s[70:71]
  v_add_f32 v201, v201, v198
  s_waitcnt lgkmcnt(4)
  v_mfma_f32_32x32x16_bf16 v[48:63], v[172:175], v[128:131], v[48:63]
  v_cmp_gt_i32 s[74:75], 18, v206
  v_exp_f32 v192, v120
  v_cndmask_b32 v121, v121, v208, s[72:73]
  v_add_f32 v201, v201, v199
  v_cvt_pk_bf16_f32 v139, v198, v199
  v_cmp_gt_i32 s[76:77], 19, v206
  v_exp_f32 v193, v121
  v_cndmask_b32 v122, v122, v208, s[74:75]
  v_add_f32 v201, v201, v192
  s_waitcnt lgkmcnt(3)
  v_mfma_f32_32x32x16_bf16 v[0:15], v[176:179], v[132:135], v[0:15]
  v_cmp_gt_i32 s[70:71], 24, v206
  v_exp_f32 v194, v122
  v_cndmask_b32 v123, v123, v208, s[76:77]
  v_add_f32 v201, v201, v193
  v_cvt_pk_bf16_f32 v140, v192, v193
  v_cmp_gt_i32 s[72:73], 25, v206
  s_waitcnt vmcnt(12)
  s_barrier
  v_exp_f32 v195, v123
  v_cndmask_b32 v124, v124, v208, s[70:71]
  v_add_f32 v201, v201, v194
  s_add_u32 m0, s29, s30
  s_add_u32 s29, s29, 0x4000
  buffer_load_dwordx4 v253, s[12:15], s27 offen offset:0 sc1 lds
  s_waitcnt lgkmcnt(2)
  v_mfma_f32_32x32x16_bf16 v[16:31], v[180:183], v[132:135], v[16:31]
  v_cmp_gt_i32 s[74:75], 26, v206
  v_exp_f32 v196, v124
  v_cndmask_b32 v125, v125, v208, s[72:73]
  v_add_f32 v201, v201, v195
  v_cvt_pk_bf16_f32 v141, v194, v195
  v_cmp_gt_i32 s[76:77], 27, v206
  v_exp_f32 v197, v125
  v_cndmask_b32 v126, v126, v208, s[74:75]
  v_add_f32 v201, v201, v196
  buffer_load_dwordx4 v253, s[12:15], s27 offen offset:1024 sc1 lds
  s_waitcnt lgkmcnt(1)
  v_mfma_f32_32x32x16_bf16 v[32:47], v[184:187], v[132:135], v[32:47]
  v_exp_f32 v198, v126
  v_cndmask_b32 v127, v127, v208, s[76:77]
  v_add_f32 v201, v201, v197
  v_cvt_pk_bf16_f32 v142, v196, v197
  buffer_load_dwordx4 v253, s[12:15], s27 offen offset:2048 sc1 lds
  s_and_b32 s29, s29, 0x1ffff
  v_exp_f32 v199, v127
  v_add_f32 v201, v201, v198
  buffer_load_dwordx4 v253, s[12:15], s27 offen offset:3072 sc1 lds
  s_add_u32 s27, s27, 0x4000
  s_cmp_eq_u32 s27, s79
  s_cselect_b32 s27, 1081344, s27
  s_waitcnt lgkmcnt(0)
  v_mfma_f32_32x32x16_bf16 v[48:63], v[188:191], v[132:135], v[48:63]
  v_add_f32 v201, v201, v199
  v_cvt_pk_bf16_f32 v143, v198, v199
  v_cmp_lt_f32 vcc, s68, v201
  s_nop 1
  s_cbranch_vccnz slow_A1m1
back_A1m1:
  v_add_f32 v200, v200, v201
  v_mov_b32 v201, 0
  ds_read_b128 v[160:163], v204 offset:40960
  ds_read_b128 v[164:167], v204 offset:41984
  s_waitcnt lgkmcnt(1)
  v_mfma_f32_32x32x16_bf16 v[0:15], v[160:163], v[136:139], v[0:15]
  ds_read_b128 v[168:171], v204 offset:43008
  ds_read_b128 v[172:175], v204 offset:44032
  s_add_u32 m0, s29, s30
  s_add_u32 s29, s29, 0x4000
  buffer_load_dwordx4 v253, s[12:15], s27 offen offset:0 sc1 lds
  s_waitcnt lgkmcnt(2)
  v_mfma_f32_32x32x16_bf16 v[16:31], v[164:167], v[136:139], v[16:31]
  ds_read_b128 v[176:179], v204 offset:45056
  ds_read_b128 v[180:183], v204 offset:46080
  buffer_load_dwordx4 v253, s[12:15], s27 offen offset:1024 sc1 lds
  s_waitcnt lgkmcnt(3)
  v_mfma_f32_32x32x16_bf16 v[32:47], v[168:171], v[136:139], v[32:47]
  ds_read_b128 v[184:187], v204 offset:47104
  ds_read_b128 v[188:191], v204 offset:48128
  buffer_load_dwordx4 v253, s[12:15], s27 offen offset:2048 sc1 lds
  s_and_b32 s29, s29, 0x1ffff
  s_waitcnt lgkmcnt(4)
  v_mfma_f32_32x32x16_bf16 v[48:63], v[172:175], v[136:139], v[48:63]
  buffer_load_dwordx4 v253, s[12:15], s27 offen offset:3072 sc1 lds
  s_add_u32 s27, s27, 0x4000
  s_cmp_eq_u32 s27, s79
  s_cselect_b32 s27, 1081344, s27
  s_waitcnt lgkmcnt(3)
  v_mfma_f32_32x32x16_bf16 v[0:15], v[176:179], v[140:143], v[0:15]
  s_waitcnt lgkmcnt(2)
  v_mfma_f32_32x32x16_bf16 v[16:31], v[180:183], v[140:143], v[16:31]
  s_waitcnt lgkmcnt(1)
  v_mfma_f32_32x32x16_bf16 v[32:47], v[184:187], v[140:143], v[32:47]
  s_waitcnt lgkmcnt(0)
  v_mfma_f32_32x32x16_bf16 v[48:63], v[188:191], v[140:143], v[48:63]
  s_waitcnt vmcnt(12)
  s_barrier
  s_add_u32 m0, s29, s30
  s_add_u32 s29, s29, 0x4000
  buffer_load_dwordx4 v253, s[12:15], s27 offen offset:0 sc1 lds
  buffer_load_dwordx4 v253, s[12:15], s27 offen offset:1024 sc1 lds
  buffer_load_dwordx4 v253, s[12:15], s27 offen offset:2048 sc1 lds
  s_and_b32 s29, s29, 0x1ffff
  buffer_load_dwordx4 v253, s[12:15], s27 offen offset:3072 sc1 lds
  s_add_u32 s27, s27, 0x4000
  s_cmp_eq_u32 s27, s79
  s_cselect_b32 s27, 1081344, s27
  v_xor_b32 v204, 0x10000, v204
  v_xor_b32 v205, 0x10000, v205
  s_branch at_A_dend
at_A_d0:
  v_add_f32 v200, v200, v201
  ds_read_b128 v[160:163], v204 offset:8192
  v_cmp_gt_i32 s[70:71], 0, v206
  v_cmp_gt_i32 s[72:73], 1, v206
  v_cmp_gt_i32 s[74:75], 2, v206
  v_cndmask_b32 v96, v96, v208, s[70:71]
  v_cndmask_b32 v97, v97, v208, s[72:73]
  v_exp_f32 v192, v96
  ds_read_b128 v[164:167], v204 offset:9216
  v_cmp_gt_i32 s[76:77], 3, v206
  v_exp_f32 v193, v97
  v_cndmask_b32 v98, v98, v208, s[74:75]
  s_waitcnt lgkmcnt(1)
  v_mfma_f32_32x32x16_bf16 v[0:15], v[160:163], v[136:139], v[0:15]
  ds_read_b128 v[168:171], v204 offset:10240
  v_cmp_gt_i32 s[70:71], 8, v206
  v_exp_f32 v194, v98
  v_cndmask_b32 v99, v99, v208, s[76:77]
  v_add_f32 v201, v192, v193
  v_cvt_pk_bf16_f32 v128, v192, v193
  ds_read_b128 v[172:175], v204 offset:11264
  v_cmp_gt_i32 s[72:73], 9, v206
  v_exp_f32 v195, v99
  v_cndmask_b32 v100, v100, v208, s[70:71]
  v_add_f32 v201, v201, v194
  s_add_u32 m0, s29, s30
  s_add_u32 s29, s29, 0x4000
  buffer_load_dwordx4 v253, s[12:15], s27 offen offset:0 sc1 lds
  s_waitcnt lgkmcnt(2)
  v_mfma_f32_32x32x16_bf16 v[16:31], v[164:167], v[136:139], v[16:31]
  ds_read_b128 v[176:179], v204 offset:12288
  v_cmp_gt_i32 s[74:75], 10, v206
  v_exp_f32 v196, v100
  v_cndmask_b32 v101, v101, v208, s[72:73]
  v_add_f32 v201, v201, v195
  v_cvt_pk_bf16_f32 v129, v194, v195
  ds_read_b128 v[180:183], v204 offset:13312
  v_cmp_gt_i32 s[76:77], 11, v206
  v_exp_f32 v197, v101
  v_cndmask_b32 v102, v102, v208, s[74:75]
  v_add_f32 v201, v201, v196
  buffer_load_dwordx4 v253, s[12:15], s27 offen offset:1024 sc1 lds
  s_waitcnt lgkmcnt(3)
  v_mfma_f32_32x32x16_bf16 v[32:47], v[168:171], v[136:139], v[32:47]
  ds_read_b128 v[184:187], v204 offset:14336
  v_cmp_gt_i32 s[70:71], 16, v206
  v_exp_f32 v198, v102
  v_cndmask_b32 v103, v103, v208, s[76:77]
  v_add_f32 v201, v201, v197
  v_cvt_pk_bf16_f32 v130, v196, v197
  ds_read_b128 v[188:191], v204 offset:15360
  v_cmp_gt_i32 s[72:73], 17, v206
  v_exp_f32 v199, v103
  v_cndmask_b32 v104, v104, v208, s[70:71]
  v_add_f32 v201, v201, v198
  buffer_load_dwordx4 v253, s[12:15], s27 offen offset:2048 sc1 lds
  s_and_b32 s29, s29, 0x1ffff
  s_waitcnt lgkmcnt(4)
  v_mfma_f32_32x32x16_bf16 v[48:63], v[172:175], v[136:139], v[48:63]
  v_cmp_gt_i32 s[74:75], 18, v206
  v_exp_f32 v192, v104
  v_cndmask_b32 v105, v105, v208, s[72:73]
  v_add_f32 v201, v201, v199
  v_cvt_pk_bf16_f32 v131, v198, v199
  v_cmp_gt_i32 s[76:77], 19, v206
  v_exp_f32 v193, v105
  v_cndmask_b32 v106, v106, v208, s[74:75]
  v_add_f32 v201, v201, v192
  buffer_load_dwordx4 v253, s[12:15], s27 offen offset:3072 sc1 lds
  s_add_u32 s27, s27, 0x4000
  s_cmp_eq_u32 s27, s79
  s_cselect_b32 s27, 1081344, s27
  s_waitcnt lgkmcnt(3)
  v_mfma_f32_32x32x16_bf16 v[0:15], v[176:179], v[140:143], v[0:15]
  v_cmp_gt_i32 s[70:71], 24, v206
  v_exp_f32 v194, v106
  v_cndmask_b32 v107, v107, v208, s[76:77]
  v_add_f32 v201, v201, v193
  v_cvt_pk_bf16_f32 v132, v192, v193
  v_cmp_gt_i32 s[72:73], 25, v206
  v_exp_f32 v195, v107
  v_cndmask_b32 v108, v108, v208, s[70:71]
  v_add_f32 v201, v201, v194
  s_waitcnt lgkmcnt(2)
  v_mfma_f32_32x32x16_bf16 v[16:31], v[180:183], v[140:143], v[16:31]
  v_cmp_gt_i32 s[74:75], 26, v206
  v_exp_f32 v196, v108
  v_cndmask_b32 v109, v109, v208, s[72:73]
  v_add_f32 v201, v201, v195
  v_cvt_pk_bf16_f32 v133, v194, v195
  v_cmp_gt_i32 s[76:77], 27, v206
  v_exp_f32 v197, v109
  v_cndmask_b32 v110, v110, v208, s[74:75]
  v_add_f32 v201, v201, v196
  s_waitcnt lgkmcnt(1)
  v_mfma_f32_32x32x16_bf16 v[32:47], v[184:187], v[140:143], v[32:47]
  v_exp_f32 v198, v110
  v_cndmask_b32 v111, v111, v208, s[76:77]
  v_add_f32 v201, v201, v197
  v_cvt_pk_bf16_f32 v134, v196, v197
  v_exp_f32 v199, v111
  v_add_f32 v201, v201, v198
  s_waitcnt lgkmcnt(0)
  v_mfma_f32_32x32x16_bf16 v[48:63], v[188:191], v[140:143], v[48:63]
  v_add_f32 v201, v201, v199
  v_cvt_pk_bf16_f32 v135, v198, v199
  v_cmp_lt_f32 vcc, s68, v201
  s_nop 1
  s_cbranch_vccnz slow_A0m0
back_A0m0:
  v_add_f32 v200, v200, v201
  v_mov_b32 v201, 0
  ds_read_b128 v[160:163], v204 offset:24576
  ds_read_b128 v[164:167], v204 offset:25600
  s_waitcnt lgkmcnt(1)
  v_mfma_f32_32x32x16_bf16 v[0:15], v[160:163], v[128:131], v[0:15]
  ds_read_b128 v[168:171], v204 offset:26624
  ds_read_b128 v[172:175], v204 offset:27648
  s_waitcnt lgkmcnt(2)
  v_mfma_f32_32x32x16_bf16 v[16:31], v[164:167], v[128:131], v[16:31]
  ds_read_b128 v[176:179], v204 offset:28672
  ds_read_b128 v[180:183], v204 offset:29696
  s_waitcnt lgkmcnt(3)
  v_mfma_f32_32x32x16_bf16 v[32:47], v[168:171], v[128:131], v[32:47]
  ds_read_b128 v[184:187], v204 offset:30720
  ds_read_b128 v[188:191], v204 offset:31744
  s_waitcnt lgkmcnt(4)
  v_mfma_f32_32x32x16_bf16 v[48:63], v[172:175], v[128:131], v[48:63]
  s_waitcnt lgkmcnt(3)
  v_mfma_f32_32x32x16_bf16 v[0:15], v[176:179], v[132:135], v[0:15]
  s_waitcnt vmcnt(12)
  s_barrier
  s_add_u32 m0, s29, s30
  s_add_u32 s29, s29, 0x4000
  buffer_load_dwordx4 v253, s[12:15], s27 offen offset:0 sc1 lds
  s_waitcnt lgkmcnt(2)
  v_mfma_f32_32x32x16_bf16 v[16:31], v[180:183], v[132:135], v[16:31]
  buffer_load_dwordx4 v253, s[12:15], s27 offen offset:1024 sc1 lds
  s_waitcnt lgkmcnt(1)
  v_mfma_f32_32x32x16_bf16 v[32:47], v[184:187], v[132:135], v[32:47]
  buffer_load_dwordx4 v253, s[12:15], s27 offen offset:2048 sc1 lds
  s_and_b32 s29, s29, 0x1ffff
  buffer_load_dwordx4 v253, s[12:15], s27 offen offset:3072 sc1 lds
  s_add_u32 s27, s27, 0x4000
  s_cmp_eq_u32 s27, s79
  s_cselect_b32 s27, 1081344, s27
  s_waitcnt lgkmcnt(0)
  v_mfma_f32_32x32x16_bf16 v[48:63], v[188:191], v[132:135], v[48:63]
  s_add_u32 m0, s29, s30
  s_add_u32 s29, s29, 0x4000
  buffer_load_dwordx4 v253, s[12:15], s27 offen offset:0 sc1 lds
  buffer_load_dwordx4 v253, s[12:15], s27 offen offset:1024 sc1 lds
  buffer_load_dwordx4 v253, s[12:15], s27 offen offset:2048 sc1 lds
  s_and_b32 s29, s29, 0x1ffff
  buffer_load_dwordx4 v253, s[12:15], s27 offen offset:3072 sc1 lds
  s_add_u32 s27, s27, 0x4000
  s_cmp_eq_u32 s27, s79
  s_cselect_b32 s27, 1081344, s27
  s_waitcnt vmcnt(12)
  s_barrier
  s_add_u32 m0, s29, s30
  s_add_u32 s29, s29, 0x4000
  buffer_load_dwordx4 v253, s[12:15], s27 offen offset:0 sc1 lds
  buffer_load_dwordx4 v253, s[12:15], s27 offen offset:1024 sc1 lds
  buffer_load_dwordx4 v253, s[12:15], s27 offen offset:2048 sc1 lds
  s_and_b32 s29, s29, 0x1ffff
  buffer_load_dwordx4 v253, s[12:15], s27 offen offset:3072 sc1 lds
  s_add_u32 s27, s27, 0x4000
  s_cmp_eq_u32 s27, s79
  s_cselect_b32 s27, 1081344, s27
  v_xor_b32 v204, 0x10000, v204
  v_xor_b32 v205, 0x10000, v205
at_A_dend:
  v_readfirstlane_b32 s100, v251
  s_bfe_u32 s100, s100, 524312
  s_cmp_lt_u32 s100, 8
  s_cbranch_scc1 pc_spin6
pc_back6:
  s_add_u32 s96, s60, 81657856
  s_addc_u32 s97, s61, 0
  s_mov_b32 s98, 40960
  s_mov_b32 s99, 0x20000
  s_add_u32 m0, s29, s30
  s_add_u32 s29, s29, 0x4000
  buffer_load_dwordx4 v253, s[12:15], s27 offen offset:0 sc1 lds
  buffer_load_dwordx4 v253, s[12:15], s27 offen offset:1024 sc1 lds
  buffer_load_dwordx4 v253, s[12:15], s27 offen offset:2048 sc1 lds
  s_and_b32 s29, s29, 0x1ffff
  buffer_load_dwordx4 v253, s[12:15], s27 offen offset:3072 sc1 lds
  s_add_u32 s27, s27, 0x4000
  s_cmp_eq_u32 s27, s79
  s_cselect_b32 s27, 1081344, s27
  s_waitcnt lgkmcnt(0)
  s_and_b32 s33, s26, 3
  s_cmp_lg_u32 s33, 3
  s_cbranch_scc1 fin_nr_A
  ds_read_b128 v[160:163], v204 offset:8192
  ds_read_b128 v[164:167], v204 offset:9216
  ds_read_b128 v[168:171], v204 offset:10240
  ds_read_b128 v[172:175], v204 offset:11264
  ds_read_b128 v[176:179], v204 offset:12288
  ds_read_b128 v[180:183], v204 offset:13312
  ds_read_b128 v[184:187], v204 offset:14336
  ds_read_b128 v[188:191], v204 offset:15360
fin_nr_A:
  v_add_f32 v200, v200, v201
  v_mov_b32 v201, v200
  s_nop 1
  v_permlane32_swap_b32 v200, v201
  s_nop 1
  v_add_f32 v200, v200, v201
  v_rcp_f32 v200, v200
  s_waitcnt lgkmcnt(0)
  s_cbranch_scc1 fin_nm_A
  v_mfma_f32_32x32x16_bf16 v[0:15], v[160:163], v[136:139], v[0:15]
  v_mfma_f32_32x32x16_bf16 v[0:15], v[176:179], v[140:143], v[0:15]
  v_mfma_f32_32x32x16_bf16 v[16:31], v[164:167], v[136:139], v[16:31]
  v_mfma_f32_32x32x16_bf16 v[16:31], v[180:183], v[140:143], v[16:31]
  v_mfma_f32_32x32x16_bf16 v[32:47], v[168:171], v[136:139], v[32:47]
  v_mfma_f32_32x32x16_bf16 v[32:47], v[184:187], v[140:143], v[32:47]
  v_mfma_f32_32x32x16_bf16 v[48:63], v[172:175], v[136:139], v[48:63]
  v_mfma_f32_32x32x16_bf16 v[48:63], v[188:191], v[140:143], v[48:63]
fin_nm_A:
  s_lshl_b32 s33, s24, 13
  s_add_u32 s33, s33, s63
  s_add_u32 s34, s33, 4096
  s_nop 3
  v_mul_f32 v0, v0, v200
  v_mul_f32 v1, v1, v200
  v_mul_f32 v2, v2, v200
  v_mul_f32 v3, v3, v200
  v_mul_f32 v4, v4, v200
  v_mul_f32 v5, v5, v200
  v_mul_f32 v6, v6, v200
  v_mul_f32 v7, v7, v200
  v_mul_f32 v8, v8, v200
  v_mul_f32 v9, v9, v200
  v_mul_f32 v10, v10, v200
  v_mul_f32 v11, v11, v200
  v_mul_f32 v12, v12, v200
  v_mul_f32 v13, v13, v200
  v_mul_f32 v14, v14, v200
  v_mul_f32 v15, v15, v200
  v_cvt_pk_bf16_f32 v96, v0, v1
  v_cvt_pk_bf16_f32 v97, v2, v3
  v_cvt_pk_bf16_f32 v98, v4, v5
  v_cvt_pk_bf16_f32 v99, v6, v7
  v_cvt_pk_bf16_f32 v100, v8, v9
  v_cvt_pk_bf16_f32 v101, v10, v11
  v_cvt_pk_bf16_f32 v102, v12, v13
  v_cvt_pk_bf16_f32 v103, v14, v15
  buffer_store_dwordx4 v[96:99], v250, s[16:19], s33 offen offset:0 sc1
  buffer_store_dwordx4 v[100:103], v250, s[16:19], s33 offen offset:1024 sc1
  v_mul_f32 v16, v16, v200
  v_mul_f32 v17, v17, v200
  v_mul_f32 v18, v18, v200
  v_mul_f32 v19, v19, v200
  v_mul_f32 v20, v20, v200
  v_mul_f32 v21, v21, v200
  v_mul_f32 v22, v22, v200
  v_mul_f32 v23, v23, v200
  v_mul_f32 v24, v24, v200
  v_mul_f32 v25, v25, v200
  v_mul_f32 v26, v26, v200
  v_mul_f32 v27, v27, v200
  v_mul_f32 v28, v28, v200
  v_mul_f32 v29, v29, v200
  v_mul_f32 v30, v30, v200
  v_mul_f32 v31, v31, v200
  v_cvt_pk_bf16_f32 v104, v16, v17
  v_cvt_pk_bf16_f32 v105, v18, v19
  v_cvt_pk_bf16_f32 v106, v20, v21
  v_cvt_pk_bf16_f32 v107, v22, v23
  v_cvt_pk_bf16_f32 v108, v24, v25
  v_cvt_pk_bf16_f32 v109, v26, v27
  v_cvt_pk_bf16_f32 v110, v28, v29
  v_cvt_pk_bf16_f32 v111, v30, v31
  buffer_store_dwordx4 v[104:107], v250, s[16:19], s33 offen offset:2048 sc1
  buffer_store_dwordx4 v[108:111], v250, s[16:19], s33 offen offset:3072 sc1
  v_mul_f32 v32, v32, v200
  v_mul_f32 v33, v33, v200
  v_mul_f32 v34, v34, v200
  v_mul_f32 v35, v35, v200
  v_mul_f32 v36, v36, v200
  v_mul_f32 v37, v37, v200
  v_mul_f32 v38, v38, v200
  v_mul_f32 v39, v39, v200
  v_mul_f32 v40, v40, v200
  v_mul_f32 v41, v41, v200
  v_mul_f32 v42, v42, v200
  v_mul_f32 v43, v43, v200
  v_mul_f32 v44, v44, v200
  v_mul_f32 v45, v45, v200
  v_mul_f32 v46, v46, v200
  v_mul_f32 v47, v47, v200
  v_cvt_pk_bf16_f32 v112, v32, v33
  v_cvt_pk_bf16_f32 v113, v34, v35
  v_cvt_pk_bf16_f32 v114, v36, v37
  v_cvt_pk_bf16_f32 v115, v38, v39
  v_cvt_pk_bf16_f32 v116, v40, v41
  v_cvt_pk_bf16_f32 v117, v42, v43
  v_cvt_pk_bf16_f32 v118, v44, v45
  v_cvt_pk_bf16_f32 v119, v46, v47
  buffer_store_dwordx4 v[112:115], v250, s[16:19], s34 offen offset:0 sc1
  buffer_store_dwordx4 v[116:119], v250, s[16:19], s34 offen offset:1024 sc1
  s_nop 3
  v_mul_f32 v48, v48, v200
  v_mul_f32 v49, v49, v200
  v_mul_f32 v50, v50, v200
  v_mul_f32 v51, v51, v200
  v_mul_f32 v52, v52, v200
  v_mul_f32 v53, v53, v200
  v_mul_f32 v54, v54, v200
  v_mul_f32 v55, v55, v200
  v_mul_f32 v56, v56, v200
  v_mul_f32 v57, v57, v200
  v_mul_f32 v58, v58, v200
  v_mul_f32 v59, v59, v200
  v_mul_f32 v60, v60, v200
  v_mul_f32 v61, v61, v200
  v_mul_f32 v62, v62, v200
  v_mul_f32 v63, v63, v200
  v_cvt_pk_bf16_f32 v120, v48, v49
  v_cvt_pk_bf16_f32 v121, v50, v51
  v_cvt_pk_bf16_f32 v122, v52, v53
  v_cvt_pk_bf16_f32 v123, v54, v55
  v_cvt_pk_bf16_f32 v124, v56, v57
  v_cvt_pk_bf16_f32 v125, v58, v59
  v_cvt_pk_bf16_f32 v126, v60, v61
  v_cvt_pk_bf16_f32 v127, v62, v63
  buffer_store_dwordx4 v[120:123], v250, s[16:19], s34 offen offset:2048 sc1
  buffer_store_dwordx4 v[124:127], v250, s[16:19], s34 offen offset:3072 sc1
  s_add_u32 s66, s65, 2
  s_waitcnt vmcnt(12)
  s_barrier
  s_add_u32 m0, s29, s30
  s_add_u32 s29, s29, 0x4000
  buffer_load_dwordx4 v253, s[12:15], s27 offen offset:0 sc1 lds
  buffer_load_dwordx4 v253, s[12:15], s27 offen offset:1024 sc1 lds
  buffer_load_dwordx4 v253, s[12:15], s27 offen offset:2048 sc1 lds
  s_and_b32 s29, s29, 0x1ffff
  buffer_load_dwordx4 v253, s[12:15], s27 offen offset:3072 sc1 lds
  s_add_u32 s27, s27, 0x4000
  s_cmp_eq_u32 s27, s79
  s_cselect_b32 s27, 1081344, s27
  s_add_u32 m0, s29, s30
  s_add_u32 s29, s29, 0x4000
  buffer_load_dwordx4 v253, s[12:15], s27 offen offset:0 sc1 lds
  buffer_load_dwordx4 v253, s[12:15], s27 offen offset:1024 sc1 lds
  buffer_load_dwordx4 v253, s[12:15], s27 offen offset:2048 sc1 lds
  s_and_b32 s29, s29, 0x1ffff
  buffer_load_dwordx4 v253, s[12:15], s27 offen offset:3072 sc1 lds
  s_add_u32 s27, s27, 0x4000
  s_cmp_eq_u32 s27, s79
  s_cselect_b32 s27, 1081344, s27
  s_waitcnt vmcnt(8)
  s_barrier
  s_cmp_eq_u32 s26, 0
  s_cbranch_scc1 sg_do7
sg_back7:
  s_branch at_ld1
at_ld:
  s_waitcnt vmcnt(12)
  s_barrier
at_ld1:
  s_add_u32 s66, s66, 2
  s_cmp_ge_u32 s66, s67
  s_cbranch_scc1 at_ld_done
  s_add_u32 m0, s29, s30
  s_add_u32 s29, s29, 0x4000
  buffer_load_dwordx4 v253, s[12:15], s27 offen offset:0 sc1 lds
  buffer_load_dwordx4 v253, s[12:15], s27 offen offset:1024 sc1 lds
  buffer_load_dwordx4 v253, s[12:15], s27 offen offset:2048 sc1 lds
  s_and_b32 s29, s29, 0x1ffff
  buffer_load_dwordx4 v253, s[12:15], s27 offen offset:3072 sc1 lds
  s_add_u32 s27, s27, 0x4000
  s_cmp_eq_u32 s27, s79
  s_cselect_b32 s27, 1081344, s27
  s_add_u32 m0, s29, s30
  s_add_u32 s29, s29, 0x4000
  buffer_load_dwordx4 v253, s[12:15], s27 offen offset:0 sc1 lds
  buffer_load_dwordx4 v253, s[12:15], s27 offen offset:1024 sc1 lds
  buffer_load_dwordx4 v253, s[12:15], s27 offen offset:2048 sc1 lds
  s_and_b32 s29, s29, 0x1ffff
  buffer_load_dwordx4 v253, s[12:15], s27 offen offset:3072 sc1 lds
  s_add_u32 s27, s27, 0x4000
  s_cmp_eq_u32 s27, s79
  s_cselect_b32 s27, 1081344, s27
  s_branch at_ld
at_ld_done:
  buffer_load_dword v251, off, s[96:99], s69 offset:0 sc1
  s_add_u32 m0, s29, s30
  s_add_u32 s29, s29, 0x4000
  buffer_load_dwordx4 v253, s[12:15], s27 offen offset:0 sc1 lds
  buffer_load_dwordx4 v253, s[12:15], s27 offen offset:1024 sc1 lds
  buffer_load_dwordx4 v253, s[12:15], s27 offen offset:2048 sc1 lds
  s_and_b32 s29, s29, 0x1ffff
  buffer_load_dwordx4 v253, s[12:15], s27 offen offset:3072 sc1 lds
  s_add_u32 s27, s27, 0x4000
  s_cmp_eq_u32 s27, s79
  s_cselect_b32 s27, 1081344, s27
  s_add_u32 m0, s29, s30
  s_add_u32 s29, s29, 0x4000
  buffer_load_dwordx4 v253, s[12:15], s27 offen offset:0 sc1 lds
  buffer_load_dwordx4 v253, s[12:15], s27 offen offset:1024 sc1 lds
  buffer_load_dwordx4 v253, s[12:15], s27 offen offset:2048 sc1 lds
  s_and_b32 s29, s29, 0x1ffff
  buffer_load_dwordx4 v253, s[12:15], s27 offen offset:3072 sc1 lds
  s_add_u32 s27, s27, 0x4000
  s_cmp_eq_u32 s27, s79
  s_cselect_b32 s27, 1081344, s27
  s_mov_b32 s33, 1212416
  s_add_u32 m0, s30, 131072
  s_nop 0
  buffer_load_dwordx4 v253, s[12:15], s33 offen offset:0 sc1 lds
  buffer_load_dwordx4 v253, s[12:15], s33 offen offset:1024 sc1 lds
  buffer_load_dwordx4 v253, s[12:15], s33 offen offset:2048 sc1 lds
  buffer_load_dwordx4 v253, s[12:15], s33 offen offset:3072 sc1 lds
  s_add_u32 s33, s33, 0x4000
  s_add_u32 m0, s30, 147456
  s_nop 0
  buffer_load_dwordx4 v253, s[12:15], s33 offen offset:0 sc1 lds
  buffer_load_dwordx4 v253, s[12:15], s33 offen offset:1024 sc1 lds
  buffer_load_dwordx4 v253, s[12:15], s33 offen offset:2048 sc1 lds
  buffer_load_dwordx4 v253, s[12:15], s33 offen offset:3072 sc1 lds
  s_waitcnt vmcnt(16)
  v_readfirstlane_b32 s100, v251
  s_bfe_u32 s100, s100, 524288
  s_cmp_lt_u32 s100, 4
  s_cbranch_scc1 pc_spin8
pc_back8:
  s_add_u32 s33, s63, 42467328
  s_add_u32 s8, s60, s33
  s_addc_u32 s9, s61, 0
  s_mov_b32 s10, 350208
  s_and_b32 s33, s24, 28
  s_mul_i32 s33, s33, 3072
  s_add_u32 s33, s33, 262144
  v_add_u32 v254, s33, v250
  buffer_load_dwordx4 v[64:67], v254, s[8:11], 0 offen offset:0 sc1
  buffer_load_dwordx4 v[68:71], v254, s[8:11], 0 offen offset:1024 sc1
  buffer_load_dwordx4 v[72:75], v254, s[8:11], 0 offen offset:2048 sc1
  buffer_load_dwordx4 v[76:79], v254, s[8:11], 0 offen offset:3072 sc1
  v_add_u32 v254, 0x1000, v254
  buffer_load_dwordx4 v[80:83], v254, s[8:11], 0 offen offset:0 sc1
  buffer_load_dwordx4 v[84:87], v254, s[8:11], 0 offen offset:1024 sc1
  buffer_load_dwordx4 v[88:91], v254, s[8:11], 0 offen offset:2048 sc1
  buffer_load_dwordx4 v[92:95], v254, s[8:11], 0 offen offset:3072 sc1
  v_add_u32 v254, 0x1000, v254
  buffer_load_dwordx4 v[144:147], v254, s[8:11], 0 offen offset:0 sc1
  buffer_load_dwordx4 v[148:151], v254, s[8:11], 0 offen offset:1024 sc1
  buffer_load_dwordx4 v[152:155], v254, s[8:11], 0 offen offset:2048 sc1
  buffer_load_dwordx4 v[156:159], v254, s[8:11], 0 offen offset:3072 sc1
  v_add_u32 v254, 0x1000, v254
  s_sub_u32 s33, s67, s65
  s_and_b32 s33, s33, 4
  s_lshl_b32 s33, s33, 14
  v_xor_b32 v204, s33, v204
  v_xor_b32 v205, s33, v205
  s_waitcnt vmcnt(28)
  s_branch at_done
at_B:
  s_add_u32 s96, s60, 81657856
  s_addc_u32 s97, s61, 0
  s_mov_b32 s98, 40960
  s_mov_b32 s99, 0x20000
  s_cmp_eq_u32 s66, 1
  s_cbranch_scc1 at_B_last
.p2align 3
at_B_loop:
  v_add_f32 v200, v200, v201
  v_exp_f32 v192, v96
  s_waitcnt lgkmcnt(4)
  v_mfma_f32_32x32x16_bf16 v[112:127], v[160:163], v[64:67], v[144:159]
  ds_read_b128 v[184:187], v204 offset:6144
  v_exp_f32 v193, v97
  v_mfma_f32_32x32x16_bf16 v[112:127], v[164:167], v[68:71], v[112:127]
  ds_read_b128 v[188:191], v204 offset:7168
  v_exp_f32 v194, v98
  v_add_f32 v201, v192, v193
  v_cvt_pk_bf16_f32 v128, v192, v193
  s_waitcnt lgkmcnt(4)
  v_mfma_f32_32x32x16_bf16 v[112:127], v[168:171], v[72:75], v[112:127]
  ds_read_b128 v[160:163], v204 offset:8192
  v_exp_f32 v195, v99
  v_add_f32 v201, v201, v194
  v_mfma_f32_32x32x16_bf16 v[112:127], v[172:175], v[76:79], v[112:127]
  ds_read_b128 v[164:167], v204 offset:9216
  v_exp_f32 v196, v100
  v_add_f32 v201, v201, v195
  v_cvt_pk_bf16_f32 v129, v194, v195
  s_waitcnt lgkmcnt(4)
  v_mfma_f32_32x32x16_bf16 v[112:127], v[176:179], v[80:83], v[112:127]
  ds_read_b128 v[168:171], v204 offset:10240
  v_exp_f32 v197, v101
  v_add_f32 v201, v201, v196
  v_mfma_f32_32x32x16_bf16 v[112:127], v[180:183], v[84:87], v[112:127]
  ds_read_b128 v[172:175], v204 offset:11264
  v_exp_f32 v198, v102
  v_add_f32 v201, v201, v197
  v_cvt_pk_bf16_f32 v130, v196, v197
  s_waitcnt lgkmcnt(4)
  v_mfma_f32_32x32x16_bf16 v[112:127], v[184:187], v[88:91], v[112:127]
  ds_read_b128 v[176:179], v204 offset:12288
  v_exp_f32 v199, v103
  v_add_f32 v201, v201, v198
  v_mfma_f32_32x32x16_bf16 v[112:127], v[188:191], v[92:95], v[112:127]
  ds_read_b128 v[180:183], v204 offset:13312
  v_exp_f32 v192, v104
  v_add_f32 v201, v201, v199
  v_cvt_pk_bf16_f32 v131, v198, v199
  s_waitcnt lgkmcnt(4)
  v_mfma_f32_32x32x16_bf16 v[0:15], v[160:163], v[136:139], v[0:15]
  ds_read_b128 v[184:187], v204 offset:14336
  v_exp_f32 v193, v105
  v_add_f32 v201, v201, v192
  v_mfma_f32_32x32x16_bf16 v[16:31], v[164:167], v[136:139], v[16:31]
  ds_read_b128 v[188:191], v204 offset:15360
  v_exp_f32 v194, v106
  v_add_f32 v201, v201, v193
  v_cvt_pk_bf16_f32 v132, v192, v193
  s_waitcnt lgkmcnt(4)
  v_mfma_f32_32x32x16_bf16 v[32:47], v[168:171], v[136:139], v[32:47]
  ds_read_b128 v[160:163], v204 offset:16384
  v_exp_f32 v195, v107
  v_add_f32 v201, v201, v194
  v_mfma_f32_32x32x16_bf16 v[48:63], v[172:175], v[136:139], v[48:63]
  ds_read_b128 v[164:167], v204 offset:17408
  v_exp_f32 v196, v108
  v_add_f32 v201, v201, v195
  v_cvt_pk_bf16_f32 v133, v194, v195
  s_waitcnt lgkmcnt(4)
  v_mfma_f32_32x32x16_bf16 v[0:15], v[176:179], v[140:143], v[0:15]
  ds_read_b128 v[168:171], v204 offset:18432
  v_exp_f32 v197, v109
  v_add_f32 v201, v201, v196
  v_mfma_f32_32x32x16_bf16 v[16:31], v[180:183], v[140:143], v[16:31]
  ds_read_b128 v[172:175], v204 offset:19456
  v_exp_f32 v198, v110
  v_add_f32 v201, v201, v197
  v_cvt_pk_bf16_f32 v134, v196, v197
  s_waitcnt lgkmcnt(4)
  v_mfma_f32_32x32x16_bf16 v[32:47], v[184:187], v[140:143], v[32:47]
  ds_read_b128 v[176:179], v204 offset:20480
  v_exp_f32 v199, v111
  v_add_f32 v201, v201, v198
  v_mfma_f32_32x32x16_bf16 v[48:63], v[188:191], v[140:143], v[48:63]
  ds_read_b128 v[180:183], v204 offset:21504
  v_add_f32 v201, v201, v199
  v_cvt_pk_bf16_f32 v135, v198, v199
  v_cmp_lt_f32 vcc, s68, v201
  s_cbranch_vccnz slow_Bn0
back_Bn0:
  v_add_f32 v200, v200, v201
  v_exp_f32 v192, v112
  s_waitcnt lgkmcnt(4)
  v_mfma_f32_32x32x16_bf16 v[96:111], v[160:163], v[64:67], v[144:159]
  ds_read_b128 v[184:187], v204 offset:22528
  v_exp_f32 v193, v113
  v_mfma_f32_32x32x16_bf16 v[96:111], v[164:167], v[68:71], v[96:111]
  ds_read_b128 v[188:191], v204 offset:23552
  v_exp_f32 v194, v114
  v_add_f32 v201, v192, v193
  v_cvt_pk_bf16_f32 v136, v192, v193
  s_waitcnt lgkmcnt(4)
  v_mfma_f32_32x32x16_bf16 v[96:111], v[168:171], v[72:75], v[96:111]
  ds_read_b128 v[160:163], v204 offset:24576
  v_exp_f32 v195, v115
  v_add_f32 v201, v201, v194
  v_mfma_f32_32x32x16_bf16 v[96:111], v[172:175], v[76:79], v[96:111]
  ds_read_b128 v[164:167], v204 offset:25600
  v_exp_f32 v196, v116
  v_add_f32 v201, v201, v195
  v_cvt_pk_bf16_f32 v137, v194, v195
  s_waitcnt lgkmcnt(4)
  v_mfma_f32_32x32x16_bf16 v[96:111], v[176:179], v[80:83], v[96:111]
  ds_read_b128 v[168:171], v204 offset:26624
  v_exp_f32 v197, v117
  v_add_f32 v201, v201, v196
  v_mfma_f32_32x32x16_bf16 v[96:111], v[180:183], v[84:87], v[96:111]
  ds_read_b128 v[172:175], v204 offset:27648
  v_exp_f32 v198, v118
  v_add_f32 v201, v201, v197
  v_cvt_pk_bf16_f32 v138, v196, v197
  s_waitcnt lgkmcnt(4)
  v_mfma_f32_32x32x16_bf16 v[96:111], v[184:187], v[88:91], v[96:111]
  ds_read_b128 v[176:179], v204 offset:28672
  v_exp_f32 v199, v119
  v_add_f32 v201, v201, v198
  v_mfma_f32_32x32x16_bf16 v[96:111], v[188:191], v[92:95], v[96:111]
  ds_read_b128 v[180:183], v204 offset:29696
  v_exp_f32 v192, v120
  v_add_f32 v201, v201, v199
  v_cvt_pk_bf16_f32 v139, v198, v199
  s_waitcnt lgkmcnt(4)
  v_mfma_f32_32x32x16_bf16 v[0:15], v[160:163], v[128:131], v[0:15]
  ds_read_b128 v[184:187], v204 offset:30720
  v_exp_f32 v193, v121
  v_add_f32 v201, v201, v192
  v_mfma_f32_32x32x16_bf16 v[16:31], v[164:167], v[128:131], v[16:31]
  ds_read_b128 v[188:191], v204 offset:31744
  v_exp_f32 v194, v122
  v_add_f32 v201, v201, v193
  v_cvt_pk_bf16_f32 v140, v192, v193
  s_waitcnt lgkmcnt(4)
  v_mfma_f32_32x32x16_bf16 v[32:47], v[168:171], v[128:131], v[32:47]
  s_barrier
  ds_read_b128 v[160:163], v204 offset:32768
  v_exp_f32 v195, v123
  v_add_f32 v201, v201, v194
  v_mfma_f32_32x32x16_bf16 v[48:63], v[172:175], v[128:131], v[48:63]
  ds_read_b128 v[164:167], v204 offset:33792
  v_exp_f32 v196, v124
  v_add_f32 v201, v201, v195
  v_cvt_pk_bf16_f32 v141, v194, v195
  s_waitcnt lgkmcnt(4)
  v_mfma_f32_32x32x16_bf16 v[0:15], v[176:179], v[132:135], v[0:15]
  ds_read_b128 v[168:171], v204 offset:34816
  v_exp_f32 v197, v125
  v_add_f32 v201, v201, v196
  v_mfma_f32_32x32x16_bf16 v[16:31], v[180:183], v[132:135], v[16:31]
  ds_read_b128 v[172:175], v204 offset:35840
  v_exp_f32 v198, v126
  v_add_f32 v201, v201, v197
  v_cvt_pk_bf16_f32 v142, v196, v197
  s_waitcnt lgkmcnt(4)
  v_mfma_f32_32x32x16_bf16 v[32:47], v[184:187], v[132:135], v[32:47]
  ds_read_b128 v[176:179], v204 offset:36864
  v_exp_f32 v199, v127
  v_add_f32 v201, v201, v198
  v_mfma_f32_32x32x16_bf16 v[48:63], v[188:191], v[132:135], v[48:63]
  ds_read_b128 v[180:183], v204 offset:37888
  v_add_f32 v201, v201, v199
  v_cvt_pk_bf16_f32 v143, v198, v199
  v_cmp_lt_f32 vcc, s68, v201
  s_cbranch_vccnz slow_Bn1
back_Bn1:
  v_add_f32 v200, v200, v201
  v_exp_f32 v192, v96
  s_waitcnt lgkmcnt(4)
  v_mfma_f32_32x32x16_bf16 v[112:127], v[160:163], v[64:67], v[144:159]
  ds_read_b128 v[184:187], v204 offset:38912
  v_exp_f32 v193, v97
  v_mfma_f32_32x32x16_bf16 v[112:127], v[164:167], v[68:71], v[112:127]
  ds_read_b128 v[188:191], v204 offset:39936
  v_exp_f32 v194, v98
  v_add_f32 v201, v192, v193
  v_cvt_pk_bf16_f32 v128, v192, v193
  s_waitcnt lgkmcnt(4)
  v_mfma_f32_32x32x16_bf16 v[112:127], v[168:171], v[72:75], v[112:127]
  ds_read_b128 v[160:163], v204 offset:40960
  v_exp_f32 v195, v99
  v_add_f32 v201, v201, v194
  v_mfma_f32_32x32x16_bf16 v[112:127], v[172:175], v[76:79], v[112:127]
  ds_read_b128 v[164:167], v204 offset:41984
  v_exp_f32 v196, v100
  v_add_f32 v201, v201, v195
  v_cvt_pk_bf16_f32 v129, v194, v195
  s_waitcnt lgkmcnt(4)
  v_mfma_f32_32x32x16_bf16 v[112:127], v[176:179], v[80:83], v[112:127]
  ds_read_b128 v[168:171], v204 offset:43008
  v_exp_f32 v197, v101
  v_add_f32 v201, v201, v196
  v_mfma_f32_32x32x16_bf16 v[112:127], v[180:183], v[84:87], v[112:127]
  ds_read_b128 v[172:175], v204 offset:44032
  v_exp_f32 v198, v102
  v_add_f32 v201, v201, v197
  v_cvt_pk_bf16_f32 v130, v196, v197
  s_waitcnt lgkmcnt(4)
  v_mfma_f32_32x32x16_bf16 v[112:127], v[184:187], v[88:91], v[112:127]
  ds_read_b128 v[176:179], v204 offset:45056
  v_exp_f32 v199, v103
  v_add_f32 v201, v201, v198
  v_mfma_f32_32x32x16_bf16 v[112:127], v[188:191], v[92:95], v[112:127]
  ds_read_b128 v[180:183], v204 offset:46080
  v_exp_f32 v192, v104
  v_add_f32 v201, v201, v199
  v_cvt_pk_bf16_f32 v131, v198, v199
  s_waitcnt lgkmcnt(4)
  v_mfma_f32_32x32x16_bf16 v[0:15], v[160:163], v[136:139], v[0:15]
  ds_read_b128 v[184:187], v204 offset:47104
  v_exp_f32 v193, v105
  v_add_f32 v201, v201, v192
  v_mfma_f32_32x32x16_bf16 v[16:31], v[164:167], v[136:139], v[16:31]
  ds_read_b128 v[188:191], v204 offset:48128
  v_exp_f32 v194, v106
  v_add_f32 v201, v201, v193
  v_cvt_pk_bf16_f32 v132, v192, v193
  s_waitcnt lgkmcnt(4)
  v_mfma_f32_32x32x16_bf16 v[32:47], v[168:171], v[136:139], v[32:47]
  ds_read_b128 v[160:163], v204 offset:49152
  v_exp_f32 v195, v107
  v_add_f32 v201, v201, v194
  v_mfma_f32_32x32x16_bf16 v[48:63], v[172:175], v[136:139], v[48:63]
  ds_read_b128 v[164:167], v204 offset:50176
  v_exp_f32 v196, v108
  v_add_f32 v201, v201, v195
  v_cvt_pk_bf16_f32 v133, v194, v195
  s_waitcnt lgkmcnt(4)
  v_mfma_f32_32x32x16_bf16 v[0:15], v[176:179], v[140:143], v[0:15]
  ds_read_b128 v[168:171], v204 offset:51200
  v_exp_f32 v197, v109
  v_add_f32 v201, v201, v196
  v_mfma_f32_32x32x16_bf16 v[16:31], v[180:183], v[140:143], v[16:31]
  ds_read_b128 v[172:175], v204 offset:52224
  v_exp_f32 v198, v110
  v_add_f32 v201, v201, v197
  v_cvt_pk_bf16_f32 v134, v196, v197
  s_waitcnt lgkmcnt(4)
  v_mfma_f32_32x32x16_bf16 v[32:47], v[184:187], v[140:143], v[32:47]
  ds_read_b128 v[176:179], v204 offset:53248
  v_exp_f32 v199, v111
  v_add_f32 v201, v201, v198
  v_mfma_f32_32x32x16_bf16 v[48:63], v[188:191], v[140:143], v[48:63]
  ds_read_b128 v[180:183], v204 offset:54272
  v_add_f32 v201, v201, v199
  v_cvt_pk_bf16_f32 v135, v198, v199
  v_cmp_lt_f32 vcc, s68, v201
  s_cbranch_vccnz slow_Bn2
back_Bn2:
  v_add_f32 v200, v200, v201
  v_exp_f32 v192, v112
  s_waitcnt lgkmcnt(4)
  v_mfma_f32_32x32x16_bf16 v[96:111], v[160:163], v[64:67], v[144:159]
  ds_read_b128 v[184:187], v204 offset:55296
  v_exp_f32 v193, v113
  v_mfma_f32_32x32x16_bf16 v[96:111], v[164:167], v[68:71], v[96:111]
  ds_read_b128 v[188:191], v204 offset:56320
  v_exp_f32 v194, v114
  v_add_f32 v201, v192, v193
  v_cvt_pk_bf16_f32 v136, v192, v193
  s_waitcnt lgkmcnt(4)
  v_mfma_f32_32x32x16_bf16 v[96:111], v[168:171], v[72:75], v[96:111]
  ds_read_b128 v[160:163], v204 offset:57344
  v_exp_f32 v195, v115
  v_add_f32 v201, v201, v194
  v_mfma_f32_32x32x16_bf16 v[96:111], v[172:175], v[76:79], v[96:111]
  ds_read_b128 v[164:167], v204 offset:58368
  v_exp_f32 v196, v116
  v_add_f32 v201, v201, v195
  v_cvt_pk_bf16_f32 v137, v194, v195
  s_waitcnt lgkmcnt(4)
  v_mfma_f32_32x32x16_bf16 v[96:111], v[176:179], v[80:83], v[96:111]
  ds_read_b128 v[168:171], v204 offset:59392
  v_exp_f32 v197, v117
  v_add_f32 v201, v201, v196
  v_mfma_f32_32x32x16_bf16 v[96:111], v[180:183], v[84:87], v[96:111]
  ds_read_b128 v[172:175], v204 offset:60416
  v_exp_f32 v198, v118
  v_add_f32 v201, v201, v197
  v_cvt_pk_bf16_f32 v138, v196, v197
  s_waitcnt lgkmcnt(4)
  v_mfma_f32_32x32x16_bf16 v[96:111], v[184:187], v[88:91], v[96:111]
  ds_read_b128 v[176:179], v204 offset:61440
  v_exp_f32 v199, v119
  v_add_f32 v201, v201, v198
  v_mfma_f32_32x32x16_bf16 v[96:111], v[188:191], v[92:95], v[96:111]
  ds_read_b128 v[180:183], v204 offset:62464
  v_exp_f32 v192, v120
  v_add_f32 v201, v201, v199
  v_cvt_pk_bf16_f32 v139, v198, v199
  s_waitcnt lgkmcnt(4)
  v_mfma_f32_32x32x16_bf16 v[0:15], v[160:163], v[128:131], v[0:15]
  ds_read_b128 v[184:187], v204 offset:63488
  v_exp_f32 v193, v121
  v_add_f32 v201, v201, v192
  v_mfma_f32_32x32x16_bf16 v[16:31], v[164:167], v[128:131], v[16:31]
  ds_read_b128 v[188:191], v204 offset:64512
  v_exp_f32 v194, v122
  v_add_f32 v201, v201, v193
  v_cvt_pk_bf16_f32 v140, v192, v193
  s_waitcnt lgkmcnt(4)
  v_mfma_f32_32x32x16_bf16 v[32:47], v[168:171], v[128:131], v[32:47]
  s_barrier
  ds_read_b128 v[160:163], v205 offset:0
  v_exp_f32 v195, v123
  v_add_f32 v201, v201, v194
  v_mfma_f32_32x32x16_bf16 v[48:63], v[172:175], v[128:131], v[48:63]
  ds_read_b128 v[164:167], v205 offset:1024
  v_exp_f32 v196, v124
  v_add_f32 v201, v201, v195
  v_cvt_pk_bf16_f32 v141, v194, v195
  s_waitcnt lgkmcnt(4)
  v_mfma_f32_32x32x16_bf16 v[0:15], v[176:179], v[132:135], v[0:15]
  ds_read_b128 v[168:171], v205 offset:2048
  v_exp_f32 v197, v125
  v_add_f32 v201, v201, v196
  v_mfma_f32_32x32x16_bf16 v[16:31], v[180:183], v[132:135], v[16:31]
  ds_read_b128 v[172:175], v205 offset:3072
  v_exp_f32 v198, v126
  v_add_f32 v201, v201, v197
  v_cvt_pk_bf16_f32 v142, v196, v197
  s_waitcnt lgkmcnt(4)
  v_mfma_f32_32x32x16_bf16 v[32:47], v[184:187], v[132:135], v[32:47]
  ds_read_b128 v[176:179], v205 offset:4096
  v_exp_f32 v199, v127
  v_add_f32 v201, v201, v198
  v_mfma_f32_32x32x16_bf16 v[48:63], v[188:191], v[132:135], v[48:63]
  ds_read_b128 v[180:183], v205 offset:5120
  v_add_f32 v201, v201, v199
  v_cvt_pk_bf16_f32 v143, v198, v199
  v_cmp_lt_f32 vcc, s68, v201
  v_xor_b32 v204, 0x10000, v204
  v_xor_b32 v205, 0x10000, v205
  s_cbranch_vccnz slow_Bn3
back_Bn3:
  s_sub_u32 s66, s66, 1
  s_cmp_gt_u32 s66, 1
  s_cbranch_scc1 at_B_loop
at_B_last:
  s_and_b32 s33, s26, 3
  s_cmp_eq_u32 s33, 0
  s_cbranch_scc1 at_B_d0
  s_cmp_eq_u32 s33, 1
  s_cbranch_scc1 at_B_d1
  s_cmp_eq_u32 s33, 2
  s_cbranch_scc1 at_B_d2
at_B_d3:
  v_subrev_u32 v206, 96, v206
  v_add_f32 v200, v200, v201
  v_exp_f32 v192, v96
  s_waitcnt lgkmcnt(4)
  v_mfma_f32_32x32x16_bf16 v[112:127], v[160:163], v[64:67], v[144:159]
  ds_read_b128 v[184:187], v204 offset:6144
  v_exp_f32 v193, v97
  v_mfma_f32_32x32x16_bf16 v[112:127], v[164:167], v[68:71], v[112:127]
  ds_read_b128 v[188:191], v204 offset:7168
  v_exp_f32 v194, v98
  v_add_f32 v201, v192, v193
  v_cvt_pk_bf16_f32 v128, v192, v193
  s_waitcnt lgkmcnt(4)
  v_mfma_f32_32x32x16_bf16 v[112:127], v[168:171], v[72:75], v[112:127]
  ds_read_b128 v[160:163], v204 offset:8192
  v_exp_f32 v195, v99
  v_add_f32 v201, v201, v194
  v_mfma_f32_32x32x16_bf16 v[112:127], v[172:175], v[76:79], v[112:127]
  ds_read_b128 v[164:167], v204 offset:9216
  v_exp_f32 v196, v100
  v_add_f32 v201, v201, v195
  v_cvt_pk_bf16_f32 v129, v194, v195
  s_waitcnt lgkmcnt(4)
  v_mfma_f32_32x32x16_bf16 v[112:127], v[176:179], v[80:83], v[112:127]
  ds_read_b128 v[168:171], v204 offset:10240
  v_exp_f32 v197, v101
  v_add_f32 v201, v201, v196
  v_mfma_f32_32x32x16_bf16 v[112:127], v[180:183], v[84:87], v[112:127]
  ds_read_b128 v[172:175], v204 offset:11264
  v_exp_f32 v198, v102
  v_add_f32 v201, v201, v197
  v_cvt_pk_bf16_f32 v130, v196, v197
  s_waitcnt lgkmcnt(4)
  v_mfma_f32_32x32x16_bf16 v[112:127], v[184:187], v[88:91], v[112:127]
  ds_read_b128 v[176:179], v204 offset:12288
  v_exp_f32 v199, v103
  v_add_f32 v201, v201, v198
  v_mfma_f32_32x32x16_bf16 v[112:127], v[188:191], v[92:95], v[112:127]
  ds_read_b128 v[180:183], v204 offset:13312
  v_exp_f32 v192, v104
  v_add_f32 v201, v201, v199
  v_cvt_pk_bf16_f32 v131, v198, v199
  s_waitcnt lgkmcnt(4)
  v_mfma_f32_32x32x16_bf16 v[0:15], v[160:163], v[136:139], v[0:15]
  ds_read_b128 v[184:187], v204 offset:14336
  v_exp_f32 v193, v105
  v_add_f32 v201, v201, v192
  v_mfma_f32_32x32x16_bf16 v[16:31], v[164:167], v[136:139], v[16:31]
  ds_read_b128 v[188:191], v204 offset:15360
  v_exp_f32 v194, v106
  v_add_f32 v201, v201, v193
  v_cvt_pk_bf16_f32 v132, v192, v193
  s_waitcnt lgkmcnt(4)
  v_mfma_f32_32x32x16_bf16 v[32:47], v[168:171], v[136:139], v[32:47]
  ds_read_b128 v[160:163], v204 offset:16384
  v_exp_f32 v195, v107
  v_add_f32 v201, v201, v194
  v_mfma_f32_32x32x16_bf16 v[48:63], v[172:175], v[136:139], v[48:63]
  ds_read_b128 v[164:167], v204 offset:17408
  v_exp_f32 v196, v108
  v_add_f32 v201, v201, v195
  v_cvt_pk_bf16_f32 v133, v194, v195
  s_waitcnt lgkmcnt(4)
  v_mfma_f32_32x32x16_bf16 v[0:15], v[176:179], v[140:143], v[0:15]
  ds_read_b128 v[168:171], v204 offset:18432
  v_exp_f32 v197, v109
  v_add_f32 v201, v201, v196
  v_mfma_f32_32x32x16_bf16 v[16:31], v[180:183], v[140:143], v[16:31]
  ds_read_b128 v[172:175], v204 offset:19456
  v_exp_f32 v198, v110
  v_add_f32 v201, v201, v197
  v_cvt_pk_bf16_f32 v134, v196, v197
  s_waitcnt lgkmcnt(4)
  v_mfma_f32_32x32x16_bf16 v[32:47], v[184:187], v[140:143], v[32:47]
  ds_read_b128 v[176:179], v204 offset:20480
  v_exp_f32 v199, v111
  v_add_f32 v201, v201, v198
  v_mfma_f32_32x32x16_bf16 v[48:63], v[188:191], v[140:143], v[48:63]
  ds_read_b128 v[180:183], v204 offset:21504
  v_add_f32 v201, v201, v199
  v_cvt_pk_bf16_f32 v135, v198, v199
  v_cmp_lt_f32 vcc, s68, v201
  s_cbranch_vccnz slow_B3m0
back_B3m0:
  v_add_f32 v200, v200, v201
  v_exp_f32 v192, v112
  s_waitcnt lgkmcnt(4)
  v_mfma_f32_32x32x16_bf16 v[96:111], v[160:163], v[64:67], v[144:159]
  ds_read_b128 v[184:187], v204 offset:22528
  v_exp_f32 v193, v113
  v_mfma_f32_32x32x16_bf16 v[96:111], v[164:167], v[68:71], v[96:111]
  ds_read_b128 v[188:191], v204 offset:23552
  v_exp_f32 v194, v114
  v_add_f32 v201, v192, v193
  v_cvt_pk_bf16_f32 v136, v192, v193
  s_waitcnt lgkmcnt(4)
  v_mfma_f32_32x32x16_bf16 v[96:111], v[168:171], v[72:75], v[96:111]
  ds_read_b128 v[160:163], v204 offset:24576
  v_exp_f32 v195, v115
  v_add_f32 v201, v201, v194
  v_mfma_f32_32x32x16_bf16 v[96:111], v[172:175], v[76:79], v[96:111]
  ds_read_b128 v[164:167], v204 offset:25600
  v_exp_f32 v196, v116
  v_add_f32 v201, v201, v195
  v_cvt_pk_bf16_f32 v137, v194, v195
  s_waitcnt lgkmcnt(4)
  v_mfma_f32_32x32x16_bf16 v[96:111], v[176:179], v[80:83], v[96:111]
  ds_read_b128 v[168:171], v204 offset:26624
  v_exp_f32 v197, v117
  v_add_f32 v201, v201, v196
  v_mfma_f32_32x32x16_bf16 v[96:111], v[180:183], v[84:87], v[96:111]
  ds_read_b128 v[172:175], v204 offset:27648
  v_exp_f32 v198, v118
  v_add_f32 v201, v201, v197
  v_cvt_pk_bf16_f32 v138, v196, v197
  s_waitcnt lgkmcnt(4)
  v_mfma_f32_32x32x16_bf16 v[96:111], v[184:187], v[88:91], v[96:111]
  ds_read_b128 v[176:179], v204 offset:28672
  v_exp_f32 v199, v119
  v_add_f32 v201, v201, v198
  v_mfma_f32_32x32x16_bf16 v[96:111], v[188:191], v[92:95], v[96:111]
  ds_read_b128 v[180:183], v204 offset:29696
  v_exp_f32 v192, v120
  v_add_f32 v201, v201, v199
  v_cvt_pk_bf16_f32 v139, v198, v199
  s_waitcnt lgkmcnt(4)
  v_mfma_f32_32x32x16_bf16 v[0:15], v[160:163], v[128:131], v[0:15]
  ds_read_b128 v[184:187], v204 offset:30720
  v_exp_f32 v193, v121
  v_add_f32 v201, v201, v192
  v_mfma_f32_32x32x16_bf16 v[16:31], v[164:167], v[128:131], v[16:31]
  ds_read_b128 v[188:191], v204 offset:31744
  v_exp_f32 v194, v122
  v_add_f32 v201, v201, v193
  v_cvt_pk_bf16_f32 v140, v192, v193
  s_waitcnt lgkmcnt(4)
  v_mfma_f32_32x32x16_bf16 v[32:47], v[168:171], v[128:131], v[32:47]
  s_barrier
  ds_read_b128 v[160:163], v204 offset:32768
  v_exp_f32 v195, v123
  v_add_f32 v201, v201, v194
  v_mfma_f32_32x32x16_bf16 v[48:63], v[172:175], v[128:131], v[48:63]
  ds_read_b128 v[164:167], v204 offset:33792
  v_exp_f32 v196, v124
  v_add_f32 v201, v201, v195
  v_cvt_pk_bf16_f32 v141, v194, v195
  s_waitcnt lgkmcnt(4)
  v_mfma_f32_32x32x16_bf16 v[0:15], v[176:179], v[132:135], v[0:15]
  ds_read_b128 v[168:171], v204 offset:34816
  v_exp_f32 v197, v125
  v_add_f32 v201, v201, v196
  v_mfma_f32_32x32x16_bf16 v[16:31], v[180:183], v[132:135], v[16:31]
  ds_read_b128 v[172:175], v204 offset:35840
  v_exp_f32 v198, v126
  v_add_f32 v201, v201, v197
  v_cvt_pk_bf16_f32 v142, v196, v197
  s_waitcnt lgkmcnt(4)
  v_mfma_f32_32x32x16_bf16 v[32:47], v[184:187], v[132:135], v[32:47]
  ds_read_b128 v[176:179], v204 offset:36864
  v_exp_f32 v199, v127
  v_add_f32 v201, v201, v198
  v_mfma_f32_32x32x16_bf16 v[48:63], v[188:191], v[132:135], v[48:63]
  ds_read_b128 v[180:183], v204 offset:37888
  v_add_f32 v201, v201, v199
  v_cvt_pk_bf16_f32 v143, v198, v199
  v_cmp_lt_f32 vcc, s68, v201
  s_cbranch_vccnz slow_B3m1
back_B3m1:
  v_add_f32 v200, v200, v201
  v_exp_f32 v192, v96
  s_waitcnt lgkmcnt(4)
  v_mfma_f32_32x32x16_bf16 v[112:127], v[160:163], v[64:67], v[144:159]
  ds_read_b128 v[184:187], v204 offset:38912
  v_exp_f32 v193, v97
  v_mfma_f32_32x32x16_bf16 v[112:127], v[164:167], v[68:71], v[112:127]
  ds_read_b128 v[188:191], v204 offset:39936
  v_exp_f32 v194, v98
  v_add_f32 v201, v192, v193
  v_cvt_pk_bf16_f32 v128, v192, v193
  s_waitcnt lgkmcnt(4)
  v_mfma_f32_32x32x16_bf16 v[112:127], v[168:171], v[72:75], v[112:127]
  ds_read_b128 v[160:163], v204 offset:40960
  v_exp_f32 v195, v99
  v_add_f32 v201, v201, v194
  v_mfma_f32_32x32x16_bf16 v[112:127], v[172:175], v[76:79], v[112:127]
  ds_read_b128 v[164:167], v204 offset:41984
  v_exp_f32 v196, v100
  v_add_f32 v201, v201, v195
  v_cvt_pk_bf16_f32 v129, v194, v195
  s_waitcnt lgkmcnt(4)
  v_mfma_f32_32x32x16_bf16 v[112:127], v[176:179], v[80:83], v[112:127]
  ds_read_b128 v[168:171], v204 offset:43008
  v_exp_f32 v197, v101
  v_add_f32 v201, v201, v196
  v_mfma_f32_32x32x16_bf16 v[112:127], v[180:183], v[84:87], v[112:127]
  ds_read_b128 v[172:175], v204 offset:44032
  v_exp_f32 v198, v102
  v_add_f32 v201, v201, v197
  v_cvt_pk_bf16_f32 v130, v196, v197
  s_waitcnt lgkmcnt(4)
  v_mfma_f32_32x32x16_bf16 v[112:127], v[184:187], v[88:91], v[112:127]
  ds_read_b128 v[176:179], v204 offset:45056
  v_exp_f32 v199, v103
  v_add_f32 v201, v201, v198
  v_mfma_f32_32x32x16_bf16 v[112:127], v[188:191], v[92:95], v[112:127]
  ds_read_b128 v[180:183], v204 offset:46080
  v_exp_f32 v192, v104
  v_add_f32 v201, v201, v199
  v_cvt_pk_bf16_f32 v131, v198, v199
  s_waitcnt lgkmcnt(4)
  v_mfma_f32_32x32x16_bf16 v[0:15], v[160:163], v[136:139], v[0:15]
  ds_read_b128 v[184:187], v204 offset:47104
  v_exp_f32 v193, v105
  v_add_f32 v201, v201, v192
  v_mfma_f32_32x32x16_bf16 v[16:31], v[164:167], v[136:139], v[16:31]
  ds_read_b128 v[188:191], v204 offset:48128
  v_exp_f32 v194, v106
  v_add_f32 v201, v201, v193
  v_cvt_pk_bf16_f32 v132, v192, v193
  s_waitcnt lgkmcnt(4)
  v_mfma_f32_32x32x16_bf16 v[32:47], v[168:171], v[136:139], v[32:47]
  v_exp_f32 v195, v107
  v_add_f32 v201, v201, v194
  v_mfma_f32_32x32x16_bf16 v[48:63], v[172:175], v[136:139], v[48:63]
  v_exp_f32 v196, v108
  v_add_f32 v201, v201, v195
  v_cvt_pk_bf16_f32 v133, v194, v195
  s_waitcnt lgkmcnt(2)
  v_mfma_f32_32x32x16_bf16 v[0:15], v[176:179], v[140:143], v[0:15]
  v_exp_f32 v197, v109
  v_add_f32 v201, v201, v196
  v_mfma_f32_32x32x16_bf16 v[16:31], v[180:183], v[140:143], v[16:31]
  v_exp_f32 v198, v110
  v_add_f32 v201, v201, v197
  v_cvt_pk_bf16_f32 v134, v196, v197
  s_waitcnt lgkmcnt(0)
  v_mfma_f32_32x32x16_bf16 v[32:47], v[184:187], v[140:143], v[32:47]
  v_exp_f32 v199, v111
  v_add_f32 v201, v201, v198
  v_mfma_f32_32x32x16_bf16 v[48:63], v[188:191], v[140:143], v[48:63]
  v_add_f32 v201, v201, v199
  v_cvt_pk_bf16_f32 v135, v198, v199
  v_cmp_lt_f32 vcc, s68, v201
  s_cbranch_vccnz slow_B3m2
back_B3m2:
  buffer_load_dword v251, off, s[96:99], s69 offset:0 sc1
  v_add_f32 v200, v200, v201
  ds_read_b128 v[160:163], v204 offset:57344
  v_cmp_gt_i32 s[70:71], 0, v206
  v_cmp_gt_i32 s[72:73], 1, v206
  v_cmp_gt_i32 s[74:75], 2, v206
  v_cndmask_b32 v112, v112, v208, s[70:71]
  v_cndmask_b32 v113, v113, v208, s[72:73]
  v_exp_f32 v192, v112
  ds_read_b128 v[164:167], v204 offset:58368
  v_cmp_gt_i32 s[76:77], 3, v206
  v_exp_f32 v193, v113
  v_cndmask_b32 v114, v114, v208, s[74:75]
  s_waitcnt lgkmcnt(1)
  v_mfma_f32_32x32x16_bf16 v[0:15], v[160:163], v[128:131], v[0:15]
  ds_read_b128 v[168:171], v204 offset:59392
  v_cmp_gt_i32 s[70:71], 8, v206
  v_exp_f32 v194, v114
  v_cndmask_b32 v115, v115, v208, s[76:77]
  v_add_f32 v201, v192, v193
  v_cvt_pk_bf16_f32 v136, v192, v193
  ds_read_b128 v[172:175], v204 offset:60416
  v_cmp_gt_i32 s[72:73], 9, v206
  v_exp_f32 v195, v115
  v_cndmask_b32 v116, v116, v208, s[70:71]
  v_add_f32 v201, v201, v194
  s_waitcnt lgkmcnt(2)
  v_mfma_f32_32x32x16_bf16 v[16:31], v[164:167], v[128:131], v[16:31]
  ds_read_b128 v[176:179], v204 offset:61440
  v_cmp_gt_i32 s[74:75], 10, v206
  v_exp_f32 v196, v116
  v_cndmask_b32 v117, v117, v208, s[72:73]
  v_add_f32 v201, v201, v195
  v_cvt_pk_bf16_f32 v137, v194, v195
  ds_read_b128 v[180:183], v204 offset:62464
  v_cmp_gt_i32 s[76:77], 11, v206
  v_exp_f32 v197, v117
  v_cndmask_b32 v118, v118, v208, s[74:75]
  v_add_f32 v201, v201, v196
  s_waitcnt lgkmcnt(3)
  v_mfma_f32_32x32x16_bf16 v[32:47], v[168:171], v[128:131], v[32:47]
  ds_read_b128 v[184:187], v204 offset:63488
  v_cmp_gt_i32 s[70:71], 16, v206
  v_exp_f32 v198, v118
  v_cndmask_b32 v119, v119, v208, s[76:77]
  v_add_f32 v201, v201, v197
  v_cvt_pk_bf16_f32 v138, v196, v197
  ds_read_b128 v[188:191], v204 offset:64512
  v_cmp_gt_i32 s[72:73], 17, v206
  v_exp_f32 v199, v119
  v_cndmask_b32 v120, v120, v208, s[70:71]
  v_add_f32 v201, v201, v198
  s_waitcnt lgkmcnt(4)
  v_mfma_f32_32x32x16_bf16 v[48:63], v[172:175], v[128:131], v[48:63]
  v_cmp_gt_i32 s[74:75], 18, v206
  v_exp_f32 v192, v120
  v_cndmask_b32 v121, v121, v208, s[72:73]
  v_add_f32 v201, v201, v199
  v_cvt_pk_bf16_f32 v139, v198, v199
  v_cmp_gt_i32 s[76:77], 19, v206
  v_exp_f32 v193, v121
  v_cndmask_b32 v122, v122, v208, s[74:75]
  v_add_f32 v201, v201, v192
  s_waitcnt lgkmcnt(3)
  v_mfma_f32_32x32x16_bf16 v[0:15], v[176:179], v[132:135], v[0:15]
  v_cmp_gt_i32 s[70:71], 24, v206
  v_exp_f32 v194, v122
  v_cndmask_b32 v123, v123, v208, s[76:77]
  v_add_f32 v201, v201, v193
  v_cvt_pk_bf16_f32 v140, v192, v193
  v_cmp_gt_i32 s[72:73], 25, v206
  s_barrier
  v_exp_f32 v195, v123
  v_cndmask_b32 v124, v124, v208, s[70:71]
  v_add_f32 v201, v201, v194
  s_waitcnt lgkmcnt(2)
  v_mfma_f32_32x32x16_bf16 v[16:31], v[180:183], v[132:135], v[16:31]
  v_cmp_gt_i32 s[74:75], 26, v206
  v_exp_f32 v196, v124
  v_cndmask_b32 v125, v125, v208, s[72:73]
  v_add_f32 v201, v201, v195
  v_cvt_pk_bf16_f32 v141, v194, v195
  v_cmp_gt_i32 s[76:77], 27, v206
  v_exp_f32 v197, v125
  v_cndmask_b32 v126, v126, v208, s[74:75]
  v_add_f32 v201, v201, v196
  s_waitcnt lgkmcnt(1)
  v_mfma_f32_32x32x16_bf16 v[32:47], v[184:187], v[132:135], v[32:47]
  v_exp_f32 v198, v126
  v_cndmask_b32 v127, v127, v208, s[76:77]
  v_add_f32 v201, v201, v197
  v_cvt_pk_bf16_f32 v142, v196, v197
  v_exp_f32 v199, v127
  v_add_f32 v201, v201, v198
  s_waitcnt lgkmcnt(0)
  v_mfma_f32_32x32x16_bf16 v[48:63], v[188:191], v[132:135], v[48:63]
  v_add_f32 v201, v201, v199
  v_cvt_pk_bf16_f32 v143, v198, v199
  v_cmp_lt_f32 vcc, s68, v201
  v_xor_b32 v204, 0x10000, v204
  v_xor_b32 v205, 0x10000, v205
  s_cbranch_vccnz slow_B3m3
back_B3m3:
  s_branch at_B_dend
at_B_d2:
  v_subrev_u32 v206, 64, v206
  v_add_f32 v200, v200, v201
  v_exp_f32 v192, v96
  s_waitcnt lgkmcnt(4)
  v_mfma_f32_32x32x16_bf16 v[112:127], v[160:163], v[64:67], v[144:159]
  ds_read_b128 v[184:187], v204 offset:6144
  v_exp_f32 v193, v97
  v_mfma_f32_32x32x16_bf16 v[112:127], v[164:167], v[68:71], v[112:127]
  ds_read_b128 v[188:191], v204 offset:7168
  v_exp_f32 v194, v98
  v_add_f32 v201, v192, v193
  v_cvt_pk_bf16_f32 v128, v192, v193
  s_waitcnt lgkmcnt(4)
  v_mfma_f32_32x32x16_bf16 v[112:127], v[168:171], v[72:75], v[112:127]
  ds_read_b128 v[160:163], v204 offset:8192
  v_exp_f32 v195, v99
  v_add_f32 v201, v201, v194
  v_mfma_f32_32x32x16_bf16 v[112:127], v[172:175], v[76:79], v[112:127]
  ds_read_b128 v[164:167], v204 offset:9216
  v_exp_f32 v196, v100
  v_add_f32 v201, v201, v195
  v_cvt_pk_bf16_f32 v129, v194, v195
  s_waitcnt lgkmcnt(4)
  v_mfma_f32_32x32x16_bf16 v[112:127], v[176:179], v[80:83], v[112:127]
  ds_read_b128 v[168:171], v204 offset:10240
  v_exp_f32 v197, v101
  v_add_f32 v201, v201, v196
  v_mfma_f32_32x32x16_bf16 v[112:127], v[180:183], v[84:87], v[112:127]
  ds_read_b128 v[172:175], v204 offset:11264
  v_exp_f32 v198, v102
  v_add_f32 v201, v201, v197
  v_cvt_pk_bf16_f32 v130, v196, v197
  s_waitcnt lgkmcnt(4)
  v_mfma_f32_32x32x16_bf16 v[112:127], v[184:187], v[88:91], v[112:127]
  ds_read_b128 v[176:179], v204 offset:12288
  v_exp_f32 v199, v103
  v_add_f32 v201, v201, v198
  v_mfma_f32_32x32x16_bf16 v[112:127], v[188:191], v[92:95], v[112:127]
  ds_read_b128 v[180:183], v204 offset:13312
  v_exp_f32 v192, v104
  v_add_f32 v201, v201, v199
  v_cvt_pk_bf16_f32 v131, v198, v199
  s_waitcnt lgkmcnt(4)
  v_mfma_f32_32x32x16_bf16 v[0:15], v[160:163], v[136:139], v[0:15]
  ds_read_b128 v[184:187], v204 offset:14336
  v_exp_f32 v193, v105
  v_add_f32 v201, v201, v192
  v_mfma_f32_32x32x16_bf16 v[16:31], v[164:167], v[136:139], v[16:31]
  ds_read_b128 v[188:191], v204 offset:15360
  v_exp_f32 v194, v106
  v_add_f32 v201, v201, v193
  v_cvt_pk_bf16_f32 v132, v192, v193
  s_waitcnt lgkmcnt(4)
  v_mfma_f32_32x32x16_bf16 v[32:47], v[168:171], v[136:139], v[32:47]
  ds_read_b128 v[160:163], v204 offset:16384
  v_exp_f32 v195, v107
  v_add_f32 v201, v201, v194
  v_mfma_f32_32x32x16_bf16 v[48:63], v[172:175], v[136:139], v[48:63]
  ds_read_b128 v[164:167], v204 offset:17408
  v_exp_f32 v196, v108
  v_add_f32 v201, v201, v195
  v_cvt_pk_bf16_f32 v133, v194, v195
  s_waitcnt lgkmcnt(4)
  v_mfma_f32_32x32x16_bf16 v[0:15], v[176:179], v[140:143], v[0:15]
  ds_read_b128 v[168:171], v204 offset:18432
  v_exp_f32 v197, v109
  v_add_f32 v201, v201, v196
  v_mfma_f32_32x32x16_bf16 v[16:31], v[180:183], v[140:143], v[16:31]
  ds_read_b128 v[172:175], v204 offset:19456
  v_exp_f32 v198, v110
  v_add_f32 v201, v201, v197
  v_cvt_pk_bf16_f32 v134, v196, v197
  s_waitcnt lgkmcnt(4)
  v_mfma_f32_32x32x16_bf16 v[32:47], v[184:187], v[140:143], v[32:47]
  ds_read_b128 v[176:179], v204 offset:20480
  v_exp_f32 v199, v111
  v_add_f32 v201, v201, v198
  v_mfma_f32_32x32x16_bf16 v[48:63], v[188:191], v[140:143], v[48:63]
  ds_read_b128 v[180:183], v204 offset:21504
  v_add_f32 v201, v201, v199
  v_cvt_pk_bf16_f32 v135, v198, v199
  v_cmp_lt_f32 vcc, s68, v201
  s_cbranch_vccnz slow_B2m0
back_B2m0:
  v_add_f32 v200, v200, v201
  v_exp_f32 v192, v112
  s_waitcnt lgkmcnt(4)
  v_mfma_f32_32x32x16_bf16 v[96:111], v[160:163], v[64:67], v[144:159]
  ds_read_b128 v[184:187], v204 offset:22528
  v_exp_f32 v193, v113
  v_mfma_f32_32x32x16_bf16 v[96:111], v[164:167], v[68:71], v[96:111]
  ds_read_b128 v[188:191], v204 offset:23552
  v_exp_f32 v194, v114
  v_add_f32 v201, v192, v193
  v_cvt_pk_bf16_f32 v136, v192, v193
  s_waitcnt lgkmcnt(4)
  v_mfma_f32_32x32x16_bf16 v[96:111], v[168:171], v[72:75], v[96:111]
  ds_read_b128 v[160:163], v204 offset:24576
  v_exp_f32 v195, v115
  v_add_f32 v201, v201, v194
  v_mfma_f32_32x32x16_bf16 v[96:111], v[172:175], v[76:79], v[96:111]
  ds_read_b128 v[164:167], v204 offset:25600
  v_exp_f32 v196, v116
  v_add_f32 v201, v201, v195
  v_cvt_pk_bf16_f32 v137, v194, v195
  s_waitcnt lgkmcnt(4)
  v_mfma_f32_32x32x16_bf16 v[96:111], v[176:179], v[80:83], v[96:111]
  ds_read_b128 v[168:171], v204 offset:26624
  v_exp_f32 v197, v117
  v_add_f32 v201, v201, v196
  v_mfma_f32_32x32x16_bf16 v[96:111], v[180:183], v[84:87], v[96:111]
  ds_read_b128 v[172:175], v204 offset:27648
  v_exp_f32 v198, v118
  v_add_f32 v201, v201, v197
  v_cvt_pk_bf16_f32 v138, v196, v197
  s_waitcnt lgkmcnt(4)
  v_mfma_f32_32x32x16_bf16 v[96:111], v[184:187], v[88:91], v[96:111]
  ds_read_b128 v[176:179], v204 offset:28672
  v_exp_f32 v199, v119
  v_add_f32 v201, v201, v198
  v_mfma_f32_32x32x16_bf16 v[96:111], v[188:191], v[92:95], v[96:111]
  ds_read_b128 v[180:183], v204 offset:29696
  v_exp_f32 v192, v120
  v_add_f32 v201, v201, v199
  v_cvt_pk_bf16_f32 v139, v198, v199
  s_waitcnt lgkmcnt(4)
  v_mfma_f32_32x32x16_bf16 v[0:15], v[160:163], v[128:131], v[0:15]
  ds_read_b128 v[184:187], v204 offset:30720
  v_exp_f32 v193, v121
  v_add_f32 v201, v201, v192
  v_mfma_f32_32x32x16_bf16 v[16:31], v[164:167], v[128:131], v[16:31]
  ds_read_b128 v[188:191], v204 offset:31744
  v_exp_f32 v194, v122
  v_add_f32 v201, v201, v193
  v_cvt_pk_bf16_f32 v140, v192, v193
  s_waitcnt lgkmcnt(4)
  v_mfma_f32_32x32x16_bf16 v[32:47], v[168:171], v[128:131], v[32:47]
  s_barrier
  v_exp_f32 v195, v123
  v_add_f32 v201, v201, v194
  v_mfma_f32_32x32x16_bf16 v[48:63], v[172:175], v[128:131], v[48:63]
  v_exp_f32 v196, v124
  v_add_f32 v201, v201, v195
  v_cvt_pk_bf16_f32 v141, v194, v195
  s_waitcnt lgkmcnt(2)
  v_mfma_f32_32x32x16_bf16 v[0:15], v[176:179], v[132:135], v[0:15]
  v_exp_f32 v197, v125
  v_add_f32 v201, v201, v196
  v_mfma_f32_32x32x16_bf16 v[16:31], v[180:183], v[132:135], v[16:31]
  v_exp_f32 v198, v126
  v_add_f32 v201, v201, v197
  v_cvt_pk_bf16_f32 v142, v196, v197
  s_waitcnt lgkmcnt(0)
  v_mfma_f32_32x32x16_bf16 v[32:47], v[184:187], v[132:135], v[32:47]
  v_exp_f32 v199, v127
  v_add_f32 v201, v201, v198
  v_mfma_f32_32x32x16_bf16 v[48:63], v[188:191], v[132:135], v[48:63]
  v_add_f32 v201, v201, v199
  v_cvt_pk_bf16_f32 v143, v198, v199
  v_cmp_lt_f32 vcc, s68, v201
  s_cbranch_vccnz slow_B2m1
back_B2m1:
  v_add_f32 v200, v200, v201
  ds_read_b128 v[160:163], v204 offset:40960
  v_cmp_gt_i32 s[70:71], 0, v206
  v_cmp_gt_i32 s[72:73], 1, v206
  v_cmp_gt_i32 s[74:75], 2, v206
  v_cndmask_b32 v96, v96, v208, s[70:71]
  v_cndmask_b32 v97, v97, v208, s[72:73]
  v_exp_f32 v192, v96
  ds_read_b128 v[164:167], v204 offset:41984
  v_cmp_gt_i32 s[76:77], 3, v206
  v_exp_f32 v193, v97
  v_cndmask_b32 v98, v98, v208, s[74:75]
  s_waitcnt lgkmcnt(1)
  v_mfma_f32_32x32x16_bf16 v[0:15], v[160:163], v[136:139], v[0:15]
  ds_read_b128 v[168:171], v204 offset:43008
  v_cmp_gt_i32 s[70:71], 8, v206
  v_exp_f32 v194, v98
  v_cndmask_b32 v99, v99, v208, s[76:77]
  v_add_f32 v201, v192, v193
  v_cvt_pk_bf16_f32 v128, v192, v193
  ds_read_b128 v[172:175], v204 offset:44032
  v_cmp_gt_i32 s[72:73], 9, v206
  v_exp_f32 v195, v99
  v_cndmask_b32 v100, v100, v208, s[70:71]
  v_add_f32 v201, v201, v194
  s_waitcnt lgkmcnt(2)
  v_mfma_f32_32x32x16_bf16 v[16:31], v[164:167], v[136:139], v[16:31]
  ds_read_b128 v[176:179], v204 offset:45056
  v_cmp_gt_i32 s[74:75], 10, v206
  v_exp_f32 v196, v100
  v_cndmask_b32 v101, v101, v208, s[72:73]
  v_add_f32 v201, v201, v195
  v_cvt_pk_bf16_f32 v129, v194, v195
  ds_read_b128 v[180:183], v204 offset:46080
  v_cmp_gt_i32 s[76:77], 11, v206
  v_exp_f32 v197, v101
  v_cndmask_b32 v102, v102, v208, s[74:75]
  v_add_f32 v201, v201, v196
  s_waitcnt lgkmcnt(3)
  v_mfma_f32_32x32x16_bf16 v[32:47], v[168:171], v[136:139], v[32:47]
  ds_read_b128 v[184:187], v204 offset:47104
  v_cmp_gt_i32 s[70:71], 16, v206
  v_exp_f32 v198, v102
  v_cndmask_b32 v103, v103, v208, s[76:77]
  v_add_f32 v201, v201, v197
  v_cvt_pk_bf16_f32 v130, v196, v197
  ds_read_b128 v[188:191], v204 offset:48128
  v_cmp_gt_i32 s[72:73], 17, v206
  v_exp_f32 v199, v103
  v_cndmask_b32 v104, v104, v208, s[70:71]
  v_add_f32 v201, v201, v198
  s_waitcnt lgkmcnt(4)
  v_mfma_f32_32x32x16_bf16 v[48:63], v[172:175], v[136:139], v[48:63]
  v_cmp_gt_i32 s[74:75], 18, v206
  v_exp_f32 v192, v104
  v_cndmask_b32 v105, v105, v208, s[72:73]
  v_add_f32 v201, v201, v199
  v_cvt_pk_bf16_f32 v131, v198, v199
  v_cmp_gt_i32 s[76:77], 19, v206
  v_exp_f32 v193, v105
  v_cndmask_b32 v106, v106, v208, s[74:75]
  v_add_f32 v201, v201, v192
  s_waitcnt lgkmcnt(3)
  v_mfma_f32_32x32x16_bf16 v[0:15], v[176:179], v[140:143], v[0:15]
  v_cmp_gt_i32 s[70:71], 24, v206
  v_exp_f32 v194, v106
  v_cndmask_b32 v107, v107, v208, s[76:77]
  v_add_f32 v201, v201, v193
  v_cvt_pk_bf16_f32 v132, v192, v193
  v_cmp_gt_i32 s[72:73], 25, v206
  v_exp_f32 v195, v107
  v_cndmask_b32 v108, v108, v208, s[70:71]
  v_add_f32 v201, v201, v194
  s_waitcnt lgkmcnt(2)
  v_mfma_f32_32x32x16_bf16 v[16:31], v[180:183], v[140:143], v[16:31]
  v_cmp_gt_i32 s[74:75], 26, v206
  v_exp_f32 v196, v108
  v_cndmask_b32 v109, v109, v208, s[72:73]
  v_add_f32 v201, v201, v195
  v_cvt_pk_bf16_f32 v133, v194, v195
  v_cmp_gt_i32 s[76:77], 27, v206
  v_exp_f32 v197, v109
  v_cndmask_b32 v110, v110, v208, s[74:75]
  v_add_f32 v201, v201, v196
  s_waitcnt lgkmcnt(1)
  v_mfma_f32_32x32x16_bf16 v[32:47], v[184:187], v[140:143], v[32:47]
  v_exp_f32 v198, v110
  v_cndmask_b32 v111, v111, v208, s[76:77]
  v_add_f32 v201, v201, v197
  v_cvt_pk_bf16_f32 v134, v196, v197
  v_exp_f32 v199, v111
  v_add_f32 v201, v201, v198
  s_waitcnt lgkmcnt(0)
  v_mfma_f32_32x32x16_bf16 v[48:63], v[188:191], v[140:143], v[48:63]
  v_add_f32 v201, v201, v199
  v_cvt_pk_bf16_f32 v135, v198, v199
  v_cmp_lt_f32 vcc, s68, v201
  s_nop 1
  s_cbranch_vccnz slow_B2m2
back_B2m2:
  buffer_load_dword v251, off, s[96:99], s69 offset:0 sc1
  v_add_f32 v200, v200, v201
  v_mov_b32 v201, 0
  ds_read_b128 v[160:163], v204 offset:57344
  ds_read_b128 v[164:167], v204 offset:58368
  s_waitcnt lgkmcnt(1)
  v_mfma_f32_32x32x16_bf16 v[0:15], v[160:163], v[128:131], v[0:15]
  ds_read_b128 v[168:171], v204 offset:59392
  ds_read_b128 v[172:175], v204 offset:60416
  s_waitcnt lgkmcnt(2)
  v_mfma_f32_32x32x16_bf16 v[16:31], v[164:167], v[128:131], v[16:31]
  ds_read_b128 v[176:179], v204 offset:61440
  ds_read_b128 v[180:183], v204 offset:62464
  s_waitcnt lgkmcnt(3)
  v_mfma_f32_32x32x16_bf16 v[32:47], v[168:171], v[128:131], v[32:47]
  ds_read_b128 v[184:187], v204 offset:63488
  ds_read_b128 v[188:191], v204 offset:64512
  s_waitcnt lgkmcnt(4)
  v_mfma_f32_32x32x16_bf16 v[48:63], v[172:175], v[128:131], v[48:63]
  s_waitcnt lgkmcnt(3)
  v_mfma_f32_32x32x16_bf16 v[0:15], v[176:179], v[132:135], v[0:15]
  s_barrier
  s_waitcnt lgkmcnt(2)
  v_mfma_f32_32x32x16_bf16 v[16:31], v[180:183], v[132:135], v[16:31]
  s_waitcnt lgkmcnt(1)
  v_mfma_f32_32x32x16_bf16 v[32:47], v[184:187], v[132:135], v[32:47]
  s_waitcnt lgkmcnt(0)
  v_mfma_f32_32x32x16_bf16 v[48:63], v[188:191], v[132:135], v[48:63]
  v_xor_b32 v204, 0x10000, v204
  v_xor_b32 v205, 0x10000, v205
  s_branch at_B_dend
at_B_d1:
  v_subrev_u32 v206, 32, v206
  v_add_f32 v200, v200, v201
  v_exp_f32 v192, v96
  s_waitcnt lgkmcnt(4)
  v_mfma_f32_32x32x16_bf16 v[112:127], v[160:163], v[64:67], v[144:159]
  ds_read_b128 v[184:187], v204 offset:6144
  v_exp_f32 v193, v97
  v_mfma_f32_32x32x16_bf16 v[112:127], v[164:167], v[68:71], v[112:127]
  ds_read_b128 v[188:191], v204 offset:7168
  v_exp_f32 v194, v98
  v_add_f32 v201, v192, v193
  v_cvt_pk_bf16_f32 v128, v192, v193
  s_waitcnt lgkmcnt(4)
  v_mfma_f32_32x32x16_bf16 v[112:127], v[168:171], v[72:75], v[112:127]
  ds_read_b128 v[160:163], v204 offset:8192
  v_exp_f32 v195, v99
  v_add_f32 v201, v201, v194
  v_mfma_f32_32x32x16_bf16 v[112:127], v[172:175], v[76:79], v[112:127]
  ds_read_b128 v[164:167], v204 offset:9216
  v_exp_f32 v196, v100
  v_add_f32 v201, v201, v195
  v_cvt_pk_bf16_f32 v129, v194, v195
  s_waitcnt lgkmcnt(4)
  v_mfma_f32_32x32x16_bf16 v[112:127], v[176:179], v[80:83], v[112:127]
  ds_read_b128 v[168:171], v204 offset:10240
  v_exp_f32 v197, v101
  v_add_f32 v201, v201, v196
  v_mfma_f32_32x32x16_bf16 v[112:127], v[180:183], v[84:87], v[112:127]
  ds_read_b128 v[172:175], v204 offset:11264
  v_exp_f32 v198, v102
  v_add_f32 v201, v201, v197
  v_cvt_pk_bf16_f32 v130, v196, v197
  s_waitcnt lgkmcnt(4)
  v_mfma_f32_32x32x16_bf16 v[112:127], v[184:187], v[88:91], v[112:127]
  ds_read_b128 v[176:179], v204 offset:12288
  v_exp_f32 v199, v103
  v_add_f32 v201, v201, v198
  v_mfma_f32_32x32x16_bf16 v[112:127], v[188:191], v[92:95], v[112:127]
  ds_read_b128 v[180:183], v204 offset:13312
  v_exp_f32 v192, v104
  v_add_f32 v201, v201, v199
  v_cvt_pk_bf16_f32 v131, v198, v199
  s_waitcnt lgkmcnt(4)
  v_mfma_f32_32x32x16_bf16 v[0:15], v[160:163], v[136:139], v[0:15]
  ds_read_b128 v[184:187], v204 offset:14336
  v_exp_f32 v193, v105
  v_add_f32 v201, v201, v192
  v_mfma_f32_32x32x16_bf16 v[16:31], v[164:167], v[136:139], v[16:31]
  ds_read_b128 v[188:191], v204 offset:15360
  v_exp_f32 v194, v106
  v_add_f32 v201, v201, v193
  v_cvt_pk_bf16_f32 v132, v192, v193
  s_waitcnt lgkmcnt(4)
  v_mfma_f32_32x32x16_bf16 v[32:47], v[168:171], v[136:139], v[32:47]
  v_exp_f32 v195, v107
  v_add_f32 v201, v201, v194
  v_mfma_f32_32x32x16_bf16 v[48:63], v[172:175], v[136:139], v[48:63]
  v_exp_f32 v196, v108
  v_add_f32 v201, v201, v195
  v_cvt_pk_bf16_f32 v133, v194, v195
  s_waitcnt lgkmcnt(2)
  v_mfma_f32_32x32x16_bf16 v[0:15], v[176:179], v[140:143], v[0:15]
  v_exp_f32 v197, v109
  v_add_f32 v201, v201, v196
  v_mfma_f32_32x32x16_bf16 v[16:31], v[180:183], v[140:143], v[16:31]
  v_exp_f32 v198, v110
  v_add_f32 v201, v201, v197
  v_cvt_pk_bf16_f32 v134, v196, v197
  s_waitcnt lgkmcnt(0)
  v_mfma_f32_32x32x16_bf16 v[32:47], v[184:187], v[140:143], v[32:47]
  v_exp_f32 v199, v111
  v_add_f32 v201, v201, v198
  v_mfma_f32_32x32x16_bf16 v[48:63], v[188:191], v[140:143], v[48:63]
  v_add_f32 v201, v201, v199
  v_cvt_pk_bf16_f32 v135, v198, v199
  v_cmp_lt_f32 vcc, s68, v201
  s_cbranch_vccnz slow_B1m0
back_B1m0:
  v_add_f32 v200, v200, v201
  ds_read_b128 v[160:163], v204 offset:24576
  v_cmp_gt_i32 s[70:71], 0, v206
  v_cmp_gt_i32 s[72:73], 1, v206
  v_cmp_gt_i32 s[74:75], 2, v206
  v_cndmask_b32 v112, v112, v208, s[70:71]
  v_cndmask_b32 v113, v113, v208, s[72:73]
  v_exp_f32 v192, v112
  ds_read_b128 v[164:167], v204 offset:25600
  v_cmp_gt_i32 s[76:77], 3, v206
  v_exp_f32 v193, v113
  v_cndmask_b32 v114, v114, v208, s[74:75]
  s_waitcnt lgkmcnt(1)
  v_mfma_f32_32x32x16_bf16 v[0:15], v[160:163], v[128:131], v[0:15]
  ds_read_b128 v[168:171], v204 offset:26624
  v_cmp_gt_i32 s[70:71], 8, v206
  v_exp_f32 v194, v114
  v_cndmask_b32 v115, v115, v208, s[76:77]
  v_add_f32 v201, v192, v193
  v_cvt_pk_bf16_f32 v136, v192, v193
  ds_read_b128 v[172:175], v204 offset:27648
  v_cmp_gt_i32 s[72:73], 9, v206
  v_exp_f32 v195, v115
  v_cndmask_b32 v116, v116, v208, s[70:71]
  v_add_f32 v201, v201, v194
  s_waitcnt lgkmcnt(2)
  v_mfma_f32_32x32x16_bf16 v[16:31], v[164:167], v[128:131], v[16:31]
  ds_read_b128 v[176:179], v204 offset:28672
  v_cmp_gt_i32 s[74:75], 10, v206
  v_exp_f32 v196, v116
  v_cndmask_b32 v117, v117, v208, s[72:73]
  v_add_f32 v201, v201, v195
  v_cvt_pk_bf16_f32 v137, v194, v195
  ds_read_b128 v[180:183], v204 offset:29696
  v_cmp_gt_i32 s[76:77], 11, v206
  v_exp_f32 v197, v117
  v_cndmask_b32 v118, v118, v208, s[74:75]
  v_add_f32 v201, v201, v196
  s_waitcnt lgkmcnt(3)
  v_mfma_f32_32x32x16_bf16 v[32:47], v[168:171], v[128:131], v[32:47]
  ds_read_b128 v[184:187], v204 offset:30720
  v_cmp_gt_i32 s[70:71], 16, v206
  v_exp_f32 v198, v118
  v_cndmask_b32 v119, v119, v208, s[76:77]
  v_add_f32 v201, v201, v197
  v_cvt_pk_bf16_f32 v138, v196, v197
  ds_read_b128 v[188:191], v204 offset:31744
  v_cmp_gt_i32 s[72:73], 17, v206
  v_exp_f32 v199, v119
  v_cndmask_b32 v120, v120, v208, s[70:71]
  v_add_f32 v201, v201, v198
  s_waitcnt lgkmcnt(4)
  v_mfma_f32_32x32x16_bf16 v[48:63], v[172:175], v[128:131], v[48:63]
  v_cmp_gt_i32 s[74:75], 18, v206
  v_exp_f32 v192, v120
  v_cndmask_b32 v121, v121, v208, s[72:73]
  v_add_f32 v201, v201, v199
  v_cvt_pk_bf16_f32 v139, v198, v199
  v_cmp_gt_i32 s[76:77], 19, v206
  v_exp_f32 v193, v121
  v_cndmask_b32 v122, v122, v208, s[74:75]
  v_add_f32 v201, v201, v192
  s_waitcnt lgkmcnt(3)
  v_mfma_f32_32x32x16_bf16 v[0:15], v[176:179], v[132:135], v[0:15]
  v_cmp_gt_i32 s[70:71], 24, v206
  v_exp_f32 v194, v122
  v_cndmask_b32 v123, v123, v208, s[76:77]
  v_add_f32 v201, v201, v193
  v_cvt_pk_bf16_f32 v140, v192, v193
  v_cmp_gt_i32 s[72:73], 25, v206
  s_barrier
  v_exp_f32 v195, v123
  v_cndmask_b32 v124, v124, v208, s[70:71]
  v_add_f32 v201, v201, v194
  s_waitcnt lgkmcnt(2)
  v_mfma_f32_32x32x16_bf16 v[16:31], v[180:183], v[132:135], v[16:31]
  v_cmp_gt_i32 s[74:75], 26, v206
  v_exp_f32 v196, v124
  v_cndmask_b32 v125, v125, v208, s[72:73]
  v_add_f32 v201, v201, v195
  v_cvt_pk_bf16_f32 v141, v194, v195
  v_cmp_gt_i32 s[76:77], 27, v206
  v_exp_f32 v197, v125
  v_cndmask_b32 v126, v126, v208, s[74:75]
  v_add_f32 v201, v201, v196
  s_waitcnt lgkmcnt(1)
  v_mfma_f32_32x32x16_bf16 v[32:47], v[184:187], v[132:135], v[32:47]
  v_exp_f32 v198, v126
  v_cndmask_b32 v127, v127, v208, s[76:77]
  v_add_f32 v201, v201, v197
  v_cvt_pk_bf16_f32 v142, v196, v197
  v_exp_f32 v199, v127
  v_add_f32 v201, v201, v198
  s_waitcnt lgkmcnt(0)
  v_mfma_f32_32x32x16_bf16 v[48:63], v[188:191], v[132:135], v[48:63]
  v_add_f32 v201, v201, v199
  v_cvt_pk_bf16_f32 v143, v198, v199
  v_cmp_lt_f32 vcc, s68, v201
  s_nop 1
  s_cbranch_vccnz slow_B1m1
back_B1m1:
  v_add_f32 v200, v200, v201
  v_mov_b32 v201, 0
  ds_read_b128 v[160:163], v204 offset:40960
  ds_read_b128 v[164:167], v204 offset:41984
  s_waitcnt lgkmcnt(1)
  v_mfma_f32_32x32x16_bf16 v[0:15], v[160:163], v[136:139], v[0:15]
  ds_read_b128 v[168:171], v204 offset:43008
  ds_read_b128 v[172:175], v204 offset:44032
  s_waitcnt lgkmcnt(2)
  v_mfma_f32_32x32x16_bf16 v[16:31], v[164:167], v[136:139], v[16:31]
  ds_read_b128 v[176:179], v204 offset:45056
  ds_read_b128 v[180:183], v204 offset:46080
  s_waitcnt lgkmcnt(3)
  v_mfma_f32_32x32x16_bf16 v[32:47], v[168:171], v[136:139], v[32:47]
  ds_read_b128 v[184:187], v204 offset:47104
  ds_read_b128 v[188:191], v204 offset:48128
  s_waitcnt lgkmcnt(4)
  v_mfma_f32_32x32x16_bf16 v[48:63], v[172:175], v[136:139], v[48:63]
  s_waitcnt lgkmcnt(3)
  v_mfma_f32_32x32x16_bf16 v[0:15], v[176:179], v[140:143], v[0:15]
  s_waitcnt lgkmcnt(2)
  v_mfma_f32_32x32x16_bf16 v[16:31], v[180:183], v[140:143], v[16:31]
  s_waitcnt lgkmcnt(1)
  v_mfma_f32_32x32x16_bf16 v[32:47], v[184:187], v[140:143], v[32:47]
  s_waitcnt lgkmcnt(0)
  v_mfma_f32_32x32x16_bf16 v[48:63], v[188:191], v[140:143], v[48:63]
  buffer_load_dword v251, off, s[96:99], s69 offset:0 sc1
  s_barrier
  v_xor_b32 v204, 0x10000, v204
  v_xor_b32 v205, 0x10000, v205
  s_branch at_B_dend
at_B_d0:
  v_add_f32 v200, v200, v201
  ds_read_b128 v[160:163], v204 offset:8192
  v_cmp_gt_i32 s[70:71], 0, v206
  v_cmp_gt_i32 s[72:73], 1, v206
  v_cmp_gt_i32 s[74:75], 2, v206
  v_cndmask_b32 v96, v96, v208, s[70:71]
  v_cndmask_b32 v97, v97, v208, s[72:73]
  v_exp_f32 v192, v96
  ds_read_b128 v[164:167], v204 offset:9216
  v_cmp_gt_i32 s[76:77], 3, v206
  v_exp_f32 v193, v97
  v_cndmask_b32 v98, v98, v208, s[74:75]
  s_waitcnt lgkmcnt(1)
  v_mfma_f32_32x32x16_bf16 v[0:15], v[160:163], v[136:139], v[0:15]
  ds_read_b128 v[168:171], v204 offset:10240
  v_cmp_gt_i32 s[70:71], 8, v206
  v_exp_f32 v194, v98
  v_cndmask_b32 v99, v99, v208, s[76:77]
  v_add_f32 v201, v192, v193
  v_cvt_pk_bf16_f32 v128, v192, v193
  ds_read_b128 v[172:175], v204 offset:11264
  v_cmp_gt_i32 s[72:73], 9, v206
  v_exp_f32 v195, v99
  v_cndmask_b32 v100, v100, v208, s[70:71]
  v_add_f32 v201, v201, v194
  s_waitcnt lgkmcnt(2)
  v_mfma_f32_32x32x16_bf16 v[16:31], v[164:167], v[136:139], v[16:31]
  ds_read_b128 v[176:179], v204 offset:12288
  v_cmp_gt_i32 s[74:75], 10, v206
  v_exp_f32 v196, v100
  v_cndmask_b32 v101, v101, v208, s[72:73]
  v_add_f32 v201, v201, v195
  v_cvt_pk_bf16_f32 v129, v194, v195
  ds_read_b128 v[180:183], v204 offset:13312
  v_cmp_gt_i32 s[76:77], 11, v206
  v_exp_f32 v197, v101
  v_cndmask_b32 v102, v102, v208, s[74:75]
  v_add_f32 v201, v201, v196
  s_waitcnt lgkmcnt(3)
  v_mfma_f32_32x32x16_bf16 v[32:47], v[168:171], v[136:139], v[32:47]
  ds_read_b128 v[184:187], v204 offset:14336
  v_cmp_gt_i32 s[70:71], 16, v206
  v_exp_f32 v198, v102
  v_cndmask_b32 v103, v103, v208, s[76:77]
  v_add_f32 v201, v201, v197
  v_cvt_pk_bf16_f32 v130, v196, v197
  ds_read_b128 v[188:191], v204 offset:15360
  v_cmp_gt_i32 s[72:73], 17, v206
  v_exp_f32 v199, v103
  v_cndmask_b32 v104, v104, v208, s[70:71]
  v_add_f32 v201, v201, v198
  s_waitcnt lgkmcnt(4)
  v_mfma_f32_32x32x16_bf16 v[48:63], v[172:175], v[136:139], v[48:63]
  v_cmp_gt_i32 s[74:75], 18, v206
  v_exp_f32 v192, v104
  v_cndmask_b32 v105, v105, v208, s[72:73]
  v_add_f32 v201, v201, v199
  v_cvt_pk_bf16_f32 v131, v198, v199
  v_cmp_gt_i32 s[76:77], 19, v206
  v_exp_f32 v193, v105
  v_cndmask_b32 v106, v106, v208, s[74:75]
  v_add_f32 v201, v201, v192
  s_waitcnt lgkmcnt(3)
  v_mfma_f32_32x32x16_bf16 v[0:15], v[176:179], v[140:143], v[0:15]
  v_cmp_gt_i32 s[70:71], 24, v206
  v_exp_f32 v194, v106
  v_cndmask_b32 v107, v107, v208, s[76:77]
  v_add_f32 v201, v201, v193
  v_cvt_pk_bf16_f32 v132, v192, v193
  v_cmp_gt_i32 s[72:73], 25, v206
  v_exp_f32 v195, v107
  v_cndmask_b32 v108, v108, v208, s[70:71]
  v_add_f32 v201, v201, v194
  s_waitcnt lgkmcnt(2)
  v_mfma_f32_32x32x16_bf16 v[16:31], v[180:183], v[140:143], v[16:31]
  v_cmp_gt_i32 s[74:75], 26, v206
  v_exp_f32 v196, v108
  v_cndmask_b32 v109, v109, v208, s[72:73]
  v_add_f32 v201, v201, v195
  v_cvt_pk_bf16_f32 v133, v194, v195
  v_cmp_gt_i32 s[76:77], 27, v206
  v_exp_f32 v197, v109
  v_cndmask_b32 v110, v110, v208, s[74:75]
  v_add_f32 v201, v201, v196
  s_waitcnt lgkmcnt(1)
  v_mfma_f32_32x32x16_bf16 v[32:47], v[184:187], v[140:143], v[32:47]
  v_exp_f32 v198, v110
  v_cndmask_b32 v111, v111, v208, s[76:77]
  v_add_f32 v201, v201, v197
  v_cvt_pk_bf16_f32 v134, v196, v197
  v_exp_f32 v199, v111
  v_add_f32 v201, v201, v198
  s_waitcnt lgkmcnt(0)
  v_mfma_f32_32x32x16_bf16 v[48:63], v[188:191], v[140:143], v[48:63]
  v_add_f32 v201, v201, v199
  v_cvt_pk_bf16_f32 v135, v198, v199
  v_cmp_lt_f32 vcc, s68, v201
  s_nop 1
  s_cbranch_vccnz slow_B0m0
back_B0m0:
  v_add_f32 v200, v200, v201
  v_mov_b32 v201, 0
  ds_read_b128 v[160:163], v204 offset:24576
  ds_read_b128 v[164:167], v204 offset:25600
  s_waitcnt lgkmcnt(1)
  v_mfma_f32_32x32x16_bf16 v[0:15], v[160:163], v[128:131], v[0:15]
  ds_read_b128 v[168:171], v204 offset:26624
  ds_read_b128 v[172:175], v204 offset:27648
  s_waitcnt lgkmcnt(2)
  v_mfma_f32_32x32x16_bf16 v[16:31], v[164:167], v[128:131], v[16:31]
  ds_read_b128 v[176:179], v204 offset:28672
  ds_read_b128 v[180:183], v204 offset:29696
  s_waitcnt lgkmcnt(3)
  v_mfma_f32_32x32x16_bf16 v[32:47], v[168:171], v[128:131], v[32:47]
  ds_read_b128 v[184:187], v204 offset:30720
  ds_read_b128 v[188:191], v204 offset:31744
  s_waitcnt lgkmcnt(4)
  v_mfma_f32_32x32x16_bf16 v[48:63], v[172:175], v[128:131], v[48:63]
  s_waitcnt lgkmcnt(3)
  v_mfma_f32_32x32x16_bf16 v[0:15], v[176:179], v[132:135], v[0:15]
  s_barrier
  s_waitcnt lgkmcnt(2)
  v_mfma_f32_32x32x16_bf16 v[16:31], v[180:183], v[132:135], v[16:31]
  s_waitcnt lgkmcnt(1)
  v_mfma_f32_32x32x16_bf16 v[32:47], v[184:187], v[132:135], v[32:47]
  s_waitcnt lgkmcnt(0)
  v_mfma_f32_32x32x16_bf16 v[48:63], v[188:191], v[132:135], v[48:63]
  buffer_load_dword v251, off, s[96:99], s69 offset:0 sc1
  s_barrier
  v_xor_b32 v204, 0x10000, v204
  v_xor_b32 v205, 0x10000, v205
at_B_dend:
  s_waitcnt vmcnt(0)
  v_readfirstlane_b32 s100, v251
  s_bfe_u32 s100, s100, 524288
  s_cmp_lt_u32 s100, 4
  s_cbranch_scc1 pc_spin9
pc_back9:
  s_add_u32 s33, s63, 42467328
  s_add_u32 s8, s60, s33
  s_addc_u32 s9, s61, 0
  s_mov_b32 s10, 350208
  s_and_b32 s33, s24, 28
  s_mul_i32 s33, s33, 3072
  s_add_u32 s33, s33, 262144
  v_add_u32 v254, s33, v250
  buffer_load_dwordx4 v[64:67], v254, s[8:11], 0 offen offset:0 sc1
  buffer_load_dwordx4 v[68:71], v254, s[8:11], 0 offen offset:1024 sc1
  buffer_load_dwordx4 v[72:75], v254, s[8:11], 0 offen offset:2048 sc1
  buffer_load_dwordx4 v[76:79], v254, s[8:11], 0 offen offset:3072 sc1
  v_add_u32 v254, 0x1000, v254
  buffer_load_dwordx4 v[80:83], v254, s[8:11], 0 offen offset:0 sc1
  buffer_load_dwordx4 v[84:87], v254, s[8:11], 0 offen offset:1024 sc1
  buffer_load_dwordx4 v[88:91], v254, s[8:11], 0 offen offset:2048 sc1
  buffer_load_dwordx4 v[92:95], v254, s[8:11], 0 offen offset:3072 sc1
  v_add_u32 v254, 0x1000, v254
  buffer_load_dwordx4 v[144:147], v254, s[8:11], 0 offen offset:0 sc1
  buffer_load_dwordx4 v[148:151], v254, s[8:11], 0 offen offset:1024 sc1
  buffer_load_dwordx4 v[152:155], v254, s[8:11], 0 offen offset:2048 sc1
  buffer_load_dwordx4 v[156:159], v254, s[8:11], 0 offen offset:3072 sc1
  v_add_u32 v254, 0x1000, v254
  s_waitcnt lgkmcnt(0)
  s_and_b32 s33, s26, 3
  s_cmp_lg_u32 s33, 3
  s_cbranch_scc1 fin_nr_B
  ds_read_b128 v[160:163], v204 offset:8192
  ds_read_b128 v[164:167], v204 offset:9216
  ds_read_b128 v[168:171], v204 offset:10240
  ds_read_b128 v[172:175], v204 offset:11264
  ds_read_b128 v[176:179], v204 offset:12288
  ds_read_b128 v[180:183], v204 offset:13312
  ds_read_b128 v[184:187], v204 offset:14336
  ds_read_b128 v[188:191], v204 offset:15360
fin_nr_B:
  v_add_f32 v200, v200, v201
  v_mov_b32 v201, v200
  s_nop 1
  v_permlane32_swap_b32 v200, v201
  s_nop 1
  v_add_f32 v200, v200, v201
  v_rcp_f32 v200, v200
  s_waitcnt lgkmcnt(0)
  s_cbranch_scc1 fin_nm_B
  v_mfma_f32_32x32x16_bf16 v[0:15], v[160:163], v[136:139], v[0:15]
  v_mfma_f32_32x32x16_bf16 v[0:15], v[176:179], v[140:143], v[0:15]
  v_mfma_f32_32x32x16_bf16 v[16:31], v[164:167], v[136:139], v[16:31]
  v_mfma_f32_32x32x16_bf16 v[16:31], v[180:183], v[140:143], v[16:31]
  v_mfma_f32_32x32x16_bf16 v[32:47], v[168:171], v[136:139], v[32:47]
  v_mfma_f32_32x32x16_bf16 v[32:47], v[184:187], v[140:143], v[32:47]
  v_mfma_f32_32x32x16_bf16 v[48:63], v[172:175], v[136:139], v[48:63]
  v_mfma_f32_32x32x16_bf16 v[48:63], v[188:191], v[140:143], v[48:63]
fin_nm_B:
  s_lshl_b32 s33, s24, 13
  s_add_u32 s33, s33, s63
  s_add_u32 s34, s33, 4096
  s_nop 3
  v_mul_f32 v0, v0, v200
  v_mul_f32 v1, v1, v200
  v_mul_f32 v2, v2, v200
  v_mul_f32 v3, v3, v200
  v_mul_f32 v4, v4, v200
  v_mul_f32 v5, v5, v200
  v_mul_f32 v6, v6, v200
  v_mul_f32 v7, v7, v200
  v_mul_f32 v8, v8, v200
  v_mul_f32 v9, v9, v200
  v_mul_f32 v10, v10, v200
  v_mul_f32 v11, v11, v200
  v_mul_f32 v12, v12, v200
  v_mul_f32 v13, v13, v200
  v_mul_f32 v14, v14, v200
  v_mul_f32 v15, v15, v200
  v_cvt_pk_bf16_f32 v96, v0, v1
  v_cvt_pk_bf16_f32 v97, v2, v3
  v_cvt_pk_bf16_f32 v98, v4, v5
  v_cvt_pk_bf16_f32 v99, v6, v7
  v_cvt_pk_bf16_f32 v100, v8, v9
  v_cvt_pk_bf16_f32 v101, v10, v11
  v_cvt_pk_bf16_f32 v102, v12, v13
  v_cvt_pk_bf16_f32 v103, v14, v15
  buffer_store_dwordx4 v[96:99], v250, s[16:19], s33 offen offset:0 sc1
  buffer_store_dwordx4 v[100:103], v250, s[16:19], s33 offen offset:1024 sc1
  v_mul_f32 v16, v16, v200
  v_mul_f32 v17, v17, v200
  v_mul_f32 v18, v18, v200
  v_mul_f32 v19, v19, v200
  v_mul_f32 v20, v20, v200
  v_mul_f32 v21, v21, v200
  v_mul_f32 v22, v22, v200
  v_mul_f32 v23, v23, v200
  v_mul_f32 v24, v24, v200
  v_mul_f32 v25, v25, v200
  v_mul_f32 v26, v26, v200
  v_mul_f32 v27, v27, v200
  v_mul_f32 v28, v28, v200
  v_mul_f32 v29, v29, v200
  v_mul_f32 v30, v30, v200
  v_mul_f32 v31, v31, v200
  v_cvt_pk_bf16_f32 v104, v16, v17
  v_cvt_pk_bf16_f32 v105, v18, v19
  v_cvt_pk_bf16_f32 v106, v20, v21
  v_cvt_pk_bf16_f32 v107, v22, v23
  v_cvt_pk_bf16_f32 v108, v24, v25
  v_cvt_pk_bf16_f32 v109, v26, v27
  v_cvt_pk_bf16_f32 v110, v28, v29
  v_cvt_pk_bf16_f32 v111, v30, v31
  buffer_store_dwordx4 v[104:107], v250, s[16:19], s33 offen offset:2048 sc1
  buffer_store_dwordx4 v[108:111], v250, s[16:19], s33 offen offset:3072 sc1
  v_mul_f32 v32, v32, v200
  v_mul_f32 v33, v33, v200
  v_mul_f32 v34, v34, v200
  v_mul_f32 v35, v35, v200
  v_mul_f32 v36, v36, v200
  v_mul_f32 v37, v37, v200
  v_mul_f32 v38, v38, v200
  v_mul_f32 v39, v39, v200
  v_mul_f32 v40, v40, v200
  v_mul_f32 v41, v41, v200
  v_mul_f32 v42, v42, v200
  v_mul_f32 v43, v43, v200
  v_mul_f32 v44, v44, v200
  v_mul_f32 v45, v45, v200
  v_mul_f32 v46, v46, v200
  v_mul_f32 v47, v47, v200
  v_cvt_pk_bf16_f32 v112, v32, v33
  v_cvt_pk_bf16_f32 v113, v34, v35
  v_cvt_pk_bf16_f32 v114, v36, v37
  v_cvt_pk_bf16_f32 v115, v38, v39
  v_cvt_pk_bf16_f32 v116, v40, v41
  v_cvt_pk_bf16_f32 v117, v42, v43
  v_cvt_pk_bf16_f32 v118, v44, v45
  v_cvt_pk_bf16_f32 v119, v46, v47
  buffer_store_dwordx4 v[112:115], v250, s[16:19], s34 offen offset:0 sc1
  buffer_store_dwordx4 v[116:119], v250, s[16:19], s34 offen offset:1024 sc1
  s_nop 3
  v_mul_f32 v48, v48, v200
  v_mul_f32 v49, v49, v200
  v_mul_f32 v50, v50, v200
  v_mul_f32 v51, v51, v200
  v_mul_f32 v52, v52, v200
  v_mul_f32 v53, v53, v200
  v_mul_f32 v54, v54, v200
  v_mul_f32 v55, v55, v200
  v_mul_f32 v56, v56, v200
  v_mul_f32 v57, v57, v200
  v_mul_f32 v58, v58, v200
  v_mul_f32 v59, v59, v200
  v_mul_f32 v60, v60, v200
  v_mul_f32 v61, v61, v200
  v_mul_f32 v62, v62, v200
  v_mul_f32 v63, v63, v200
  v_cvt_pk_bf16_f32 v120, v48, v49
  v_cvt_pk_bf16_f32 v121, v50, v51
  v_cvt_pk_bf16_f32 v122, v52, v53
  v_cvt_pk_bf16_f32 v123, v54, v55
  v_cvt_pk_bf16_f32 v124, v56, v57
  v_cvt_pk_bf16_f32 v125, v58, v59
  v_cvt_pk_bf16_f32 v126, v60, v61
  v_cvt_pk_bf16_f32 v127, v62, v63
  buffer_store_dwordx4 v[120:123], v250, s[16:19], s34 offen offset:2048 sc1
  buffer_store_dwordx4 v[124:127], v250, s[16:19], s34 offen offset:3072 sc1
at_done:
  s_barrier
  v_add_u32 v255, 131072, v250
  v_mov_b32 v246, v204
  v_mov_b32 v247, v205
  s_cmp_ge_u32 s26, 4
  s_cbranch_scc1 ao_skip10
  s_add_u32 m0, s29, s30
  s_add_u32 s29, s29, 0x4000
  buffer_load_dwordx4 v253, s[12:15], s27 offen offset:0 sc1 lds
  buffer_load_dwordx4 v253, s[12:15], s27 offen offset:1024 sc1 lds
  buffer_load_dwordx4 v253, s[12:15], s27 offen offset:2048 sc1 lds
  s_and_b32 s29, s29, 0x1ffff
  buffer_load_dwordx4 v253, s[12:15], s27 offen offset:3072 sc1 lds
  s_add_u32 s27, s27, 0x4000
  s_cmp_eq_u32 s27, s79
  s_cselect_b32 s27, 1081344, s27
  s_add_u32 m0, s29, s30
  s_add_u32 s29, s29, 0x4000
  buffer_load_dwordx4 v253, s[12:15], s27 offen offset:0 sc1 lds
  buffer_load_dwordx4 v253, s[12:15], s27 offen offset:1024 sc1 lds
  buffer_load_dwordx4 v253, s[12:15], s27 offen offset:2048 sc1 lds
  s_and_b32 s29, s29, 0x1ffff
  buffer_load_dwordx4 v253, s[12:15], s27 offen offset:3072 sc1 lds
  s_add_u32 s27, s27, 0x4000
  s_cmp_eq_u32 s27, s79
  s_cselect_b32 s27, 1081344, s27
ao_skip10:
  ds_read_b128 v[160:163], v246 offset:16384
  ds_read_b128 v[164:167], v246 offset:17408
  ds_read_b128 v[168:171], v246 offset:18432
  ds_read_b128 v[172:175], v246 offset:19456
  ds_read_b128 v[176:179], v246 offset:20480
  ds_read_b128 v[180:183], v246 offset:21504
  s_waitcnt lgkmcnt(5)
  v_mfma_f32_32x32x16_bf16 v[0:15], v[160:163], v[96:99], 0
  ds_read_b128 v[184:187], v246 offset:22528
  s_waitcnt lgkmcnt(5)
  v_mfma_f32_32x32x16_bf16 v[16:31], v[164:167], v[96:99], 0
  ds_read_b128 v[188:191], v246 offset:23552
  s_waitcnt lgkmcnt(5)
  v_mfma_f32_32x32x16_bf16 v[32:47], v[168:171], v[96:99], 0
  s_cmp_ge_u32 s26, 4
  s_cbranch_scc1 sibA_skip
  s_add_u32 s33, s24, 1
  s_and_b32 s33, s33, 3
  s_and_b32 s34, s24, 28
  s_or_b32 s33, s33, s34
  s_lshl_b32 s33, s33, 13
  s_add_u32 s34, s33, 4096
  buffer_load_dwordx4 v[128:131], v250, s[8:11], s33 offen offset:0 sc1
  buffer_load_dwordx4 v[132:135], v250, s[8:11], s33 offen offset:1024 sc1
  buffer_load_dwordx4 v[136:139], v250, s[8:11], s33 offen offset:2048 sc1
  buffer_load_dwordx4 v[140:143], v250, s[8:11], s33 offen offset:3072 sc1
  buffer_load_dwordx4 v[192:195], v250, s[8:11], s34 offen offset:0 sc1
  buffer_load_dwordx4 v[196:199], v250, s[8:11], s34 offen offset:1024 sc1
  buffer_load_dwordx4 v[200:203], v250, s[8:11], s34 offen offset:2048 sc1
  buffer_load_dwordx4 v[204:207], v250, s[8:11], s34 offen offset:3072 sc1
  s_add_u32 s33, s24, 2
  s_and_b32 s33, s33, 3
  s_and_b32 s34, s24, 28
  s_or_b32 s33, s33, s34
  s_lshl_b32 s33, s33, 13
  s_add_u32 s34, s33, 4096
  buffer_load_dwordx4 v[208:211], v250, s[8:11], s33 offen offset:0 sc1
  buffer_load_dwordx4 v[212:215], v250, s[8:11], s33 offen offset:1024 sc1
  buffer_load_dwordx4 v[216:219], v250, s[8:11], s33 offen offset:2048 sc1
  buffer_load_dwordx4 v[220:223], v250, s[8:11], s33 offen offset:3072 sc1
  buffer_load_dwordx4 v[224:227], v250, s[8:11], s34 offen offset:0 sc1
  buffer_load_dwordx4 v[228:231], v250, s[8:11], s34 offen offset:1024 sc1
  buffer_load_dwordx4 v[232:235], v250, s[8:11], s34 offen offset:2048 sc1
  buffer_load_dwordx4 v[236:239], v250, s[8:11], s34 offen offset:3072 sc1
sibA_skip:
  ds_read_b128 v[160:163], v246 offset:24576
  s_waitcnt lgkmcnt(5)
  v_mfma_f32_32x32x16_bf16 v[48:63], v[172:175], v[96:99], 0
  ds_read_b128 v[164:167], v246 offset:25600
  s_waitcnt lgkmcnt(5)
  v_mfma_f32_32x32x16_bf16 v[0:15], v[176:179], v[100:103], v[0:15]
  ds_read_b128 v[168:171], v246 offset:26624
  s_waitcnt lgkmcnt(5)
  v_mfma_f32_32x32x16_bf16 v[16:31], v[180:183], v[100:103], v[16:31]
  ds_read_b128 v[172:175], v246 offset:27648
  s_waitcnt lgkmcnt(5)
  v_mfma_f32_32x32x16_bf16 v[32:47], v[184:187], v[100:103], v[32:47]
  ds_read_b128 v[176:179], v246 offset:28672
  s_waitcnt lgkmcnt(5)
  v_mfma_f32_32x32x16_bf16 v[48:63], v[188:191], v[100:103], v[48:63]
  ds_read_b128 v[180:183], v246 offset:29696
  s_waitcnt lgkmcnt(5)
  v_mfma_f32_32x32x16_bf16 v[0:15], v[160:163], v[104:107], v[0:15]
  ds_read_b128 v[184:187], v246 offset:30720
  s_waitcnt lgkmcnt(5)
  v_mfma_f32_32x32x16_bf16 v[16:31], v[164:167], v[104:107], v[16:31]
  ds_read_b128 v[188:191], v246 offset:31744
  s_waitcnt lgkmcnt(5)
  v_mfma_f32_32x32x16_bf16 v[32:47], v[168:171], v[104:107], v[32:47]
  ds_read_b128 v[160:163], v246 offset:32768
  s_waitcnt lgkmcnt(5)
  v_mfma_f32_32x32x16_bf16 v[48:63], v[172:175], v[104:107], v[48:63]
  ds_read_b128 v[164:167], v246 offset:33792
  s_waitcnt lgkmcnt(5)
  v_mfma_f32_32x32x16_bf16 v[0:15], v[176:179], v[108:111], v[0:15]
  ds_read_b128 v[168:171], v246 offset:34816
  s_waitcnt lgkmcnt(5)
  v_mfma_f32_32x32x16_bf16 v[16:31], v[180:183], v[108:111], v[16:31]
  ds_read_b128 v[172:175], v246 offset:35840
  s_waitcnt lgkmcnt(5)
  v_mfma_f32_32x32x16_bf16 v[32:47], v[184:187], v[108:111], v[32:47]
  ds_read_b128 v[176:179], v246 offset:36864
  s_waitcnt lgkmcnt(5)
  v_mfma_f32_32x32x16_bf16 v[48:63], v[188:191], v[108:111], v[48:63]
  ds_read_b128 v[180:183], v246 offset:37888
  s_waitcnt lgkmcnt(5)
  v_mfma_f32_32x32x16_bf16 v[0:15], v[160:163], v[112:115], v[0:15]
  ds_read_b128 v[184:187], v246 offset:38912
  s_waitcnt lgkmcnt(5)
  v_mfma_f32_32x32x16_bf16 v[16:31], v[164:167], v[112:115], v[16:31]
  ds_read_b128 v[188:191], v246 offset:39936
  s_waitcnt lgkmcnt(5)
  v_mfma_f32_32x32x16_bf16 v[32:47], v[168:171], v[112:115], v[32:47]
  ds_read_b128 v[160:163], v246 offset:40960
  s_waitcnt lgkmcnt(5)
  v_mfma_f32_32x32x16_bf16 v[48:63], v[172:175], v[112:115], v[48:63]
  ds_read_b128 v[164:167], v246 offset:41984
  s_waitcnt lgkmcnt(5)
  v_mfma_f32_32x32x16_bf16 v[0:15], v[176:179], v[116:119], v[0:15]
  ds_read_b128 v[168:171], v246 offset:43008
  s_waitcnt lgkmcnt(5)
  v_mfma_f32_32x32x16_bf16 v[16:31], v[180:183], v[116:119], v[16:31]
  ds_read_b128 v[172:175], v246 offset:44032
  s_waitcnt lgkmcnt(5)
  v_mfma_f32_32x32x16_bf16 v[32:47], v[184:187], v[116:119], v[32:47]
  ds_read_b128 v[176:179], v246 offset:45056
  s_waitcnt lgkmcnt(5)
  v_mfma_f32_32x32x16_bf16 v[48:63], v[188:191], v[116:119], v[48:63]
  ds_read_b128 v[180:183], v246 offset:46080
  s_waitcnt lgkmcnt(5)
  v_mfma_f32_32x32x16_bf16 v[0:15], v[160:163], v[120:123], v[0:15]
  ds_read_b128 v[184:187], v246 offset:47104
  s_waitcnt lgkmcnt(5)
  v_mfma_f32_32x32x16_bf16 v[16:31], v[164:167], v[120:123], v[16:31]
  ds_read_b128 v[188:191], v246 offset:48128
  s_waitcnt lgkmcnt(5)
  v_mfma_f32_32x32x16_bf16 v[32:47], v[168:171], v[120:123], v[32:47]
  s_waitcnt vmcnt(16)
  s_cmp_lt_u32 s26, 4
  s_cbranch_scc1 x1_w
  s_waitcnt vmcnt(0)
x1_w:
  s_barrier
  s_cmp_eq_u32 s26, 0
  s_cbranch_scc1 sg_do11
sg_back11:
  s_cmp_ge_u32 s26, 4
  s_cbranch_scc1 ao_skip12
  s_mov_b32 s27, 1245184
  s_add_u32 m0, s29, s30
  s_add_u32 s29, s29, 0x4000
  buffer_load_dwordx4 v253, s[12:15], s27 offen offset:0 sc1 lds
  buffer_load_dwordx4 v253, s[12:15], s27 offen offset:1024 sc1 lds
  buffer_load_dwordx4 v253, s[12:15], s27 offen offset:2048 sc1 lds
  s_and_b32 s29, s29, 0x1ffff
  buffer_load_dwordx4 v253, s[12:15], s27 offen offset:3072 sc1 lds
  s_add_u32 s27, s27, 0x4000
  s_cmp_eq_u32 s27, s79
  s_cselect_b32 s27, 1081344, s27
ao_skip12:
  ds_read_b128 v[160:163], v246 offset:49152
  s_waitcnt lgkmcnt(5)
  v_mfma_f32_32x32x16_bf16 v[48:63], v[172:175], v[120:123], v[48:63]
  ds_read_b128 v[164:167], v246 offset:50176
  s_waitcnt lgkmcnt(5)
  v_mfma_f32_32x32x16_bf16 v[0:15], v[176:179], v[124:127], v[0:15]
  ds_read_b128 v[168:171], v246 offset:51200
  s_waitcnt lgkmcnt(5)
  v_mfma_f32_32x32x16_bf16 v[16:31], v[180:183], v[124:127], v[16:31]
  ds_read_b128 v[172:175], v246 offset:52224
  s_waitcnt lgkmcnt(5)
  v_mfma_f32_32x32x16_bf16 v[32:47], v[184:187], v[124:127], v[32:47]
  ds_read_b128 v[176:179], v246 offset:53248
  s_waitcnt lgkmcnt(5)
  v_mfma_f32_32x32x16_bf16 v[48:63], v[188:191], v[124:127], v[48:63]
  ds_read_b128 v[180:183], v246 offset:54272
  s_waitcnt lgkmcnt(5)
  v_mfma_f32_32x32x16_bf16 v[0:15], v[160:163], v[64:67], v[0:15]
  ds_read_b128 v[184:187], v246 offset:55296
  s_waitcnt lgkmcnt(5)
  v_mfma_f32_32x32x16_bf16 v[16:31], v[164:167], v[64:67], v[16:31]
  s_cmp_ge_u32 s26, 4
  s_cbranch_scc1 sibA2_skip
  s_add_u32 s33, s24, 3
  s_and_b32 s33, s33, 3
  s_and_b32 s34, s24, 28
  s_or_b32 s33, s33, s34
  s_lshl_b32 s33, s33, 13
  s_add_u32 s34, s33, 4096
  buffer_load_dwordx4 v[96:99], v250, s[8:11], s33 offen offset:0 sc1
  buffer_load_dwordx4 v[100:103], v250, s[8:11], s33 offen offset:1024 sc1
  buffer_load_dwordx4 v[104:107], v250, s[8:11], s33 offen offset:2048 sc1
  buffer_load_dwordx4 v[108:111], v250, s[8:11], s33 offen offset:3072 sc1
  buffer_load_dwordx4 v[112:115], v250, s[8:11], s34 offen offset:0 sc1
  buffer_load_dwordx4 v[116:119], v250, s[8:11], s34 offen offset:1024 sc1
  buffer_load_dwordx4 v[120:123], v250, s[8:11], s34 offen offset:2048 sc1
  buffer_load_dwordx4 v[124:127], v250, s[8:11], s34 offen offset:3072 sc1
sibA2_skip:
  ds_read_b128 v[188:191], v246 offset:56320
  s_waitcnt lgkmcnt(5)
  v_mfma_f32_32x32x16_bf16 v[32:47], v[168:171], v[64:67], v[32:47]
  ds_read_b128 v[160:163], v246 offset:57344
  s_waitcnt lgkmcnt(5)
  v_mfma_f32_32x32x16_bf16 v[48:63], v[172:175], v[64:67], v[48:63]
  ds_read_b128 v[164:167], v246 offset:58368
  s_waitcnt lgkmcnt(5)
  v_mfma_f32_32x32x16_bf16 v[0:15], v[176:179], v[68:71], v[0:15]
  ds_read_b128 v[168:171], v246 offset:59392
  s_waitcnt lgkmcnt(5)
  v_mfma_f32_32x32x16_bf16 v[16:31], v[180:183], v[68:71], v[16:31]
  ds_read_b128 v[172:175], v246 offset:60416
  s_waitcnt lgkmcnt(5)
  v_mfma_f32_32x32x16_bf16 v[32:47], v[184:187], v[68:71], v[32:47]
  ds_read_b128 v[176:179], v246 offset:61440
  s_waitcnt lgkmcnt(5)
  v_mfma_f32_32x32x16_bf16 v[48:63], v[188:191], v[68:71], v[48:63]
  ds_read_b128 v[180:183], v246 offset:62464
  s_waitcnt lgkmcnt(5)
  v_mfma_f32_32x32x16_bf16 v[0:15], v[160:163], v[72:75], v[0:15]
  ds_read_b128 v[184:187], v246 offset:63488
  s_waitcnt lgkmcnt(5)
  v_mfma_f32_32x32x16_bf16 v[16:31], v[164:167], v[72:75], v[16:31]
  ds_read_b128 v[188:191], v246 offset:64512
  s_waitcnt lgkmcnt(5)
  v_mfma_f32_32x32x16_bf16 v[32:47], v[168:171], v[72:75], v[32:47]
  ds_read_b128 v[160:163], v247 offset:0
  s_waitcnt lgkmcnt(5)
  v_mfma_f32_32x32x16_bf16 v[48:63], v[172:175], v[72:75], v[48:63]
  ds_read_b128 v[164:167], v247 offset:1024
  s_waitcnt lgkmcnt(5)
  v_mfma_f32_32x32x16_bf16 v[0:15], v[176:179], v[76:79], v[0:15]
  ds_read_b128 v[168:171], v247 offset:2048
  s_waitcnt lgkmcnt(5)
  v_mfma_f32_32x32x16_bf16 v[16:31], v[180:183], v[76:79], v[16:31]
  ds_read_b128 v[172:175], v247 offset:3072
  s_waitcnt lgkmcnt(5)
  v_mfma_f32_32x32x16_bf16 v[32:47], v[184:187], v[76:79], v[32:47]
  ds_read_b128 v[176:179], v247 offset:4096
  s_waitcnt lgkmcnt(5)
  v_mfma_f32_32x32x16_bf16 v[48:63], v[188:191], v[76:79], v[48:63]
  ds_read_b128 v[180:183], v247 offset:5120
  s_waitcnt lgkmcnt(5)
  v_mfma_f32_32x32x16_bf16 v[0:15], v[160:163], v[80:83], v[0:15]
  buffer_load_dword v251, off, s[96:99], s69 offset:4 sc1
  ds_read_b128 v[184:187], v247 offset:6144
  s_waitcnt lgkmcnt(5)
  v_mfma_f32_32x32x16_bf16 v[16:31], v[164:167], v[80:83], v[16:31]
  ds_read_b128 v[188:191], v247 offset:7168
  s_waitcnt lgkmcnt(5)
  v_mfma_f32_32x32x16_bf16 v[32:47], v[168:171], v[80:83], v[32:47]
  ds_read_b128 v[160:163], v247 offset:8192
  s_waitcnt lgkmcnt(5)
  v_mfma_f32_32x32x16_bf16 v[48:63], v[172:175], v[80:83], v[48:63]
  ds_read_b128 v[164:167], v247 offset:9216
  s_waitcnt lgkmcnt(5)
  v_mfma_f32_32x32x16_bf16 v[0:15], v[176:179], v[84:87], v[0:15]
  ds_read_b128 v[168:171], v247 offset:10240
  s_waitcnt lgkmcnt(5)
  v_mfma_f32_32x32x16_bf16 v[16:31], v[180:183], v[84:87], v[16:31]
  ds_read_b128 v[172:175], v247 offset:11264
  s_waitcnt lgkmcnt(5)
  v_mfma_f32_32x32x16_bf16 v[32:47], v[184:187], v[84:87], v[32:47]
  ds_read_b128 v[176:179], v247 offset:12288
  s_waitcnt lgkmcnt(5)
  v_mfma_f32_32x32x16_bf16 v[48:63], v[188:191], v[84:87], v[48:63]
  ds_read_b128 v[180:183], v247 offset:13312
  s_waitcnt lgkmcnt(5)
  v_mfma_f32_32x32x16_bf16 v[0:15], v[160:163], v[88:91], v[0:15]
  ds_read_b128 v[184:187], v247 offset:14336
  s_waitcnt lgkmcnt(5)
  v_mfma_f32_32x32x16_bf16 v[16:31], v[164:167], v[88:91], v[16:31]
  ds_read_b128 v[188:191], v247 offset:15360
  s_waitcnt vmcnt(0)
  s_barrier
  s_cmp_lt_u32 s26, 4
  s_cbranch_scc1 sibB_skip
  v_readfirstlane_b32 s100, v251
  s_bfe_u32 s100, s100, 524288
  s_cmp_lt_u32 s100, 4
  s_cbranch_scc1 pc_spin13
pc_back13:
  s_add_u32 s33, s24, 1
  s_and_b32 s33, s33, 3
  s_and_b32 s34, s24, 28
  s_or_b32 s33, s33, s34
  s_lshl_b32 s33, s33, 13
  s_add_u32 s34, s33, 4096
  buffer_load_dwordx4 v[128:131], v250, s[8:11], s33 offen offset:0 sc1
  buffer_load_dwordx4 v[132:135], v250, s[8:11], s33 offen offset:1024 sc1
  buffer_load_dwordx4 v[136:139], v250, s[8:11], s33 offen offset:2048 sc1
  buffer_load_dwordx4 v[140:143], v250, s[8:11], s33 offen offset:3072 sc1
  buffer_load_dwordx4 v[192:195], v250, s[8:11], s34 offen offset:0 sc1
  buffer_load_dwordx4 v[196:199], v250, s[8:11], s34 offen offset:1024 sc1
  buffer_load_dwordx4 v[200:203], v250, s[8:11], s34 offen offset:2048 sc1
  buffer_load_dwordx4 v[204:207], v250, s[8:11], s34 offen offset:3072 sc1
  s_add_u32 s33, s24, 2
  s_and_b32 s33, s33, 3
  s_and_b32 s34, s24, 28
  s_or_b32 s33, s33, s34
  s_lshl_b32 s33, s33, 13
  s_add_u32 s34, s33, 4096
  buffer_load_dwordx4 v[208:211], v250, s[8:11], s33 offen offset:0 sc1
  buffer_load_dwordx4 v[212:215], v250, s[8:11], s33 offen offset:1024 sc1
  buffer_load_dwordx4 v[216:219], v250, s[8:11], s33 offen offset:2048 sc1
  buffer_load_dwordx4 v[220:223], v250, s[8:11], s33 offen offset:3072 sc1
  buffer_load_dwordx4 v[224:227], v250, s[8:11], s34 offen offset:0 sc1
  buffer_load_dwordx4 v[228:231], v250, s[8:11], s34 offen offset:1024 sc1
  buffer_load_dwordx4 v[232:235], v250, s[8:11], s34 offen offset:2048 sc1
  buffer_load_dwordx4 v[236:239], v250, s[8:11], s34 offen offset:3072 sc1
  s_add_u32 s33, s24, 3
  s_and_b32 s33, s33, 3
  s_and_b32 s34, s24, 28
  s_or_b32 s33, s33, s34
  s_lshl_b32 s33, s33, 13
  s_add_u32 s34, s33, 4096
  buffer_load_dwordx4 v[96:99], v250, s[8:11], s33 offen offset:0 sc1
  buffer_load_dwordx4 v[100:103], v250, s[8:11], s33 offen offset:1024 sc1
  buffer_load_dwordx4 v[104:107], v250, s[8:11], s33 offen offset:2048 sc1
  buffer_load_dwordx4 v[108:111], v250, s[8:11], s33 offen offset:3072 sc1
  buffer_load_dwordx4 v[112:115], v250, s[8:11], s34 offen offset:0 sc1
  buffer_load_dwordx4 v[116:119], v250, s[8:11], s34 offen offset:1024 sc1
  buffer_load_dwordx4 v[120:123], v250, s[8:11], s34 offen offset:2048 sc1
  buffer_load_dwordx4 v[124:127], v250, s[8:11], s34 offen offset:3072 sc1
sibB_skip:
  s_waitcnt lgkmcnt(5)
  v_mfma_f32_32x32x16_bf16 v[32:47], v[168:171], v[88:91], v[32:47]
  ds_read_b128 v[160:163], v247 offset:16384
  s_waitcnt lgkmcnt(5)
  v_mfma_f32_32x32x16_bf16 v[48:63], v[172:175], v[88:91], v[48:63]
  ds_read_b128 v[164:167], v247 offset:17408
  s_waitcnt lgkmcnt(5)
  v_mfma_f32_32x32x16_bf16 v[0:15], v[176:179], v[92:95], v[0:15]
  ds_read_b128 v[168:171], v247 offset:18432
  s_waitcnt lgkmcnt(5)
  v_mfma_f32_32x32x16_bf16 v[16:31], v[180:183], v[92:95], v[16:31]
  ds_read_b128 v[172:175], v247 offset:19456
  s_waitcnt lgkmcnt(5)
  v_mfma_f32_32x32x16_bf16 v[32:47], v[184:187], v[92:95], v[32:47]
  ds_read_b128 v[176:179], v247 offset:20480
  s_waitcnt lgkmcnt(5)
  v_mfma_f32_32x32x16_bf16 v[48:63], v[188:191], v[92:95], v[48:63]
  ds_read_b128 v[180:183], v247 offset:21504
  s_waitcnt lgkmcnt(5)
  v_mfma_f32_32x32x16_bf16 v[0:15], v[160:163], v[144:147], v[0:15]
  ds_read_b128 v[184:187], v247 offset:22528
  s_waitcnt lgkmcnt(5)
  v_mfma_f32_32x32x16_bf16 v[16:31], v[164:167], v[144:147], v[16:31]
  ds_read_b128 v[188:191], v247 offset:23552
  s_waitcnt lgkmcnt(5)
  v_mfma_f32_32x32x16_bf16 v[32:47], v[168:171], v[144:147], v[32:47]
  ds_read_b128 v[160:163], v247 offset:24576
  s_waitcnt lgkmcnt(5)
  v_mfma_f32_32x32x16_bf16 v[48:63], v[172:175], v[144:147], v[48:63]
  ds_read_b128 v[164:167], v247 offset:25600
  s_waitcnt lgkmcnt(5)
  v_mfma_f32_32x32x16_bf16 v[0:15], v[176:179], v[148:151], v[0:15]
  ds_read_b128 v[168:171], v247 offset:26624
  s_waitcnt lgkmcnt(5)
  v_mfma_f32_32x32x16_bf16 v[16:31], v[180:183], v[148:151], v[16:31]
  ds_read_b128 v[172:175], v247 offset:27648
  s_waitcnt lgkmcnt(5)
  v_mfma_f32_32x32x16_bf16 v[32:47], v[184:187], v[148:151], v[32:47]
  ds_read_b128 v[176:179], v247 offset:28672
  s_waitcnt lgkmcnt(5)
  v_mfma_f32_32x32x16_bf16 v[48:63], v[188:191], v[148:151], v[48:63]
  ds_read_b128 v[180:183], v247 offset:29696
  s_waitcnt lgkmcnt(5)
  v_mfma_f32_32x32x16_bf16 v[0:15], v[160:163], v[152:155], v[0:15]
  ds_read_b128 v[184:187], v247 offset:30720
  s_waitcnt lgkmcnt(5)
  v_mfma_f32_32x32x16_bf16 v[16:31], v[164:167], v[152:155], v[16:31]
  ds_read_b128 v[188:191], v247 offset:31744
  s_waitcnt lgkmcnt(5)
  v_mfma_f32_32x32x16_bf16 v[32:47], v[168:171], v[152:155], v[32:47]
  ds_read_b128 v[160:163], v247 offset:32768
  s_waitcnt lgkmcnt(5)
  v_mfma_f32_32x32x16_bf16 v[48:63], v[172:175], v[152:155], v[48:63]
  ds_read_b128 v[164:167], v247 offset:33792
  s_waitcnt lgkmcnt(5)
  v_mfma_f32_32x32x16_bf16 v[0:15], v[176:179], v[156:159], v[0:15]
  ds_read_b128 v[168:171], v247 offset:34816
  s_waitcnt lgkmcnt(5)
  v_mfma_f32_32x32x16_bf16 v[16:31], v[180:183], v[156:159], v[16:31]
  ds_read_b128 v[172:175], v247 offset:35840
  s_waitcnt lgkmcnt(5)
  v_mfma_f32_32x32x16_bf16 v[32:47], v[184:187], v[156:159], v[32:47]
  ds_read_b128 v[176:179], v247 offset:36864
  s_waitcnt lgkmcnt(5)
  v_mfma_f32_32x32x16_bf16 v[48:63], v[188:191], v[156:159], v[48:63]
  ds_read_b128 v[180:183], v247 offset:37888
  s_waitcnt vmcnt(23)
  s_waitcnt lgkmcnt(5)
  v_mfma_f32_32x32x16_bf16 v[0:15], v[160:163], v[128:131], v[0:15]
  ds_read_b128 v[184:187], v247 offset:38912
  s_waitcnt lgkmcnt(5)
  v_mfma_f32_32x32x16_bf16 v[16:31], v[164:167], v[128:131], v[16:31]
  ds_read_b128 v[188:191], v247 offset:39936
  s_waitcnt lgkmcnt(5)
  v_mfma_f32_32x32x16_bf16 v[32:47], v[168:171], v[128:131], v[32:47]
  ds_read_b128 v[160:163], v247 offset:40960
  s_waitcnt lgkmcnt(5)
  v_mfma_f32_32x32x16_bf16 v[48:63], v[172:175], v[128:131], v[48:63]
  ds_read_b128 v[164:167], v247 offset:41984
  s_waitcnt vmcnt(22)
  s_waitcnt lgkmcnt(5)
  v_mfma_f32_32x32x16_bf16 v[0:15], v[176:179], v[132:135], v[0:15]
  ds_read_b128 v[168:171], v247 offset:43008
  s_waitcnt lgkmcnt(5)
  v_mfma_f32_32x32x16_bf16 v[16:31], v[180:183], v[132:135], v[16:31]
  ds_read_b128 v[172:175], v247 offset:44032
  s_waitcnt lgkmcnt(5)
  v_mfma_f32_32x32x16_bf16 v[32:47], v[184:187], v[132:135], v[32:47]
  ds_read_b128 v[176:179], v247 offset:45056
  s_waitcnt lgkmcnt(5)
  v_mfma_f32_32x32x16_bf16 v[48:63], v[188:191], v[132:135], v[48:63]
  ds_read_b128 v[180:183], v247 offset:46080
  s_waitcnt vmcnt(21)
  s_waitcnt lgkmcnt(5)
  v_mfma_f32_32x32x16_bf16 v[0:15], v[160:163], v[136:139], v[0:15]
  ds_read_b128 v[184:187], v247 offset:47104
  s_waitcnt lgkmcnt(5)
  v_mfma_f32_32x32x16_bf16 v[16:31], v[164:167], v[136:139], v[16:31]
  ds_read_b128 v[188:191], v247 offset:48128
  s_waitcnt lgkmcnt(5)
  v_mfma_f32_32x32x16_bf16 v[32:47], v[168:171], v[136:139], v[32:47]
  ds_read_b128 v[160:163], v247 offset:49152
  s_waitcnt lgkmcnt(5)
  v_mfma_f32_32x32x16_bf16 v[48:63], v[172:175], v[136:139], v[48:63]
  ds_read_b128 v[164:167], v247 offset:50176
  s_waitcnt vmcnt(20)
  s_waitcnt lgkmcnt(5)
  v_mfma_f32_32x32x16_bf16 v[0:15], v[176:179], v[140:143], v[0:15]
  ds_read_b128 v[168:171], v247 offset:51200
  s_waitcnt lgkmcnt(5)
  v_mfma_f32_32x32x16_bf16 v[16:31], v[180:183], v[140:143], v[16:31]
  ds_read_b128 v[172:175], v247 offset:52224
  s_waitcnt lgkmcnt(5)
  v_mfma_f32_32x32x16_bf16 v[32:47], v[184:187], v[140:143], v[32:47]
  ds_read_b128 v[176:179], v247 offset:53248
  s_waitcnt lgkmcnt(5)
  v_mfma_f32_32x32x16_bf16 v[48:63], v[188:191], v[140:143], v[48:63]
  ds_read_b128 v[180:183], v247 offset:54272
  s_waitcnt vmcnt(19)
  s_waitcnt lgkmcnt(5)
  v_mfma_f32_32x32x16_bf16 v[0:15], v[160:163], v[192:195], v[0:15]
  ds_read_b128 v[184:187], v247 offset:55296
  s_waitcnt lgkmcnt(5)
  v_mfma_f32_32x32x16_bf16 v[16:31], v[164:167], v[192:195], v[16:31]
  ds_read_b128 v[188:191], v247 offset:56320
  s_waitcnt lgkmcnt(5)
  v_mfma_f32_32x32x16_bf16 v[32:47], v[168:171], v[192:195], v[32:47]
  ds_read_b128 v[160:163], v247 offset:57344
  s_waitcnt lgkmcnt(5)
  v_mfma_f32_32x32x16_bf16 v[48:63], v[172:175], v[192:195], v[48:63]
  ds_read_b128 v[164:167], v247 offset:58368
  s_waitcnt vmcnt(18)
  s_waitcnt lgkmcnt(5)
  v_mfma_f32_32x32x16_bf16 v[0:15], v[176:179], v[196:199], v[0:15]
  ds_read_b128 v[168:171], v247 offset:59392
  s_waitcnt lgkmcnt(5)
  v_mfma_f32_32x32x16_bf16 v[16:31], v[180:183], v[196:199], v[16:31]
  ds_read_b128 v[172:175], v247 offset:60416
  s_waitcnt lgkmcnt(5)
  v_mfma_f32_32x32x16_bf16 v[32:47], v[184:187], v[196:199], v[32:47]
  ds_read_b128 v[176:179], v247 offset:61440
  s_waitcnt lgkmcnt(5)
  v_mfma_f32_32x32x16_bf16 v[48:63], v[188:191], v[196:199], v[48:63]
  ds_read_b128 v[180:183], v247 offset:62464
  s_waitcnt vmcnt(17)
  s_waitcnt lgkmcnt(5)
  v_mfma_f32_32x32x16_bf16 v[0:15], v[160:163], v[200:203], v[0:15]
  ds_read_b128 v[184:187], v247 offset:63488
  s_waitcnt lgkmcnt(5)
  v_mfma_f32_32x32x16_bf16 v[16:31], v[164:167], v[200:203], v[16:31]
  ds_read_b128 v[188:191], v247 offset:64512
  s_waitcnt lgkmcnt(5)
  v_mfma_f32_32x32x16_bf16 v[32:47], v[168:171], v[200:203], v[32:47]
  ds_read_b128 v[160:163], v246 offset:0
  s_waitcnt lgkmcnt(5)
  v_mfma_f32_32x32x16_bf16 v[48:63], v[172:175], v[200:203], v[48:63]
  ds_read_b128 v[164:167], v246 offset:1024
  s_waitcnt vmcnt(16)
  s_waitcnt lgkmcnt(5)
  v_mfma_f32_32x32x16_bf16 v[0:15], v[176:179], v[204:207], v[0:15]
  ds_read_b128 v[168:171], v246 offset:2048
  s_waitcnt lgkmcnt(5)
  v_mfma_f32_32x32x16_bf16 v[16:31], v[180:183], v[204:207], v[16:31]
  ds_read_b128 v[172:175], v246 offset:3072
  s_waitcnt lgkmcnt(5)
  v_mfma_f32_32x32x16_bf16 v[32:47], v[184:187], v[204:207], v[32:47]
  ds_read_b128 v[176:179], v246 offset:4096
  s_waitcnt lgkmcnt(5)
  v_mfma_f32_32x32x16_bf16 v[48:63], v[188:191], v[204:207], v[48:63]
  ds_read_b128 v[180:183], v246 offset:5120
  s_waitcnt vmcnt(15)
  s_waitcnt lgkmcnt(5)
  v_mfma_f32_32x32x16_bf16 v[0:15], v[160:163], v[208:211], v[0:15]
  ds_read_b128 v[184:187], v246 offset:6144
  s_waitcnt lgkmcnt(5)
  v_mfma_f32_32x32x16_bf16 v[16:31], v[164:167], v[208:211], v[16:31]
  ds_read_b128 v[188:191], v246 offset:7168
  s_waitcnt lgkmcnt(5)
  v_mfma_f32_32x32x16_bf16 v[32:47], v[168:171], v[208:211], v[32:47]
  ds_read_b128 v[160:163], v246 offset:8192
  s_waitcnt lgkmcnt(5)
  v_mfma_f32_32x32x16_bf16 v[48:63], v[172:175], v[208:211], v[48:63]
  ds_read_b128 v[164:167], v246 offset:9216
  s_waitcnt vmcnt(14)
  s_waitcnt lgkmcnt(5)
  v_mfma_f32_32x32x16_bf16 v[0:15], v[176:179], v[212:215], v[0:15]
  ds_read_b128 v[168:171], v246 offset:10240
  s_waitcnt lgkmcnt(5)
  v_mfma_f32_32x32x16_bf16 v[16:31], v[180:183], v[212:215], v[16:31]
  ds_read_b128 v[172:175], v246 offset:11264
  s_waitcnt lgkmcnt(5)
  v_mfma_f32_32x32x16_bf16 v[32:47], v[184:187], v[212:215], v[32:47]
  ds_read_b128 v[176:179], v246 offset:12288
  s_waitcnt lgkmcnt(5)
  v_mfma_f32_32x32x16_bf16 v[48:63], v[188:191], v[212:215], v[48:63]
  ds_read_b128 v[180:183], v246 offset:13312
  s_waitcnt vmcnt(13)
  s_waitcnt lgkmcnt(5)
  v_mfma_f32_32x32x16_bf16 v[0:15], v[160:163], v[216:219], v[0:15]
  ds_read_b128 v[184:187], v246 offset:14336
  s_waitcnt lgkmcnt(5)
  v_mfma_f32_32x32x16_bf16 v[16:31], v[164:167], v[216:219], v[16:31]
  ds_read_b128 v[188:191], v246 offset:15360
  s_waitcnt lgkmcnt(5)
  v_mfma_f32_32x32x16_bf16 v[32:47], v[168:171], v[216:219], v[32:47]
  ds_read_b128 v[160:163], v255 offset:0
  s_waitcnt lgkmcnt(5)
  v_mfma_f32_32x32x16_bf16 v[48:63], v[172:175], v[216:219], v[48:63]
  ds_read_b128 v[164:167], v255 offset:1024
  s_waitcnt vmcnt(12)
  s_waitcnt lgkmcnt(5)
  v_mfma_f32_32x32x16_bf16 v[0:15], v[176:179], v[220:223], v[0:15]
  ds_read_b128 v[168:171], v255 offset:2048
  s_waitcnt lgkmcnt(5)
  v_mfma_f32_32x32x16_bf16 v[16:31], v[180:183], v[220:223], v[16:31]
  ds_read_b128 v[172:175], v255 offset:3072
  s_waitcnt lgkmcnt(5)
  v_mfma_f32_32x32x16_bf16 v[32:47], v[184:187], v[220:223], v[32:47]
  ds_read_b128 v[176:179], v255 offset:4096
  s_waitcnt lgkmcnt(5)
  v_mfma_f32_32x32x16_bf16 v[48:63], v[188:191], v[220:223], v[48:63]
  ds_read_b128 v[180:183], v255 offset:5120
  s_waitcnt vmcnt(11)
  s_waitcnt lgkmcnt(5)
  v_mfma_f32_32x32x16_bf16 v[0:15], v[160:163], v[224:227], v[0:15]
  ds_read_b128 v[184:187], v255 offset:6144
  s_waitcnt lgkmcnt(5)
  v_mfma_f32_32x32x16_bf16 v[16:31], v[164:167], v[224:227], v[16:31]
  ds_read_b128 v[188:191], v255 offset:7168
  s_waitcnt lgkmcnt(5)
  v_mfma_f32_32x32x16_bf16 v[32:47], v[168:171], v[224:227], v[32:47]
  ds_read_b128 v[160:163], v255 offset:8192
  s_waitcnt lgkmcnt(5)
  v_mfma_f32_32x32x16_bf16 v[48:63], v[172:175], v[224:227], v[48:63]
  ds_read_b128 v[164:167], v255 offset:9216
  s_waitcnt vmcnt(10)
  s_waitcnt lgkmcnt(5)
  v_mfma_f32_32x32x16_bf16 v[0:15], v[176:179], v[228:231], v[0:15]
  ds_read_b128 v[168:171], v255 offset:10240
  s_waitcnt lgkmcnt(5)
  v_mfma_f32_32x32x16_bf16 v[16:31], v[180:183], v[228:231], v[16:31]
  ds_read_b128 v[172:175], v255 offset:11264
  s_waitcnt lgkmcnt(5)
  v_mfma_f32_32x32x16_bf16 v[32:47], v[184:187], v[228:231], v[32:47]
  ds_read_b128 v[176:179], v255 offset:12288
  s_waitcnt lgkmcnt(5)
  v_mfma_f32_32x32x16_bf16 v[48:63], v[188:191], v[228:231], v[48:63]
  ds_read_b128 v[180:183], v255 offset:13312
  s_waitcnt vmcnt(9)
  s_waitcnt lgkmcnt(5)
  v_mfma_f32_32x32x16_bf16 v[0:15], v[160:163], v[232:235], v[0:15]
  ds_read_b128 v[184:187], v255 offset:14336
  s_waitcnt lgkmcnt(5)
  v_mfma_f32_32x32x16_bf16 v[16:31], v[164:167], v[232:235], v[16:31]
  ds_read_b128 v[188:191], v255 offset:15360
  s_waitcnt lgkmcnt(5)
  v_mfma_f32_32x32x16_bf16 v[32:47], v[168:171], v[232:235], v[32:47]
  ds_read_b128 v[160:163], v255 offset:16384
  s_waitcnt lgkmcnt(5)
  v_mfma_f32_32x32x16_bf16 v[48:63], v[172:175], v[232:235], v[48:63]
  ds_read_b128 v[164:167], v255 offset:17408
  s_waitcnt vmcnt(8)
  s_waitcnt lgkmcnt(5)
  v_mfma_f32_32x32x16_bf16 v[0:15], v[176:179], v[236:239], v[0:15]
  ds_read_b128 v[168:171], v255 offset:18432
  s_waitcnt lgkmcnt(5)
  v_mfma_f32_32x32x16_bf16 v[16:31], v[180:183], v[236:239], v[16:31]
  ds_read_b128 v[172:175], v255 offset:19456
  s_waitcnt lgkmcnt(5)
  v_mfma_f32_32x32x16_bf16 v[32:47], v[184:187], v[236:239], v[32:47]
  ds_read_b128 v[176:179], v255 offset:20480
  s_waitcnt lgkmcnt(5)
  v_mfma_f32_32x32x16_bf16 v[48:63], v[188:191], v[236:239], v[48:63]
  ds_read_b128 v[180:183], v255 offset:21504
  s_waitcnt vmcnt(7)
  s_waitcnt lgkmcnt(5)
  v_mfma_f32_32x32x16_bf16 v[0:15], v[160:163], v[96:99], v[0:15]
  ds_read_b128 v[184:187], v255 offset:22528
  s_waitcnt lgkmcnt(5)
  v_mfma_f32_32x32x16_bf16 v[16:31], v[164:167], v[96:99], v[16:31]
  ds_read_b128 v[188:191], v255 offset:23552
  s_waitcnt lgkmcnt(5)
  v_mfma_f32_32x32x16_bf16 v[32:47], v[168:171], v[96:99], v[32:47]
  ds_read_b128 v[160:163], v255 offset:24576
  s_waitcnt lgkmcnt(5)
  v_mfma_f32_32x32x16_bf16 v[48:63], v[172:175], v[96:99], v[48:63]
  ds_read_b128 v[164:167], v255 offset:25600
  s_waitcnt vmcnt(6)
  s_waitcnt lgkmcnt(5)
  v_mfma_f32_32x32x16_bf16 v[0:15], v[176:179], v[100:103], v[0:15]
  ds_read_b128 v[168:171], v255 offset:26624
  s_waitcnt lgkmcnt(5)
  v_mfma_f32_32x32x16_bf16 v[16:31], v[180:183], v[100:103], v[16:31]
  ds_read_b128 v[172:175], v255 offset:27648
  s_waitcnt lgkmcnt(5)
  v_mfma_f32_32x32x16_bf16 v[32:47], v[184:187], v[100:103], v[32:47]
  ds_read_b128 v[176:179], v255 offset:28672
  s_waitcnt lgkmcnt(5)
  v_mfma_f32_32x32x16_bf16 v[48:63], v[188:191], v[100:103], v[48:63]
  ds_read_b128 v[180:183], v255 offset:29696
  s_waitcnt vmcnt(5)
  s_waitcnt lgkmcnt(5)
  v_mfma_f32_32x32x16_bf16 v[0:15], v[160:163], v[104:107], v[0:15]
  ds_read_b128 v[184:187], v255 offset:30720
  s_waitcnt lgkmcnt(5)
  v_mfma_f32_32x32x16_bf16 v[16:31], v[164:167], v[104:107], v[16:31]
  ds_read_b128 v[188:191], v255 offset:31744
  s_waitcnt lgkmcnt(5)
  v_mfma_f32_32x32x16_bf16 v[32:47], v[168:171], v[104:107], v[32:47]
  ds_read_b128 v[160:163], v246 offset:16384
  s_waitcnt lgkmcnt(5)
  v_mfma_f32_32x32x16_bf16 v[48:63], v[172:175], v[104:107], v[48:63]
  ds_read_b128 v[164:167], v246 offset:17408
  s_waitcnt vmcnt(4)
  s_waitcnt lgkmcnt(5)
  v_mfma_f32_32x32x16_bf16 v[0:15], v[176:179], v[108:111], v[0:15]
  ds_read_b128 v[168:171], v246 offset:18432
  s_waitcnt lgkmcnt(5)
  v_mfma_f32_32x32x16_bf16 v[16:31], v[180:183], v[108:111], v[16:31]
  ds_read_b128 v[172:175], v246 offset:19456
  s_waitcnt lgkmcnt(5)
  v_mfma_f32_32x32x16_bf16 v[32:47], v[184:187], v[108:111], v[32:47]
  ds_read_b128 v[176:179], v246 offset:20480
  s_waitcnt lgkmcnt(5)
  v_mfma_f32_32x32x16_bf16 v[48:63], v[188:191], v[108:111], v[48:63]
  ds_read_b128 v[180:183], v246 offset:21504
  s_waitcnt vmcnt(3)
  s_waitcnt lgkmcnt(5)
  v_mfma_f32_32x32x16_bf16 v[0:15], v[160:163], v[112:115], v[0:15]
  ds_read_b128 v[184:187], v246 offset:22528
  s_waitcnt lgkmcnt(5)
  v_mfma_f32_32x32x16_bf16 v[16:31], v[164:167], v[112:115], v[16:31]
  ds_read_b128 v[188:191], v246 offset:23552
  s_waitcnt lgkmcnt(5)
  v_mfma_f32_32x32x16_bf16 v[32:47], v[168:171], v[112:115], v[32:47]
  ds_read_b128 v[160:163], v246 offset:24576
  s_waitcnt lgkmcnt(5)
  v_mfma_f32_32x32x16_bf16 v[48:63], v[172:175], v[112:115], v[48:63]
  ds_read_b128 v[164:167], v246 offset:25600
  s_waitcnt vmcnt(2)
  s_waitcnt lgkmcnt(5)
  v_mfma_f32_32x32x16_bf16 v[0:15], v[176:179], v[116:119], v[0:15]
  ds_read_b128 v[168:171], v246 offset:26624
  s_waitcnt lgkmcnt(5)
  v_mfma_f32_32x32x16_bf16 v[16:31], v[180:183], v[116:119], v[16:31]
  ds_read_b128 v[172:175], v246 offset:27648
  s_waitcnt lgkmcnt(5)
  v_mfma_f32_32x32x16_bf16 v[32:47], v[184:187], v[116:119], v[32:47]
  ds_read_b128 v[176:179], v246 offset:28672
  s_waitcnt lgkmcnt(5)
  v_mfma_f32_32x32x16_bf16 v[48:63], v[188:191], v[116:119], v[48:63]
  ds_read_b128 v[180:183], v246 offset:29696
  s_waitcnt vmcnt(1)
  s_waitcnt lgkmcnt(5)
  v_mfma_f32_32x32x16_bf16 v[0:15], v[160:163], v[120:123], v[0:15]
  ds_read_b128 v[184:187], v246 offset:30720
  s_waitcnt lgkmcnt(5)
  v_mfma_f32_32x32x16_bf16 v[16:31], v[164:167], v[120:123], v[16:31]
  ds_read_b128 v[188:191], v246 offset:31744
  s_waitcnt lgkmcnt(5)
  v_mfma_f32_32x32x16_bf16 v[32:47], v[168:171], v[120:123], v[32:47]
  s_waitcnt lgkmcnt(4)
  v_mfma_f32_32x32x16_bf16 v[48:63], v[172:175], v[120:123], v[48:63]
  s_waitcnt vmcnt(0)
  s_waitcnt lgkmcnt(3)
  v_mfma_f32_32x32x16_bf16 v[0:15], v[176:179], v[124:127], v[0:15]
  s_waitcnt lgkmcnt(2)
  v_mfma_f32_32x32x16_bf16 v[16:31], v[180:183], v[124:127], v[16:31]
  s_waitcnt lgkmcnt(1)
  v_mfma_f32_32x32x16_bf16 v[32:47], v[184:187], v[124:127], v[32:47]
  s_waitcnt lgkmcnt(0)
  v_mfma_f32_32x32x16_bf16 v[48:63], v[188:191], v[124:127], v[48:63]
  s_add_u32 s16, s60, 64880640
  s_addc_u32 s17, s61, 0
  s_mov_b32 s18, 16777216
  s_mov_b32 s19, 0x20000
  s_lshl_b32 s33, s64, 2
  s_and_b32 s34, s24, 3
  s_add_u32 s33, s33, s34
  s_lshl_b32 s33, s33, 3
  s_lshr_b32 s34, s24, 2
  s_add_u32 s33, s33, s34
  s_lshl_b32 s33, s33, 13
  s_add_u32 s34, s33, 4096
  s_mov_b32 s20, s36
  s_mov_b32 s21, s37
  s_mov_b32 s22, 2097152
  s_mov_b32 s23, 0x20000
  s_lshl_b32 s63, s64, 15
  s_and_b32 s35, s24, 3
  s_lshl_b32 s35, s35, 8
  s_add_u32 s63, s63, s35
  s_lshr_b32 s35, s24, 2
  s_lshl_b32 s35, s35, 5
  s_add_u32 s63, s63, s35
  v_and_b32 v196, 31, v240
  v_lshrrev_b32 v197, 5, v240
  v_lshlrev_b32 v196, 10, v196
  v_lshl_add_u32 v196, v197, 4, v196
  buffer_load_dwordx4 v[192:195], v196, s[20:23], s63 offen
  v_cvt_pk_bf16_f32 v64, v0, v16
  v_cvt_pk_bf16_f32 v65, v1, v17
  v_cvt_pk_bf16_f32 v66, v2, v18
  v_cvt_pk_bf16_f32 v67, v3, v19
  buffer_store_dwordx4 v[64:67], v250, s[16:19], s33 offen offset:0 sc1
  v_cvt_pk_bf16_f32 v68, v4, v20
  v_cvt_pk_bf16_f32 v69, v5, v21
  v_cvt_pk_bf16_f32 v70, v6, v22
  v_cvt_pk_bf16_f32 v71, v7, v23
  buffer_store_dwordx4 v[68:71], v250, s[16:19], s33 offen offset:1024 sc1
  v_cvt_pk_bf16_f32 v72, v8, v24
  v_cvt_pk_bf16_f32 v73, v9, v25
  v_cvt_pk_bf16_f32 v74, v10, v26
  v_cvt_pk_bf16_f32 v75, v11, v27
  buffer_store_dwordx4 v[72:75], v250, s[16:19], s33 offen offset:2048 sc1
  v_cvt_pk_bf16_f32 v76, v12, v28
  v_cvt_pk_bf16_f32 v77, v13, v29
  v_cvt_pk_bf16_f32 v78, v14, v30
  v_cvt_pk_bf16_f32 v79, v15, v31
  buffer_store_dwordx4 v[76:79], v250, s[16:19], s33 offen offset:3072 sc1
  s_nop 1
  v_cvt_pk_bf16_f32 v80, v32, v48
  v_cvt_pk_bf16_f32 v81, v33, v49
  v_cvt_pk_bf16_f32 v82, v34, v50
  v_cvt_pk_bf16_f32 v83, v35, v51
  buffer_store_dwordx4 v[80:83], v250, s[16:19], s34 offen offset:0 sc1
  v_cvt_pk_bf16_f32 v84, v36, v52
  v_cvt_pk_bf16_f32 v85, v37, v53
  v_cvt_pk_bf16_f32 v86, v38, v54
  v_cvt_pk_bf16_f32 v87, v39, v55
  buffer_store_dwordx4 v[84:87], v250, s[16:19], s34 offen offset:1024 sc1
  v_cvt_pk_bf16_f32 v88, v40, v56
  v_cvt_pk_bf16_f32 v89, v41, v57
  v_cvt_pk_bf16_f32 v90, v42, v58
  v_cvt_pk_bf16_f32 v91, v43, v59
  buffer_store_dwordx4 v[88:91], v250, s[16:19], s34 offen offset:2048 sc1
  v_cvt_pk_bf16_f32 v92, v44, v60
  v_cvt_pk_bf16_f32 v93, v45, v61
  v_cvt_pk_bf16_f32 v94, v46, v62
  v_cvt_pk_bf16_f32 v95, v47, v63
  buffer_store_dwordx4 v[92:95], v250, s[16:19], s34 offen offset:3072 sc1
  s_lshl_b32 s66, s25, 2
  s_and_b32 s67, s24, 3
  s_add_u32 s66, s66, s67
  s_lshl_b32 s66, s66, 3
  s_add_u32 s66, s66, s26
  s_lshl_b32 s66, s66, 7
  s_add_u32 s66, s66, 8192
  s_mov_b32 s20, s56
  s_mov_b32 s21, s57
  s_mov_b32 s22, 2097152
  s_mov_b32 s23, 0x20000
  s_and_b32 s33, s33, 0xffff0000
  s_lshr_b32 s35, s24, 2
  s_lshl_b32 s35, s35, 10
  s_add_u32 s33, s33, s35
  v_mov_b32 v252, 1
  s_waitcnt vmcnt(0)
  s_mov_b64 exec, 1
  buffer_atomic_add v252, off, s[96:99], s66 sc1
  s_mov_b64 exec, -1
  buffer_load_dword v251, off, s[96:99], s66 offset:0 sc1
  s_waitcnt vmcnt(0)
  v_readfirstlane_b32 s100, v251
  s_bfe_u32 s100, s100, 524288
  s_cmp_lt_u32 s100, 8
  s_cbranch_scc1 pc_spin14
pc_back14:
  buffer_load_dwordx4 v[160:163], v250, s[16:19], s33 offen sc1
  s_add_u32 s33, s33, 8192
  buffer_load_dwordx4 v[164:167], v250, s[16:19], s33 offen sc1
  s_add_u32 s33, s33, 8192
  buffer_load_dwordx4 v[168:171], v250, s[16:19], s33 offen sc1
  s_add_u32 s33, s33, 8192
  buffer_load_dwordx4 v[172:175], v250, s[16:19], s33 offen sc1
  s_add_u32 s33, s33, 8192
  buffer_load_dwordx4 v[176:179], v250, s[16:19], s33 offen sc1
  s_add_u32 s33, s33, 8192
  buffer_load_dwordx4 v[180:183], v250, s[16:19], s33 offen sc1
  s_add_u32 s33, s33, 8192
  buffer_load_dwordx4 v[184:187], v250, s[16:19], s33 offen sc1
  s_add_u32 s33, s33, 8192
  buffer_load_dwordx4 v[188:191], v250, s[16:19], s33 offen sc1
  s_add_u32 s33, s33, 8192
  s_waitcnt vmcnt(7)
  v_lshlrev_b32 v0, 16, v160
  v_and_b32 v1, 0xffff0000, v160
  v_lshlrev_b32 v2, 16, v161
  v_and_b32 v3, 0xffff0000, v161
  v_lshlrev_b32 v4, 16, v162
  v_and_b32 v5, 0xffff0000, v162
  v_lshlrev_b32 v6, 16, v163
  v_and_b32 v7, 0xffff0000, v163
  s_waitcnt vmcnt(6)
  v_lshlrev_b32 v12, 16, v164
  v_and_b32 v13, 0xffff0000, v164
  v_add_f32 v0, v0, v12
  v_add_f32 v1, v1, v13
  v_lshlrev_b32 v12, 16, v165
  v_and_b32 v13, 0xffff0000, v165
  v_add_f32 v2, v2, v12
  v_add_f32 v3, v3, v13
  v_lshlrev_b32 v12, 16, v166
  v_and_b32 v13, 0xffff0000, v166
  v_add_f32 v4, v4, v12
  v_add_f32 v5, v5, v13
  v_lshlrev_b32 v12, 16, v167
  v_and_b32 v13, 0xffff0000, v167
  v_add_f32 v6, v6, v12
  v_add_f32 v7, v7, v13
  s_waitcnt vmcnt(5)
  v_lshlrev_b32 v12, 16, v168
  v_and_b32 v13, 0xffff0000, v168
  v_add_f32 v0, v0, v12
  v_add_f32 v1, v1, v13
  v_lshlrev_b32 v12, 16, v169
  v_and_b32 v13, 0xffff0000, v169
  v_add_f32 v2, v2, v12
  v_add_f32 v3, v3, v13
  v_lshlrev_b32 v12, 16, v170
  v_and_b32 v13, 0xffff0000, v170
  v_add_f32 v4, v4, v12
  v_add_f32 v5, v5, v13
  v_lshlrev_b32 v12, 16, v171
  v_and_b32 v13, 0xffff0000, v171
  v_add_f32 v6, v6, v12
  v_add_f32 v7, v7, v13
  s_waitcnt vmcnt(4)
  v_lshlrev_b32 v12, 16, v172
  v_and_b32 v13, 0xffff0000, v172
  v_add_f32 v0, v0, v12
  v_add_f32 v1, v1, v13
  v_lshlrev_b32 v12, 16, v173
  v_and_b32 v13, 0xffff0000, v173
  v_add_f32 v2, v2, v12
  v_add_f32 v3, v3, v13
  v_lshlrev_b32 v12, 16, v174
  v_and_b32 v13, 0xffff0000, v174
  v_add_f32 v4, v4, v12
  v_add_f32 v5, v5, v13
  v_lshlrev_b32 v12, 16, v175
  v_and_b32 v13, 0xffff0000, v175
  v_add_f32 v6, v6, v12
  v_add_f32 v7, v7, v13
  s_waitcnt vmcnt(3)
  v_lshlrev_b32 v12, 16, v176
  v_and_b32 v13, 0xffff0000, v176
  v_add_f32 v0, v0, v12
  v_add_f32 v1, v1, v13
  v_lshlrev_b32 v12, 16, v177
  v_and_b32 v13, 0xffff0000, v177
  v_add_f32 v2, v2, v12
  v_add_f32 v3, v3, v13
  v_lshlrev_b32 v12, 16, v178
  v_and_b32 v13, 0xffff0000, v178
  v_add_f32 v4, v4, v12
  v_add_f32 v5, v5, v13
  v_lshlrev_b32 v12, 16, v179
  v_and_b32 v13, 0xffff0000, v179
  v_add_f32 v6, v6, v12
  v_add_f32 v7, v7, v13
  s_waitcnt vmcnt(2)
  v_lshlrev_b32 v12, 16, v180
  v_and_b32 v13, 0xffff0000, v180
  v_add_f32 v0, v0, v12
  v_add_f32 v1, v1, v13
  v_lshlrev_b32 v12, 16, v181
  v_and_b32 v13, 0xffff0000, v181
  v_add_f32 v2, v2, v12
  v_add_f32 v3, v3, v13
  v_lshlrev_b32 v12, 16, v182
  v_and_b32 v13, 0xffff0000, v182
  v_add_f32 v4, v4, v12
  v_add_f32 v5, v5, v13
  v_lshlrev_b32 v12, 16, v183
  v_and_b32 v13, 0xffff0000, v183
  v_add_f32 v6, v6, v12
  v_add_f32 v7, v7, v13
  s_waitcnt vmcnt(1)
  v_lshlrev_b32 v12, 16, v184
  v_and_b32 v13, 0xffff0000, v184
  v_add_f32 v0, v0, v12
  v_add_f32 v1, v1, v13
  v_lshlrev_b32 v12, 16, v185
  v_and_b32 v13, 0xffff0000, v185
  v_add_f32 v2, v2, v12
  v_add_f32 v3, v3, v13
  v_lshlrev_b32 v12, 16, v186
  v_and_b32 v13, 0xffff0000, v186
  v_add_f32 v4, v4, v12
  v_add_f32 v5, v5, v13
  v_lshlrev_b32 v12, 16, v187
  v_and_b32 v13, 0xffff0000, v187
  v_add_f32 v6, v6, v12
  v_add_f32 v7, v7, v13
  s_waitcnt vmcnt(0)
  v_lshlrev_b32 v12, 16, v188
  v_and_b32 v13, 0xffff0000, v188
  v_add_f32 v0, v0, v12
  v_add_f32 v1, v1, v13
  v_lshlrev_b32 v12, 16, v189
  v_and_b32 v13, 0xffff0000, v189
  v_add_f32 v2, v2, v12
  v_add_f32 v3, v3, v13
  v_lshlrev_b32 v12, 16, v190
  v_and_b32 v13, 0xffff0000, v190
  v_add_f32 v4, v4, v12
  v_add_f32 v5, v5, v13
  v_lshlrev_b32 v12, 16, v191
  v_and_b32 v13, 0xffff0000, v191
  v_add_f32 v6, v6, v12
  v_add_f32 v7, v7, v13
  v_lshlrev_b32 v12, 16, v192
  v_and_b32 v13, 0xffff0000, v192
  v_add_f32 v0, v0, v12
  v_add_f32 v1, v1, v13
  v_lshlrev_b32 v12, 16, v193
  v_and_b32 v13, 0xffff0000, v193
  v_add_f32 v2, v2, v12
  v_add_f32 v3, v3, v13
  v_lshlrev_b32 v12, 16, v194
  v_and_b32 v13, 0xffff0000, v194
  v_add_f32 v4, v4, v12
  v_add_f32 v5, v5, v13
  v_lshlrev_b32 v12, 16, v195
  v_and_b32 v13, 0xffff0000, v195
  v_add_f32 v6, v6, v12
  v_add_f32 v7, v7, v13
  v_cvt_pk_bf16_f32 v8, v0, v1
  v_cvt_pk_bf16_f32 v9, v2, v3
  v_cvt_pk_bf16_f32 v10, v4, v5
  v_cvt_pk_bf16_f32 v11, v6, v7
  buffer_store_dwordx4 v[8:11], v196, s[20:23], s63 offen
parallel_sum__compressed_kv_cla__glu_gated_geglu__prompt_kernel_end:
  s_endpgm
slow_An0:
  s_nop 15
  v_max3_f32 v210, v96, v97, v98
  v_max3_f32 v210, v210, v99, v100
  v_max3_f32 v210, v210, v101, v102
  v_max3_f32 v210, v210, v103, v104
  v_max3_f32 v210, v210, v105, v106
  v_max3_f32 v210, v210, v107, v108
  v_max3_f32 v210, v210, v109, v110
  v_max_f32 v210, v210, v111
  v_mov_b32 v211, v210
  s_nop 1
  v_permlane32_swap_b32 v210, v211
  s_nop 1
  v_max_f32 v210, v210, v211
  v_max_f32 v210, 0, v210
  v_sub_f32 v211, 0, v210
  v_exp_f32 v211, v211
  v_sub_f32 v96, v96, v210
  v_sub_f32 v112, v112, v210
  v_sub_f32 v144, v144, v210
  v_sub_f32 v97, v97, v210
  v_sub_f32 v113, v113, v210
  v_sub_f32 v145, v145, v210
  v_sub_f32 v98, v98, v210
  v_sub_f32 v114, v114, v210
  v_sub_f32 v146, v146, v210
  v_sub_f32 v99, v99, v210
  v_sub_f32 v115, v115, v210
  v_sub_f32 v147, v147, v210
  v_sub_f32 v100, v100, v210
  v_sub_f32 v116, v116, v210
  v_sub_f32 v148, v148, v210
  v_sub_f32 v101, v101, v210
  v_sub_f32 v117, v117, v210
  v_sub_f32 v149, v149, v210
  v_sub_f32 v102, v102, v210
  v_sub_f32 v118, v118, v210
  v_sub_f32 v150, v150, v210
  v_sub_f32 v103, v103, v210
  v_sub_f32 v119, v119, v210
  v_sub_f32 v151, v151, v210
  v_sub_f32 v104, v104, v210
  v_sub_f32 v120, v120, v210
  v_sub_f32 v152, v152, v210
  v_sub_f32 v105, v105, v210
  v_sub_f32 v121, v121, v210
  v_sub_f32 v153, v153, v210
  v_sub_f32 v106, v106, v210
  v_sub_f32 v122, v122, v210
  v_sub_f32 v154, v154, v210
  v_sub_f32 v107, v107, v210
  v_sub_f32 v123, v123, v210
  v_sub_f32 v155, v155, v210
  v_sub_f32 v108, v108, v210
  v_sub_f32 v124, v124, v210
  v_sub_f32 v156, v156, v210
  v_sub_f32 v109, v109, v210
  v_sub_f32 v125, v125, v210
  v_sub_f32 v157, v157, v210
  v_sub_f32 v110, v110, v210
  v_sub_f32 v126, v126, v210
  v_sub_f32 v158, v158, v210
  v_sub_f32 v111, v111, v210
  v_sub_f32 v127, v127, v210
  v_sub_f32 v159, v159, v210
  v_mul_f32 v200, v200, v211
  v_mul_f32 v0, v0, v211
  v_mul_f32 v1, v1, v211
  v_mul_f32 v2, v2, v211
  v_mul_f32 v3, v3, v211
  v_mul_f32 v4, v4, v211
  v_mul_f32 v5, v5, v211
  v_mul_f32 v6, v6, v211
  v_mul_f32 v7, v7, v211
  v_mul_f32 v8, v8, v211
  v_mul_f32 v9, v9, v211
  v_mul_f32 v10, v10, v211
  v_mul_f32 v11, v11, v211
  v_mul_f32 v12, v12, v211
  v_mul_f32 v13, v13, v211
  v_mul_f32 v14, v14, v211
  v_mul_f32 v15, v15, v211
  v_mul_f32 v16, v16, v211
  v_mul_f32 v17, v17, v211
  v_mul_f32 v18, v18, v211
  v_mul_f32 v19, v19, v211
  v_mul_f32 v20, v20, v211
  v_mul_f32 v21, v21, v211
  v_mul_f32 v22, v22, v211
  v_mul_f32 v23, v23, v211
  v_mul_f32 v24, v24, v211
  v_mul_f32 v25, v25, v211
  v_mul_f32 v26, v26, v211
  v_mul_f32 v27, v27, v211
  v_mul_f32 v28, v28, v211
  v_mul_f32 v29, v29, v211
  v_mul_f32 v30, v30, v211
  v_mul_f32 v31, v31, v211
  v_mul_f32 v32, v32, v211
  v_mul_f32 v33, v33, v211
  v_mul_f32 v34, v34, v211
  v_mul_f32 v35, v35, v211
  v_mul_f32 v36, v36, v211
  v_mul_f32 v37, v37, v211
  v_mul_f32 v38, v38, v211
  v_mul_f32 v39, v39, v211
  v_mul_f32 v40, v40, v211
  v_mul_f32 v41, v41, v211
  v_mul_f32 v42, v42, v211
  v_mul_f32 v43, v43, v211
  v_mul_f32 v44, v44, v211
  v_mul_f32 v45, v45, v211
  v_mul_f32 v46, v46, v211
  v_mul_f32 v47, v47, v211
  v_mul_f32 v48, v48, v211
  v_mul_f32 v49, v49, v211
  v_mul_f32 v50, v50, v211
  v_mul_f32 v51, v51, v211
  v_mul_f32 v52, v52, v211
  v_mul_f32 v53, v53, v211
  v_mul_f32 v54, v54, v211
  v_mul_f32 v55, v55, v211
  v_mul_f32 v56, v56, v211
  v_mul_f32 v57, v57, v211
  v_mul_f32 v58, v58, v211
  v_mul_f32 v59, v59, v211
  v_mul_f32 v60, v60, v211
  v_mul_f32 v61, v61, v211
  v_mul_f32 v62, v62, v211
  v_mul_f32 v63, v63, v211
  v_exp_f32 v192, v96
  v_exp_f32 v193, v97
  v_exp_f32 v194, v98
  v_add_f32 v201, v192, v193
  v_cvt_pk_bf16_f32 v128, v192, v193
  v_exp_f32 v195, v99
  v_add_f32 v201, v201, v194
  v_exp_f32 v196, v100
  v_add_f32 v201, v201, v195
  v_cvt_pk_bf16_f32 v129, v194, v195
  v_exp_f32 v197, v101
  v_add_f32 v201, v201, v196
  v_exp_f32 v198, v102
  v_add_f32 v201, v201, v197
  v_cvt_pk_bf16_f32 v130, v196, v197
  v_exp_f32 v199, v103
  v_add_f32 v201, v201, v198
  v_exp_f32 v192, v104
  v_add_f32 v201, v201, v199
  v_cvt_pk_bf16_f32 v131, v198, v199
  v_exp_f32 v193, v105
  v_add_f32 v201, v201, v192
  v_exp_f32 v194, v106
  v_add_f32 v201, v201, v193
  v_cvt_pk_bf16_f32 v132, v192, v193
  v_exp_f32 v195, v107
  v_add_f32 v201, v201, v194
  v_exp_f32 v196, v108
  v_add_f32 v201, v201, v195
  v_cvt_pk_bf16_f32 v133, v194, v195
  v_exp_f32 v197, v109
  v_add_f32 v201, v201, v196
  v_exp_f32 v198, v110
  v_add_f32 v201, v201, v197
  v_cvt_pk_bf16_f32 v134, v196, v197
  v_exp_f32 v199, v111
  v_add_f32 v201, v201, v198
  s_nop 0
  v_add_f32 v201, v201, v199
  v_cvt_pk_bf16_f32 v135, v198, v199
  s_nop 1
  s_branch back_An0
slow_An1:
  s_nop 15
  v_max3_f32 v210, v112, v113, v114
  v_max3_f32 v210, v210, v115, v116
  v_max3_f32 v210, v210, v117, v118
  v_max3_f32 v210, v210, v119, v120
  v_max3_f32 v210, v210, v121, v122
  v_max3_f32 v210, v210, v123, v124
  v_max3_f32 v210, v210, v125, v126
  v_max_f32 v210, v210, v127
  v_mov_b32 v211, v210
  s_nop 1
  v_permlane32_swap_b32 v210, v211
  s_nop 1
  v_max_f32 v210, v210, v211
  v_max_f32 v210, 0, v210
  v_sub_f32 v211, 0, v210
  v_exp_f32 v211, v211
  v_sub_f32 v112, v112, v210
  v_sub_f32 v96, v96, v210
  v_sub_f32 v144, v144, v210
  v_sub_f32 v113, v113, v210
  v_sub_f32 v97, v97, v210
  v_sub_f32 v145, v145, v210
  v_sub_f32 v114, v114, v210
  v_sub_f32 v98, v98, v210
  v_sub_f32 v146, v146, v210
  v_sub_f32 v115, v115, v210
  v_sub_f32 v99, v99, v210
  v_sub_f32 v147, v147, v210
  v_sub_f32 v116, v116, v210
  v_sub_f32 v100, v100, v210
  v_sub_f32 v148, v148, v210
  v_sub_f32 v117, v117, v210
  v_sub_f32 v101, v101, v210
  v_sub_f32 v149, v149, v210
  v_sub_f32 v118, v118, v210
  v_sub_f32 v102, v102, v210
  v_sub_f32 v150, v150, v210
  v_sub_f32 v119, v119, v210
  v_sub_f32 v103, v103, v210
  v_sub_f32 v151, v151, v210
  v_sub_f32 v120, v120, v210
  v_sub_f32 v104, v104, v210
  v_sub_f32 v152, v152, v210
  v_sub_f32 v121, v121, v210
  v_sub_f32 v105, v105, v210
  v_sub_f32 v153, v153, v210
  v_sub_f32 v122, v122, v210
  v_sub_f32 v106, v106, v210
  v_sub_f32 v154, v154, v210
  v_sub_f32 v123, v123, v210
  v_sub_f32 v107, v107, v210
  v_sub_f32 v155, v155, v210
  v_sub_f32 v124, v124, v210
  v_sub_f32 v108, v108, v210
  v_sub_f32 v156, v156, v210
  v_sub_f32 v125, v125, v210
  v_sub_f32 v109, v109, v210
  v_sub_f32 v157, v157, v210
  v_sub_f32 v126, v126, v210
  v_sub_f32 v110, v110, v210
  v_sub_f32 v158, v158, v210
  v_sub_f32 v127, v127, v210
  v_sub_f32 v111, v111, v210
  v_sub_f32 v159, v159, v210
  v_mul_f32 v200, v200, v211
  v_mul_f32 v0, v0, v211
  v_mul_f32 v1, v1, v211
  v_mul_f32 v2, v2, v211
  v_mul_f32 v3, v3, v211
  v_mul_f32 v4, v4, v211
  v_mul_f32 v5, v5, v211
  v_mul_f32 v6, v6, v211
  v_mul_f32 v7, v7, v211
  v_mul_f32 v8, v8, v211
  v_mul_f32 v9, v9, v211
  v_mul_f32 v10, v10, v211
  v_mul_f32 v11, v11, v211
  v_mul_f32 v12, v12, v211
  v_mul_f32 v13, v13, v211
  v_mul_f32 v14, v14, v211
  v_mul_f32 v15, v15, v211
  v_mul_f32 v16, v16, v211
  v_mul_f32 v17, v17, v211
  v_mul_f32 v18, v18, v211
  v_mul_f32 v19, v19, v211
  v_mul_f32 v20, v20, v211
  v_mul_f32 v21, v21, v211
  v_mul_f32 v22, v22, v211
  v_mul_f32 v23, v23, v211
  v_mul_f32 v24, v24, v211
  v_mul_f32 v25, v25, v211
  v_mul_f32 v26, v26, v211
  v_mul_f32 v27, v27, v211
  v_mul_f32 v28, v28, v211
  v_mul_f32 v29, v29, v211
  v_mul_f32 v30, v30, v211
  v_mul_f32 v31, v31, v211
  v_mul_f32 v32, v32, v211
  v_mul_f32 v33, v33, v211
  v_mul_f32 v34, v34, v211
  v_mul_f32 v35, v35, v211
  v_mul_f32 v36, v36, v211
  v_mul_f32 v37, v37, v211
  v_mul_f32 v38, v38, v211
  v_mul_f32 v39, v39, v211
  v_mul_f32 v40, v40, v211
  v_mul_f32 v41, v41, v211
  v_mul_f32 v42, v42, v211
  v_mul_f32 v43, v43, v211
  v_mul_f32 v44, v44, v211
  v_mul_f32 v45, v45, v211
  v_mul_f32 v46, v46, v211
  v_mul_f32 v47, v47, v211
  v_mul_f32 v48, v48, v211
  v_mul_f32 v49, v49, v211
  v_mul_f32 v50, v50, v211
  v_mul_f32 v51, v51, v211
  v_mul_f32 v52, v52, v211
  v_mul_f32 v53, v53, v211
  v_mul_f32 v54, v54, v211
  v_mul_f32 v55, v55, v211
  v_mul_f32 v56, v56, v211
  v_mul_f32 v57, v57, v211
  v_mul_f32 v58, v58, v211
  v_mul_f32 v59, v59, v211
  v_mul_f32 v60, v60, v211
  v_mul_f32 v61, v61, v211
  v_mul_f32 v62, v62, v211
  v_mul_f32 v63, v63, v211
  v_exp_f32 v192, v112
  v_exp_f32 v193, v113
  v_exp_f32 v194, v114
  v_add_f32 v201, v192, v193
  v_cvt_pk_bf16_f32 v136, v192, v193
  v_exp_f32 v195, v115
  v_add_f32 v201, v201, v194
  v_exp_f32 v196, v116
  v_add_f32 v201, v201, v195
  v_cvt_pk_bf16_f32 v137, v194, v195
  v_exp_f32 v197, v117
  v_add_f32 v201, v201, v196
  v_exp_f32 v198, v118
  v_add_f32 v201, v201, v197
  v_cvt_pk_bf16_f32 v138, v196, v197
  v_exp_f32 v199, v119
  v_add_f32 v201, v201, v198
  v_exp_f32 v192, v120
  v_add_f32 v201, v201, v199
  v_cvt_pk_bf16_f32 v139, v198, v199
  v_exp_f32 v193, v121
  v_add_f32 v201, v201, v192
  v_exp_f32 v194, v122
  v_add_f32 v201, v201, v193
  v_cvt_pk_bf16_f32 v140, v192, v193
  v_exp_f32 v195, v123
  v_add_f32 v201, v201, v194
  v_exp_f32 v196, v124
  v_add_f32 v201, v201, v195
  v_cvt_pk_bf16_f32 v141, v194, v195
  v_exp_f32 v197, v125
  v_add_f32 v201, v201, v196
  v_exp_f32 v198, v126
  v_add_f32 v201, v201, v197
  v_cvt_pk_bf16_f32 v142, v196, v197
  v_exp_f32 v199, v127
  v_add_f32 v201, v201, v198
  s_nop 0
  v_add_f32 v201, v201, v199
  v_cvt_pk_bf16_f32 v143, v198, v199
  s_nop 1
  s_branch back_An1
slow_An2:
  s_nop 15
  v_max3_f32 v210, v96, v97, v98
  v_max3_f32 v210, v210, v99, v100
  v_max3_f32 v210, v210, v101, v102
  v_max3_f32 v210, v210, v103, v104
  v_max3_f32 v210, v210, v105, v106
  v_max3_f32 v210, v210, v107, v108
  v_max3_f32 v210, v210, v109, v110
  v_max_f32 v210, v210, v111
  v_mov_b32 v211, v210
  s_nop 1
  v_permlane32_swap_b32 v210, v211
  s_nop 1
  v_max_f32 v210, v210, v211
  v_max_f32 v210, 0, v210
  v_sub_f32 v211, 0, v210
  v_exp_f32 v211, v211
  v_sub_f32 v96, v96, v210
  v_sub_f32 v112, v112, v210
  v_sub_f32 v144, v144, v210
  v_sub_f32 v97, v97, v210
  v_sub_f32 v113, v113, v210
  v_sub_f32 v145, v145, v210
  v_sub_f32 v98, v98, v210
  v_sub_f32 v114, v114, v210
  v_sub_f32 v146, v146, v210
  v_sub_f32 v99, v99, v210
  v_sub_f32 v115, v115, v210
  v_sub_f32 v147, v147, v210
  v_sub_f32 v100, v100, v210
  v_sub_f32 v116, v116, v210
  v_sub_f32 v148, v148, v210
  v_sub_f32 v101, v101, v210
  v_sub_f32 v117, v117, v210
  v_sub_f32 v149, v149, v210
  v_sub_f32 v102, v102, v210
  v_sub_f32 v118, v118, v210
  v_sub_f32 v150, v150, v210
  v_sub_f32 v103, v103, v210
  v_sub_f32 v119, v119, v210
  v_sub_f32 v151, v151, v210
  v_sub_f32 v104, v104, v210
  v_sub_f32 v120, v120, v210
  v_sub_f32 v152, v152, v210
  v_sub_f32 v105, v105, v210
  v_sub_f32 v121, v121, v210
  v_sub_f32 v153, v153, v210
  v_sub_f32 v106, v106, v210
  v_sub_f32 v122, v122, v210
  v_sub_f32 v154, v154, v210
  v_sub_f32 v107, v107, v210
  v_sub_f32 v123, v123, v210
  v_sub_f32 v155, v155, v210
  v_sub_f32 v108, v108, v210
  v_sub_f32 v124, v124, v210
  v_sub_f32 v156, v156, v210
  v_sub_f32 v109, v109, v210
  v_sub_f32 v125, v125, v210
  v_sub_f32 v157, v157, v210
  v_sub_f32 v110, v110, v210
  v_sub_f32 v126, v126, v210
  v_sub_f32 v158, v158, v210
  v_sub_f32 v111, v111, v210
  v_sub_f32 v127, v127, v210
  v_sub_f32 v159, v159, v210
  v_mul_f32 v200, v200, v211
  v_mul_f32 v0, v0, v211
  v_mul_f32 v1, v1, v211
  v_mul_f32 v2, v2, v211
  v_mul_f32 v3, v3, v211
  v_mul_f32 v4, v4, v211
  v_mul_f32 v5, v5, v211
  v_mul_f32 v6, v6, v211
  v_mul_f32 v7, v7, v211
  v_mul_f32 v8, v8, v211
  v_mul_f32 v9, v9, v211
  v_mul_f32 v10, v10, v211
  v_mul_f32 v11, v11, v211
  v_mul_f32 v12, v12, v211
  v_mul_f32 v13, v13, v211
  v_mul_f32 v14, v14, v211
  v_mul_f32 v15, v15, v211
  v_mul_f32 v16, v16, v211
  v_mul_f32 v17, v17, v211
  v_mul_f32 v18, v18, v211
  v_mul_f32 v19, v19, v211
  v_mul_f32 v20, v20, v211
  v_mul_f32 v21, v21, v211
  v_mul_f32 v22, v22, v211
  v_mul_f32 v23, v23, v211
  v_mul_f32 v24, v24, v211
  v_mul_f32 v25, v25, v211
  v_mul_f32 v26, v26, v211
  v_mul_f32 v27, v27, v211
  v_mul_f32 v28, v28, v211
  v_mul_f32 v29, v29, v211
  v_mul_f32 v30, v30, v211
  v_mul_f32 v31, v31, v211
  v_mul_f32 v32, v32, v211
  v_mul_f32 v33, v33, v211
  v_mul_f32 v34, v34, v211
  v_mul_f32 v35, v35, v211
  v_mul_f32 v36, v36, v211
  v_mul_f32 v37, v37, v211
  v_mul_f32 v38, v38, v211
  v_mul_f32 v39, v39, v211
  v_mul_f32 v40, v40, v211
  v_mul_f32 v41, v41, v211
  v_mul_f32 v42, v42, v211
  v_mul_f32 v43, v43, v211
  v_mul_f32 v44, v44, v211
  v_mul_f32 v45, v45, v211
  v_mul_f32 v46, v46, v211
  v_mul_f32 v47, v47, v211
  v_mul_f32 v48, v48, v211
  v_mul_f32 v49, v49, v211
  v_mul_f32 v50, v50, v211
  v_mul_f32 v51, v51, v211
  v_mul_f32 v52, v52, v211
  v_mul_f32 v53, v53, v211
  v_mul_f32 v54, v54, v211
  v_mul_f32 v55, v55, v211
  v_mul_f32 v56, v56, v211
  v_mul_f32 v57, v57, v211
  v_mul_f32 v58, v58, v211
  v_mul_f32 v59, v59, v211
  v_mul_f32 v60, v60, v211
  v_mul_f32 v61, v61, v211
  v_mul_f32 v62, v62, v211
  v_mul_f32 v63, v63, v211
  v_exp_f32 v192, v96
  v_exp_f32 v193, v97
  v_exp_f32 v194, v98
  v_add_f32 v201, v192, v193
  v_cvt_pk_bf16_f32 v128, v192, v193
  v_exp_f32 v195, v99
  v_add_f32 v201, v201, v194
  v_exp_f32 v196, v100
  v_add_f32 v201, v201, v195
  v_cvt_pk_bf16_f32 v129, v194, v195
  v_exp_f32 v197, v101
  v_add_f32 v201, v201, v196
  v_exp_f32 v198, v102
  v_add_f32 v201, v201, v197
  v_cvt_pk_bf16_f32 v130, v196, v197
  v_exp_f32 v199, v103
  v_add_f32 v201, v201, v198
  v_exp_f32 v192, v104
  v_add_f32 v201, v201, v199
  v_cvt_pk_bf16_f32 v131, v198, v199
  v_exp_f32 v193, v105
  v_add_f32 v201, v201, v192
  v_exp_f32 v194, v106
  v_add_f32 v201, v201, v193
  v_cvt_pk_bf16_f32 v132, v192, v193
  v_exp_f32 v195, v107
  v_add_f32 v201, v201, v194
  v_exp_f32 v196, v108
  v_add_f32 v201, v201, v195
  v_cvt_pk_bf16_f32 v133, v194, v195
  v_exp_f32 v197, v109
  v_add_f32 v201, v201, v196
  v_exp_f32 v198, v110
  v_add_f32 v201, v201, v197
  v_cvt_pk_bf16_f32 v134, v196, v197
  v_exp_f32 v199, v111
  v_add_f32 v201, v201, v198
  s_nop 0
  v_add_f32 v201, v201, v199
  v_cvt_pk_bf16_f32 v135, v198, v199
  s_nop 1
  s_branch back_An2
slow_An3:
  s_nop 15
  v_max3_f32 v210, v112, v113, v114
  v_max3_f32 v210, v210, v115, v116
  v_max3_f32 v210, v210, v117, v118
  v_max3_f32 v210, v210, v119, v120
  v_max3_f32 v210, v210, v121, v122
  v_max3_f32 v210, v210, v123, v124
  v_max3_f32 v210, v210, v125, v126
  v_max_f32 v210, v210, v127
  v_mov_b32 v211, v210
  s_nop 1
  v_permlane32_swap_b32 v210, v211
  s_nop 1
  v_max_f32 v210, v210, v211
  v_max_f32 v210, 0, v210
  v_sub_f32 v211, 0, v210
  v_exp_f32 v211, v211
  v_sub_f32 v112, v112, v210
  v_sub_f32 v96, v96, v210
  v_sub_f32 v144, v144, v210
  v_sub_f32 v113, v113, v210
  v_sub_f32 v97, v97, v210
  v_sub_f32 v145, v145, v210
  v_sub_f32 v114, v114, v210
  v_sub_f32 v98, v98, v210
  v_sub_f32 v146, v146, v210
  v_sub_f32 v115, v115, v210
  v_sub_f32 v99, v99, v210
  v_sub_f32 v147, v147, v210
  v_sub_f32 v116, v116, v210
  v_sub_f32 v100, v100, v210
  v_sub_f32 v148, v148, v210
  v_sub_f32 v117, v117, v210
  v_sub_f32 v101, v101, v210
  v_sub_f32 v149, v149, v210
  v_sub_f32 v118, v118, v210
  v_sub_f32 v102, v102, v210
  v_sub_f32 v150, v150, v210
  v_sub_f32 v119, v119, v210
  v_sub_f32 v103, v103, v210
  v_sub_f32 v151, v151, v210
  v_sub_f32 v120, v120, v210
  v_sub_f32 v104, v104, v210
  v_sub_f32 v152, v152, v210
  v_sub_f32 v121, v121, v210
  v_sub_f32 v105, v105, v210
  v_sub_f32 v153, v153, v210
  v_sub_f32 v122, v122, v210
  v_sub_f32 v106, v106, v210
  v_sub_f32 v154, v154, v210
  v_sub_f32 v123, v123, v210
  v_sub_f32 v107, v107, v210
  v_sub_f32 v155, v155, v210
  v_sub_f32 v124, v124, v210
  v_sub_f32 v108, v108, v210
  v_sub_f32 v156, v156, v210
  v_sub_f32 v125, v125, v210
  v_sub_f32 v109, v109, v210
  v_sub_f32 v157, v157, v210
  v_sub_f32 v126, v126, v210
  v_sub_f32 v110, v110, v210
  v_sub_f32 v158, v158, v210
  v_sub_f32 v127, v127, v210
  v_sub_f32 v111, v111, v210
  v_sub_f32 v159, v159, v210
  v_mul_f32 v200, v200, v211
  v_mul_f32 v0, v0, v211
  v_mul_f32 v1, v1, v211
  v_mul_f32 v2, v2, v211
  v_mul_f32 v3, v3, v211
  v_mul_f32 v4, v4, v211
  v_mul_f32 v5, v5, v211
  v_mul_f32 v6, v6, v211
  v_mul_f32 v7, v7, v211
  v_mul_f32 v8, v8, v211
  v_mul_f32 v9, v9, v211
  v_mul_f32 v10, v10, v211
  v_mul_f32 v11, v11, v211
  v_mul_f32 v12, v12, v211
  v_mul_f32 v13, v13, v211
  v_mul_f32 v14, v14, v211
  v_mul_f32 v15, v15, v211
  v_mul_f32 v16, v16, v211
  v_mul_f32 v17, v17, v211
  v_mul_f32 v18, v18, v211
  v_mul_f32 v19, v19, v211
  v_mul_f32 v20, v20, v211
  v_mul_f32 v21, v21, v211
  v_mul_f32 v22, v22, v211
  v_mul_f32 v23, v23, v211
  v_mul_f32 v24, v24, v211
  v_mul_f32 v25, v25, v211
  v_mul_f32 v26, v26, v211
  v_mul_f32 v27, v27, v211
  v_mul_f32 v28, v28, v211
  v_mul_f32 v29, v29, v211
  v_mul_f32 v30, v30, v211
  v_mul_f32 v31, v31, v211
  v_mul_f32 v32, v32, v211
  v_mul_f32 v33, v33, v211
  v_mul_f32 v34, v34, v211
  v_mul_f32 v35, v35, v211
  v_mul_f32 v36, v36, v211
  v_mul_f32 v37, v37, v211
  v_mul_f32 v38, v38, v211
  v_mul_f32 v39, v39, v211
  v_mul_f32 v40, v40, v211
  v_mul_f32 v41, v41, v211
  v_mul_f32 v42, v42, v211
  v_mul_f32 v43, v43, v211
  v_mul_f32 v44, v44, v211
  v_mul_f32 v45, v45, v211
  v_mul_f32 v46, v46, v211
  v_mul_f32 v47, v47, v211
  v_mul_f32 v48, v48, v211
  v_mul_f32 v49, v49, v211
  v_mul_f32 v50, v50, v211
  v_mul_f32 v51, v51, v211
  v_mul_f32 v52, v52, v211
  v_mul_f32 v53, v53, v211
  v_mul_f32 v54, v54, v211
  v_mul_f32 v55, v55, v211
  v_mul_f32 v56, v56, v211
  v_mul_f32 v57, v57, v211
  v_mul_f32 v58, v58, v211
  v_mul_f32 v59, v59, v211
  v_mul_f32 v60, v60, v211
  v_mul_f32 v61, v61, v211
  v_mul_f32 v62, v62, v211
  v_mul_f32 v63, v63, v211
  v_exp_f32 v192, v112
  v_exp_f32 v193, v113
  v_exp_f32 v194, v114
  v_add_f32 v201, v192, v193
  v_cvt_pk_bf16_f32 v136, v192, v193
  v_exp_f32 v195, v115
  v_add_f32 v201, v201, v194
  v_exp_f32 v196, v116
  v_add_f32 v201, v201, v195
  v_cvt_pk_bf16_f32 v137, v194, v195
  v_exp_f32 v197, v117
  v_add_f32 v201, v201, v196
  v_exp_f32 v198, v118
  v_add_f32 v201, v201, v197
  v_cvt_pk_bf16_f32 v138, v196, v197
  v_exp_f32 v199, v119
  v_add_f32 v201, v201, v198
  v_exp_f32 v192, v120
  v_add_f32 v201, v201, v199
  v_cvt_pk_bf16_f32 v139, v198, v199
  v_exp_f32 v193, v121
  v_add_f32 v201, v201, v192
  v_exp_f32 v194, v122
  v_add_f32 v201, v201, v193
  v_cvt_pk_bf16_f32 v140, v192, v193
  v_exp_f32 v195, v123
  v_add_f32 v201, v201, v194
  v_exp_f32 v196, v124
  v_add_f32 v201, v201, v195
  v_cvt_pk_bf16_f32 v141, v194, v195
  v_exp_f32 v197, v125
  v_add_f32 v201, v201, v196
  v_exp_f32 v198, v126
  v_add_f32 v201, v201, v197
  v_cvt_pk_bf16_f32 v142, v196, v197
  v_exp_f32 v199, v127
  v_add_f32 v201, v201, v198
  s_nop 0
  v_add_f32 v201, v201, v199
  v_cvt_pk_bf16_f32 v143, v198, v199
  s_nop 1
  s_branch back_An3
slow_A3m0:
  s_nop 15
  v_max3_f32 v210, v96, v97, v98
  v_max3_f32 v210, v210, v99, v100
  v_max3_f32 v210, v210, v101, v102
  v_max3_f32 v210, v210, v103, v104
  v_max3_f32 v210, v210, v105, v106
  v_max3_f32 v210, v210, v107, v108
  v_max3_f32 v210, v210, v109, v110
  v_max_f32 v210, v210, v111
  v_mov_b32 v211, v210
  s_nop 1
  v_permlane32_swap_b32 v210, v211
  s_nop 1
  v_max_f32 v210, v210, v211
  v_max_f32 v210, 0, v210
  v_sub_f32 v211, 0, v210
  v_exp_f32 v211, v211
  v_sub_f32 v96, v96, v210
  v_sub_f32 v112, v112, v210
  v_sub_f32 v144, v144, v210
  v_sub_f32 v97, v97, v210
  v_sub_f32 v113, v113, v210
  v_sub_f32 v145, v145, v210
  v_sub_f32 v98, v98, v210
  v_sub_f32 v114, v114, v210
  v_sub_f32 v146, v146, v210
  v_sub_f32 v99, v99, v210
  v_sub_f32 v115, v115, v210
  v_sub_f32 v147, v147, v210
  v_sub_f32 v100, v100, v210
  v_sub_f32 v116, v116, v210
  v_sub_f32 v148, v148, v210
  v_sub_f32 v101, v101, v210
  v_sub_f32 v117, v117, v210
  v_sub_f32 v149, v149, v210
  v_sub_f32 v102, v102, v210
  v_sub_f32 v118, v118, v210
  v_sub_f32 v150, v150, v210
  v_sub_f32 v103, v103, v210
  v_sub_f32 v119, v119, v210
  v_sub_f32 v151, v151, v210
  v_sub_f32 v104, v104, v210
  v_sub_f32 v120, v120, v210
  v_sub_f32 v152, v152, v210
  v_sub_f32 v105, v105, v210
  v_sub_f32 v121, v121, v210
  v_sub_f32 v153, v153, v210
  v_sub_f32 v106, v106, v210
  v_sub_f32 v122, v122, v210
  v_sub_f32 v154, v154, v210
  v_sub_f32 v107, v107, v210
  v_sub_f32 v123, v123, v210
  v_sub_f32 v155, v155, v210
  v_sub_f32 v108, v108, v210
  v_sub_f32 v124, v124, v210
  v_sub_f32 v156, v156, v210
  v_sub_f32 v109, v109, v210
  v_sub_f32 v125, v125, v210
  v_sub_f32 v157, v157, v210
  v_sub_f32 v110, v110, v210
  v_sub_f32 v126, v126, v210
  v_sub_f32 v158, v158, v210
  v_sub_f32 v111, v111, v210
  v_sub_f32 v127, v127, v210
  v_sub_f32 v159, v159, v210
  v_mul_f32 v200, v200, v211
  v_mul_f32 v0, v0, v211
  v_mul_f32 v1, v1, v211
  v_mul_f32 v2, v2, v211
  v_mul_f32 v3, v3, v211
  v_mul_f32 v4, v4, v211
  v_mul_f32 v5, v5, v211
  v_mul_f32 v6, v6, v211
  v_mul_f32 v7, v7, v211
  v_mul_f32 v8, v8, v211
  v_mul_f32 v9, v9, v211
  v_mul_f32 v10, v10, v211
  v_mul_f32 v11, v11, v211
  v_mul_f32 v12, v12, v211
  v_mul_f32 v13, v13, v211
  v_mul_f32 v14, v14, v211
  v_mul_f32 v15, v15, v211
  v_mul_f32 v16, v16, v211
  v_mul_f32 v17, v17, v211
  v_mul_f32 v18, v18, v211
  v_mul_f32 v19, v19, v211
  v_mul_f32 v20, v20, v211
  v_mul_f32 v21, v21, v211
  v_mul_f32 v22, v22, v211
  v_mul_f32 v23, v23, v211
  v_mul_f32 v24, v24, v211
  v_mul_f32 v25, v25, v211
  v_mul_f32 v26, v26, v211
  v_mul_f32 v27, v27, v211
  v_mul_f32 v28, v28, v211
  v_mul_f32 v29, v29, v211
  v_mul_f32 v30, v30, v211
  v_mul_f32 v31, v31, v211
  v_mul_f32 v32, v32, v211
  v_mul_f32 v33, v33, v211
  v_mul_f32 v34, v34, v211
  v_mul_f32 v35, v35, v211
  v_mul_f32 v36, v36, v211
  v_mul_f32 v37, v37, v211
  v_mul_f32 v38, v38, v211
  v_mul_f32 v39, v39, v211
  v_mul_f32 v40, v40, v211
  v_mul_f32 v41, v41, v211
  v_mul_f32 v42, v42, v211
  v_mul_f32 v43, v43, v211
  v_mul_f32 v44, v44, v211
  v_mul_f32 v45, v45, v211
  v_mul_f32 v46, v46, v211
  v_mul_f32 v47, v47, v211
  v_mul_f32 v48, v48, v211
  v_mul_f32 v49, v49, v211
  v_mul_f32 v50, v50, v211
  v_mul_f32 v51, v51, v211
  v_mul_f32 v52, v52, v211
  v_mul_f32 v53, v53, v211
  v_mul_f32 v54, v54, v211
  v_mul_f32 v55, v55, v211
  v_mul_f32 v56, v56, v211
  v_mul_f32 v57, v57, v211
  v_mul_f32 v58, v58, v211
  v_mul_f32 v59, v59, v211
  v_mul_f32 v60, v60, v211
  v_mul_f32 v61, v61, v211
  v_mul_f32 v62, v62, v211
  v_mul_f32 v63, v63, v211
  v_exp_f32 v192, v96
  v_exp_f32 v193, v97
  v_exp_f32 v194, v98
  v_add_f32 v201, v192, v193
  v_cvt_pk_bf16_f32 v128, v192, v193
  v_exp_f32 v195, v99
  v_add_f32 v201, v201, v194
  v_exp_f32 v196, v100
  v_add_f32 v201, v201, v195
  v_cvt_pk_bf16_f32 v129, v194, v195
  v_exp_f32 v197, v101
  v_add_f32 v201, v201, v196
  v_exp_f32 v198, v102
  v_add_f32 v201, v201, v197
  v_cvt_pk_bf16_f32 v130, v196, v197
  v_exp_f32 v199, v103
  v_add_f32 v201, v201, v198
  v_exp_f32 v192, v104
  v_add_f32 v201, v201, v199
  v_cvt_pk_bf16_f32 v131, v198, v199
  v_exp_f32 v193, v105
  v_add_f32 v201, v201, v192
  v_exp_f32 v194, v106
  v_add_f32 v201, v201, v193
  v_cvt_pk_bf16_f32 v132, v192, v193
  v_exp_f32 v195, v107
  v_add_f32 v201, v201, v194
  v_exp_f32 v196, v108
  v_add_f32 v201, v201, v195
  v_cvt_pk_bf16_f32 v133, v194, v195
  v_exp_f32 v197, v109
  v_add_f32 v201, v201, v196
  v_exp_f32 v198, v110
  v_add_f32 v201, v201, v197
  v_cvt_pk_bf16_f32 v134, v196, v197
  v_exp_f32 v199, v111
  v_add_f32 v201, v201, v198
  s_nop 0
  v_add_f32 v201, v201, v199
  v_cvt_pk_bf16_f32 v135, v198, v199
  s_nop 1
  s_branch back_A3m0
slow_A3m1:
  s_nop 15
  v_max3_f32 v210, v112, v113, v114
  v_max3_f32 v210, v210, v115, v116
  v_max3_f32 v210, v210, v117, v118
  v_max3_f32 v210, v210, v119, v120
  v_max3_f32 v210, v210, v121, v122
  v_max3_f32 v210, v210, v123, v124
  v_max3_f32 v210, v210, v125, v126
  v_max_f32 v210, v210, v127
  v_mov_b32 v211, v210
  s_nop 1
  v_permlane32_swap_b32 v210, v211
  s_nop 1
  v_max_f32 v210, v210, v211
  v_max_f32 v210, 0, v210
  v_sub_f32 v211, 0, v210
  v_exp_f32 v211, v211
  v_sub_f32 v112, v112, v210
  v_sub_f32 v96, v96, v210
  v_sub_f32 v144, v144, v210
  v_sub_f32 v113, v113, v210
  v_sub_f32 v97, v97, v210
  v_sub_f32 v145, v145, v210
  v_sub_f32 v114, v114, v210
  v_sub_f32 v98, v98, v210
  v_sub_f32 v146, v146, v210
  v_sub_f32 v115, v115, v210
  v_sub_f32 v99, v99, v210
  v_sub_f32 v147, v147, v210
  v_sub_f32 v116, v116, v210
  v_sub_f32 v100, v100, v210
  v_sub_f32 v148, v148, v210
  v_sub_f32 v117, v117, v210
  v_sub_f32 v101, v101, v210
  v_sub_f32 v149, v149, v210
  v_sub_f32 v118, v118, v210
  v_sub_f32 v102, v102, v210
  v_sub_f32 v150, v150, v210
  v_sub_f32 v119, v119, v210
  v_sub_f32 v103, v103, v210
  v_sub_f32 v151, v151, v210
  v_sub_f32 v120, v120, v210
  v_sub_f32 v104, v104, v210
  v_sub_f32 v152, v152, v210
  v_sub_f32 v121, v121, v210
  v_sub_f32 v105, v105, v210
  v_sub_f32 v153, v153, v210
  v_sub_f32 v122, v122, v210
  v_sub_f32 v106, v106, v210
  v_sub_f32 v154, v154, v210
  v_sub_f32 v123, v123, v210
  v_sub_f32 v107, v107, v210
  v_sub_f32 v155, v155, v210
  v_sub_f32 v124, v124, v210
  v_sub_f32 v108, v108, v210
  v_sub_f32 v156, v156, v210
  v_sub_f32 v125, v125, v210
  v_sub_f32 v109, v109, v210
  v_sub_f32 v157, v157, v210
  v_sub_f32 v126, v126, v210
  v_sub_f32 v110, v110, v210
  v_sub_f32 v158, v158, v210
  v_sub_f32 v127, v127, v210
  v_sub_f32 v111, v111, v210
  v_sub_f32 v159, v159, v210
  v_mul_f32 v200, v200, v211
  v_mul_f32 v0, v0, v211
  v_mul_f32 v1, v1, v211
  v_mul_f32 v2, v2, v211
  v_mul_f32 v3, v3, v211
  v_mul_f32 v4, v4, v211
  v_mul_f32 v5, v5, v211
  v_mul_f32 v6, v6, v211
  v_mul_f32 v7, v7, v211
  v_mul_f32 v8, v8, v211
  v_mul_f32 v9, v9, v211
  v_mul_f32 v10, v10, v211
  v_mul_f32 v11, v11, v211
  v_mul_f32 v12, v12, v211
  v_mul_f32 v13, v13, v211
  v_mul_f32 v14, v14, v211
  v_mul_f32 v15, v15, v211
  v_mul_f32 v16, v16, v211
  v_mul_f32 v17, v17, v211
  v_mul_f32 v18, v18, v211
  v_mul_f32 v19, v19, v211
  v_mul_f32 v20, v20, v211
  v_mul_f32 v21, v21, v211
  v_mul_f32 v22, v22, v211
  v_mul_f32 v23, v23, v211
  v_mul_f32 v24, v24, v211
  v_mul_f32 v25, v25, v211
  v_mul_f32 v26, v26, v211
  v_mul_f32 v27, v27, v211
  v_mul_f32 v28, v28, v211
  v_mul_f32 v29, v29, v211
  v_mul_f32 v30, v30, v211
  v_mul_f32 v31, v31, v211
  v_mul_f32 v32, v32, v211
  v_mul_f32 v33, v33, v211
  v_mul_f32 v34, v34, v211
  v_mul_f32 v35, v35, v211
  v_mul_f32 v36, v36, v211
  v_mul_f32 v37, v37, v211
  v_mul_f32 v38, v38, v211
  v_mul_f32 v39, v39, v211
  v_mul_f32 v40, v40, v211
  v_mul_f32 v41, v41, v211
  v_mul_f32 v42, v42, v211
  v_mul_f32 v43, v43, v211
  v_mul_f32 v44, v44, v211
  v_mul_f32 v45, v45, v211
  v_mul_f32 v46, v46, v211
  v_mul_f32 v47, v47, v211
  v_mul_f32 v48, v48, v211
  v_mul_f32 v49, v49, v211
  v_mul_f32 v50, v50, v211
  v_mul_f32 v51, v51, v211
  v_mul_f32 v52, v52, v211
  v_mul_f32 v53, v53, v211
  v_mul_f32 v54, v54, v211
  v_mul_f32 v55, v55, v211
  v_mul_f32 v56, v56, v211
  v_mul_f32 v57, v57, v211
  v_mul_f32 v58, v58, v211
  v_mul_f32 v59, v59, v211
  v_mul_f32 v60, v60, v211
  v_mul_f32 v61, v61, v211
  v_mul_f32 v62, v62, v211
  v_mul_f32 v63, v63, v211
  v_exp_f32 v192, v112
  v_exp_f32 v193, v113
  v_exp_f32 v194, v114
  v_add_f32 v201, v192, v193
  v_cvt_pk_bf16_f32 v136, v192, v193
  v_exp_f32 v195, v115
  v_add_f32 v201, v201, v194
  v_exp_f32 v196, v116
  v_add_f32 v201, v201, v195
  v_cvt_pk_bf16_f32 v137, v194, v195
  v_exp_f32 v197, v117
  v_add_f32 v201, v201, v196
  v_exp_f32 v198, v118
  v_add_f32 v201, v201, v197
  v_cvt_pk_bf16_f32 v138, v196, v197
  v_exp_f32 v199, v119
  v_add_f32 v201, v201, v198
  v_exp_f32 v192, v120
  v_add_f32 v201, v201, v199
  v_cvt_pk_bf16_f32 v139, v198, v199
  v_exp_f32 v193, v121
  v_add_f32 v201, v201, v192
  v_exp_f32 v194, v122
  v_add_f32 v201, v201, v193
  v_cvt_pk_bf16_f32 v140, v192, v193
  v_exp_f32 v195, v123
  v_add_f32 v201, v201, v194
  v_exp_f32 v196, v124
  v_add_f32 v201, v201, v195
  v_cvt_pk_bf16_f32 v141, v194, v195
  v_exp_f32 v197, v125
  v_add_f32 v201, v201, v196
  v_exp_f32 v198, v126
  v_add_f32 v201, v201, v197
  v_cvt_pk_bf16_f32 v142, v196, v197
  v_exp_f32 v199, v127
  v_add_f32 v201, v201, v198
  s_nop 0
  v_add_f32 v201, v201, v199
  v_cvt_pk_bf16_f32 v143, v198, v199
  s_nop 1
  s_branch back_A3m1
slow_A3m2:
  s_nop 15
  v_max3_f32 v210, v96, v97, v98
  v_max3_f32 v210, v210, v99, v100
  v_max3_f32 v210, v210, v101, v102
  v_max3_f32 v210, v210, v103, v104
  v_max3_f32 v210, v210, v105, v106
  v_max3_f32 v210, v210, v107, v108
  v_max3_f32 v210, v210, v109, v110
  v_max_f32 v210, v210, v111
  v_mov_b32 v211, v210
  s_nop 1
  v_permlane32_swap_b32 v210, v211
  s_nop 1
  v_max_f32 v210, v210, v211
  v_max_f32 v210, 0, v210
  v_sub_f32 v211, 0, v210
  v_exp_f32 v211, v211
  v_sub_f32 v96, v96, v210
  v_sub_f32 v112, v112, v210
  v_sub_f32 v144, v144, v210
  v_sub_f32 v97, v97, v210
  v_sub_f32 v113, v113, v210
  v_sub_f32 v145, v145, v210
  v_sub_f32 v98, v98, v210
  v_sub_f32 v114, v114, v210
  v_sub_f32 v146, v146, v210
  v_sub_f32 v99, v99, v210
  v_sub_f32 v115, v115, v210
  v_sub_f32 v147, v147, v210
  v_sub_f32 v100, v100, v210
  v_sub_f32 v116, v116, v210
  v_sub_f32 v148, v148, v210
  v_sub_f32 v101, v101, v210
  v_sub_f32 v117, v117, v210
  v_sub_f32 v149, v149, v210
  v_sub_f32 v102, v102, v210
  v_sub_f32 v118, v118, v210
  v_sub_f32 v150, v150, v210
  v_sub_f32 v103, v103, v210
  v_sub_f32 v119, v119, v210
  v_sub_f32 v151, v151, v210
  v_sub_f32 v104, v104, v210
  v_sub_f32 v120, v120, v210
  v_sub_f32 v152, v152, v210
  v_sub_f32 v105, v105, v210
  v_sub_f32 v121, v121, v210
  v_sub_f32 v153, v153, v210
  v_sub_f32 v106, v106, v210
  v_sub_f32 v122, v122, v210
  v_sub_f32 v154, v154, v210
  v_sub_f32 v107, v107, v210
  v_sub_f32 v123, v123, v210
  v_sub_f32 v155, v155, v210
  v_sub_f32 v108, v108, v210
  v_sub_f32 v124, v124, v210
  v_sub_f32 v156, v156, v210
  v_sub_f32 v109, v109, v210
  v_sub_f32 v125, v125, v210
  v_sub_f32 v157, v157, v210
  v_sub_f32 v110, v110, v210
  v_sub_f32 v126, v126, v210
  v_sub_f32 v158, v158, v210
  v_sub_f32 v111, v111, v210
  v_sub_f32 v127, v127, v210
  v_sub_f32 v159, v159, v210
  v_mul_f32 v200, v200, v211
  v_mul_f32 v0, v0, v211
  v_mul_f32 v1, v1, v211
  v_mul_f32 v2, v2, v211
  v_mul_f32 v3, v3, v211
  v_mul_f32 v4, v4, v211
  v_mul_f32 v5, v5, v211
  v_mul_f32 v6, v6, v211
  v_mul_f32 v7, v7, v211
  v_mul_f32 v8, v8, v211
  v_mul_f32 v9, v9, v211
  v_mul_f32 v10, v10, v211
  v_mul_f32 v11, v11, v211
  v_mul_f32 v12, v12, v211
  v_mul_f32 v13, v13, v211
  v_mul_f32 v14, v14, v211
  v_mul_f32 v15, v15, v211
  v_mul_f32 v16, v16, v211
  v_mul_f32 v17, v17, v211
  v_mul_f32 v18, v18, v211
  v_mul_f32 v19, v19, v211
  v_mul_f32 v20, v20, v211
  v_mul_f32 v21, v21, v211
  v_mul_f32 v22, v22, v211
  v_mul_f32 v23, v23, v211
  v_mul_f32 v24, v24, v211
  v_mul_f32 v25, v25, v211
  v_mul_f32 v26, v26, v211
  v_mul_f32 v27, v27, v211
  v_mul_f32 v28, v28, v211
  v_mul_f32 v29, v29, v211
  v_mul_f32 v30, v30, v211
  v_mul_f32 v31, v31, v211
  v_mul_f32 v32, v32, v211
  v_mul_f32 v33, v33, v211
  v_mul_f32 v34, v34, v211
  v_mul_f32 v35, v35, v211
  v_mul_f32 v36, v36, v211
  v_mul_f32 v37, v37, v211
  v_mul_f32 v38, v38, v211
  v_mul_f32 v39, v39, v211
  v_mul_f32 v40, v40, v211
  v_mul_f32 v41, v41, v211
  v_mul_f32 v42, v42, v211
  v_mul_f32 v43, v43, v211
  v_mul_f32 v44, v44, v211
  v_mul_f32 v45, v45, v211
  v_mul_f32 v46, v46, v211
  v_mul_f32 v47, v47, v211
  v_mul_f32 v48, v48, v211
  v_mul_f32 v49, v49, v211
  v_mul_f32 v50, v50, v211
  v_mul_f32 v51, v51, v211
  v_mul_f32 v52, v52, v211
  v_mul_f32 v53, v53, v211
  v_mul_f32 v54, v54, v211
  v_mul_f32 v55, v55, v211
  v_mul_f32 v56, v56, v211
  v_mul_f32 v57, v57, v211
  v_mul_f32 v58, v58, v211
  v_mul_f32 v59, v59, v211
  v_mul_f32 v60, v60, v211
  v_mul_f32 v61, v61, v211
  v_mul_f32 v62, v62, v211
  v_mul_f32 v63, v63, v211
  v_exp_f32 v192, v96
  v_exp_f32 v193, v97
  v_exp_f32 v194, v98
  v_add_f32 v201, v192, v193
  v_cvt_pk_bf16_f32 v128, v192, v193
  v_exp_f32 v195, v99
  v_add_f32 v201, v201, v194
  v_exp_f32 v196, v100
  v_add_f32 v201, v201, v195
  v_cvt_pk_bf16_f32 v129, v194, v195
  v_exp_f32 v197, v101
  v_add_f32 v201, v201, v196
  v_exp_f32 v198, v102
  v_add_f32 v201, v201, v197
  v_cvt_pk_bf16_f32 v130, v196, v197
  v_exp_f32 v199, v103
  v_add_f32 v201, v201, v198
  v_exp_f32 v192, v104
  v_add_f32 v201, v201, v199
  v_cvt_pk_bf16_f32 v131, v198, v199
  v_exp_f32 v193, v105
  v_add_f32 v201, v201, v192
  v_exp_f32 v194, v106
  v_add_f32 v201, v201, v193
  v_cvt_pk_bf16_f32 v132, v192, v193
  v_exp_f32 v195, v107
  v_add_f32 v201, v201, v194
  v_exp_f32 v196, v108
  v_add_f32 v201, v201, v195
  v_cvt_pk_bf16_f32 v133, v194, v195
  v_exp_f32 v197, v109
  v_add_f32 v201, v201, v196
  v_exp_f32 v198, v110
  v_add_f32 v201, v201, v197
  v_cvt_pk_bf16_f32 v134, v196, v197
  v_exp_f32 v199, v111
  v_add_f32 v201, v201, v198
  s_nop 0
  v_add_f32 v201, v201, v199
  v_cvt_pk_bf16_f32 v135, v198, v199
  s_nop 1
  s_branch back_A3m2
slow_A3m3:
  s_nop 15
  v_max3_f32 v210, v112, v113, v114
  v_max3_f32 v210, v210, v115, v116
  v_max3_f32 v210, v210, v117, v118
  v_max3_f32 v210, v210, v119, v120
  v_max3_f32 v210, v210, v121, v122
  v_max3_f32 v210, v210, v123, v124
  v_max3_f32 v210, v210, v125, v126
  v_max_f32 v210, v210, v127
  v_mov_b32 v211, v210
  s_nop 1
  v_permlane32_swap_b32 v210, v211
  s_nop 1
  v_max_f32 v210, v210, v211
  v_max_f32 v210, 0, v210
  v_sub_f32 v211, 0, v210
  v_exp_f32 v211, v211
  v_sub_f32 v112, v112, v210
  v_sub_f32 v96, v96, v210
  v_sub_f32 v144, v144, v210
  v_sub_f32 v113, v113, v210
  v_sub_f32 v97, v97, v210
  v_sub_f32 v145, v145, v210
  v_sub_f32 v114, v114, v210
  v_sub_f32 v98, v98, v210
  v_sub_f32 v146, v146, v210
  v_sub_f32 v115, v115, v210
  v_sub_f32 v99, v99, v210
  v_sub_f32 v147, v147, v210
  v_sub_f32 v116, v116, v210
  v_sub_f32 v100, v100, v210
  v_sub_f32 v148, v148, v210
  v_sub_f32 v117, v117, v210
  v_sub_f32 v101, v101, v210
  v_sub_f32 v149, v149, v210
  v_sub_f32 v118, v118, v210
  v_sub_f32 v102, v102, v210
  v_sub_f32 v150, v150, v210
  v_sub_f32 v119, v119, v210
  v_sub_f32 v103, v103, v210
  v_sub_f32 v151, v151, v210
  v_sub_f32 v120, v120, v210
  v_sub_f32 v104, v104, v210
  v_sub_f32 v152, v152, v210
  v_sub_f32 v121, v121, v210
  v_sub_f32 v105, v105, v210
  v_sub_f32 v153, v153, v210
  v_sub_f32 v122, v122, v210
  v_sub_f32 v106, v106, v210
  v_sub_f32 v154, v154, v210
  v_sub_f32 v123, v123, v210
  v_sub_f32 v107, v107, v210
  v_sub_f32 v155, v155, v210
  v_sub_f32 v124, v124, v210
  v_sub_f32 v108, v108, v210
  v_sub_f32 v156, v156, v210
  v_sub_f32 v125, v125, v210
  v_sub_f32 v109, v109, v210
  v_sub_f32 v157, v157, v210
  v_sub_f32 v126, v126, v210
  v_sub_f32 v110, v110, v210
  v_sub_f32 v158, v158, v210
  v_sub_f32 v127, v127, v210
  v_sub_f32 v111, v111, v210
  v_sub_f32 v159, v159, v210
  v_mul_f32 v200, v200, v211
  v_mul_f32 v0, v0, v211
  v_mul_f32 v1, v1, v211
  v_mul_f32 v2, v2, v211
  v_mul_f32 v3, v3, v211
  v_mul_f32 v4, v4, v211
  v_mul_f32 v5, v5, v211
  v_mul_f32 v6, v6, v211
  v_mul_f32 v7, v7, v211
  v_mul_f32 v8, v8, v211
  v_mul_f32 v9, v9, v211
  v_mul_f32 v10, v10, v211
  v_mul_f32 v11, v11, v211
  v_mul_f32 v12, v12, v211
  v_mul_f32 v13, v13, v211
  v_mul_f32 v14, v14, v211
  v_mul_f32 v15, v15, v211
  v_mul_f32 v16, v16, v211
  v_mul_f32 v17, v17, v211
  v_mul_f32 v18, v18, v211
  v_mul_f32 v19, v19, v211
  v_mul_f32 v20, v20, v211
  v_mul_f32 v21, v21, v211
  v_mul_f32 v22, v22, v211
  v_mul_f32 v23, v23, v211
  v_mul_f32 v24, v24, v211
  v_mul_f32 v25, v25, v211
  v_mul_f32 v26, v26, v211
  v_mul_f32 v27, v27, v211
  v_mul_f32 v28, v28, v211
  v_mul_f32 v29, v29, v211
  v_mul_f32 v30, v30, v211
  v_mul_f32 v31, v31, v211
  v_mul_f32 v32, v32, v211
  v_mul_f32 v33, v33, v211
  v_mul_f32 v34, v34, v211
  v_mul_f32 v35, v35, v211
  v_mul_f32 v36, v36, v211
  v_mul_f32 v37, v37, v211
  v_mul_f32 v38, v38, v211
  v_mul_f32 v39, v39, v211
  v_mul_f32 v40, v40, v211
  v_mul_f32 v41, v41, v211
  v_mul_f32 v42, v42, v211
  v_mul_f32 v43, v43, v211
  v_mul_f32 v44, v44, v211
  v_mul_f32 v45, v45, v211
  v_mul_f32 v46, v46, v211
  v_mul_f32 v47, v47, v211
  v_mul_f32 v48, v48, v211
  v_mul_f32 v49, v49, v211
  v_mul_f32 v50, v50, v211
  v_mul_f32 v51, v51, v211
  v_mul_f32 v52, v52, v211
  v_mul_f32 v53, v53, v211
  v_mul_f32 v54, v54, v211
  v_mul_f32 v55, v55, v211
  v_mul_f32 v56, v56, v211
  v_mul_f32 v57, v57, v211
  v_mul_f32 v58, v58, v211
  v_mul_f32 v59, v59, v211
  v_mul_f32 v60, v60, v211
  v_mul_f32 v61, v61, v211
  v_mul_f32 v62, v62, v211
  v_mul_f32 v63, v63, v211
  v_exp_f32 v192, v112
  v_exp_f32 v193, v113
  v_exp_f32 v194, v114
  v_add_f32 v201, v192, v193
  v_cvt_pk_bf16_f32 v136, v192, v193
  v_exp_f32 v195, v115
  v_add_f32 v201, v201, v194
  v_exp_f32 v196, v116
  v_add_f32 v201, v201, v195
  v_cvt_pk_bf16_f32 v137, v194, v195
  v_exp_f32 v197, v117
  v_add_f32 v201, v201, v196
  v_exp_f32 v198, v118
  v_add_f32 v201, v201, v197
  v_cvt_pk_bf16_f32 v138, v196, v197
  v_exp_f32 v199, v119
  v_add_f32 v201, v201, v198
  v_exp_f32 v192, v120
  v_add_f32 v201, v201, v199
  v_cvt_pk_bf16_f32 v139, v198, v199
  v_exp_f32 v193, v121
  v_add_f32 v201, v201, v192
  v_exp_f32 v194, v122
  v_add_f32 v201, v201, v193
  v_cvt_pk_bf16_f32 v140, v192, v193
  v_exp_f32 v195, v123
  v_add_f32 v201, v201, v194
  v_exp_f32 v196, v124
  v_add_f32 v201, v201, v195
  v_cvt_pk_bf16_f32 v141, v194, v195
  v_exp_f32 v197, v125
  v_add_f32 v201, v201, v196
  v_exp_f32 v198, v126
  v_add_f32 v201, v201, v197
  v_cvt_pk_bf16_f32 v142, v196, v197
  v_exp_f32 v199, v127
  v_add_f32 v201, v201, v198
  s_nop 0
  v_add_f32 v201, v201, v199
  v_cvt_pk_bf16_f32 v143, v198, v199
  s_nop 1
  s_branch back_A3m3
slow_A2m0:
  s_nop 15
  v_max3_f32 v210, v96, v97, v98
  v_max3_f32 v210, v210, v99, v100
  v_max3_f32 v210, v210, v101, v102
  v_max3_f32 v210, v210, v103, v104
  v_max3_f32 v210, v210, v105, v106
  v_max3_f32 v210, v210, v107, v108
  v_max3_f32 v210, v210, v109, v110
  v_max_f32 v210, v210, v111
  v_mov_b32 v211, v210
  s_nop 1
  v_permlane32_swap_b32 v210, v211
  s_nop 1
  v_max_f32 v210, v210, v211
  v_max_f32 v210, 0, v210
  v_sub_f32 v211, 0, v210
  v_exp_f32 v211, v211
  v_sub_f32 v96, v96, v210
  v_sub_f32 v112, v112, v210
  v_sub_f32 v144, v144, v210
  v_sub_f32 v97, v97, v210
  v_sub_f32 v113, v113, v210
  v_sub_f32 v145, v145, v210
  v_sub_f32 v98, v98, v210
  v_sub_f32 v114, v114, v210
  v_sub_f32 v146, v146, v210
  v_sub_f32 v99, v99, v210
  v_sub_f32 v115, v115, v210
  v_sub_f32 v147, v147, v210
  v_sub_f32 v100, v100, v210
  v_sub_f32 v116, v116, v210
  v_sub_f32 v148, v148, v210
  v_sub_f32 v101, v101, v210
  v_sub_f32 v117, v117, v210
  v_sub_f32 v149, v149, v210
  v_sub_f32 v102, v102, v210
  v_sub_f32 v118, v118, v210
  v_sub_f32 v150, v150, v210
  v_sub_f32 v103, v103, v210
  v_sub_f32 v119, v119, v210
  v_sub_f32 v151, v151, v210
  v_sub_f32 v104, v104, v210
  v_sub_f32 v120, v120, v210
  v_sub_f32 v152, v152, v210
  v_sub_f32 v105, v105, v210
  v_sub_f32 v121, v121, v210
  v_sub_f32 v153, v153, v210
  v_sub_f32 v106, v106, v210
  v_sub_f32 v122, v122, v210
  v_sub_f32 v154, v154, v210
  v_sub_f32 v107, v107, v210
  v_sub_f32 v123, v123, v210
  v_sub_f32 v155, v155, v210
  v_sub_f32 v108, v108, v210
  v_sub_f32 v124, v124, v210
  v_sub_f32 v156, v156, v210
  v_sub_f32 v109, v109, v210
  v_sub_f32 v125, v125, v210
  v_sub_f32 v157, v157, v210
  v_sub_f32 v110, v110, v210
  v_sub_f32 v126, v126, v210
  v_sub_f32 v158, v158, v210
  v_sub_f32 v111, v111, v210
  v_sub_f32 v127, v127, v210
  v_sub_f32 v159, v159, v210
  v_mul_f32 v200, v200, v211
  v_mul_f32 v0, v0, v211
  v_mul_f32 v1, v1, v211
  v_mul_f32 v2, v2, v211
  v_mul_f32 v3, v3, v211
  v_mul_f32 v4, v4, v211
  v_mul_f32 v5, v5, v211
  v_mul_f32 v6, v6, v211
  v_mul_f32 v7, v7, v211
  v_mul_f32 v8, v8, v211
  v_mul_f32 v9, v9, v211
  v_mul_f32 v10, v10, v211
  v_mul_f32 v11, v11, v211
  v_mul_f32 v12, v12, v211
  v_mul_f32 v13, v13, v211
  v_mul_f32 v14, v14, v211
  v_mul_f32 v15, v15, v211
  v_mul_f32 v16, v16, v211
  v_mul_f32 v17, v17, v211
  v_mul_f32 v18, v18, v211
  v_mul_f32 v19, v19, v211
  v_mul_f32 v20, v20, v211
  v_mul_f32 v21, v21, v211
  v_mul_f32 v22, v22, v211
  v_mul_f32 v23, v23, v211
  v_mul_f32 v24, v24, v211
  v_mul_f32 v25, v25, v211
  v_mul_f32 v26, v26, v211
  v_mul_f32 v27, v27, v211
  v_mul_f32 v28, v28, v211
  v_mul_f32 v29, v29, v211
  v_mul_f32 v30, v30, v211
  v_mul_f32 v31, v31, v211
  v_mul_f32 v32, v32, v211
  v_mul_f32 v33, v33, v211
  v_mul_f32 v34, v34, v211
  v_mul_f32 v35, v35, v211
  v_mul_f32 v36, v36, v211
  v_mul_f32 v37, v37, v211
  v_mul_f32 v38, v38, v211
  v_mul_f32 v39, v39, v211
  v_mul_f32 v40, v40, v211
  v_mul_f32 v41, v41, v211
  v_mul_f32 v42, v42, v211
  v_mul_f32 v43, v43, v211
  v_mul_f32 v44, v44, v211
  v_mul_f32 v45, v45, v211
  v_mul_f32 v46, v46, v211
  v_mul_f32 v47, v47, v211
  v_mul_f32 v48, v48, v211
  v_mul_f32 v49, v49, v211
  v_mul_f32 v50, v50, v211
  v_mul_f32 v51, v51, v211
  v_mul_f32 v52, v52, v211
  v_mul_f32 v53, v53, v211
  v_mul_f32 v54, v54, v211
  v_mul_f32 v55, v55, v211
  v_mul_f32 v56, v56, v211
  v_mul_f32 v57, v57, v211
  v_mul_f32 v58, v58, v211
  v_mul_f32 v59, v59, v211
  v_mul_f32 v60, v60, v211
  v_mul_f32 v61, v61, v211
  v_mul_f32 v62, v62, v211
  v_mul_f32 v63, v63, v211
  v_exp_f32 v192, v96
  v_exp_f32 v193, v97
  v_exp_f32 v194, v98
  v_add_f32 v201, v192, v193
  v_cvt_pk_bf16_f32 v128, v192, v193
  v_exp_f32 v195, v99
  v_add_f32 v201, v201, v194
  v_exp_f32 v196, v100
  v_add_f32 v201, v201, v195
  v_cvt_pk_bf16_f32 v129, v194, v195
  v_exp_f32 v197, v101
  v_add_f32 v201, v201, v196
  v_exp_f32 v198, v102
  v_add_f32 v201, v201, v197
  v_cvt_pk_bf16_f32 v130, v196, v197
  v_exp_f32 v199, v103
  v_add_f32 v201, v201, v198
  v_exp_f32 v192, v104
  v_add_f32 v201, v201, v199
  v_cvt_pk_bf16_f32 v131, v198, v199
  v_exp_f32 v193, v105
  v_add_f32 v201, v201, v192
  v_exp_f32 v194, v106
  v_add_f32 v201, v201, v193
  v_cvt_pk_bf16_f32 v132, v192, v193
  v_exp_f32 v195, v107
  v_add_f32 v201, v201, v194
  v_exp_f32 v196, v108
  v_add_f32 v201, v201, v195
  v_cvt_pk_bf16_f32 v133, v194, v195
  v_exp_f32 v197, v109
  v_add_f32 v201, v201, v196
  v_exp_f32 v198, v110
  v_add_f32 v201, v201, v197
  v_cvt_pk_bf16_f32 v134, v196, v197
  v_exp_f32 v199, v111
  v_add_f32 v201, v201, v198
  s_nop 0
  v_add_f32 v201, v201, v199
  v_cvt_pk_bf16_f32 v135, v198, v199
  s_nop 1
  s_branch back_A2m0
slow_A2m1:
  s_nop 15
  v_max3_f32 v210, v112, v113, v114
  v_max3_f32 v210, v210, v115, v116
  v_max3_f32 v210, v210, v117, v118
  v_max3_f32 v210, v210, v119, v120
  v_max3_f32 v210, v210, v121, v122
  v_max3_f32 v210, v210, v123, v124
  v_max3_f32 v210, v210, v125, v126
  v_max_f32 v210, v210, v127
  v_mov_b32 v211, v210
  s_nop 1
  v_permlane32_swap_b32 v210, v211
  s_nop 1
  v_max_f32 v210, v210, v211
  v_max_f32 v210, 0, v210
  v_sub_f32 v211, 0, v210
  v_exp_f32 v211, v211
  v_sub_f32 v112, v112, v210
  v_sub_f32 v96, v96, v210
  v_sub_f32 v144, v144, v210
  v_sub_f32 v113, v113, v210
  v_sub_f32 v97, v97, v210
  v_sub_f32 v145, v145, v210
  v_sub_f32 v114, v114, v210
  v_sub_f32 v98, v98, v210
  v_sub_f32 v146, v146, v210
  v_sub_f32 v115, v115, v210
  v_sub_f32 v99, v99, v210
  v_sub_f32 v147, v147, v210
  v_sub_f32 v116, v116, v210
  v_sub_f32 v100, v100, v210
  v_sub_f32 v148, v148, v210
  v_sub_f32 v117, v117, v210
  v_sub_f32 v101, v101, v210
  v_sub_f32 v149, v149, v210
  v_sub_f32 v118, v118, v210
  v_sub_f32 v102, v102, v210
  v_sub_f32 v150, v150, v210
  v_sub_f32 v119, v119, v210
  v_sub_f32 v103, v103, v210
  v_sub_f32 v151, v151, v210
  v_sub_f32 v120, v120, v210
  v_sub_f32 v104, v104, v210
  v_sub_f32 v152, v152, v210
  v_sub_f32 v121, v121, v210
  v_sub_f32 v105, v105, v210
  v_sub_f32 v153, v153, v210
  v_sub_f32 v122, v122, v210
  v_sub_f32 v106, v106, v210
  v_sub_f32 v154, v154, v210
  v_sub_f32 v123, v123, v210
  v_sub_f32 v107, v107, v210
  v_sub_f32 v155, v155, v210
  v_sub_f32 v124, v124, v210
  v_sub_f32 v108, v108, v210
  v_sub_f32 v156, v156, v210
  v_sub_f32 v125, v125, v210
  v_sub_f32 v109, v109, v210
  v_sub_f32 v157, v157, v210
  v_sub_f32 v126, v126, v210
  v_sub_f32 v110, v110, v210
  v_sub_f32 v158, v158, v210
  v_sub_f32 v127, v127, v210
  v_sub_f32 v111, v111, v210
  v_sub_f32 v159, v159, v210
  v_mul_f32 v200, v200, v211
  v_mul_f32 v0, v0, v211
  v_mul_f32 v1, v1, v211
  v_mul_f32 v2, v2, v211
  v_mul_f32 v3, v3, v211
  v_mul_f32 v4, v4, v211
  v_mul_f32 v5, v5, v211
  v_mul_f32 v6, v6, v211
  v_mul_f32 v7, v7, v211
  v_mul_f32 v8, v8, v211
  v_mul_f32 v9, v9, v211
  v_mul_f32 v10, v10, v211
  v_mul_f32 v11, v11, v211
  v_mul_f32 v12, v12, v211
  v_mul_f32 v13, v13, v211
  v_mul_f32 v14, v14, v211
  v_mul_f32 v15, v15, v211
  v_mul_f32 v16, v16, v211
  v_mul_f32 v17, v17, v211
  v_mul_f32 v18, v18, v211
  v_mul_f32 v19, v19, v211
  v_mul_f32 v20, v20, v211
  v_mul_f32 v21, v21, v211
  v_mul_f32 v22, v22, v211
  v_mul_f32 v23, v23, v211
  v_mul_f32 v24, v24, v211
  v_mul_f32 v25, v25, v211
  v_mul_f32 v26, v26, v211
  v_mul_f32 v27, v27, v211
  v_mul_f32 v28, v28, v211
  v_mul_f32 v29, v29, v211
  v_mul_f32 v30, v30, v211
  v_mul_f32 v31, v31, v211
  v_mul_f32 v32, v32, v211
  v_mul_f32 v33, v33, v211
  v_mul_f32 v34, v34, v211
  v_mul_f32 v35, v35, v211
  v_mul_f32 v36, v36, v211
  v_mul_f32 v37, v37, v211
  v_mul_f32 v38, v38, v211
  v_mul_f32 v39, v39, v211
  v_mul_f32 v40, v40, v211
  v_mul_f32 v41, v41, v211
  v_mul_f32 v42, v42, v211
  v_mul_f32 v43, v43, v211
  v_mul_f32 v44, v44, v211
  v_mul_f32 v45, v45, v211
  v_mul_f32 v46, v46, v211
  v_mul_f32 v47, v47, v211
  v_mul_f32 v48, v48, v211
  v_mul_f32 v49, v49, v211
  v_mul_f32 v50, v50, v211
  v_mul_f32 v51, v51, v211
  v_mul_f32 v52, v52, v211
  v_mul_f32 v53, v53, v211
  v_mul_f32 v54, v54, v211
  v_mul_f32 v55, v55, v211
  v_mul_f32 v56, v56, v211
  v_mul_f32 v57, v57, v211
  v_mul_f32 v58, v58, v211
  v_mul_f32 v59, v59, v211
  v_mul_f32 v60, v60, v211
  v_mul_f32 v61, v61, v211
  v_mul_f32 v62, v62, v211
  v_mul_f32 v63, v63, v211
  v_exp_f32 v192, v112
  v_exp_f32 v193, v113
  v_exp_f32 v194, v114
  v_add_f32 v201, v192, v193
  v_cvt_pk_bf16_f32 v136, v192, v193
  v_exp_f32 v195, v115
  v_add_f32 v201, v201, v194
  v_exp_f32 v196, v116
  v_add_f32 v201, v201, v195
  v_cvt_pk_bf16_f32 v137, v194, v195
  v_exp_f32 v197, v117
  v_add_f32 v201, v201, v196
  v_exp_f32 v198, v118
  v_add_f32 v201, v201, v197
  v_cvt_pk_bf16_f32 v138, v196, v197
  v_exp_f32 v199, v119
  v_add_f32 v201, v201, v198
  v_exp_f32 v192, v120
  v_add_f32 v201, v201, v199
  v_cvt_pk_bf16_f32 v139, v198, v199
  v_exp_f32 v193, v121
  v_add_f32 v201, v201, v192
  v_exp_f32 v194, v122
  v_add_f32 v201, v201, v193
  v_cvt_pk_bf16_f32 v140, v192, v193
  v_exp_f32 v195, v123
  v_add_f32 v201, v201, v194
  v_exp_f32 v196, v124
  v_add_f32 v201, v201, v195
  v_cvt_pk_bf16_f32 v141, v194, v195
  v_exp_f32 v197, v125
  v_add_f32 v201, v201, v196
  v_exp_f32 v198, v126
  v_add_f32 v201, v201, v197
  v_cvt_pk_bf16_f32 v142, v196, v197
  v_exp_f32 v199, v127
  v_add_f32 v201, v201, v198
  s_nop 0
  v_add_f32 v201, v201, v199
  v_cvt_pk_bf16_f32 v143, v198, v199
  s_nop 1
  s_branch back_A2m1
slow_A2m2:
  s_nop 15
  v_max3_f32 v210, v96, v97, v98
  v_max3_f32 v210, v210, v99, v100
  v_max3_f32 v210, v210, v101, v102
  v_max3_f32 v210, v210, v103, v104
  v_max3_f32 v210, v210, v105, v106
  v_max3_f32 v210, v210, v107, v108
  v_max3_f32 v210, v210, v109, v110
  v_max_f32 v210, v210, v111
  v_mov_b32 v211, v210
  s_nop 1
  v_permlane32_swap_b32 v210, v211
  s_nop 1
  v_max_f32 v210, v210, v211
  v_max_f32 v210, 0, v210
  v_sub_f32 v211, 0, v210
  v_exp_f32 v211, v211
  v_sub_f32 v96, v96, v210
  v_sub_f32 v112, v112, v210
  v_sub_f32 v144, v144, v210
  v_sub_f32 v97, v97, v210
  v_sub_f32 v113, v113, v210
  v_sub_f32 v145, v145, v210
  v_sub_f32 v98, v98, v210
  v_sub_f32 v114, v114, v210
  v_sub_f32 v146, v146, v210
  v_sub_f32 v99, v99, v210
  v_sub_f32 v115, v115, v210
  v_sub_f32 v147, v147, v210
  v_sub_f32 v100, v100, v210
  v_sub_f32 v116, v116, v210
  v_sub_f32 v148, v148, v210
  v_sub_f32 v101, v101, v210
  v_sub_f32 v117, v117, v210
  v_sub_f32 v149, v149, v210
  v_sub_f32 v102, v102, v210
  v_sub_f32 v118, v118, v210
  v_sub_f32 v150, v150, v210
  v_sub_f32 v103, v103, v210
  v_sub_f32 v119, v119, v210
  v_sub_f32 v151, v151, v210
  v_sub_f32 v104, v104, v210
  v_sub_f32 v120, v120, v210
  v_sub_f32 v152, v152, v210
  v_sub_f32 v105, v105, v210
  v_sub_f32 v121, v121, v210
  v_sub_f32 v153, v153, v210
  v_sub_f32 v106, v106, v210
  v_sub_f32 v122, v122, v210
  v_sub_f32 v154, v154, v210
  v_sub_f32 v107, v107, v210
  v_sub_f32 v123, v123, v210
  v_sub_f32 v155, v155, v210
  v_sub_f32 v108, v108, v210
  v_sub_f32 v124, v124, v210
  v_sub_f32 v156, v156, v210
  v_sub_f32 v109, v109, v210
  v_sub_f32 v125, v125, v210
  v_sub_f32 v157, v157, v210
  v_sub_f32 v110, v110, v210
  v_sub_f32 v126, v126, v210
  v_sub_f32 v158, v158, v210
  v_sub_f32 v111, v111, v210
  v_sub_f32 v127, v127, v210
  v_sub_f32 v159, v159, v210
  v_mul_f32 v200, v200, v211
  v_mul_f32 v0, v0, v211
  v_mul_f32 v1, v1, v211
  v_mul_f32 v2, v2, v211
  v_mul_f32 v3, v3, v211
  v_mul_f32 v4, v4, v211
  v_mul_f32 v5, v5, v211
  v_mul_f32 v6, v6, v211
  v_mul_f32 v7, v7, v211
  v_mul_f32 v8, v8, v211
  v_mul_f32 v9, v9, v211
  v_mul_f32 v10, v10, v211
  v_mul_f32 v11, v11, v211
  v_mul_f32 v12, v12, v211
  v_mul_f32 v13, v13, v211
  v_mul_f32 v14, v14, v211
  v_mul_f32 v15, v15, v211
  v_mul_f32 v16, v16, v211
  v_mul_f32 v17, v17, v211
  v_mul_f32 v18, v18, v211
  v_mul_f32 v19, v19, v211
  v_mul_f32 v20, v20, v211
  v_mul_f32 v21, v21, v211
  v_mul_f32 v22, v22, v211
  v_mul_f32 v23, v23, v211
  v_mul_f32 v24, v24, v211
  v_mul_f32 v25, v25, v211
  v_mul_f32 v26, v26, v211
  v_mul_f32 v27, v27, v211
  v_mul_f32 v28, v28, v211
  v_mul_f32 v29, v29, v211
  v_mul_f32 v30, v30, v211
  v_mul_f32 v31, v31, v211
  v_mul_f32 v32, v32, v211
  v_mul_f32 v33, v33, v211
  v_mul_f32 v34, v34, v211
  v_mul_f32 v35, v35, v211
  v_mul_f32 v36, v36, v211
  v_mul_f32 v37, v37, v211
  v_mul_f32 v38, v38, v211
  v_mul_f32 v39, v39, v211
  v_mul_f32 v40, v40, v211
  v_mul_f32 v41, v41, v211
  v_mul_f32 v42, v42, v211
  v_mul_f32 v43, v43, v211
  v_mul_f32 v44, v44, v211
  v_mul_f32 v45, v45, v211
  v_mul_f32 v46, v46, v211
  v_mul_f32 v47, v47, v211
  v_mul_f32 v48, v48, v211
  v_mul_f32 v49, v49, v211
  v_mul_f32 v50, v50, v211
  v_mul_f32 v51, v51, v211
  v_mul_f32 v52, v52, v211
  v_mul_f32 v53, v53, v211
  v_mul_f32 v54, v54, v211
  v_mul_f32 v55, v55, v211
  v_mul_f32 v56, v56, v211
  v_mul_f32 v57, v57, v211
  v_mul_f32 v58, v58, v211
  v_mul_f32 v59, v59, v211
  v_mul_f32 v60, v60, v211
  v_mul_f32 v61, v61, v211
  v_mul_f32 v62, v62, v211
  v_mul_f32 v63, v63, v211
  v_exp_f32 v192, v96
  v_exp_f32 v193, v97
  v_exp_f32 v194, v98
  v_add_f32 v201, v192, v193
  v_cvt_pk_bf16_f32 v128, v192, v193
  v_exp_f32 v195, v99
  v_add_f32 v201, v201, v194
  v_exp_f32 v196, v100
  v_add_f32 v201, v201, v195
  v_cvt_pk_bf16_f32 v129, v194, v195
  v_exp_f32 v197, v101
  v_add_f32 v201, v201, v196
  v_exp_f32 v198, v102
  v_add_f32 v201, v201, v197
  v_cvt_pk_bf16_f32 v130, v196, v197
  v_exp_f32 v199, v103
  v_add_f32 v201, v201, v198
  v_exp_f32 v192, v104
  v_add_f32 v201, v201, v199
  v_cvt_pk_bf16_f32 v131, v198, v199
  v_exp_f32 v193, v105
  v_add_f32 v201, v201, v192
  v_exp_f32 v194, v106
  v_add_f32 v201, v201, v193
  v_cvt_pk_bf16_f32 v132, v192, v193
  v_exp_f32 v195, v107
  v_add_f32 v201, v201, v194
  v_exp_f32 v196, v108
  v_add_f32 v201, v201, v195
  v_cvt_pk_bf16_f32 v133, v194, v195
  v_exp_f32 v197, v109
  v_add_f32 v201, v201, v196
  v_exp_f32 v198, v110
  v_add_f32 v201, v201, v197
  v_cvt_pk_bf16_f32 v134, v196, v197
  v_exp_f32 v199, v111
  v_add_f32 v201, v201, v198
  s_nop 0
  v_add_f32 v201, v201, v199
  v_cvt_pk_bf16_f32 v135, v198, v199
  s_nop 1
  s_branch back_A2m2
slow_A1m0:
  s_nop 15
  v_max3_f32 v210, v96, v97, v98
  v_max3_f32 v210, v210, v99, v100
  v_max3_f32 v210, v210, v101, v102
  v_max3_f32 v210, v210, v103, v104
  v_max3_f32 v210, v210, v105, v106
  v_max3_f32 v210, v210, v107, v108
  v_max3_f32 v210, v210, v109, v110
  v_max_f32 v210, v210, v111
  v_mov_b32 v211, v210
  s_nop 1
  v_permlane32_swap_b32 v210, v211
  s_nop 1
  v_max_f32 v210, v210, v211
  v_max_f32 v210, 0, v210
  v_sub_f32 v211, 0, v210
  v_exp_f32 v211, v211
  v_sub_f32 v96, v96, v210
  v_sub_f32 v112, v112, v210
  v_sub_f32 v144, v144, v210
  v_sub_f32 v97, v97, v210
  v_sub_f32 v113, v113, v210
  v_sub_f32 v145, v145, v210
  v_sub_f32 v98, v98, v210
  v_sub_f32 v114, v114, v210
  v_sub_f32 v146, v146, v210
  v_sub_f32 v99, v99, v210
  v_sub_f32 v115, v115, v210
  v_sub_f32 v147, v147, v210
  v_sub_f32 v100, v100, v210
  v_sub_f32 v116, v116, v210
  v_sub_f32 v148, v148, v210
  v_sub_f32 v101, v101, v210
  v_sub_f32 v117, v117, v210
  v_sub_f32 v149, v149, v210
  v_sub_f32 v102, v102, v210
  v_sub_f32 v118, v118, v210
  v_sub_f32 v150, v150, v210
  v_sub_f32 v103, v103, v210
  v_sub_f32 v119, v119, v210
  v_sub_f32 v151, v151, v210
  v_sub_f32 v104, v104, v210
  v_sub_f32 v120, v120, v210
  v_sub_f32 v152, v152, v210
  v_sub_f32 v105, v105, v210
  v_sub_f32 v121, v121, v210
  v_sub_f32 v153, v153, v210
  v_sub_f32 v106, v106, v210
  v_sub_f32 v122, v122, v210
  v_sub_f32 v154, v154, v210
  v_sub_f32 v107, v107, v210
  v_sub_f32 v123, v123, v210
  v_sub_f32 v155, v155, v210
  v_sub_f32 v108, v108, v210
  v_sub_f32 v124, v124, v210
  v_sub_f32 v156, v156, v210
  v_sub_f32 v109, v109, v210
  v_sub_f32 v125, v125, v210
  v_sub_f32 v157, v157, v210
  v_sub_f32 v110, v110, v210
  v_sub_f32 v126, v126, v210
  v_sub_f32 v158, v158, v210
  v_sub_f32 v111, v111, v210
  v_sub_f32 v127, v127, v210
  v_sub_f32 v159, v159, v210
  v_mul_f32 v200, v200, v211
  v_mul_f32 v0, v0, v211
  v_mul_f32 v1, v1, v211
  v_mul_f32 v2, v2, v211
  v_mul_f32 v3, v3, v211
  v_mul_f32 v4, v4, v211
  v_mul_f32 v5, v5, v211
  v_mul_f32 v6, v6, v211
  v_mul_f32 v7, v7, v211
  v_mul_f32 v8, v8, v211
  v_mul_f32 v9, v9, v211
  v_mul_f32 v10, v10, v211
  v_mul_f32 v11, v11, v211
  v_mul_f32 v12, v12, v211
  v_mul_f32 v13, v13, v211
  v_mul_f32 v14, v14, v211
  v_mul_f32 v15, v15, v211
  v_mul_f32 v16, v16, v211
  v_mul_f32 v17, v17, v211
  v_mul_f32 v18, v18, v211
  v_mul_f32 v19, v19, v211
  v_mul_f32 v20, v20, v211
  v_mul_f32 v21, v21, v211
  v_mul_f32 v22, v22, v211
  v_mul_f32 v23, v23, v211
  v_mul_f32 v24, v24, v211
  v_mul_f32 v25, v25, v211
  v_mul_f32 v26, v26, v211
  v_mul_f32 v27, v27, v211
  v_mul_f32 v28, v28, v211
  v_mul_f32 v29, v29, v211
  v_mul_f32 v30, v30, v211
  v_mul_f32 v31, v31, v211
  v_mul_f32 v32, v32, v211
  v_mul_f32 v33, v33, v211
  v_mul_f32 v34, v34, v211
  v_mul_f32 v35, v35, v211
  v_mul_f32 v36, v36, v211
  v_mul_f32 v37, v37, v211
  v_mul_f32 v38, v38, v211
  v_mul_f32 v39, v39, v211
  v_mul_f32 v40, v40, v211
  v_mul_f32 v41, v41, v211
  v_mul_f32 v42, v42, v211
  v_mul_f32 v43, v43, v211
  v_mul_f32 v44, v44, v211
  v_mul_f32 v45, v45, v211
  v_mul_f32 v46, v46, v211
  v_mul_f32 v47, v47, v211
  v_mul_f32 v48, v48, v211
  v_mul_f32 v49, v49, v211
  v_mul_f32 v50, v50, v211
  v_mul_f32 v51, v51, v211
  v_mul_f32 v52, v52, v211
  v_mul_f32 v53, v53, v211
  v_mul_f32 v54, v54, v211
  v_mul_f32 v55, v55, v211
  v_mul_f32 v56, v56, v211
  v_mul_f32 v57, v57, v211
  v_mul_f32 v58, v58, v211
  v_mul_f32 v59, v59, v211
  v_mul_f32 v60, v60, v211
  v_mul_f32 v61, v61, v211
  v_mul_f32 v62, v62, v211
  v_mul_f32 v63, v63, v211
  v_exp_f32 v192, v96
  v_exp_f32 v193, v97
  v_exp_f32 v194, v98
  v_add_f32 v201, v192, v193
  v_cvt_pk_bf16_f32 v128, v192, v193
  v_exp_f32 v195, v99
  v_add_f32 v201, v201, v194
  v_exp_f32 v196, v100
  v_add_f32 v201, v201, v195
  v_cvt_pk_bf16_f32 v129, v194, v195
  v_exp_f32 v197, v101
  v_add_f32 v201, v201, v196
  v_exp_f32 v198, v102
  v_add_f32 v201, v201, v197
  v_cvt_pk_bf16_f32 v130, v196, v197
  v_exp_f32 v199, v103
  v_add_f32 v201, v201, v198
  v_exp_f32 v192, v104
  v_add_f32 v201, v201, v199
  v_cvt_pk_bf16_f32 v131, v198, v199
  v_exp_f32 v193, v105
  v_add_f32 v201, v201, v192
  v_exp_f32 v194, v106
  v_add_f32 v201, v201, v193
  v_cvt_pk_bf16_f32 v132, v192, v193
  v_exp_f32 v195, v107
  v_add_f32 v201, v201, v194
  v_exp_f32 v196, v108
  v_add_f32 v201, v201, v195
  v_cvt_pk_bf16_f32 v133, v194, v195
  v_exp_f32 v197, v109
  v_add_f32 v201, v201, v196
  v_exp_f32 v198, v110
  v_add_f32 v201, v201, v197
  v_cvt_pk_bf16_f32 v134, v196, v197
  v_exp_f32 v199, v111
  v_add_f32 v201, v201, v198
  s_nop 0
  v_add_f32 v201, v201, v199
  v_cvt_pk_bf16_f32 v135, v198, v199
  s_nop 1
  s_branch back_A1m0
slow_A1m1:
  s_nop 15
  v_max3_f32 v210, v112, v113, v114
  v_max3_f32 v210, v210, v115, v116
  v_max3_f32 v210, v210, v117, v118
  v_max3_f32 v210, v210, v119, v120
  v_max3_f32 v210, v210, v121, v122
  v_max3_f32 v210, v210, v123, v124
  v_max3_f32 v210, v210, v125, v126
  v_max_f32 v210, v210, v127
  v_mov_b32 v211, v210
  s_nop 1
  v_permlane32_swap_b32 v210, v211
  s_nop 1
  v_max_f32 v210, v210, v211
  v_max_f32 v210, 0, v210
  v_sub_f32 v211, 0, v210
  v_exp_f32 v211, v211
  v_sub_f32 v112, v112, v210
  v_sub_f32 v96, v96, v210
  v_sub_f32 v144, v144, v210
  v_sub_f32 v113, v113, v210
  v_sub_f32 v97, v97, v210
  v_sub_f32 v145, v145, v210
  v_sub_f32 v114, v114, v210
  v_sub_f32 v98, v98, v210
  v_sub_f32 v146, v146, v210
  v_sub_f32 v115, v115, v210
  v_sub_f32 v99, v99, v210
  v_sub_f32 v147, v147, v210
  v_sub_f32 v116, v116, v210
  v_sub_f32 v100, v100, v210
  v_sub_f32 v148, v148, v210
  v_sub_f32 v117, v117, v210
  v_sub_f32 v101, v101, v210
  v_sub_f32 v149, v149, v210
  v_sub_f32 v118, v118, v210
  v_sub_f32 v102, v102, v210
  v_sub_f32 v150, v150, v210
  v_sub_f32 v119, v119, v210
  v_sub_f32 v103, v103, v210
  v_sub_f32 v151, v151, v210
  v_sub_f32 v120, v120, v210
  v_sub_f32 v104, v104, v210
  v_sub_f32 v152, v152, v210
  v_sub_f32 v121, v121, v210
  v_sub_f32 v105, v105, v210
  v_sub_f32 v153, v153, v210
  v_sub_f32 v122, v122, v210
  v_sub_f32 v106, v106, v210
  v_sub_f32 v154, v154, v210
  v_sub_f32 v123, v123, v210
  v_sub_f32 v107, v107, v210
  v_sub_f32 v155, v155, v210
  v_sub_f32 v124, v124, v210
  v_sub_f32 v108, v108, v210
  v_sub_f32 v156, v156, v210
  v_sub_f32 v125, v125, v210
  v_sub_f32 v109, v109, v210
  v_sub_f32 v157, v157, v210
  v_sub_f32 v126, v126, v210
  v_sub_f32 v110, v110, v210
  v_sub_f32 v158, v158, v210
  v_sub_f32 v127, v127, v210
  v_sub_f32 v111, v111, v210
  v_sub_f32 v159, v159, v210
  v_mul_f32 v200, v200, v211
  v_mul_f32 v0, v0, v211
  v_mul_f32 v1, v1, v211
  v_mul_f32 v2, v2, v211
  v_mul_f32 v3, v3, v211
  v_mul_f32 v4, v4, v211
  v_mul_f32 v5, v5, v211
  v_mul_f32 v6, v6, v211
  v_mul_f32 v7, v7, v211
  v_mul_f32 v8, v8, v211
  v_mul_f32 v9, v9, v211
  v_mul_f32 v10, v10, v211
  v_mul_f32 v11, v11, v211
  v_mul_f32 v12, v12, v211
  v_mul_f32 v13, v13, v211
  v_mul_f32 v14, v14, v211
  v_mul_f32 v15, v15, v211
  v_mul_f32 v16, v16, v211
  v_mul_f32 v17, v17, v211
  v_mul_f32 v18, v18, v211
  v_mul_f32 v19, v19, v211
  v_mul_f32 v20, v20, v211
  v_mul_f32 v21, v21, v211
  v_mul_f32 v22, v22, v211
  v_mul_f32 v23, v23, v211
  v_mul_f32 v24, v24, v211
  v_mul_f32 v25, v25, v211
  v_mul_f32 v26, v26, v211
  v_mul_f32 v27, v27, v211
  v_mul_f32 v28, v28, v211
  v_mul_f32 v29, v29, v211
  v_mul_f32 v30, v30, v211
  v_mul_f32 v31, v31, v211
  v_mul_f32 v32, v32, v211
  v_mul_f32 v33, v33, v211
  v_mul_f32 v34, v34, v211
  v_mul_f32 v35, v35, v211
  v_mul_f32 v36, v36, v211
  v_mul_f32 v37, v37, v211
  v_mul_f32 v38, v38, v211
  v_mul_f32 v39, v39, v211
  v_mul_f32 v40, v40, v211
  v_mul_f32 v41, v41, v211
  v_mul_f32 v42, v42, v211
  v_mul_f32 v43, v43, v211
  v_mul_f32 v44, v44, v211
  v_mul_f32 v45, v45, v211
  v_mul_f32 v46, v46, v211
  v_mul_f32 v47, v47, v211
  v_mul_f32 v48, v48, v211
  v_mul_f32 v49, v49, v211
  v_mul_f32 v50, v50, v211
  v_mul_f32 v51, v51, v211
  v_mul_f32 v52, v52, v211
  v_mul_f32 v53, v53, v211
  v_mul_f32 v54, v54, v211
  v_mul_f32 v55, v55, v211
  v_mul_f32 v56, v56, v211
  v_mul_f32 v57, v57, v211
  v_mul_f32 v58, v58, v211
  v_mul_f32 v59, v59, v211
  v_mul_f32 v60, v60, v211
  v_mul_f32 v61, v61, v211
  v_mul_f32 v62, v62, v211
  v_mul_f32 v63, v63, v211
  v_exp_f32 v192, v112
  v_exp_f32 v193, v113
  v_exp_f32 v194, v114
  v_add_f32 v201, v192, v193
  v_cvt_pk_bf16_f32 v136, v192, v193
  v_exp_f32 v195, v115
  v_add_f32 v201, v201, v194
  v_exp_f32 v196, v116
  v_add_f32 v201, v201, v195
  v_cvt_pk_bf16_f32 v137, v194, v195
  v_exp_f32 v197, v117
  v_add_f32 v201, v201, v196
  v_exp_f32 v198, v118
  v_add_f32 v201, v201, v197
  v_cvt_pk_bf16_f32 v138, v196, v197
  v_exp_f32 v199, v119
  v_add_f32 v201, v201, v198
  v_exp_f32 v192, v120
  v_add_f32 v201, v201, v199
  v_cvt_pk_bf16_f32 v139, v198, v199
  v_exp_f32 v193, v121
  v_add_f32 v201, v201, v192
  v_exp_f32 v194, v122
  v_add_f32 v201, v201, v193
  v_cvt_pk_bf16_f32 v140, v192, v193
  v_exp_f32 v195, v123
  v_add_f32 v201, v201, v194
  v_exp_f32 v196, v124
  v_add_f32 v201, v201, v195
  v_cvt_pk_bf16_f32 v141, v194, v195
  v_exp_f32 v197, v125
  v_add_f32 v201, v201, v196
  v_exp_f32 v198, v126
  v_add_f32 v201, v201, v197
  v_cvt_pk_bf16_f32 v142, v196, v197
  v_exp_f32 v199, v127
  v_add_f32 v201, v201, v198
  s_nop 0
  v_add_f32 v201, v201, v199
  v_cvt_pk_bf16_f32 v143, v198, v199
  s_nop 1
  s_branch back_A1m1
slow_A0m0:
  s_nop 15
  v_max3_f32 v210, v96, v97, v98
  v_max3_f32 v210, v210, v99, v100
  v_max3_f32 v210, v210, v101, v102
  v_max3_f32 v210, v210, v103, v104
  v_max3_f32 v210, v210, v105, v106
  v_max3_f32 v210, v210, v107, v108
  v_max3_f32 v210, v210, v109, v110
  v_max_f32 v210, v210, v111
  v_mov_b32 v211, v210
  s_nop 1
  v_permlane32_swap_b32 v210, v211
  s_nop 1
  v_max_f32 v210, v210, v211
  v_max_f32 v210, 0, v210
  v_sub_f32 v211, 0, v210
  v_exp_f32 v211, v211
  v_sub_f32 v96, v96, v210
  v_sub_f32 v112, v112, v210
  v_sub_f32 v144, v144, v210
  v_sub_f32 v97, v97, v210
  v_sub_f32 v113, v113, v210
  v_sub_f32 v145, v145, v210
  v_sub_f32 v98, v98, v210
  v_sub_f32 v114, v114, v210
  v_sub_f32 v146, v146, v210
  v_sub_f32 v99, v99, v210
  v_sub_f32 v115, v115, v210
  v_sub_f32 v147, v147, v210
  v_sub_f32 v100, v100, v210
  v_sub_f32 v116, v116, v210
  v_sub_f32 v148, v148, v210
  v_sub_f32 v101, v101, v210
  v_sub_f32 v117, v117, v210
  v_sub_f32 v149, v149, v210
  v_sub_f32 v102, v102, v210
  v_sub_f32 v118, v118, v210
  v_sub_f32 v150, v150, v210
  v_sub_f32 v103, v103, v210
  v_sub_f32 v119, v119, v210
  v_sub_f32 v151, v151, v210
  v_sub_f32 v104, v104, v210
  v_sub_f32 v120, v120, v210
  v_sub_f32 v152, v152, v210
  v_sub_f32 v105, v105, v210
  v_sub_f32 v121, v121, v210
  v_sub_f32 v153, v153, v210
  v_sub_f32 v106, v106, v210
  v_sub_f32 v122, v122, v210
  v_sub_f32 v154, v154, v210
  v_sub_f32 v107, v107, v210
  v_sub_f32 v123, v123, v210
  v_sub_f32 v155, v155, v210
  v_sub_f32 v108, v108, v210
  v_sub_f32 v124, v124, v210
  v_sub_f32 v156, v156, v210
  v_sub_f32 v109, v109, v210
  v_sub_f32 v125, v125, v210
  v_sub_f32 v157, v157, v210
  v_sub_f32 v110, v110, v210
  v_sub_f32 v126, v126, v210
  v_sub_f32 v158, v158, v210
  v_sub_f32 v111, v111, v210
  v_sub_f32 v127, v127, v210
  v_sub_f32 v159, v159, v210
  v_mul_f32 v200, v200, v211
  v_mul_f32 v0, v0, v211
  v_mul_f32 v1, v1, v211
  v_mul_f32 v2, v2, v211
  v_mul_f32 v3, v3, v211
  v_mul_f32 v4, v4, v211
  v_mul_f32 v5, v5, v211
  v_mul_f32 v6, v6, v211
  v_mul_f32 v7, v7, v211
  v_mul_f32 v8, v8, v211
  v_mul_f32 v9, v9, v211
  v_mul_f32 v10, v10, v211
  v_mul_f32 v11, v11, v211
  v_mul_f32 v12, v12, v211
  v_mul_f32 v13, v13, v211
  v_mul_f32 v14, v14, v211
  v_mul_f32 v15, v15, v211
  v_mul_f32 v16, v16, v211
  v_mul_f32 v17, v17, v211
  v_mul_f32 v18, v18, v211
  v_mul_f32 v19, v19, v211
  v_mul_f32 v20, v20, v211
  v_mul_f32 v21, v21, v211
  v_mul_f32 v22, v22, v211
  v_mul_f32 v23, v23, v211
  v_mul_f32 v24, v24, v211
  v_mul_f32 v25, v25, v211
  v_mul_f32 v26, v26, v211
  v_mul_f32 v27, v27, v211
  v_mul_f32 v28, v28, v211
  v_mul_f32 v29, v29, v211
  v_mul_f32 v30, v30, v211
  v_mul_f32 v31, v31, v211
  v_mul_f32 v32, v32, v211
  v_mul_f32 v33, v33, v211
  v_mul_f32 v34, v34, v211
  v_mul_f32 v35, v35, v211
  v_mul_f32 v36, v36, v211
  v_mul_f32 v37, v37, v211
  v_mul_f32 v38, v38, v211
  v_mul_f32 v39, v39, v211
  v_mul_f32 v40, v40, v211
  v_mul_f32 v41, v41, v211
  v_mul_f32 v42, v42, v211
  v_mul_f32 v43, v43, v211
  v_mul_f32 v44, v44, v211
  v_mul_f32 v45, v45, v211
  v_mul_f32 v46, v46, v211
  v_mul_f32 v47, v47, v211
  v_mul_f32 v48, v48, v211
  v_mul_f32 v49, v49, v211
  v_mul_f32 v50, v50, v211
  v_mul_f32 v51, v51, v211
  v_mul_f32 v52, v52, v211
  v_mul_f32 v53, v53, v211
  v_mul_f32 v54, v54, v211
  v_mul_f32 v55, v55, v211
  v_mul_f32 v56, v56, v211
  v_mul_f32 v57, v57, v211
  v_mul_f32 v58, v58, v211
  v_mul_f32 v59, v59, v211
  v_mul_f32 v60, v60, v211
  v_mul_f32 v61, v61, v211
  v_mul_f32 v62, v62, v211
  v_mul_f32 v63, v63, v211
  v_exp_f32 v192, v96
  v_exp_f32 v193, v97
  v_exp_f32 v194, v98
  v_add_f32 v201, v192, v193
  v_cvt_pk_bf16_f32 v128, v192, v193
  v_exp_f32 v195, v99
  v_add_f32 v201, v201, v194
  v_exp_f32 v196, v100
  v_add_f32 v201, v201, v195
  v_cvt_pk_bf16_f32 v129, v194, v195
  v_exp_f32 v197, v101
  v_add_f32 v201, v201, v196
  v_exp_f32 v198, v102
  v_add_f32 v201, v201, v197
  v_cvt_pk_bf16_f32 v130, v196, v197
  v_exp_f32 v199, v103
  v_add_f32 v201, v201, v198
  v_exp_f32 v192, v104
  v_add_f32 v201, v201, v199
  v_cvt_pk_bf16_f32 v131, v198, v199
  v_exp_f32 v193, v105
  v_add_f32 v201, v201, v192
  v_exp_f32 v194, v106
  v_add_f32 v201, v201, v193
  v_cvt_pk_bf16_f32 v132, v192, v193
  v_exp_f32 v195, v107
  v_add_f32 v201, v201, v194
  v_exp_f32 v196, v108
  v_add_f32 v201, v201, v195
  v_cvt_pk_bf16_f32 v133, v194, v195
  v_exp_f32 v197, v109
  v_add_f32 v201, v201, v196
  v_exp_f32 v198, v110
  v_add_f32 v201, v201, v197
  v_cvt_pk_bf16_f32 v134, v196, v197
  v_exp_f32 v199, v111
  v_add_f32 v201, v201, v198
  s_nop 0
  v_add_f32 v201, v201, v199
  v_cvt_pk_bf16_f32 v135, v198, v199
  s_nop 1
  s_branch back_A0m0
slow_Bn0:
  s_nop 15
  v_max3_f32 v210, v96, v97, v98
  v_max3_f32 v210, v210, v99, v100
  v_max3_f32 v210, v210, v101, v102
  v_max3_f32 v210, v210, v103, v104
  v_max3_f32 v210, v210, v105, v106
  v_max3_f32 v210, v210, v107, v108
  v_max3_f32 v210, v210, v109, v110
  v_max_f32 v210, v210, v111
  v_mov_b32 v211, v210
  s_nop 1
  v_permlane32_swap_b32 v210, v211
  s_nop 1
  v_max_f32 v210, v210, v211
  v_max_f32 v210, 0, v210
  v_sub_f32 v211, 0, v210
  v_exp_f32 v211, v211
  v_sub_f32 v96, v96, v210
  v_sub_f32 v112, v112, v210
  v_sub_f32 v144, v144, v210
  v_sub_f32 v97, v97, v210
  v_sub_f32 v113, v113, v210
  v_sub_f32 v145, v145, v210
  v_sub_f32 v98, v98, v210
  v_sub_f32 v114, v114, v210
  v_sub_f32 v146, v146, v210
  v_sub_f32 v99, v99, v210
  v_sub_f32 v115, v115, v210
  v_sub_f32 v147, v147, v210
  v_sub_f32 v100, v100, v210
  v_sub_f32 v116, v116, v210
  v_sub_f32 v148, v148, v210
  v_sub_f32 v101, v101, v210
  v_sub_f32 v117, v117, v210
  v_sub_f32 v149, v149, v210
  v_sub_f32 v102, v102, v210
  v_sub_f32 v118, v118, v210
  v_sub_f32 v150, v150, v210
  v_sub_f32 v103, v103, v210
  v_sub_f32 v119, v119, v210
  v_sub_f32 v151, v151, v210
  v_sub_f32 v104, v104, v210
  v_sub_f32 v120, v120, v210
  v_sub_f32 v152, v152, v210
  v_sub_f32 v105, v105, v210
  v_sub_f32 v121, v121, v210
  v_sub_f32 v153, v153, v210
  v_sub_f32 v106, v106, v210
  v_sub_f32 v122, v122, v210
  v_sub_f32 v154, v154, v210
  v_sub_f32 v107, v107, v210
  v_sub_f32 v123, v123, v210
  v_sub_f32 v155, v155, v210
  v_sub_f32 v108, v108, v210
  v_sub_f32 v124, v124, v210
  v_sub_f32 v156, v156, v210
  v_sub_f32 v109, v109, v210
  v_sub_f32 v125, v125, v210
  v_sub_f32 v157, v157, v210
  v_sub_f32 v110, v110, v210
  v_sub_f32 v126, v126, v210
  v_sub_f32 v158, v158, v210
  v_sub_f32 v111, v111, v210
  v_sub_f32 v127, v127, v210
  v_sub_f32 v159, v159, v210
  v_mul_f32 v200, v200, v211
  v_mul_f32 v0, v0, v211
  v_mul_f32 v1, v1, v211
  v_mul_f32 v2, v2, v211
  v_mul_f32 v3, v3, v211
  v_mul_f32 v4, v4, v211
  v_mul_f32 v5, v5, v211
  v_mul_f32 v6, v6, v211
  v_mul_f32 v7, v7, v211
  v_mul_f32 v8, v8, v211
  v_mul_f32 v9, v9, v211
  v_mul_f32 v10, v10, v211
  v_mul_f32 v11, v11, v211
  v_mul_f32 v12, v12, v211
  v_mul_f32 v13, v13, v211
  v_mul_f32 v14, v14, v211
  v_mul_f32 v15, v15, v211
  v_mul_f32 v16, v16, v211
  v_mul_f32 v17, v17, v211
  v_mul_f32 v18, v18, v211
  v_mul_f32 v19, v19, v211
  v_mul_f32 v20, v20, v211
  v_mul_f32 v21, v21, v211
  v_mul_f32 v22, v22, v211
  v_mul_f32 v23, v23, v211
  v_mul_f32 v24, v24, v211
  v_mul_f32 v25, v25, v211
  v_mul_f32 v26, v26, v211
  v_mul_f32 v27, v27, v211
  v_mul_f32 v28, v28, v211
  v_mul_f32 v29, v29, v211
  v_mul_f32 v30, v30, v211
  v_mul_f32 v31, v31, v211
  v_mul_f32 v32, v32, v211
  v_mul_f32 v33, v33, v211
  v_mul_f32 v34, v34, v211
  v_mul_f32 v35, v35, v211
  v_mul_f32 v36, v36, v211
  v_mul_f32 v37, v37, v211
  v_mul_f32 v38, v38, v211
  v_mul_f32 v39, v39, v211
  v_mul_f32 v40, v40, v211
  v_mul_f32 v41, v41, v211
  v_mul_f32 v42, v42, v211
  v_mul_f32 v43, v43, v211
  v_mul_f32 v44, v44, v211
  v_mul_f32 v45, v45, v211
  v_mul_f32 v46, v46, v211
  v_mul_f32 v47, v47, v211
  v_mul_f32 v48, v48, v211
  v_mul_f32 v49, v49, v211
  v_mul_f32 v50, v50, v211
  v_mul_f32 v51, v51, v211
  v_mul_f32 v52, v52, v211
  v_mul_f32 v53, v53, v211
  v_mul_f32 v54, v54, v211
  v_mul_f32 v55, v55, v211
  v_mul_f32 v56, v56, v211
  v_mul_f32 v57, v57, v211
  v_mul_f32 v58, v58, v211
  v_mul_f32 v59, v59, v211
  v_mul_f32 v60, v60, v211
  v_mul_f32 v61, v61, v211
  v_mul_f32 v62, v62, v211
  v_mul_f32 v63, v63, v211
  v_exp_f32 v192, v96
  v_exp_f32 v193, v97
  v_exp_f32 v194, v98
  v_add_f32 v201, v192, v193
  v_cvt_pk_bf16_f32 v128, v192, v193
  v_exp_f32 v195, v99
  v_add_f32 v201, v201, v194
  v_exp_f32 v196, v100
  v_add_f32 v201, v201, v195
  v_cvt_pk_bf16_f32 v129, v194, v195
  v_exp_f32 v197, v101
  v_add_f32 v201, v201, v196
  v_exp_f32 v198, v102
  v_add_f32 v201, v201, v197
  v_cvt_pk_bf16_f32 v130, v196, v197
  v_exp_f32 v199, v103
  v_add_f32 v201, v201, v198
  v_exp_f32 v192, v104
  v_add_f32 v201, v201, v199
  v_cvt_pk_bf16_f32 v131, v198, v199
  v_exp_f32 v193, v105
  v_add_f32 v201, v201, v192
  v_exp_f32 v194, v106
  v_add_f32 v201, v201, v193
  v_cvt_pk_bf16_f32 v132, v192, v193
  v_exp_f32 v195, v107
  v_add_f32 v201, v201, v194
  v_exp_f32 v196, v108
  v_add_f32 v201, v201, v195
  v_cvt_pk_bf16_f32 v133, v194, v195
  v_exp_f32 v197, v109
  v_add_f32 v201, v201, v196
  v_exp_f32 v198, v110
  v_add_f32 v201, v201, v197
  v_cvt_pk_bf16_f32 v134, v196, v197
  v_exp_f32 v199, v111
  v_add_f32 v201, v201, v198
  s_nop 0
  v_add_f32 v201, v201, v199
  v_cvt_pk_bf16_f32 v135, v198, v199
  s_nop 1
  s_branch back_Bn0
slow_Bn1:
  s_nop 15
  v_max3_f32 v210, v112, v113, v114
  v_max3_f32 v210, v210, v115, v116
  v_max3_f32 v210, v210, v117, v118
  v_max3_f32 v210, v210, v119, v120
  v_max3_f32 v210, v210, v121, v122
  v_max3_f32 v210, v210, v123, v124
  v_max3_f32 v210, v210, v125, v126
  v_max_f32 v210, v210, v127
  v_mov_b32 v211, v210
  s_nop 1
  v_permlane32_swap_b32 v210, v211
  s_nop 1
  v_max_f32 v210, v210, v211
  v_max_f32 v210, 0, v210
  v_sub_f32 v211, 0, v210
  v_exp_f32 v211, v211
  v_sub_f32 v112, v112, v210
  v_sub_f32 v96, v96, v210
  v_sub_f32 v144, v144, v210
  v_sub_f32 v113, v113, v210
  v_sub_f32 v97, v97, v210
  v_sub_f32 v145, v145, v210
  v_sub_f32 v114, v114, v210
  v_sub_f32 v98, v98, v210
  v_sub_f32 v146, v146, v210
  v_sub_f32 v115, v115, v210
  v_sub_f32 v99, v99, v210
  v_sub_f32 v147, v147, v210
  v_sub_f32 v116, v116, v210
  v_sub_f32 v100, v100, v210
  v_sub_f32 v148, v148, v210
  v_sub_f32 v117, v117, v210
  v_sub_f32 v101, v101, v210
  v_sub_f32 v149, v149, v210
  v_sub_f32 v118, v118, v210
  v_sub_f32 v102, v102, v210
  v_sub_f32 v150, v150, v210
  v_sub_f32 v119, v119, v210
  v_sub_f32 v103, v103, v210
  v_sub_f32 v151, v151, v210
  v_sub_f32 v120, v120, v210
  v_sub_f32 v104, v104, v210
  v_sub_f32 v152, v152, v210
  v_sub_f32 v121, v121, v210
  v_sub_f32 v105, v105, v210
  v_sub_f32 v153, v153, v210
  v_sub_f32 v122, v122, v210
  v_sub_f32 v106, v106, v210
  v_sub_f32 v154, v154, v210
  v_sub_f32 v123, v123, v210
  v_sub_f32 v107, v107, v210
  v_sub_f32 v155, v155, v210
  v_sub_f32 v124, v124, v210
  v_sub_f32 v108, v108, v210
  v_sub_f32 v156, v156, v210
  v_sub_f32 v125, v125, v210
  v_sub_f32 v109, v109, v210
  v_sub_f32 v157, v157, v210
  v_sub_f32 v126, v126, v210
  v_sub_f32 v110, v110, v210
  v_sub_f32 v158, v158, v210
  v_sub_f32 v127, v127, v210
  v_sub_f32 v111, v111, v210
  v_sub_f32 v159, v159, v210
  v_mul_f32 v200, v200, v211
  v_mul_f32 v0, v0, v211
  v_mul_f32 v1, v1, v211
  v_mul_f32 v2, v2, v211
  v_mul_f32 v3, v3, v211
  v_mul_f32 v4, v4, v211
  v_mul_f32 v5, v5, v211
  v_mul_f32 v6, v6, v211
  v_mul_f32 v7, v7, v211
  v_mul_f32 v8, v8, v211
  v_mul_f32 v9, v9, v211
  v_mul_f32 v10, v10, v211
  v_mul_f32 v11, v11, v211
  v_mul_f32 v12, v12, v211
  v_mul_f32 v13, v13, v211
  v_mul_f32 v14, v14, v211
  v_mul_f32 v15, v15, v211
  v_mul_f32 v16, v16, v211
  v_mul_f32 v17, v17, v211
  v_mul_f32 v18, v18, v211
  v_mul_f32 v19, v19, v211
  v_mul_f32 v20, v20, v211
  v_mul_f32 v21, v21, v211
  v_mul_f32 v22, v22, v211
  v_mul_f32 v23, v23, v211
  v_mul_f32 v24, v24, v211
  v_mul_f32 v25, v25, v211
  v_mul_f32 v26, v26, v211
  v_mul_f32 v27, v27, v211
  v_mul_f32 v28, v28, v211
  v_mul_f32 v29, v29, v211
  v_mul_f32 v30, v30, v211
  v_mul_f32 v31, v31, v211
  v_mul_f32 v32, v32, v211
  v_mul_f32 v33, v33, v211
  v_mul_f32 v34, v34, v211
  v_mul_f32 v35, v35, v211
  v_mul_f32 v36, v36, v211
  v_mul_f32 v37, v37, v211
  v_mul_f32 v38, v38, v211
  v_mul_f32 v39, v39, v211
  v_mul_f32 v40, v40, v211
  v_mul_f32 v41, v41, v211
  v_mul_f32 v42, v42, v211
  v_mul_f32 v43, v43, v211
  v_mul_f32 v44, v44, v211
  v_mul_f32 v45, v45, v211
  v_mul_f32 v46, v46, v211
  v_mul_f32 v47, v47, v211
  v_mul_f32 v48, v48, v211
  v_mul_f32 v49, v49, v211
  v_mul_f32 v50, v50, v211
  v_mul_f32 v51, v51, v211
  v_mul_f32 v52, v52, v211
  v_mul_f32 v53, v53, v211
  v_mul_f32 v54, v54, v211
  v_mul_f32 v55, v55, v211
  v_mul_f32 v56, v56, v211
  v_mul_f32 v57, v57, v211
  v_mul_f32 v58, v58, v211
  v_mul_f32 v59, v59, v211
  v_mul_f32 v60, v60, v211
  v_mul_f32 v61, v61, v211
  v_mul_f32 v62, v62, v211
  v_mul_f32 v63, v63, v211
  v_exp_f32 v192, v112
  v_exp_f32 v193, v113
  v_exp_f32 v194, v114
  v_add_f32 v201, v192, v193
  v_cvt_pk_bf16_f32 v136, v192, v193
  v_exp_f32 v195, v115
  v_add_f32 v201, v201, v194
  v_exp_f32 v196, v116
  v_add_f32 v201, v201, v195
  v_cvt_pk_bf16_f32 v137, v194, v195
  v_exp_f32 v197, v117
  v_add_f32 v201, v201, v196
  v_exp_f32 v198, v118
  v_add_f32 v201, v201, v197
  v_cvt_pk_bf16_f32 v138, v196, v197
  v_exp_f32 v199, v119
  v_add_f32 v201, v201, v198
  v_exp_f32 v192, v120
  v_add_f32 v201, v201, v199
  v_cvt_pk_bf16_f32 v139, v198, v199
  v_exp_f32 v193, v121
  v_add_f32 v201, v201, v192
  v_exp_f32 v194, v122
  v_add_f32 v201, v201, v193
  v_cvt_pk_bf16_f32 v140, v192, v193
  v_exp_f32 v195, v123
  v_add_f32 v201, v201, v194
  v_exp_f32 v196, v124
  v_add_f32 v201, v201, v195
  v_cvt_pk_bf16_f32 v141, v194, v195
  v_exp_f32 v197, v125
  v_add_f32 v201, v201, v196
  v_exp_f32 v198, v126
  v_add_f32 v201, v201, v197
  v_cvt_pk_bf16_f32 v142, v196, v197
  v_exp_f32 v199, v127
  v_add_f32 v201, v201, v198
  s_nop 0
  v_add_f32 v201, v201, v199
  v_cvt_pk_bf16_f32 v143, v198, v199
  s_nop 1
  s_branch back_Bn1
slow_Bn2:
  s_nop 15
  v_max3_f32 v210, v96, v97, v98
  v_max3_f32 v210, v210, v99, v100
  v_max3_f32 v210, v210, v101, v102
  v_max3_f32 v210, v210, v103, v104
  v_max3_f32 v210, v210, v105, v106
  v_max3_f32 v210, v210, v107, v108
  v_max3_f32 v210, v210, v109, v110
  v_max_f32 v210, v210, v111
  v_mov_b32 v211, v210
  s_nop 1
  v_permlane32_swap_b32 v210, v211
  s_nop 1
  v_max_f32 v210, v210, v211
  v_max_f32 v210, 0, v210
  v_sub_f32 v211, 0, v210
  v_exp_f32 v211, v211
  v_sub_f32 v96, v96, v210
  v_sub_f32 v112, v112, v210
  v_sub_f32 v144, v144, v210
  v_sub_f32 v97, v97, v210
  v_sub_f32 v113, v113, v210
  v_sub_f32 v145, v145, v210
  v_sub_f32 v98, v98, v210
  v_sub_f32 v114, v114, v210
  v_sub_f32 v146, v146, v210
  v_sub_f32 v99, v99, v210
  v_sub_f32 v115, v115, v210
  v_sub_f32 v147, v147, v210
  v_sub_f32 v100, v100, v210
  v_sub_f32 v116, v116, v210
  v_sub_f32 v148, v148, v210
  v_sub_f32 v101, v101, v210
  v_sub_f32 v117, v117, v210
  v_sub_f32 v149, v149, v210
  v_sub_f32 v102, v102, v210
  v_sub_f32 v118, v118, v210
  v_sub_f32 v150, v150, v210
  v_sub_f32 v103, v103, v210
  v_sub_f32 v119, v119, v210
  v_sub_f32 v151, v151, v210
  v_sub_f32 v104, v104, v210
  v_sub_f32 v120, v120, v210
  v_sub_f32 v152, v152, v210
  v_sub_f32 v105, v105, v210
  v_sub_f32 v121, v121, v210
  v_sub_f32 v153, v153, v210
  v_sub_f32 v106, v106, v210
  v_sub_f32 v122, v122, v210
  v_sub_f32 v154, v154, v210
  v_sub_f32 v107, v107, v210
  v_sub_f32 v123, v123, v210
  v_sub_f32 v155, v155, v210
  v_sub_f32 v108, v108, v210
  v_sub_f32 v124, v124, v210
  v_sub_f32 v156, v156, v210
  v_sub_f32 v109, v109, v210
  v_sub_f32 v125, v125, v210
  v_sub_f32 v157, v157, v210
  v_sub_f32 v110, v110, v210
  v_sub_f32 v126, v126, v210
  v_sub_f32 v158, v158, v210
  v_sub_f32 v111, v111, v210
  v_sub_f32 v127, v127, v210
  v_sub_f32 v159, v159, v210
  v_mul_f32 v200, v200, v211
  v_mul_f32 v0, v0, v211
  v_mul_f32 v1, v1, v211
  v_mul_f32 v2, v2, v211
  v_mul_f32 v3, v3, v211
  v_mul_f32 v4, v4, v211
  v_mul_f32 v5, v5, v211
  v_mul_f32 v6, v6, v211
  v_mul_f32 v7, v7, v211
  v_mul_f32 v8, v8, v211
  v_mul_f32 v9, v9, v211
  v_mul_f32 v10, v10, v211
  v_mul_f32 v11, v11, v211
  v_mul_f32 v12, v12, v211
  v_mul_f32 v13, v13, v211
  v_mul_f32 v14, v14, v211
  v_mul_f32 v15, v15, v211
  v_mul_f32 v16, v16, v211
  v_mul_f32 v17, v17, v211
  v_mul_f32 v18, v18, v211
  v_mul_f32 v19, v19, v211
  v_mul_f32 v20, v20, v211
  v_mul_f32 v21, v21, v211
  v_mul_f32 v22, v22, v211
  v_mul_f32 v23, v23, v211
  v_mul_f32 v24, v24, v211
  v_mul_f32 v25, v25, v211
  v_mul_f32 v26, v26, v211
  v_mul_f32 v27, v27, v211
  v_mul_f32 v28, v28, v211
  v_mul_f32 v29, v29, v211
  v_mul_f32 v30, v30, v211
  v_mul_f32 v31, v31, v211
  v_mul_f32 v32, v32, v211
  v_mul_f32 v33, v33, v211
  v_mul_f32 v34, v34, v211
  v_mul_f32 v35, v35, v211
  v_mul_f32 v36, v36, v211
  v_mul_f32 v37, v37, v211
  v_mul_f32 v38, v38, v211
  v_mul_f32 v39, v39, v211
  v_mul_f32 v40, v40, v211
  v_mul_f32 v41, v41, v211
  v_mul_f32 v42, v42, v211
  v_mul_f32 v43, v43, v211
  v_mul_f32 v44, v44, v211
  v_mul_f32 v45, v45, v211
  v_mul_f32 v46, v46, v211
  v_mul_f32 v47, v47, v211
  v_mul_f32 v48, v48, v211
  v_mul_f32 v49, v49, v211
  v_mul_f32 v50, v50, v211
  v_mul_f32 v51, v51, v211
  v_mul_f32 v52, v52, v211
  v_mul_f32 v53, v53, v211
  v_mul_f32 v54, v54, v211
  v_mul_f32 v55, v55, v211
  v_mul_f32 v56, v56, v211
  v_mul_f32 v57, v57, v211
  v_mul_f32 v58, v58, v211
  v_mul_f32 v59, v59, v211
  v_mul_f32 v60, v60, v211
  v_mul_f32 v61, v61, v211
  v_mul_f32 v62, v62, v211
  v_mul_f32 v63, v63, v211
  v_exp_f32 v192, v96
  v_exp_f32 v193, v97
  v_exp_f32 v194, v98
  v_add_f32 v201, v192, v193
  v_cvt_pk_bf16_f32 v128, v192, v193
  v_exp_f32 v195, v99
  v_add_f32 v201, v201, v194
  v_exp_f32 v196, v100
  v_add_f32 v201, v201, v195
  v_cvt_pk_bf16_f32 v129, v194, v195
  v_exp_f32 v197, v101
  v_add_f32 v201, v201, v196
  v_exp_f32 v198, v102
  v_add_f32 v201, v201, v197
  v_cvt_pk_bf16_f32 v130, v196, v197
  v_exp_f32 v199, v103
  v_add_f32 v201, v201, v198
  v_exp_f32 v192, v104
  v_add_f32 v201, v201, v199
  v_cvt_pk_bf16_f32 v131, v198, v199
  v_exp_f32 v193, v105
  v_add_f32 v201, v201, v192
  v_exp_f32 v194, v106
  v_add_f32 v201, v201, v193
  v_cvt_pk_bf16_f32 v132, v192, v193
  v_exp_f32 v195, v107
  v_add_f32 v201, v201, v194
  v_exp_f32 v196, v108
  v_add_f32 v201, v201, v195
  v_cvt_pk_bf16_f32 v133, v194, v195
  v_exp_f32 v197, v109
  v_add_f32 v201, v201, v196
  v_exp_f32 v198, v110
  v_add_f32 v201, v201, v197
  v_cvt_pk_bf16_f32 v134, v196, v197
  v_exp_f32 v199, v111
  v_add_f32 v201, v201, v198
  s_nop 0
  v_add_f32 v201, v201, v199
  v_cvt_pk_bf16_f32 v135, v198, v199
  s_nop 1
  s_branch back_Bn2
slow_Bn3:
  s_nop 15
  v_max3_f32 v210, v112, v113, v114
  v_max3_f32 v210, v210, v115, v116
  v_max3_f32 v210, v210, v117, v118
  v_max3_f32 v210, v210, v119, v120
  v_max3_f32 v210, v210, v121, v122
  v_max3_f32 v210, v210, v123, v124
  v_max3_f32 v210, v210, v125, v126
  v_max_f32 v210, v210, v127
  v_mov_b32 v211, v210
  s_nop 1
  v_permlane32_swap_b32 v210, v211
  s_nop 1
  v_max_f32 v210, v210, v211
  v_max_f32 v210, 0, v210
  v_sub_f32 v211, 0, v210
  v_exp_f32 v211, v211
  v_sub_f32 v112, v112, v210
  v_sub_f32 v96, v96, v210
  v_sub_f32 v144, v144, v210
  v_sub_f32 v113, v113, v210
  v_sub_f32 v97, v97, v210
  v_sub_f32 v145, v145, v210
  v_sub_f32 v114, v114, v210
  v_sub_f32 v98, v98, v210
  v_sub_f32 v146, v146, v210
  v_sub_f32 v115, v115, v210
  v_sub_f32 v99, v99, v210
  v_sub_f32 v147, v147, v210
  v_sub_f32 v116, v116, v210
  v_sub_f32 v100, v100, v210
  v_sub_f32 v148, v148, v210
  v_sub_f32 v117, v117, v210
  v_sub_f32 v101, v101, v210
  v_sub_f32 v149, v149, v210
  v_sub_f32 v118, v118, v210
  v_sub_f32 v102, v102, v210
  v_sub_f32 v150, v150, v210
  v_sub_f32 v119, v119, v210
  v_sub_f32 v103, v103, v210
  v_sub_f32 v151, v151, v210
  v_sub_f32 v120, v120, v210
  v_sub_f32 v104, v104, v210
  v_sub_f32 v152, v152, v210
  v_sub_f32 v121, v121, v210
  v_sub_f32 v105, v105, v210
  v_sub_f32 v153, v153, v210
  v_sub_f32 v122, v122, v210
  v_sub_f32 v106, v106, v210
  v_sub_f32 v154, v154, v210
  v_sub_f32 v123, v123, v210
  v_sub_f32 v107, v107, v210
  v_sub_f32 v155, v155, v210
  v_sub_f32 v124, v124, v210
  v_sub_f32 v108, v108, v210
  v_sub_f32 v156, v156, v210
  v_sub_f32 v125, v125, v210
  v_sub_f32 v109, v109, v210
  v_sub_f32 v157, v157, v210
  v_sub_f32 v126, v126, v210
  v_sub_f32 v110, v110, v210
  v_sub_f32 v158, v158, v210
  v_sub_f32 v127, v127, v210
  v_sub_f32 v111, v111, v210
  v_sub_f32 v159, v159, v210
  v_mul_f32 v200, v200, v211
  v_mul_f32 v0, v0, v211
  v_mul_f32 v1, v1, v211
  v_mul_f32 v2, v2, v211
  v_mul_f32 v3, v3, v211
  v_mul_f32 v4, v4, v211
  v_mul_f32 v5, v5, v211
  v_mul_f32 v6, v6, v211
  v_mul_f32 v7, v7, v211
  v_mul_f32 v8, v8, v211
  v_mul_f32 v9, v9, v211
  v_mul_f32 v10, v10, v211
  v_mul_f32 v11, v11, v211
  v_mul_f32 v12, v12, v211
  v_mul_f32 v13, v13, v211
  v_mul_f32 v14, v14, v211
  v_mul_f32 v15, v15, v211
  v_mul_f32 v16, v16, v211
  v_mul_f32 v17, v17, v211
  v_mul_f32 v18, v18, v211
  v_mul_f32 v19, v19, v211
  v_mul_f32 v20, v20, v211
  v_mul_f32 v21, v21, v211
  v_mul_f32 v22, v22, v211
  v_mul_f32 v23, v23, v211
  v_mul_f32 v24, v24, v211
  v_mul_f32 v25, v25, v211
  v_mul_f32 v26, v26, v211
  v_mul_f32 v27, v27, v211
  v_mul_f32 v28, v28, v211
  v_mul_f32 v29, v29, v211
  v_mul_f32 v30, v30, v211
  v_mul_f32 v31, v31, v211
  v_mul_f32 v32, v32, v211
  v_mul_f32 v33, v33, v211
  v_mul_f32 v34, v34, v211
  v_mul_f32 v35, v35, v211
  v_mul_f32 v36, v36, v211
  v_mul_f32 v37, v37, v211
  v_mul_f32 v38, v38, v211
  v_mul_f32 v39, v39, v211
  v_mul_f32 v40, v40, v211
  v_mul_f32 v41, v41, v211
  v_mul_f32 v42, v42, v211
  v_mul_f32 v43, v43, v211
  v_mul_f32 v44, v44, v211
  v_mul_f32 v45, v45, v211
  v_mul_f32 v46, v46, v211
  v_mul_f32 v47, v47, v211
  v_mul_f32 v48, v48, v211
  v_mul_f32 v49, v49, v211
  v_mul_f32 v50, v50, v211
  v_mul_f32 v51, v51, v211
  v_mul_f32 v52, v52, v211
  v_mul_f32 v53, v53, v211
  v_mul_f32 v54, v54, v211
  v_mul_f32 v55, v55, v211
  v_mul_f32 v56, v56, v211
  v_mul_f32 v57, v57, v211
  v_mul_f32 v58, v58, v211
  v_mul_f32 v59, v59, v211
  v_mul_f32 v60, v60, v211
  v_mul_f32 v61, v61, v211
  v_mul_f32 v62, v62, v211
  v_mul_f32 v63, v63, v211
  v_exp_f32 v192, v112
  v_exp_f32 v193, v113
  v_exp_f32 v194, v114
  v_add_f32 v201, v192, v193
  v_cvt_pk_bf16_f32 v136, v192, v193
  v_exp_f32 v195, v115
  v_add_f32 v201, v201, v194
  v_exp_f32 v196, v116
  v_add_f32 v201, v201, v195
  v_cvt_pk_bf16_f32 v137, v194, v195
  v_exp_f32 v197, v117
  v_add_f32 v201, v201, v196
  v_exp_f32 v198, v118
  v_add_f32 v201, v201, v197
  v_cvt_pk_bf16_f32 v138, v196, v197
  v_exp_f32 v199, v119
  v_add_f32 v201, v201, v198
  v_exp_f32 v192, v120
  v_add_f32 v201, v201, v199
  v_cvt_pk_bf16_f32 v139, v198, v199
  v_exp_f32 v193, v121
  v_add_f32 v201, v201, v192
  v_exp_f32 v194, v122
  v_add_f32 v201, v201, v193
  v_cvt_pk_bf16_f32 v140, v192, v193
  v_exp_f32 v195, v123
  v_add_f32 v201, v201, v194
  v_exp_f32 v196, v124
  v_add_f32 v201, v201, v195
  v_cvt_pk_bf16_f32 v141, v194, v195
  v_exp_f32 v197, v125
  v_add_f32 v201, v201, v196
  v_exp_f32 v198, v126
  v_add_f32 v201, v201, v197
  v_cvt_pk_bf16_f32 v142, v196, v197
  v_exp_f32 v199, v127
  v_add_f32 v201, v201, v198
  s_nop 0
  v_add_f32 v201, v201, v199
  v_cvt_pk_bf16_f32 v143, v198, v199
  s_nop 1
  s_branch back_Bn3
slow_B3m0:
  s_nop 15
  v_max3_f32 v210, v96, v97, v98
  v_max3_f32 v210, v210, v99, v100
  v_max3_f32 v210, v210, v101, v102
  v_max3_f32 v210, v210, v103, v104
  v_max3_f32 v210, v210, v105, v106
  v_max3_f32 v210, v210, v107, v108
  v_max3_f32 v210, v210, v109, v110
  v_max_f32 v210, v210, v111
  v_mov_b32 v211, v210
  s_nop 1
  v_permlane32_swap_b32 v210, v211
  s_nop 1
  v_max_f32 v210, v210, v211
  v_max_f32 v210, 0, v210
  v_sub_f32 v211, 0, v210
  v_exp_f32 v211, v211
  v_sub_f32 v96, v96, v210
  v_sub_f32 v112, v112, v210
  v_sub_f32 v144, v144, v210
  v_sub_f32 v97, v97, v210
  v_sub_f32 v113, v113, v210
  v_sub_f32 v145, v145, v210
  v_sub_f32 v98, v98, v210
  v_sub_f32 v114, v114, v210
  v_sub_f32 v146, v146, v210
  v_sub_f32 v99, v99, v210
  v_sub_f32 v115, v115, v210
  v_sub_f32 v147, v147, v210
  v_sub_f32 v100, v100, v210
  v_sub_f32 v116, v116, v210
  v_sub_f32 v148, v148, v210
  v_sub_f32 v101, v101, v210
  v_sub_f32 v117, v117, v210
  v_sub_f32 v149, v149, v210
  v_sub_f32 v102, v102, v210
  v_sub_f32 v118, v118, v210
  v_sub_f32 v150, v150, v210
  v_sub_f32 v103, v103, v210
  v_sub_f32 v119, v119, v210
  v_sub_f32 v151, v151, v210
  v_sub_f32 v104, v104, v210
  v_sub_f32 v120, v120, v210
  v_sub_f32 v152, v152, v210
  v_sub_f32 v105, v105, v210
  v_sub_f32 v121, v121, v210
  v_sub_f32 v153, v153, v210
  v_sub_f32 v106, v106, v210
  v_sub_f32 v122, v122, v210
  v_sub_f32 v154, v154, v210
  v_sub_f32 v107, v107, v210
  v_sub_f32 v123, v123, v210
  v_sub_f32 v155, v155, v210
  v_sub_f32 v108, v108, v210
  v_sub_f32 v124, v124, v210
  v_sub_f32 v156, v156, v210
  v_sub_f32 v109, v109, v210
  v_sub_f32 v125, v125, v210
  v_sub_f32 v157, v157, v210
  v_sub_f32 v110, v110, v210
  v_sub_f32 v126, v126, v210
  v_sub_f32 v158, v158, v210
  v_sub_f32 v111, v111, v210
  v_sub_f32 v127, v127, v210
  v_sub_f32 v159, v159, v210
  v_mul_f32 v200, v200, v211
  v_mul_f32 v0, v0, v211
  v_mul_f32 v1, v1, v211
  v_mul_f32 v2, v2, v211
  v_mul_f32 v3, v3, v211
  v_mul_f32 v4, v4, v211
  v_mul_f32 v5, v5, v211
  v_mul_f32 v6, v6, v211
  v_mul_f32 v7, v7, v211
  v_mul_f32 v8, v8, v211
  v_mul_f32 v9, v9, v211
  v_mul_f32 v10, v10, v211
  v_mul_f32 v11, v11, v211
  v_mul_f32 v12, v12, v211
  v_mul_f32 v13, v13, v211
  v_mul_f32 v14, v14, v211
  v_mul_f32 v15, v15, v211
  v_mul_f32 v16, v16, v211
  v_mul_f32 v17, v17, v211
  v_mul_f32 v18, v18, v211
  v_mul_f32 v19, v19, v211
  v_mul_f32 v20, v20, v211
  v_mul_f32 v21, v21, v211
  v_mul_f32 v22, v22, v211
  v_mul_f32 v23, v23, v211
  v_mul_f32 v24, v24, v211
  v_mul_f32 v25, v25, v211
  v_mul_f32 v26, v26, v211
  v_mul_f32 v27, v27, v211
  v_mul_f32 v28, v28, v211
  v_mul_f32 v29, v29, v211
  v_mul_f32 v30, v30, v211
  v_mul_f32 v31, v31, v211
  v_mul_f32 v32, v32, v211
  v_mul_f32 v33, v33, v211
  v_mul_f32 v34, v34, v211
  v_mul_f32 v35, v35, v211
  v_mul_f32 v36, v36, v211
  v_mul_f32 v37, v37, v211
  v_mul_f32 v38, v38, v211
  v_mul_f32 v39, v39, v211
  v_mul_f32 v40, v40, v211
  v_mul_f32 v41, v41, v211
  v_mul_f32 v42, v42, v211
  v_mul_f32 v43, v43, v211
  v_mul_f32 v44, v44, v211
  v_mul_f32 v45, v45, v211
  v_mul_f32 v46, v46, v211
  v_mul_f32 v47, v47, v211
  v_mul_f32 v48, v48, v211
  v_mul_f32 v49, v49, v211
  v_mul_f32 v50, v50, v211
  v_mul_f32 v51, v51, v211
  v_mul_f32 v52, v52, v211
  v_mul_f32 v53, v53, v211
  v_mul_f32 v54, v54, v211
  v_mul_f32 v55, v55, v211
  v_mul_f32 v56, v56, v211
  v_mul_f32 v57, v57, v211
  v_mul_f32 v58, v58, v211
  v_mul_f32 v59, v59, v211
  v_mul_f32 v60, v60, v211
  v_mul_f32 v61, v61, v211
  v_mul_f32 v62, v62, v211
  v_mul_f32 v63, v63, v211
  v_exp_f32 v192, v96
  v_exp_f32 v193, v97
  v_exp_f32 v194, v98
  v_add_f32 v201, v192, v193
  v_cvt_pk_bf16_f32 v128, v192, v193
  v_exp_f32 v195, v99
  v_add_f32 v201, v201, v194
  v_exp_f32 v196, v100
  v_add_f32 v201, v201, v195
  v_cvt_pk_bf16_f32 v129, v194, v195
  v_exp_f32 v197, v101
  v_add_f32 v201, v201, v196
  v_exp_f32 v198, v102
  v_add_f32 v201, v201, v197
  v_cvt_pk_bf16_f32 v130, v196, v197
  v_exp_f32 v199, v103
  v_add_f32 v201, v201, v198
  v_exp_f32 v192, v104
  v_add_f32 v201, v201, v199
  v_cvt_pk_bf16_f32 v131, v198, v199
  v_exp_f32 v193, v105
  v_add_f32 v201, v201, v192
  v_exp_f32 v194, v106
  v_add_f32 v201, v201, v193
  v_cvt_pk_bf16_f32 v132, v192, v193
  v_exp_f32 v195, v107
  v_add_f32 v201, v201, v194
  v_exp_f32 v196, v108
  v_add_f32 v201, v201, v195
  v_cvt_pk_bf16_f32 v133, v194, v195
  v_exp_f32 v197, v109
  v_add_f32 v201, v201, v196
  v_exp_f32 v198, v110
  v_add_f32 v201, v201, v197
  v_cvt_pk_bf16_f32 v134, v196, v197
  v_exp_f32 v199, v111
  v_add_f32 v201, v201, v198
  s_nop 0
  v_add_f32 v201, v201, v199
  v_cvt_pk_bf16_f32 v135, v198, v199
  s_nop 1
  s_branch back_B3m0
slow_B3m1:
  s_nop 15
  v_max3_f32 v210, v112, v113, v114
  v_max3_f32 v210, v210, v115, v116
  v_max3_f32 v210, v210, v117, v118
  v_max3_f32 v210, v210, v119, v120
  v_max3_f32 v210, v210, v121, v122
  v_max3_f32 v210, v210, v123, v124
  v_max3_f32 v210, v210, v125, v126
  v_max_f32 v210, v210, v127
  v_mov_b32 v211, v210
  s_nop 1
  v_permlane32_swap_b32 v210, v211
  s_nop 1
  v_max_f32 v210, v210, v211
  v_max_f32 v210, 0, v210
  v_sub_f32 v211, 0, v210
  v_exp_f32 v211, v211
  v_sub_f32 v112, v112, v210
  v_sub_f32 v96, v96, v210
  v_sub_f32 v144, v144, v210
  v_sub_f32 v113, v113, v210
  v_sub_f32 v97, v97, v210
  v_sub_f32 v145, v145, v210
  v_sub_f32 v114, v114, v210
  v_sub_f32 v98, v98, v210
  v_sub_f32 v146, v146, v210
  v_sub_f32 v115, v115, v210
  v_sub_f32 v99, v99, v210
  v_sub_f32 v147, v147, v210
  v_sub_f32 v116, v116, v210
  v_sub_f32 v100, v100, v210
  v_sub_f32 v148, v148, v210
  v_sub_f32 v117, v117, v210
  v_sub_f32 v101, v101, v210
  v_sub_f32 v149, v149, v210
  v_sub_f32 v118, v118, v210
  v_sub_f32 v102, v102, v210
  v_sub_f32 v150, v150, v210
  v_sub_f32 v119, v119, v210
  v_sub_f32 v103, v103, v210
  v_sub_f32 v151, v151, v210
  v_sub_f32 v120, v120, v210
  v_sub_f32 v104, v104, v210
  v_sub_f32 v152, v152, v210
  v_sub_f32 v121, v121, v210
  v_sub_f32 v105, v105, v210
  v_sub_f32 v153, v153, v210
  v_sub_f32 v122, v122, v210
  v_sub_f32 v106, v106, v210
  v_sub_f32 v154, v154, v210
  v_sub_f32 v123, v123, v210
  v_sub_f32 v107, v107, v210
  v_sub_f32 v155, v155, v210
  v_sub_f32 v124, v124, v210
  v_sub_f32 v108, v108, v210
  v_sub_f32 v156, v156, v210
  v_sub_f32 v125, v125, v210
  v_sub_f32 v109, v109, v210
  v_sub_f32 v157, v157, v210
  v_sub_f32 v126, v126, v210
  v_sub_f32 v110, v110, v210
  v_sub_f32 v158, v158, v210
  v_sub_f32 v127, v127, v210
  v_sub_f32 v111, v111, v210
  v_sub_f32 v159, v159, v210
  v_mul_f32 v200, v200, v211
  v_mul_f32 v0, v0, v211
  v_mul_f32 v1, v1, v211
  v_mul_f32 v2, v2, v211
  v_mul_f32 v3, v3, v211
  v_mul_f32 v4, v4, v211
  v_mul_f32 v5, v5, v211
  v_mul_f32 v6, v6, v211
  v_mul_f32 v7, v7, v211
  v_mul_f32 v8, v8, v211
  v_mul_f32 v9, v9, v211
  v_mul_f32 v10, v10, v211
  v_mul_f32 v11, v11, v211
  v_mul_f32 v12, v12, v211
  v_mul_f32 v13, v13, v211
  v_mul_f32 v14, v14, v211
  v_mul_f32 v15, v15, v211
  v_mul_f32 v16, v16, v211
  v_mul_f32 v17, v17, v211
  v_mul_f32 v18, v18, v211
  v_mul_f32 v19, v19, v211
  v_mul_f32 v20, v20, v211
  v_mul_f32 v21, v21, v211
  v_mul_f32 v22, v22, v211
  v_mul_f32 v23, v23, v211
  v_mul_f32 v24, v24, v211
  v_mul_f32 v25, v25, v211
  v_mul_f32 v26, v26, v211
  v_mul_f32 v27, v27, v211
  v_mul_f32 v28, v28, v211
  v_mul_f32 v29, v29, v211
  v_mul_f32 v30, v30, v211
  v_mul_f32 v31, v31, v211
  v_mul_f32 v32, v32, v211
  v_mul_f32 v33, v33, v211
  v_mul_f32 v34, v34, v211
  v_mul_f32 v35, v35, v211
  v_mul_f32 v36, v36, v211
  v_mul_f32 v37, v37, v211
  v_mul_f32 v38, v38, v211
  v_mul_f32 v39, v39, v211
  v_mul_f32 v40, v40, v211
  v_mul_f32 v41, v41, v211
  v_mul_f32 v42, v42, v211
  v_mul_f32 v43, v43, v211
  v_mul_f32 v44, v44, v211
  v_mul_f32 v45, v45, v211
  v_mul_f32 v46, v46, v211
  v_mul_f32 v47, v47, v211
  v_mul_f32 v48, v48, v211
  v_mul_f32 v49, v49, v211
  v_mul_f32 v50, v50, v211
  v_mul_f32 v51, v51, v211
  v_mul_f32 v52, v52, v211
  v_mul_f32 v53, v53, v211
  v_mul_f32 v54, v54, v211
  v_mul_f32 v55, v55, v211
  v_mul_f32 v56, v56, v211
  v_mul_f32 v57, v57, v211
  v_mul_f32 v58, v58, v211
  v_mul_f32 v59, v59, v211
  v_mul_f32 v60, v60, v211
  v_mul_f32 v61, v61, v211
  v_mul_f32 v62, v62, v211
  v_mul_f32 v63, v63, v211
  v_exp_f32 v192, v112
  v_exp_f32 v193, v113
  v_exp_f32 v194, v114
  v_add_f32 v201, v192, v193
  v_cvt_pk_bf16_f32 v136, v192, v193
  v_exp_f32 v195, v115
  v_add_f32 v201, v201, v194
  v_exp_f32 v196, v116
  v_add_f32 v201, v201, v195
  v_cvt_pk_bf16_f32 v137, v194, v195
  v_exp_f32 v197, v117
  v_add_f32 v201, v201, v196
  v_exp_f32 v198, v118
  v_add_f32 v201, v201, v197
  v_cvt_pk_bf16_f32 v138, v196, v197
  v_exp_f32 v199, v119
  v_add_f32 v201, v201, v198
  v_exp_f32 v192, v120
  v_add_f32 v201, v201, v199
  v_cvt_pk_bf16_f32 v139, v198, v199
  v_exp_f32 v193, v121
  v_add_f32 v201, v201, v192
  v_exp_f32 v194, v122
  v_add_f32 v201, v201, v193
  v_cvt_pk_bf16_f32 v140, v192, v193
  v_exp_f32 v195, v123
  v_add_f32 v201, v201, v194
  v_exp_f32 v196, v124
  v_add_f32 v201, v201, v195
  v_cvt_pk_bf16_f32 v141, v194, v195
  v_exp_f32 v197, v125
  v_add_f32 v201, v201, v196
  v_exp_f32 v198, v126
  v_add_f32 v201, v201, v197
  v_cvt_pk_bf16_f32 v142, v196, v197
  v_exp_f32 v199, v127
  v_add_f32 v201, v201, v198
  s_nop 0
  v_add_f32 v201, v201, v199
  v_cvt_pk_bf16_f32 v143, v198, v199
  s_nop 1
  s_branch back_B3m1
slow_B3m2:
  s_nop 15
  v_max3_f32 v210, v96, v97, v98
  v_max3_f32 v210, v210, v99, v100
  v_max3_f32 v210, v210, v101, v102
  v_max3_f32 v210, v210, v103, v104
  v_max3_f32 v210, v210, v105, v106
  v_max3_f32 v210, v210, v107, v108
  v_max3_f32 v210, v210, v109, v110
  v_max_f32 v210, v210, v111
  v_mov_b32 v211, v210
  s_nop 1
  v_permlane32_swap_b32 v210, v211
  s_nop 1
  v_max_f32 v210, v210, v211
  v_max_f32 v210, 0, v210
  v_sub_f32 v211, 0, v210
  v_exp_f32 v211, v211
  v_sub_f32 v96, v96, v210
  v_sub_f32 v112, v112, v210
  v_sub_f32 v144, v144, v210
  v_sub_f32 v97, v97, v210
  v_sub_f32 v113, v113, v210
  v_sub_f32 v145, v145, v210
  v_sub_f32 v98, v98, v210
  v_sub_f32 v114, v114, v210
  v_sub_f32 v146, v146, v210
  v_sub_f32 v99, v99, v210
  v_sub_f32 v115, v115, v210
  v_sub_f32 v147, v147, v210
  v_sub_f32 v100, v100, v210
  v_sub_f32 v116, v116, v210
  v_sub_f32 v148, v148, v210
  v_sub_f32 v101, v101, v210
  v_sub_f32 v117, v117, v210
  v_sub_f32 v149, v149, v210
  v_sub_f32 v102, v102, v210
  v_sub_f32 v118, v118, v210
  v_sub_f32 v150, v150, v210
  v_sub_f32 v103, v103, v210
  v_sub_f32 v119, v119, v210
  v_sub_f32 v151, v151, v210
  v_sub_f32 v104, v104, v210
  v_sub_f32 v120, v120, v210
  v_sub_f32 v152, v152, v210
  v_sub_f32 v105, v105, v210
  v_sub_f32 v121, v121, v210
  v_sub_f32 v153, v153, v210
  v_sub_f32 v106, v106, v210
  v_sub_f32 v122, v122, v210
  v_sub_f32 v154, v154, v210
  v_sub_f32 v107, v107, v210
  v_sub_f32 v123, v123, v210
  v_sub_f32 v155, v155, v210
  v_sub_f32 v108, v108, v210
  v_sub_f32 v124, v124, v210
  v_sub_f32 v156, v156, v210
  v_sub_f32 v109, v109, v210
  v_sub_f32 v125, v125, v210
  v_sub_f32 v157, v157, v210
  v_sub_f32 v110, v110, v210
  v_sub_f32 v126, v126, v210
  v_sub_f32 v158, v158, v210
  v_sub_f32 v111, v111, v210
  v_sub_f32 v127, v127, v210
  v_sub_f32 v159, v159, v210
  v_mul_f32 v200, v200, v211
  v_mul_f32 v0, v0, v211
  v_mul_f32 v1, v1, v211
  v_mul_f32 v2, v2, v211
  v_mul_f32 v3, v3, v211
  v_mul_f32 v4, v4, v211
  v_mul_f32 v5, v5, v211
  v_mul_f32 v6, v6, v211
  v_mul_f32 v7, v7, v211
  v_mul_f32 v8, v8, v211
  v_mul_f32 v9, v9, v211
  v_mul_f32 v10, v10, v211
  v_mul_f32 v11, v11, v211
  v_mul_f32 v12, v12, v211
  v_mul_f32 v13, v13, v211
  v_mul_f32 v14, v14, v211
  v_mul_f32 v15, v15, v211
  v_mul_f32 v16, v16, v211
  v_mul_f32 v17, v17, v211
  v_mul_f32 v18, v18, v211
  v_mul_f32 v19, v19, v211
  v_mul_f32 v20, v20, v211
  v_mul_f32 v21, v21, v211
  v_mul_f32 v22, v22, v211
  v_mul_f32 v23, v23, v211
  v_mul_f32 v24, v24, v211
  v_mul_f32 v25, v25, v211
  v_mul_f32 v26, v26, v211
  v_mul_f32 v27, v27, v211
  v_mul_f32 v28, v28, v211
  v_mul_f32 v29, v29, v211
  v_mul_f32 v30, v30, v211
  v_mul_f32 v31, v31, v211
  v_mul_f32 v32, v32, v211
  v_mul_f32 v33, v33, v211
  v_mul_f32 v34, v34, v211
  v_mul_f32 v35, v35, v211
  v_mul_f32 v36, v36, v211
  v_mul_f32 v37, v37, v211
  v_mul_f32 v38, v38, v211
  v_mul_f32 v39, v39, v211
  v_mul_f32 v40, v40, v211
  v_mul_f32 v41, v41, v211
  v_mul_f32 v42, v42, v211
  v_mul_f32 v43, v43, v211
  v_mul_f32 v44, v44, v211
  v_mul_f32 v45, v45, v211
  v_mul_f32 v46, v46, v211
  v_mul_f32 v47, v47, v211
  v_mul_f32 v48, v48, v211
  v_mul_f32 v49, v49, v211
  v_mul_f32 v50, v50, v211
  v_mul_f32 v51, v51, v211
  v_mul_f32 v52, v52, v211
  v_mul_f32 v53, v53, v211
  v_mul_f32 v54, v54, v211
  v_mul_f32 v55, v55, v211
  v_mul_f32 v56, v56, v211
  v_mul_f32 v57, v57, v211
  v_mul_f32 v58, v58, v211
  v_mul_f32 v59, v59, v211
  v_mul_f32 v60, v60, v211
  v_mul_f32 v61, v61, v211
  v_mul_f32 v62, v62, v211
  v_mul_f32 v63, v63, v211
  v_exp_f32 v192, v96
  v_exp_f32 v193, v97
  v_exp_f32 v194, v98
  v_add_f32 v201, v192, v193
  v_cvt_pk_bf16_f32 v128, v192, v193
  v_exp_f32 v195, v99
  v_add_f32 v201, v201, v194
  v_exp_f32 v196, v100
  v_add_f32 v201, v201, v195
  v_cvt_pk_bf16_f32 v129, v194, v195
  v_exp_f32 v197, v101
  v_add_f32 v201, v201, v196
  v_exp_f32 v198, v102
  v_add_f32 v201, v201, v197
  v_cvt_pk_bf16_f32 v130, v196, v197
  v_exp_f32 v199, v103
  v_add_f32 v201, v201, v198
  v_exp_f32 v192, v104
  v_add_f32 v201, v201, v199
  v_cvt_pk_bf16_f32 v131, v198, v199
  v_exp_f32 v193, v105
  v_add_f32 v201, v201, v192
  v_exp_f32 v194, v106
  v_add_f32 v201, v201, v193
  v_cvt_pk_bf16_f32 v132, v192, v193
  v_exp_f32 v195, v107
  v_add_f32 v201, v201, v194
  v_exp_f32 v196, v108
  v_add_f32 v201, v201, v195
  v_cvt_pk_bf16_f32 v133, v194, v195
  v_exp_f32 v197, v109
  v_add_f32 v201, v201, v196
  v_exp_f32 v198, v110
  v_add_f32 v201, v201, v197
  v_cvt_pk_bf16_f32 v134, v196, v197
  v_exp_f32 v199, v111
  v_add_f32 v201, v201, v198
  s_nop 0
  v_add_f32 v201, v201, v199
  v_cvt_pk_bf16_f32 v135, v198, v199
  s_nop 1
  s_branch back_B3m2
slow_B3m3:
  s_nop 15
  v_max3_f32 v210, v112, v113, v114
  v_max3_f32 v210, v210, v115, v116
  v_max3_f32 v210, v210, v117, v118
  v_max3_f32 v210, v210, v119, v120
  v_max3_f32 v210, v210, v121, v122
  v_max3_f32 v210, v210, v123, v124
  v_max3_f32 v210, v210, v125, v126
  v_max_f32 v210, v210, v127
  v_mov_b32 v211, v210
  s_nop 1
  v_permlane32_swap_b32 v210, v211
  s_nop 1
  v_max_f32 v210, v210, v211
  v_max_f32 v210, 0, v210
  v_sub_f32 v211, 0, v210
  v_exp_f32 v211, v211
  v_sub_f32 v112, v112, v210
  v_sub_f32 v96, v96, v210
  v_sub_f32 v144, v144, v210
  v_sub_f32 v113, v113, v210
  v_sub_f32 v97, v97, v210
  v_sub_f32 v145, v145, v210
  v_sub_f32 v114, v114, v210
  v_sub_f32 v98, v98, v210
  v_sub_f32 v146, v146, v210
  v_sub_f32 v115, v115, v210
  v_sub_f32 v99, v99, v210
  v_sub_f32 v147, v147, v210
  v_sub_f32 v116, v116, v210
  v_sub_f32 v100, v100, v210
  v_sub_f32 v148, v148, v210
  v_sub_f32 v117, v117, v210
  v_sub_f32 v101, v101, v210
  v_sub_f32 v149, v149, v210
  v_sub_f32 v118, v118, v210
  v_sub_f32 v102, v102, v210
  v_sub_f32 v150, v150, v210
  v_sub_f32 v119, v119, v210
  v_sub_f32 v103, v103, v210
  v_sub_f32 v151, v151, v210
  v_sub_f32 v120, v120, v210
  v_sub_f32 v104, v104, v210
  v_sub_f32 v152, v152, v210
  v_sub_f32 v121, v121, v210
  v_sub_f32 v105, v105, v210
  v_sub_f32 v153, v153, v210
  v_sub_f32 v122, v122, v210
  v_sub_f32 v106, v106, v210
  v_sub_f32 v154, v154, v210
  v_sub_f32 v123, v123, v210
  v_sub_f32 v107, v107, v210
  v_sub_f32 v155, v155, v210
  v_sub_f32 v124, v124, v210
  v_sub_f32 v108, v108, v210
  v_sub_f32 v156, v156, v210
  v_sub_f32 v125, v125, v210
  v_sub_f32 v109, v109, v210
  v_sub_f32 v157, v157, v210
  v_sub_f32 v126, v126, v210
  v_sub_f32 v110, v110, v210
  v_sub_f32 v158, v158, v210
  v_sub_f32 v127, v127, v210
  v_sub_f32 v111, v111, v210
  v_sub_f32 v159, v159, v210
  v_mul_f32 v200, v200, v211
  v_mul_f32 v0, v0, v211
  v_mul_f32 v1, v1, v211
  v_mul_f32 v2, v2, v211
  v_mul_f32 v3, v3, v211
  v_mul_f32 v4, v4, v211
  v_mul_f32 v5, v5, v211
  v_mul_f32 v6, v6, v211
  v_mul_f32 v7, v7, v211
  v_mul_f32 v8, v8, v211
  v_mul_f32 v9, v9, v211
  v_mul_f32 v10, v10, v211
  v_mul_f32 v11, v11, v211
  v_mul_f32 v12, v12, v211
  v_mul_f32 v13, v13, v211
  v_mul_f32 v14, v14, v211
  v_mul_f32 v15, v15, v211
  v_mul_f32 v16, v16, v211
  v_mul_f32 v17, v17, v211
  v_mul_f32 v18, v18, v211
  v_mul_f32 v19, v19, v211
  v_mul_f32 v20, v20, v211
  v_mul_f32 v21, v21, v211
  v_mul_f32 v22, v22, v211
  v_mul_f32 v23, v23, v211
  v_mul_f32 v24, v24, v211
  v_mul_f32 v25, v25, v211
  v_mul_f32 v26, v26, v211
  v_mul_f32 v27, v27, v211
  v_mul_f32 v28, v28, v211
  v_mul_f32 v29, v29, v211
  v_mul_f32 v30, v30, v211
  v_mul_f32 v31, v31, v211
  v_mul_f32 v32, v32, v211
  v_mul_f32 v33, v33, v211
  v_mul_f32 v34, v34, v211
  v_mul_f32 v35, v35, v211
  v_mul_f32 v36, v36, v211
  v_mul_f32 v37, v37, v211
  v_mul_f32 v38, v38, v211
  v_mul_f32 v39, v39, v211
  v_mul_f32 v40, v40, v211
  v_mul_f32 v41, v41, v211
  v_mul_f32 v42, v42, v211
  v_mul_f32 v43, v43, v211
  v_mul_f32 v44, v44, v211
  v_mul_f32 v45, v45, v211
  v_mul_f32 v46, v46, v211
  v_mul_f32 v47, v47, v211
  v_mul_f32 v48, v48, v211
  v_mul_f32 v49, v49, v211
  v_mul_f32 v50, v50, v211
  v_mul_f32 v51, v51, v211
  v_mul_f32 v52, v52, v211
  v_mul_f32 v53, v53, v211
  v_mul_f32 v54, v54, v211
  v_mul_f32 v55, v55, v211
  v_mul_f32 v56, v56, v211
  v_mul_f32 v57, v57, v211
  v_mul_f32 v58, v58, v211
  v_mul_f32 v59, v59, v211
  v_mul_f32 v60, v60, v211
  v_mul_f32 v61, v61, v211
  v_mul_f32 v62, v62, v211
  v_mul_f32 v63, v63, v211
  v_exp_f32 v192, v112
  v_exp_f32 v193, v113
  v_exp_f32 v194, v114
  v_add_f32 v201, v192, v193
  v_cvt_pk_bf16_f32 v136, v192, v193
  v_exp_f32 v195, v115
  v_add_f32 v201, v201, v194
  v_exp_f32 v196, v116
  v_add_f32 v201, v201, v195
  v_cvt_pk_bf16_f32 v137, v194, v195
  v_exp_f32 v197, v117
  v_add_f32 v201, v201, v196
  v_exp_f32 v198, v118
  v_add_f32 v201, v201, v197
  v_cvt_pk_bf16_f32 v138, v196, v197
  v_exp_f32 v199, v119
  v_add_f32 v201, v201, v198
  v_exp_f32 v192, v120
  v_add_f32 v201, v201, v199
  v_cvt_pk_bf16_f32 v139, v198, v199
  v_exp_f32 v193, v121
  v_add_f32 v201, v201, v192
  v_exp_f32 v194, v122
  v_add_f32 v201, v201, v193
  v_cvt_pk_bf16_f32 v140, v192, v193
  v_exp_f32 v195, v123
  v_add_f32 v201, v201, v194
  v_exp_f32 v196, v124
  v_add_f32 v201, v201, v195
  v_cvt_pk_bf16_f32 v141, v194, v195
  v_exp_f32 v197, v125
  v_add_f32 v201, v201, v196
  v_exp_f32 v198, v126
  v_add_f32 v201, v201, v197
  v_cvt_pk_bf16_f32 v142, v196, v197
  v_exp_f32 v199, v127
  v_add_f32 v201, v201, v198
  s_nop 0
  v_add_f32 v201, v201, v199
  v_cvt_pk_bf16_f32 v143, v198, v199
  s_nop 1
  s_branch back_B3m3
slow_B2m0:
  s_nop 15
  v_max3_f32 v210, v96, v97, v98
  v_max3_f32 v210, v210, v99, v100
  v_max3_f32 v210, v210, v101, v102
  v_max3_f32 v210, v210, v103, v104
  v_max3_f32 v210, v210, v105, v106
  v_max3_f32 v210, v210, v107, v108
  v_max3_f32 v210, v210, v109, v110
  v_max_f32 v210, v210, v111
  v_mov_b32 v211, v210
  s_nop 1
  v_permlane32_swap_b32 v210, v211
  s_nop 1
  v_max_f32 v210, v210, v211
  v_max_f32 v210, 0, v210
  v_sub_f32 v211, 0, v210
  v_exp_f32 v211, v211
  v_sub_f32 v96, v96, v210
  v_sub_f32 v112, v112, v210
  v_sub_f32 v144, v144, v210
  v_sub_f32 v97, v97, v210
  v_sub_f32 v113, v113, v210
  v_sub_f32 v145, v145, v210
  v_sub_f32 v98, v98, v210
  v_sub_f32 v114, v114, v210
  v_sub_f32 v146, v146, v210
  v_sub_f32 v99, v99, v210
  v_sub_f32 v115, v115, v210
  v_sub_f32 v147, v147, v210
  v_sub_f32 v100, v100, v210
  v_sub_f32 v116, v116, v210
  v_sub_f32 v148, v148, v210
  v_sub_f32 v101, v101, v210
  v_sub_f32 v117, v117, v210
  v_sub_f32 v149, v149, v210
  v_sub_f32 v102, v102, v210
  v_sub_f32 v118, v118, v210
  v_sub_f32 v150, v150, v210
  v_sub_f32 v103, v103, v210
  v_sub_f32 v119, v119, v210
  v_sub_f32 v151, v151, v210
  v_sub_f32 v104, v104, v210
  v_sub_f32 v120, v120, v210
  v_sub_f32 v152, v152, v210
  v_sub_f32 v105, v105, v210
  v_sub_f32 v121, v121, v210
  v_sub_f32 v153, v153, v210
  v_sub_f32 v106, v106, v210
  v_sub_f32 v122, v122, v210
  v_sub_f32 v154, v154, v210
  v_sub_f32 v107, v107, v210
  v_sub_f32 v123, v123, v210
  v_sub_f32 v155, v155, v210
  v_sub_f32 v108, v108, v210
  v_sub_f32 v124, v124, v210
  v_sub_f32 v156, v156, v210
  v_sub_f32 v109, v109, v210
  v_sub_f32 v125, v125, v210
  v_sub_f32 v157, v157, v210
  v_sub_f32 v110, v110, v210
  v_sub_f32 v126, v126, v210
  v_sub_f32 v158, v158, v210
  v_sub_f32 v111, v111, v210
  v_sub_f32 v127, v127, v210
  v_sub_f32 v159, v159, v210
  v_mul_f32 v200, v200, v211
  v_mul_f32 v0, v0, v211
  v_mul_f32 v1, v1, v211
  v_mul_f32 v2, v2, v211
  v_mul_f32 v3, v3, v211
  v_mul_f32 v4, v4, v211
  v_mul_f32 v5, v5, v211
  v_mul_f32 v6, v6, v211
  v_mul_f32 v7, v7, v211
  v_mul_f32 v8, v8, v211
  v_mul_f32 v9, v9, v211
  v_mul_f32 v10, v10, v211
  v_mul_f32 v11, v11, v211
  v_mul_f32 v12, v12, v211
  v_mul_f32 v13, v13, v211
  v_mul_f32 v14, v14, v211
  v_mul_f32 v15, v15, v211
  v_mul_f32 v16, v16, v211
  v_mul_f32 v17, v17, v211
  v_mul_f32 v18, v18, v211
  v_mul_f32 v19, v19, v211
  v_mul_f32 v20, v20, v211
  v_mul_f32 v21, v21, v211
  v_mul_f32 v22, v22, v211
  v_mul_f32 v23, v23, v211
  v_mul_f32 v24, v24, v211
  v_mul_f32 v25, v25, v211
  v_mul_f32 v26, v26, v211
  v_mul_f32 v27, v27, v211
  v_mul_f32 v28, v28, v211
  v_mul_f32 v29, v29, v211
  v_mul_f32 v30, v30, v211
  v_mul_f32 v31, v31, v211
  v_mul_f32 v32, v32, v211
  v_mul_f32 v33, v33, v211
  v_mul_f32 v34, v34, v211
  v_mul_f32 v35, v35, v211
  v_mul_f32 v36, v36, v211
  v_mul_f32 v37, v37, v211
  v_mul_f32 v38, v38, v211
  v_mul_f32 v39, v39, v211
  v_mul_f32 v40, v40, v211
  v_mul_f32 v41, v41, v211
  v_mul_f32 v42, v42, v211
  v_mul_f32 v43, v43, v211
  v_mul_f32 v44, v44, v211
  v_mul_f32 v45, v45, v211
  v_mul_f32 v46, v46, v211
  v_mul_f32 v47, v47, v211
  v_mul_f32 v48, v48, v211
  v_mul_f32 v49, v49, v211
  v_mul_f32 v50, v50, v211
  v_mul_f32 v51, v51, v211
  v_mul_f32 v52, v52, v211
  v_mul_f32 v53, v53, v211
  v_mul_f32 v54, v54, v211
  v_mul_f32 v55, v55, v211
  v_mul_f32 v56, v56, v211
  v_mul_f32 v57, v57, v211
  v_mul_f32 v58, v58, v211
  v_mul_f32 v59, v59, v211
  v_mul_f32 v60, v60, v211
  v_mul_f32 v61, v61, v211
  v_mul_f32 v62, v62, v211
  v_mul_f32 v63, v63, v211
  v_exp_f32 v192, v96
  v_exp_f32 v193, v97
  v_exp_f32 v194, v98
  v_add_f32 v201, v192, v193
  v_cvt_pk_bf16_f32 v128, v192, v193
  v_exp_f32 v195, v99
  v_add_f32 v201, v201, v194
  v_exp_f32 v196, v100
  v_add_f32 v201, v201, v195
  v_cvt_pk_bf16_f32 v129, v194, v195
  v_exp_f32 v197, v101
  v_add_f32 v201, v201, v196
  v_exp_f32 v198, v102
  v_add_f32 v201, v201, v197
  v_cvt_pk_bf16_f32 v130, v196, v197
  v_exp_f32 v199, v103
  v_add_f32 v201, v201, v198
  v_exp_f32 v192, v104
  v_add_f32 v201, v201, v199
  v_cvt_pk_bf16_f32 v131, v198, v199
  v_exp_f32 v193, v105
  v_add_f32 v201, v201, v192
  v_exp_f32 v194, v106
  v_add_f32 v201, v201, v193
  v_cvt_pk_bf16_f32 v132, v192, v193
  v_exp_f32 v195, v107
  v_add_f32 v201, v201, v194
  v_exp_f32 v196, v108
  v_add_f32 v201, v201, v195
  v_cvt_pk_bf16_f32 v133, v194, v195
  v_exp_f32 v197, v109
  v_add_f32 v201, v201, v196
  v_exp_f32 v198, v110
  v_add_f32 v201, v201, v197
  v_cvt_pk_bf16_f32 v134, v196, v197
  v_exp_f32 v199, v111
  v_add_f32 v201, v201, v198
  s_nop 0
  v_add_f32 v201, v201, v199
  v_cvt_pk_bf16_f32 v135, v198, v199
  s_nop 1
  s_branch back_B2m0
slow_B2m1:
  s_nop 15
  v_max3_f32 v210, v112, v113, v114
  v_max3_f32 v210, v210, v115, v116
  v_max3_f32 v210, v210, v117, v118
  v_max3_f32 v210, v210, v119, v120
  v_max3_f32 v210, v210, v121, v122
  v_max3_f32 v210, v210, v123, v124
  v_max3_f32 v210, v210, v125, v126
  v_max_f32 v210, v210, v127
  v_mov_b32 v211, v210
  s_nop 1
  v_permlane32_swap_b32 v210, v211
  s_nop 1
  v_max_f32 v210, v210, v211
  v_max_f32 v210, 0, v210
  v_sub_f32 v211, 0, v210
  v_exp_f32 v211, v211
  v_sub_f32 v112, v112, v210
  v_sub_f32 v96, v96, v210
  v_sub_f32 v144, v144, v210
  v_sub_f32 v113, v113, v210
  v_sub_f32 v97, v97, v210
  v_sub_f32 v145, v145, v210
  v_sub_f32 v114, v114, v210
  v_sub_f32 v98, v98, v210
  v_sub_f32 v146, v146, v210
  v_sub_f32 v115, v115, v210
  v_sub_f32 v99, v99, v210
  v_sub_f32 v147, v147, v210
  v_sub_f32 v116, v116, v210
  v_sub_f32 v100, v100, v210
  v_sub_f32 v148, v148, v210
  v_sub_f32 v117, v117, v210
  v_sub_f32 v101, v101, v210
  v_sub_f32 v149, v149, v210
  v_sub_f32 v118, v118, v210
  v_sub_f32 v102, v102, v210
  v_sub_f32 v150, v150, v210
  v_sub_f32 v119, v119, v210
  v_sub_f32 v103, v103, v210
  v_sub_f32 v151, v151, v210
  v_sub_f32 v120, v120, v210
  v_sub_f32 v104, v104, v210
  v_sub_f32 v152, v152, v210
  v_sub_f32 v121, v121, v210
  v_sub_f32 v105, v105, v210
  v_sub_f32 v153, v153, v210
  v_sub_f32 v122, v122, v210
  v_sub_f32 v106, v106, v210
  v_sub_f32 v154, v154, v210
  v_sub_f32 v123, v123, v210
  v_sub_f32 v107, v107, v210
  v_sub_f32 v155, v155, v210
  v_sub_f32 v124, v124, v210
  v_sub_f32 v108, v108, v210
  v_sub_f32 v156, v156, v210
  v_sub_f32 v125, v125, v210
  v_sub_f32 v109, v109, v210
  v_sub_f32 v157, v157, v210
  v_sub_f32 v126, v126, v210
  v_sub_f32 v110, v110, v210
  v_sub_f32 v158, v158, v210
  v_sub_f32 v127, v127, v210
  v_sub_f32 v111, v111, v210
  v_sub_f32 v159, v159, v210
  v_mul_f32 v200, v200, v211
  v_mul_f32 v0, v0, v211
  v_mul_f32 v1, v1, v211
  v_mul_f32 v2, v2, v211
  v_mul_f32 v3, v3, v211
  v_mul_f32 v4, v4, v211
  v_mul_f32 v5, v5, v211
  v_mul_f32 v6, v6, v211
  v_mul_f32 v7, v7, v211
  v_mul_f32 v8, v8, v211
  v_mul_f32 v9, v9, v211
  v_mul_f32 v10, v10, v211
  v_mul_f32 v11, v11, v211
  v_mul_f32 v12, v12, v211
  v_mul_f32 v13, v13, v211
  v_mul_f32 v14, v14, v211
  v_mul_f32 v15, v15, v211
  v_mul_f32 v16, v16, v211
  v_mul_f32 v17, v17, v211
  v_mul_f32 v18, v18, v211
  v_mul_f32 v19, v19, v211
  v_mul_f32 v20, v20, v211
  v_mul_f32 v21, v21, v211
  v_mul_f32 v22, v22, v211
  v_mul_f32 v23, v23, v211
  v_mul_f32 v24, v24, v211
  v_mul_f32 v25, v25, v211
  v_mul_f32 v26, v26, v211
  v_mul_f32 v27, v27, v211
  v_mul_f32 v28, v28, v211
  v_mul_f32 v29, v29, v211
  v_mul_f32 v30, v30, v211
  v_mul_f32 v31, v31, v211
  v_mul_f32 v32, v32, v211
  v_mul_f32 v33, v33, v211
  v_mul_f32 v34, v34, v211
  v_mul_f32 v35, v35, v211
  v_mul_f32 v36, v36, v211
  v_mul_f32 v37, v37, v211
  v_mul_f32 v38, v38, v211
  v_mul_f32 v39, v39, v211
  v_mul_f32 v40, v40, v211
  v_mul_f32 v41, v41, v211
  v_mul_f32 v42, v42, v211
  v_mul_f32 v43, v43, v211
  v_mul_f32 v44, v44, v211
  v_mul_f32 v45, v45, v211
  v_mul_f32 v46, v46, v211
  v_mul_f32 v47, v47, v211
  v_mul_f32 v48, v48, v211
  v_mul_f32 v49, v49, v211
  v_mul_f32 v50, v50, v211
  v_mul_f32 v51, v51, v211
  v_mul_f32 v52, v52, v211
  v_mul_f32 v53, v53, v211
  v_mul_f32 v54, v54, v211
  v_mul_f32 v55, v55, v211
  v_mul_f32 v56, v56, v211
  v_mul_f32 v57, v57, v211
  v_mul_f32 v58, v58, v211
  v_mul_f32 v59, v59, v211
  v_mul_f32 v60, v60, v211
  v_mul_f32 v61, v61, v211
  v_mul_f32 v62, v62, v211
  v_mul_f32 v63, v63, v211
  v_exp_f32 v192, v112
  v_exp_f32 v193, v113
  v_exp_f32 v194, v114
  v_add_f32 v201, v192, v193
  v_cvt_pk_bf16_f32 v136, v192, v193
  v_exp_f32 v195, v115
  v_add_f32 v201, v201, v194
  v_exp_f32 v196, v116
  v_add_f32 v201, v201, v195
  v_cvt_pk_bf16_f32 v137, v194, v195
  v_exp_f32 v197, v117
  v_add_f32 v201, v201, v196
  v_exp_f32 v198, v118
  v_add_f32 v201, v201, v197
  v_cvt_pk_bf16_f32 v138, v196, v197
  v_exp_f32 v199, v119
  v_add_f32 v201, v201, v198
  v_exp_f32 v192, v120
  v_add_f32 v201, v201, v199
  v_cvt_pk_bf16_f32 v139, v198, v199
  v_exp_f32 v193, v121
  v_add_f32 v201, v201, v192
  v_exp_f32 v194, v122
  v_add_f32 v201, v201, v193
  v_cvt_pk_bf16_f32 v140, v192, v193
  v_exp_f32 v195, v123
  v_add_f32 v201, v201, v194
  v_exp_f32 v196, v124
  v_add_f32 v201, v201, v195
  v_cvt_pk_bf16_f32 v141, v194, v195
  v_exp_f32 v197, v125
  v_add_f32 v201, v201, v196
  v_exp_f32 v198, v126
  v_add_f32 v201, v201, v197
  v_cvt_pk_bf16_f32 v142, v196, v197
  v_exp_f32 v199, v127
  v_add_f32 v201, v201, v198
  s_nop 0
  v_add_f32 v201, v201, v199
  v_cvt_pk_bf16_f32 v143, v198, v199
  s_nop 1
  s_branch back_B2m1
slow_B2m2:
  s_nop 15
  v_max3_f32 v210, v96, v97, v98
  v_max3_f32 v210, v210, v99, v100
  v_max3_f32 v210, v210, v101, v102
  v_max3_f32 v210, v210, v103, v104
  v_max3_f32 v210, v210, v105, v106
  v_max3_f32 v210, v210, v107, v108
  v_max3_f32 v210, v210, v109, v110
  v_max_f32 v210, v210, v111
  v_mov_b32 v211, v210
  s_nop 1
  v_permlane32_swap_b32 v210, v211
  s_nop 1
  v_max_f32 v210, v210, v211
  v_max_f32 v210, 0, v210
  v_sub_f32 v211, 0, v210
  v_exp_f32 v211, v211
  v_sub_f32 v96, v96, v210
  v_sub_f32 v112, v112, v210
  v_sub_f32 v144, v144, v210
  v_sub_f32 v97, v97, v210
  v_sub_f32 v113, v113, v210
  v_sub_f32 v145, v145, v210
  v_sub_f32 v98, v98, v210
  v_sub_f32 v114, v114, v210
  v_sub_f32 v146, v146, v210
  v_sub_f32 v99, v99, v210
  v_sub_f32 v115, v115, v210
  v_sub_f32 v147, v147, v210
  v_sub_f32 v100, v100, v210
  v_sub_f32 v116, v116, v210
  v_sub_f32 v148, v148, v210
  v_sub_f32 v101, v101, v210
  v_sub_f32 v117, v117, v210
  v_sub_f32 v149, v149, v210
  v_sub_f32 v102, v102, v210
  v_sub_f32 v118, v118, v210
  v_sub_f32 v150, v150, v210
  v_sub_f32 v103, v103, v210
  v_sub_f32 v119, v119, v210
  v_sub_f32 v151, v151, v210
  v_sub_f32 v104, v104, v210
  v_sub_f32 v120, v120, v210
  v_sub_f32 v152, v152, v210
  v_sub_f32 v105, v105, v210
  v_sub_f32 v121, v121, v210
  v_sub_f32 v153, v153, v210
  v_sub_f32 v106, v106, v210
  v_sub_f32 v122, v122, v210
  v_sub_f32 v154, v154, v210
  v_sub_f32 v107, v107, v210
  v_sub_f32 v123, v123, v210
  v_sub_f32 v155, v155, v210
  v_sub_f32 v108, v108, v210
  v_sub_f32 v124, v124, v210
  v_sub_f32 v156, v156, v210
  v_sub_f32 v109, v109, v210
  v_sub_f32 v125, v125, v210
  v_sub_f32 v157, v157, v210
  v_sub_f32 v110, v110, v210
  v_sub_f32 v126, v126, v210
  v_sub_f32 v158, v158, v210
  v_sub_f32 v111, v111, v210
  v_sub_f32 v127, v127, v210
  v_sub_f32 v159, v159, v210
  v_mul_f32 v200, v200, v211
  v_mul_f32 v0, v0, v211
  v_mul_f32 v1, v1, v211
  v_mul_f32 v2, v2, v211
  v_mul_f32 v3, v3, v211
  v_mul_f32 v4, v4, v211
  v_mul_f32 v5, v5, v211
  v_mul_f32 v6, v6, v211
  v_mul_f32 v7, v7, v211
  v_mul_f32 v8, v8, v211
  v_mul_f32 v9, v9, v211
  v_mul_f32 v10, v10, v211
  v_mul_f32 v11, v11, v211
  v_mul_f32 v12, v12, v211
  v_mul_f32 v13, v13, v211
  v_mul_f32 v14, v14, v211
  v_mul_f32 v15, v15, v211
  v_mul_f32 v16, v16, v211
  v_mul_f32 v17, v17, v211
  v_mul_f32 v18, v18, v211
  v_mul_f32 v19, v19, v211
  v_mul_f32 v20, v20, v211
  v_mul_f32 v21, v21, v211
  v_mul_f32 v22, v22, v211
  v_mul_f32 v23, v23, v211
  v_mul_f32 v24, v24, v211
  v_mul_f32 v25, v25, v211
  v_mul_f32 v26, v26, v211
  v_mul_f32 v27, v27, v211
  v_mul_f32 v28, v28, v211
  v_mul_f32 v29, v29, v211
  v_mul_f32 v30, v30, v211
  v_mul_f32 v31, v31, v211
  v_mul_f32 v32, v32, v211
  v_mul_f32 v33, v33, v211
  v_mul_f32 v34, v34, v211
  v_mul_f32 v35, v35, v211
  v_mul_f32 v36, v36, v211
  v_mul_f32 v37, v37, v211
  v_mul_f32 v38, v38, v211
  v_mul_f32 v39, v39, v211
  v_mul_f32 v40, v40, v211
  v_mul_f32 v41, v41, v211
  v_mul_f32 v42, v42, v211
  v_mul_f32 v43, v43, v211
  v_mul_f32 v44, v44, v211
  v_mul_f32 v45, v45, v211
  v_mul_f32 v46, v46, v211
  v_mul_f32 v47, v47, v211
  v_mul_f32 v48, v48, v211
  v_mul_f32 v49, v49, v211
  v_mul_f32 v50, v50, v211
  v_mul_f32 v51, v51, v211
  v_mul_f32 v52, v52, v211
  v_mul_f32 v53, v53, v211
  v_mul_f32 v54, v54, v211
  v_mul_f32 v55, v55, v211
  v_mul_f32 v56, v56, v211
  v_mul_f32 v57, v57, v211
  v_mul_f32 v58, v58, v211
  v_mul_f32 v59, v59, v211
  v_mul_f32 v60, v60, v211
  v_mul_f32 v61, v61, v211
  v_mul_f32 v62, v62, v211
  v_mul_f32 v63, v63, v211
  v_exp_f32 v192, v96
  v_exp_f32 v193, v97
  v_exp_f32 v194, v98
  v_add_f32 v201, v192, v193
  v_cvt_pk_bf16_f32 v128, v192, v193
  v_exp_f32 v195, v99
  v_add_f32 v201, v201, v194
  v_exp_f32 v196, v100
  v_add_f32 v201, v201, v195
  v_cvt_pk_bf16_f32 v129, v194, v195
  v_exp_f32 v197, v101
  v_add_f32 v201, v201, v196
  v_exp_f32 v198, v102
  v_add_f32 v201, v201, v197
  v_cvt_pk_bf16_f32 v130, v196, v197
  v_exp_f32 v199, v103
  v_add_f32 v201, v201, v198
  v_exp_f32 v192, v104
  v_add_f32 v201, v201, v199
  v_cvt_pk_bf16_f32 v131, v198, v199
  v_exp_f32 v193, v105
  v_add_f32 v201, v201, v192
  v_exp_f32 v194, v106
  v_add_f32 v201, v201, v193
  v_cvt_pk_bf16_f32 v132, v192, v193
  v_exp_f32 v195, v107
  v_add_f32 v201, v201, v194
  v_exp_f32 v196, v108
  v_add_f32 v201, v201, v195
  v_cvt_pk_bf16_f32 v133, v194, v195
  v_exp_f32 v197, v109
  v_add_f32 v201, v201, v196
  v_exp_f32 v198, v110
  v_add_f32 v201, v201, v197
  v_cvt_pk_bf16_f32 v134, v196, v197
  v_exp_f32 v199, v111
  v_add_f32 v201, v201, v198
  s_nop 0
  v_add_f32 v201, v201, v199
  v_cvt_pk_bf16_f32 v135, v198, v199
  s_nop 1
  s_branch back_B2m2
slow_B1m0:
  s_nop 15
  v_max3_f32 v210, v96, v97, v98
  v_max3_f32 v210, v210, v99, v100
  v_max3_f32 v210, v210, v101, v102
  v_max3_f32 v210, v210, v103, v104
  v_max3_f32 v210, v210, v105, v106
  v_max3_f32 v210, v210, v107, v108
  v_max3_f32 v210, v210, v109, v110
  v_max_f32 v210, v210, v111
  v_mov_b32 v211, v210
  s_nop 1
  v_permlane32_swap_b32 v210, v211
  s_nop 1
  v_max_f32 v210, v210, v211
  v_max_f32 v210, 0, v210
  v_sub_f32 v211, 0, v210
  v_exp_f32 v211, v211
  v_sub_f32 v96, v96, v210
  v_sub_f32 v112, v112, v210
  v_sub_f32 v144, v144, v210
  v_sub_f32 v97, v97, v210
  v_sub_f32 v113, v113, v210
  v_sub_f32 v145, v145, v210
  v_sub_f32 v98, v98, v210
  v_sub_f32 v114, v114, v210
  v_sub_f32 v146, v146, v210
  v_sub_f32 v99, v99, v210
  v_sub_f32 v115, v115, v210
  v_sub_f32 v147, v147, v210
  v_sub_f32 v100, v100, v210
  v_sub_f32 v116, v116, v210
  v_sub_f32 v148, v148, v210
  v_sub_f32 v101, v101, v210
  v_sub_f32 v117, v117, v210
  v_sub_f32 v149, v149, v210
  v_sub_f32 v102, v102, v210
  v_sub_f32 v118, v118, v210
  v_sub_f32 v150, v150, v210
  v_sub_f32 v103, v103, v210
  v_sub_f32 v119, v119, v210
  v_sub_f32 v151, v151, v210
  v_sub_f32 v104, v104, v210
  v_sub_f32 v120, v120, v210
  v_sub_f32 v152, v152, v210
  v_sub_f32 v105, v105, v210
  v_sub_f32 v121, v121, v210
  v_sub_f32 v153, v153, v210
  v_sub_f32 v106, v106, v210
  v_sub_f32 v122, v122, v210
  v_sub_f32 v154, v154, v210
  v_sub_f32 v107, v107, v210
  v_sub_f32 v123, v123, v210
  v_sub_f32 v155, v155, v210
  v_sub_f32 v108, v108, v210
  v_sub_f32 v124, v124, v210
  v_sub_f32 v156, v156, v210
  v_sub_f32 v109, v109, v210
  v_sub_f32 v125, v125, v210
  v_sub_f32 v157, v157, v210
  v_sub_f32 v110, v110, v210
  v_sub_f32 v126, v126, v210
  v_sub_f32 v158, v158, v210
  v_sub_f32 v111, v111, v210
  v_sub_f32 v127, v127, v210
  v_sub_f32 v159, v159, v210
  v_mul_f32 v200, v200, v211
  v_mul_f32 v0, v0, v211
  v_mul_f32 v1, v1, v211
  v_mul_f32 v2, v2, v211
  v_mul_f32 v3, v3, v211
  v_mul_f32 v4, v4, v211
  v_mul_f32 v5, v5, v211
  v_mul_f32 v6, v6, v211
  v_mul_f32 v7, v7, v211
  v_mul_f32 v8, v8, v211
  v_mul_f32 v9, v9, v211
  v_mul_f32 v10, v10, v211
  v_mul_f32 v11, v11, v211
  v_mul_f32 v12, v12, v211
  v_mul_f32 v13, v13, v211
  v_mul_f32 v14, v14, v211
  v_mul_f32 v15, v15, v211
  v_mul_f32 v16, v16, v211
  v_mul_f32 v17, v17, v211
  v_mul_f32 v18, v18, v211
  v_mul_f32 v19, v19, v211
  v_mul_f32 v20, v20, v211
  v_mul_f32 v21, v21, v211
  v_mul_f32 v22, v22, v211
  v_mul_f32 v23, v23, v211
  v_mul_f32 v24, v24, v211
  v_mul_f32 v25, v25, v211
  v_mul_f32 v26, v26, v211
  v_mul_f32 v27, v27, v211
  v_mul_f32 v28, v28, v211
  v_mul_f32 v29, v29, v211
  v_mul_f32 v30, v30, v211
  v_mul_f32 v31, v31, v211
  v_mul_f32 v32, v32, v211
  v_mul_f32 v33, v33, v211
  v_mul_f32 v34, v34, v211
  v_mul_f32 v35, v35, v211
  v_mul_f32 v36, v36, v211
  v_mul_f32 v37, v37, v211
  v_mul_f32 v38, v38, v211
  v_mul_f32 v39, v39, v211
  v_mul_f32 v40, v40, v211
  v_mul_f32 v41, v41, v211
  v_mul_f32 v42, v42, v211
  v_mul_f32 v43, v43, v211
  v_mul_f32 v44, v44, v211
  v_mul_f32 v45, v45, v211
  v_mul_f32 v46, v46, v211
  v_mul_f32 v47, v47, v211
  v_mul_f32 v48, v48, v211
  v_mul_f32 v49, v49, v211
  v_mul_f32 v50, v50, v211
  v_mul_f32 v51, v51, v211
  v_mul_f32 v52, v52, v211
  v_mul_f32 v53, v53, v211
  v_mul_f32 v54, v54, v211
  v_mul_f32 v55, v55, v211
  v_mul_f32 v56, v56, v211
  v_mul_f32 v57, v57, v211
  v_mul_f32 v58, v58, v211
  v_mul_f32 v59, v59, v211
  v_mul_f32 v60, v60, v211
  v_mul_f32 v61, v61, v211
  v_mul_f32 v62, v62, v211
  v_mul_f32 v63, v63, v211
  v_exp_f32 v192, v96
  v_exp_f32 v193, v97
  v_exp_f32 v194, v98
  v_add_f32 v201, v192, v193
  v_cvt_pk_bf16_f32 v128, v192, v193
  v_exp_f32 v195, v99
  v_add_f32 v201, v201, v194
  v_exp_f32 v196, v100
  v_add_f32 v201, v201, v195
  v_cvt_pk_bf16_f32 v129, v194, v195
  v_exp_f32 v197, v101
  v_add_f32 v201, v201, v196
  v_exp_f32 v198, v102
  v_add_f32 v201, v201, v197
  v_cvt_pk_bf16_f32 v130, v196, v197
  v_exp_f32 v199, v103
  v_add_f32 v201, v201, v198
  v_exp_f32 v192, v104
  v_add_f32 v201, v201, v199
  v_cvt_pk_bf16_f32 v131, v198, v199
  v_exp_f32 v193, v105
  v_add_f32 v201, v201, v192
  v_exp_f32 v194, v106
  v_add_f32 v201, v201, v193
  v_cvt_pk_bf16_f32 v132, v192, v193
  v_exp_f32 v195, v107
  v_add_f32 v201, v201, v194
  v_exp_f32 v196, v108
  v_add_f32 v201, v201, v195
  v_cvt_pk_bf16_f32 v133, v194, v195
  v_exp_f32 v197, v109
  v_add_f32 v201, v201, v196
  v_exp_f32 v198, v110
  v_add_f32 v201, v201, v197
  v_cvt_pk_bf16_f32 v134, v196, v197
  v_exp_f32 v199, v111
  v_add_f32 v201, v201, v198
  s_nop 0
  v_add_f32 v201, v201, v199
  v_cvt_pk_bf16_f32 v135, v198, v199
  s_nop 1
  s_branch back_B1m0
slow_B1m1:
  s_nop 15
  v_max3_f32 v210, v112, v113, v114
  v_max3_f32 v210, v210, v115, v116
  v_max3_f32 v210, v210, v117, v118
  v_max3_f32 v210, v210, v119, v120
  v_max3_f32 v210, v210, v121, v122
  v_max3_f32 v210, v210, v123, v124
  v_max3_f32 v210, v210, v125, v126
  v_max_f32 v210, v210, v127
  v_mov_b32 v211, v210
  s_nop 1
  v_permlane32_swap_b32 v210, v211
  s_nop 1
  v_max_f32 v210, v210, v211
  v_max_f32 v210, 0, v210
  v_sub_f32 v211, 0, v210
  v_exp_f32 v211, v211
  v_sub_f32 v112, v112, v210
  v_sub_f32 v96, v96, v210
  v_sub_f32 v144, v144, v210
  v_sub_f32 v113, v113, v210
  v_sub_f32 v97, v97, v210
  v_sub_f32 v145, v145, v210
  v_sub_f32 v114, v114, v210
  v_sub_f32 v98, v98, v210
  v_sub_f32 v146, v146, v210
  v_sub_f32 v115, v115, v210
  v_sub_f32 v99, v99, v210
  v_sub_f32 v147, v147, v210
  v_sub_f32 v116, v116, v210
  v_sub_f32 v100, v100, v210
  v_sub_f32 v148, v148, v210
  v_sub_f32 v117, v117, v210
  v_sub_f32 v101, v101, v210
  v_sub_f32 v149, v149, v210
  v_sub_f32 v118, v118, v210
  v_sub_f32 v102, v102, v210
  v_sub_f32 v150, v150, v210
  v_sub_f32 v119, v119, v210
  v_sub_f32 v103, v103, v210
  v_sub_f32 v151, v151, v210
  v_sub_f32 v120, v120, v210
  v_sub_f32 v104, v104, v210
  v_sub_f32 v152, v152, v210
  v_sub_f32 v121, v121, v210
  v_sub_f32 v105, v105, v210
  v_sub_f32 v153, v153, v210
  v_sub_f32 v122, v122, v210
  v_sub_f32 v106, v106, v210
  v_sub_f32 v154, v154, v210
  v_sub_f32 v123, v123, v210
  v_sub_f32 v107, v107, v210
  v_sub_f32 v155, v155, v210
  v_sub_f32 v124, v124, v210
  v_sub_f32 v108, v108, v210
  v_sub_f32 v156, v156, v210
  v_sub_f32 v125, v125, v210
  v_sub_f32 v109, v109, v210
  v_sub_f32 v157, v157, v210
  v_sub_f32 v126, v126, v210
  v_sub_f32 v110, v110, v210
  v_sub_f32 v158, v158, v210
  v_sub_f32 v127, v127, v210
  v_sub_f32 v111, v111, v210
  v_sub_f32 v159, v159, v210
  v_mul_f32 v200, v200, v211
  v_mul_f32 v0, v0, v211
  v_mul_f32 v1, v1, v211
  v_mul_f32 v2, v2, v211
  v_mul_f32 v3, v3, v211
  v_mul_f32 v4, v4, v211
  v_mul_f32 v5, v5, v211
  v_mul_f32 v6, v6, v211
  v_mul_f32 v7, v7, v211
  v_mul_f32 v8, v8, v211
  v_mul_f32 v9, v9, v211
  v_mul_f32 v10, v10, v211
  v_mul_f32 v11, v11, v211
  v_mul_f32 v12, v12, v211
  v_mul_f32 v13, v13, v211
  v_mul_f32 v14, v14, v211
  v_mul_f32 v15, v15, v211
  v_mul_f32 v16, v16, v211
  v_mul_f32 v17, v17, v211
  v_mul_f32 v18, v18, v211
  v_mul_f32 v19, v19, v211
  v_mul_f32 v20, v20, v211
  v_mul_f32 v21, v21, v211
  v_mul_f32 v22, v22, v211
  v_mul_f32 v23, v23, v211
  v_mul_f32 v24, v24, v211
  v_mul_f32 v25, v25, v211
  v_mul_f32 v26, v26, v211
  v_mul_f32 v27, v27, v211
  v_mul_f32 v28, v28, v211
  v_mul_f32 v29, v29, v211
  v_mul_f32 v30, v30, v211
  v_mul_f32 v31, v31, v211
  v_mul_f32 v32, v32, v211
  v_mul_f32 v33, v33, v211
  v_mul_f32 v34, v34, v211
  v_mul_f32 v35, v35, v211
  v_mul_f32 v36, v36, v211
  v_mul_f32 v37, v37, v211
  v_mul_f32 v38, v38, v211
  v_mul_f32 v39, v39, v211
  v_mul_f32 v40, v40, v211
  v_mul_f32 v41, v41, v211
  v_mul_f32 v42, v42, v211
  v_mul_f32 v43, v43, v211
  v_mul_f32 v44, v44, v211
  v_mul_f32 v45, v45, v211
  v_mul_f32 v46, v46, v211
  v_mul_f32 v47, v47, v211
  v_mul_f32 v48, v48, v211
  v_mul_f32 v49, v49, v211
  v_mul_f32 v50, v50, v211
  v_mul_f32 v51, v51, v211
  v_mul_f32 v52, v52, v211
  v_mul_f32 v53, v53, v211
  v_mul_f32 v54, v54, v211
  v_mul_f32 v55, v55, v211
  v_mul_f32 v56, v56, v211
  v_mul_f32 v57, v57, v211
  v_mul_f32 v58, v58, v211
  v_mul_f32 v59, v59, v211
  v_mul_f32 v60, v60, v211
  v_mul_f32 v61, v61, v211
  v_mul_f32 v62, v62, v211
  v_mul_f32 v63, v63, v211
  v_exp_f32 v192, v112
  v_exp_f32 v193, v113
  v_exp_f32 v194, v114
  v_add_f32 v201, v192, v193
  v_cvt_pk_bf16_f32 v136, v192, v193
  v_exp_f32 v195, v115
  v_add_f32 v201, v201, v194
  v_exp_f32 v196, v116
  v_add_f32 v201, v201, v195
  v_cvt_pk_bf16_f32 v137, v194, v195
  v_exp_f32 v197, v117
  v_add_f32 v201, v201, v196
  v_exp_f32 v198, v118
  v_add_f32 v201, v201, v197
  v_cvt_pk_bf16_f32 v138, v196, v197
  v_exp_f32 v199, v119
  v_add_f32 v201, v201, v198
  v_exp_f32 v192, v120
  v_add_f32 v201, v201, v199
  v_cvt_pk_bf16_f32 v139, v198, v199
  v_exp_f32 v193, v121
  v_add_f32 v201, v201, v192
  v_exp_f32 v194, v122
  v_add_f32 v201, v201, v193
  v_cvt_pk_bf16_f32 v140, v192, v193
  v_exp_f32 v195, v123
  v_add_f32 v201, v201, v194
  v_exp_f32 v196, v124
  v_add_f32 v201, v201, v195
  v_cvt_pk_bf16_f32 v141, v194, v195
  v_exp_f32 v197, v125
  v_add_f32 v201, v201, v196
  v_exp_f32 v198, v126
  v_add_f32 v201, v201, v197
  v_cvt_pk_bf16_f32 v142, v196, v197
  v_exp_f32 v199, v127
  v_add_f32 v201, v201, v198
  s_nop 0
  v_add_f32 v201, v201, v199
  v_cvt_pk_bf16_f32 v143, v198, v199
  s_nop 1
  s_branch back_B1m1
slow_B0m0:
  s_nop 15
  v_max3_f32 v210, v96, v97, v98
  v_max3_f32 v210, v210, v99, v100
  v_max3_f32 v210, v210, v101, v102
  v_max3_f32 v210, v210, v103, v104
  v_max3_f32 v210, v210, v105, v106
  v_max3_f32 v210, v210, v107, v108
  v_max3_f32 v210, v210, v109, v110
  v_max_f32 v210, v210, v111
  v_mov_b32 v211, v210
  s_nop 1
  v_permlane32_swap_b32 v210, v211
  s_nop 1
  v_max_f32 v210, v210, v211
  v_max_f32 v210, 0, v210
  v_sub_f32 v211, 0, v210
  v_exp_f32 v211, v211
  v_sub_f32 v96, v96, v210
  v_sub_f32 v112, v112, v210
  v_sub_f32 v144, v144, v210
  v_sub_f32 v97, v97, v210
  v_sub_f32 v113, v113, v210
  v_sub_f32 v145, v145, v210
  v_sub_f32 v98, v98, v210
  v_sub_f32 v114, v114, v210
  v_sub_f32 v146, v146, v210
  v_sub_f32 v99, v99, v210
  v_sub_f32 v115, v115, v210
  v_sub_f32 v147, v147, v210
  v_sub_f32 v100, v100, v210
  v_sub_f32 v116, v116, v210
  v_sub_f32 v148, v148, v210
  v_sub_f32 v101, v101, v210
  v_sub_f32 v117, v117, v210
  v_sub_f32 v149, v149, v210
  v_sub_f32 v102, v102, v210
  v_sub_f32 v118, v118, v210
  v_sub_f32 v150, v150, v210
  v_sub_f32 v103, v103, v210
  v_sub_f32 v119, v119, v210
  v_sub_f32 v151, v151, v210
  v_sub_f32 v104, v104, v210
  v_sub_f32 v120, v120, v210
  v_sub_f32 v152, v152, v210
  v_sub_f32 v105, v105, v210
  v_sub_f32 v121, v121, v210
  v_sub_f32 v153, v153, v210
  v_sub_f32 v106, v106, v210
  v_sub_f32 v122, v122, v210
  v_sub_f32 v154, v154, v210
  v_sub_f32 v107, v107, v210
  v_sub_f32 v123, v123, v210
  v_sub_f32 v155, v155, v210
  v_sub_f32 v108, v108, v210
  v_sub_f32 v124, v124, v210
  v_sub_f32 v156, v156, v210
  v_sub_f32 v109, v109, v210
  v_sub_f32 v125, v125, v210
  v_sub_f32 v157, v157, v210
  v_sub_f32 v110, v110, v210
  v_sub_f32 v126, v126, v210
  v_sub_f32 v158, v158, v210
  v_sub_f32 v111, v111, v210
  v_sub_f32 v127, v127, v210
  v_sub_f32 v159, v159, v210
  v_mul_f32 v200, v200, v211
  v_mul_f32 v0, v0, v211
  v_mul_f32 v1, v1, v211
  v_mul_f32 v2, v2, v211
  v_mul_f32 v3, v3, v211
  v_mul_f32 v4, v4, v211
  v_mul_f32 v5, v5, v211
  v_mul_f32 v6, v6, v211
  v_mul_f32 v7, v7, v211
  v_mul_f32 v8, v8, v211
  v_mul_f32 v9, v9, v211
  v_mul_f32 v10, v10, v211
  v_mul_f32 v11, v11, v211
  v_mul_f32 v12, v12, v211
  v_mul_f32 v13, v13, v211
  v_mul_f32 v14, v14, v211
  v_mul_f32 v15, v15, v211
  v_mul_f32 v16, v16, v211
  v_mul_f32 v17, v17, v211
  v_mul_f32 v18, v18, v211
  v_mul_f32 v19, v19, v211
  v_mul_f32 v20, v20, v211
  v_mul_f32 v21, v21, v211
  v_mul_f32 v22, v22, v211
  v_mul_f32 v23, v23, v211
  v_mul_f32 v24, v24, v211
  v_mul_f32 v25, v25, v211
  v_mul_f32 v26, v26, v211
  v_mul_f32 v27, v27, v211
  v_mul_f32 v28, v28, v211
  v_mul_f32 v29, v29, v211
  v_mul_f32 v30, v30, v211
  v_mul_f32 v31, v31, v211
  v_mul_f32 v32, v32, v211
  v_mul_f32 v33, v33, v211
  v_mul_f32 v34, v34, v211
  v_mul_f32 v35, v35, v211
  v_mul_f32 v36, v36, v211
  v_mul_f32 v37, v37, v211
  v_mul_f32 v38, v38, v211
  v_mul_f32 v39, v39, v211
  v_mul_f32 v40, v40, v211
  v_mul_f32 v41, v41, v211
  v_mul_f32 v42, v42, v211
  v_mul_f32 v43, v43, v211
  v_mul_f32 v44, v44, v211
  v_mul_f32 v45, v45, v211
  v_mul_f32 v46, v46, v211
  v_mul_f32 v47, v47, v211
  v_mul_f32 v48, v48, v211
  v_mul_f32 v49, v49, v211
  v_mul_f32 v50, v50, v211
  v_mul_f32 v51, v51, v211
  v_mul_f32 v52, v52, v211
  v_mul_f32 v53, v53, v211
  v_mul_f32 v54, v54, v211
  v_mul_f32 v55, v55, v211
  v_mul_f32 v56, v56, v211
  v_mul_f32 v57, v57, v211
  v_mul_f32 v58, v58, v211
  v_mul_f32 v59, v59, v211
  v_mul_f32 v60, v60, v211
  v_mul_f32 v61, v61, v211
  v_mul_f32 v62, v62, v211
  v_mul_f32 v63, v63, v211
  v_exp_f32 v192, v96
  v_exp_f32 v193, v97
  v_exp_f32 v194, v98
  v_add_f32 v201, v192, v193
  v_cvt_pk_bf16_f32 v128, v192, v193
  v_exp_f32 v195, v99
  v_add_f32 v201, v201, v194
  v_exp_f32 v196, v100
  v_add_f32 v201, v201, v195
  v_cvt_pk_bf16_f32 v129, v194, v195
  v_exp_f32 v197, v101
  v_add_f32 v201, v201, v196
  v_exp_f32 v198, v102
  v_add_f32 v201, v201, v197
  v_cvt_pk_bf16_f32 v130, v196, v197
  v_exp_f32 v199, v103
  v_add_f32 v201, v201, v198
  v_exp_f32 v192, v104
  v_add_f32 v201, v201, v199
  v_cvt_pk_bf16_f32 v131, v198, v199
  v_exp_f32 v193, v105
  v_add_f32 v201, v201, v192
  v_exp_f32 v194, v106
  v_add_f32 v201, v201, v193
  v_cvt_pk_bf16_f32 v132, v192, v193
  v_exp_f32 v195, v107
  v_add_f32 v201, v201, v194
  v_exp_f32 v196, v108
  v_add_f32 v201, v201, v195
  v_cvt_pk_bf16_f32 v133, v194, v195
  v_exp_f32 v197, v109
  v_add_f32 v201, v201, v196
  v_exp_f32 v198, v110
  v_add_f32 v201, v201, v197
  v_cvt_pk_bf16_f32 v134, v196, v197
  v_exp_f32 v199, v111
  v_add_f32 v201, v201, v198
  s_nop 0
  v_add_f32 v201, v201, v199
  v_cvt_pk_bf16_f32 v135, v198, v199
  s_nop 1
  s_branch back_B0m0
sg_do1:
  v_mov_b32 v252, 65536
  s_mov_b64 exec, 1
  buffer_atomic_add v252, off, s[96:99], s76 offset:0 sc1
  s_mov_b64 exec, -1
  s_branch sg_back1
pc_spin2:
  buffer_load_dword v251, off, s[96:99], s76 offset:0 sc1
  s_waitcnt vmcnt(0)
  v_readfirstlane_b32 s100, v251
  s_bfe_u32 s100, s100, 524304
  s_cmp_lt_u32 s100, 32
  s_cbranch_scc1 pc_spin2
  s_branch pc_back2
kv_dup:
  s_sub_u32 s33, s72, 16384
  buffer_store_dwordx4 v[80:83], v250, s[16:19], s33 offen offset:0 sc1
  buffer_store_dwordx4 v[88:91], v250, s[16:19], s33 offen offset:1024 sc1
  buffer_store_dwordx4 v[216:219], v250, s[16:19], s33 offen offset:2048 sc1
  buffer_store_dwordx4 v[208:211], v250, s[16:19], s33 offen offset:3072 sc1
  s_sub_u32 s33, s73, 16384
  buffer_store_dwordx4 v[84:87], v250, s[16:19], s33 offen offset:0 sc1
  buffer_store_dwordx4 v[92:95], v250, s[16:19], s33 offen offset:1024 sc1
  buffer_store_dwordx4 v[220:223], v250, s[16:19], s33 offen offset:2048 sc1
  buffer_store_dwordx4 v[212:215], v250, s[16:19], s33 offen offset:3072 sc1
  s_branch kv_dup_back
sg_do3:
  v_mov_b32 v252, 256
  s_mov_b64 exec, 1
  buffer_atomic_add v252, off, s[96:99], s77 offset:0 sc1
  s_mov_b64 exec, -1
  s_branch sg_back3
pc_spin4:
  buffer_load_dword v251, off, s[96:99], s77 offset:0 sc1
  s_waitcnt vmcnt(0)
  v_readfirstlane_b32 s100, v251
  s_bfe_u32 s100, s100, 524296
  s_cmp_lt_u32 s100, 8
  s_cbranch_scc1 pc_spin4
  s_branch pc_back4
sg_do5:
  v_mov_b32 v252, 16777216
  s_mov_b64 exec, 1
  buffer_atomic_add v252, off, s[96:99], s38 offset:0 sc1
  s_mov_b64 exec, -1
  s_branch sg_back5
pc_spin6:
  buffer_load_dword v251, off, s[96:99], s38 offset:0 sc1
  s_waitcnt vmcnt(0)
  v_readfirstlane_b32 s100, v251
  s_bfe_u32 s100, s100, 524312
  s_cmp_lt_u32 s100, 8
  s_cbranch_scc1 pc_spin6
  s_branch pc_back6
sg_do7:
  v_mov_b32 v252, 1
  s_mov_b64 exec, 1
  buffer_atomic_add v252, off, s[96:99], s69 offset:0 sc1
  s_mov_b64 exec, -1
  s_branch sg_back7
pc_spin8:
  buffer_load_dword v251, off, s[96:99], s69 offset:0 sc1
  s_waitcnt vmcnt(0)
  v_readfirstlane_b32 s100, v251
  s_bfe_u32 s100, s100, 524288
  s_cmp_lt_u32 s100, 4
  s_cbranch_scc1 pc_spin8
  s_branch pc_back8
pc_spin9:
  buffer_load_dword v251, off, s[96:99], s69 offset:0 sc1
  s_waitcnt vmcnt(0)
  v_readfirstlane_b32 s100, v251
  s_bfe_u32 s100, s100, 524288
  s_cmp_lt_u32 s100, 4
  s_cbranch_scc1 pc_spin9
  s_branch pc_back9
sg_do11:
  v_mov_b32 v252, 1
  s_mov_b64 exec, 1
  buffer_atomic_add v252, off, s[96:99], s69 offset:4 sc1
  s_mov_b64 exec, -1
  s_branch sg_back11
pc_spin13:
  buffer_load_dword v251, off, s[96:99], s69 offset:4 sc1
  s_waitcnt vmcnt(0)
  v_readfirstlane_b32 s100, v251
  s_bfe_u32 s100, s100, 524288
  s_cmp_lt_u32 s100, 4
  s_cbranch_scc1 pc_spin13
  s_branch pc_back13
pc_spin14:
  buffer_load_dword v251, off, s[96:99], s66 offset:0 sc1
  s_waitcnt vmcnt(0)
  v_readfirstlane_b32 s100, v251
  s_bfe_u32 s100, s100, 524288
  s_cmp_lt_u32 s100, 8
  s_cbranch_scc1 pc_spin14
  s_branch pc_back14
.section .rodata,"a"
.p2align 6
.amdhsa_kernel parallel_sum__compressed_kv_cla__glu_gated_geglu__prompt_kernel
  .amdhsa_next_free_vgpr 256
  .amdhsa_next_free_sgpr 102
  .amdhsa_accum_offset 256
  .amdhsa_group_segment_fixed_size 0
  .amdhsa_kernarg_size 104
  .amdhsa_user_sgpr_count 2
  .amdhsa_user_sgpr_kernarg_segment_ptr 1
  .amdhsa_system_sgpr_workgroup_id_x 1
.end_amdhsa_kernel
```
